```python
import torch

def _softmax(x, axis=-1):
    return torch.softmax(x, dim=axis)
def _gelu(x):
    return torch.nn.functional.gelu(x, approximate="tanh")
def _silu(x):
    return torch.nn.functional.silu(x)
def _sigmoid(x):
    return torch.sigmoid(x)
def _layernorm(x, axis=-1, eps=1e-5):
    m = x.mean(dim=axis, keepdim=True)
    v = x.var(dim=axis, keepdim=True, unbiased=False)
    return (x - m) / torch.sqrt(v + eps)
def _scatter_add(tgt, idx, src, axis=0):
    return tgt.clone().index_add_(axis, idx, src)
def _segment_sum(src, seg, n):
    out = torch.zeros((n,) + src.shape[1:], dtype=src.dtype)
    return out.index_add_(0, seg, src)
def _pad(x, pw):
    flat = tuple(v for pair in reversed(pw) for v in pair)
    return torch.nn.functional.pad(x, flat)

kernel_name = 'recurrent_scan__gqa_block_cached__glu_gated_swiglu__prompt'

def setup_inputs():

    _w = (lambda a: (lambda t: t.to(torch.bfloat16) if t.is_floating_point() else t)(torch.as_tensor(a)))
    def _A_setup():
        B, Sq, D = 1, 2048, 576
        Hq, Hkv, Sk, Dh = 32, 16, 2048, 128
        assert Hq % Hkv == 0, (Hq, Hkv)
        return {
            "x": _w((lambda *s: torch.randn(*s, dtype=torch.bfloat16) * 0.05)(B, Sq, D)),
            "k_cache": _w((lambda *s: torch.randn(*s, dtype=torch.bfloat16) * 1.6)(B, Hkv, Sk, Dh)),
            "v_cache": _w((lambda *s: torch.randn(*s, dtype=torch.bfloat16) * 1.6)(B, Hkv, Sk, Dh)),
            "wq": _w((lambda *s: torch.randn(*s, dtype=torch.bfloat16) * 1.6)(D, Hq * Dh) * (D ** -0.5)),
            "wo": _w((lambda *s: torch.randn(*s, dtype=torch.bfloat16) * 1.6)(Hq * Dh, D) * ((Hq * Dh) ** -0.5)),
        }
    _A_in = _A_setup()

    def _B_setup():
        B, S, D, F = 1, 2048, 576, 4608
        return {
            "x": _w((lambda *s: torch.randn(*s, dtype=torch.bfloat16) * 0.05)(B, S, D)),
            "w1": _w((lambda *s: torch.randn(*s, dtype=torch.bfloat16) * 0.2)(D, F) * (2.0 / D) ** 0.5),
            "w3": _w((lambda *s: torch.randn(*s, dtype=torch.bfloat16) * 0.2)(D, F) * (2.0 / D) ** 0.5),
            "w2": _w((lambda *s: torch.randn(*s, dtype=torch.bfloat16) * 0.2)(F, D) * (2.0 / F) ** 0.5),
        }
    _B_in = _B_setup()

    return {
        "A_x": _A_in["x"],
        "A_k_cache": _A_in["k_cache"],
        "A_v_cache": _A_in["v_cache"],
        "A_wq": _A_in["wq"],
        "A_wo": _A_in["wo"],
        "B_x": _B_in["x"],
        "B_w1": _B_in["w1"],
        "B_w3": _B_in["w3"],
        "B_w2": _B_in["w2"],
    }

def reference(A_x, A_k_cache, A_v_cache, A_wq, A_wo, B_x, B_w1, B_w3, B_w2):
    def _A_ref(x, k_cache, v_cache, wq, wo):
        B, Sq, D = x.shape
        Hq, Dh = 32, 128
        Hkv = k_cache.shape[1]
        rep = Hq // Hkv
        q = (lambda x, *d: x.permute(*d))((x @ wq).reshape(B, Sq, Hq, Dh), 0, 2, 1, 3)
        k = (lambda x, n, axis: torch.repeat_interleave(x, n, dim=axis))(k_cache, rep, axis=1)
        v = (lambda x, n, axis: torch.repeat_interleave(x, n, dim=axis))(v_cache, rep, axis=1)
        scores = torch.einsum("bhqd,bhkd->bhqk", q, k) * (Dh ** -0.5)
        p = _softmax(scores, axis=-1)
        o = torch.einsum("bhqk,bhkd->bhqd", p, v)
        return (lambda x, *d: x.permute(*d))(o, 0, 2, 1, 3).reshape(B, Sq, Hq * Dh) @ wo

    def _B_ref(x, w1, w3, w2):
        gate = torch.einsum("bsd,df->bsf", x, w1)
        up = torch.einsum("bsd,df->bsf", x, w3)
        h = _silu(gate) * up
        out = torch.einsum("bsf,fd->bsd", h, w2)
        return out

    x = A_x
    xn = _layernorm(x, axis=-1)
    s = _A_ref(xn, A_k_cache, A_v_cache, A_wq, A_wo)
    g = _silu(_B_ref(xn, B_w1, B_w3, B_w2))
    return x + s * g
```

```asm
; @launch grid=(256,1,1) block=(256,1,1) lds=163840
.amdgcn_target "amdgcn-amd-amdhsa--gfx950"
.text
.globl recurrent_scan__gqa_block_cached__glu_gated_swiglu__prompt_kernel
.p2align 8
.type recurrent_scan__gqa_block_cached__glu_gated_swiglu__prompt_kernel,@function
recurrent_scan__gqa_block_cached__glu_gated_swiglu__prompt_kernel:
    s_cmp_ge_u32 s2, 256
    s_cbranch_scc1 L_k2_end
    s_load_dwordx2 s[12:13], s[0:1], 0
    s_load_dwordx2 s[56:57], s[0:1], 88
    s_load_dwordx4 s[16:19], s[0:1], 24
    s_load_dwordx4 s[8:11], s[0:1], 8
    s_load_dwordx4 s[20:23], s[0:1], 48
    s_load_dwordx2 s[94:95], s[0:1], 64
    v_lshrrev_b32 v97, 5, v0
    v_and_b32 v98, 31, v0
    v_mul_u32_u24 v101, 1152, v97
    v_lshrrev_b32 v99, 2, v98
    v_and_b32 v100, 3, v0
    v_cmp_gt_u32 vcc, 24, v98
    v_lshl_add_u32 v101, v99, 6, v101
    v_lshl_add_u32 v101, v100, 3, v101
    s_mul_i32 s49, s2, 9216
    v_cndmask_b32 v101, 2.0, v101, vcc
    s_mov_b32 s14, 2359296
    s_mov_b32 s15, 0x00020000
    s_getpc_b64 s[4:5]
L_pc1:
    s_waitcnt lgkmcnt(0)
    buffer_load_dwordx2 v[104:105], v101, s[12:15], s49 offen offset:0
    buffer_load_dwordx2 v[106:107], v101, s[12:15], s49 offen offset:32
    buffer_load_dwordx2 v[108:109], v101, s[12:15], s49 offen offset:384
    buffer_load_dwordx2 v[110:111], v101, s[12:15], s49 offen offset:416
    buffer_load_dwordx2 v[112:113], v101, s[12:15], s49 offen offset:768
    buffer_load_dwordx2 v[114:115], v101, s[12:15], s49 offen offset:800
    s_lshr_b32 s3, s2, 3
    s_lshl_b32 s3, s3, 7
    v_lshrrev_b32 v13, 4, v0
    v_lshl_add_u32 v14, v13, 12, s3
    v_min_u32 v14, L_att_last-L_pc1, v14
    v_mov_b32 v15, 0
    v_lshl_add_u64 v[14:15], v[14:15], 0, s[4:5]
    global_load_dword v159, v[14:15], off
    v_lshrrev_b32 v1, 6, v0
    v_and_b32 v0, 63, v0
    v_readfirstlane_b32 s40, v1
    s_and_b32 s3, s2, 7
    s_lshr_b32 s4, s2, 3
    s_and_b32 s43, s4, 3
    s_lshl_b32 s41, s3, 2
    s_add_u32 s41, s41, s43
    s_lshr_b32 s42, s4, 2
    s_mov_b32 s90, s2
    v_mov_b32 v156, 0
    s_lshl_b32 s91, s42, 7
    s_add_u32 s91, s91, 98304
    s_add_u32 s60, s56, 0x300000
    s_addc_u32 s61, s57, 0
    s_mov_b32 s62, 131072
    s_mov_b32 s63, 0x00020000
    buffer_load_dword v157, v156, s[60:63], s91 offen sc1
    v_cndmask_b32 v102, 0, 1.0, vcc
    v_lshlrev_b32 v158, 7, v98
    v_lshl_add_u32 v158, v97, 4, v158
    v_add_u32 v158, 0x24000, v158
    v_mov_b32 v103, 0x27000
    v_cndmask_b32 v158, v103, v158, vcc
    s_lshl_b32 s5, s41, 8
    s_lshl_b32 s45, s40, 10
    s_lshl_b32 s6, s42, 2
    s_add_u32 s6, s6, s40
    v_lshlrev_b32 v1, 4, v0
    s_mov_b32 s92, s18
    s_mov_b32 s93, s19
    s_add_u32 s16, s16, s5
    s_addc_u32 s17, s17, 0
    s_sub_u32 s18, 4718592, s5
    s_mov_b32 s19, 0x00020000
    s_mul_i32 s3, s6, 36
    v_min_u32 v12, 35, v0
    v_add_u32 v12, s3, v12
    v_and_b32 v13, 1, v12
    v_lshrrev_b32 v12, 1, v12
    v_lshlrev_b32 v12, 13, v12
    v_lshl_add_u32 v12, v13, 7, v12
    buffer_load_dword v155, v12, s[16:19], 0 offen
    s_waitcnt vmcnt(3)
    v_lshlrev_b32 v120, 16, v104
    v_and_b32 v121, 0xffff0000, v104
    v_lshlrev_b32 v122, 16, v105
    v_and_b32 v123, 0xffff0000, v105
    v_lshlrev_b32 v124, 16, v106
    v_and_b32 v125, 0xffff0000, v106
    v_lshlrev_b32 v126, 16, v107
    v_and_b32 v127, 0xffff0000, v107
    v_lshlrev_b32 v128, 16, v108
    v_and_b32 v129, 0xffff0000, v108
    v_lshlrev_b32 v130, 16, v109
    v_and_b32 v131, 0xffff0000, v109
    v_lshlrev_b32 v132, 16, v110
    v_and_b32 v133, 0xffff0000, v110
    v_lshlrev_b32 v134, 16, v111
    v_and_b32 v135, 0xffff0000, v111
    v_lshlrev_b32 v136, 16, v112
    v_and_b32 v137, 0xffff0000, v112
    v_lshlrev_b32 v138, 16, v113
    v_and_b32 v139, 0xffff0000, v113
    v_lshlrev_b32 v140, 16, v114
    v_and_b32 v141, 0xffff0000, v114
    v_lshlrev_b32 v142, 16, v115
    v_and_b32 v143, 0xffff0000, v115
    v_pk_add_f32 v[144:145], v[120:121], v[122:123]
    v_pk_add_f32 v[146:147], v[124:125], v[126:127]
    v_pk_add_f32 v[144:145], v[144:145], v[128:129]
    v_pk_add_f32 v[146:147], v[146:147], v[130:131]
    v_pk_add_f32 v[144:145], v[144:145], v[132:133]
    v_pk_add_f32 v[146:147], v[146:147], v[134:135]
    v_pk_add_f32 v[144:145], v[144:145], v[136:137]
    v_pk_add_f32 v[146:147], v[146:147], v[138:139]
    v_pk_add_f32 v[144:145], v[144:145], v[140:141]
    v_pk_add_f32 v[146:147], v[146:147], v[142:143]
    v_pk_add_f32 v[144:145], v[144:145], v[146:147]
    v_add_f32 v144, v144, v145
    s_nop 1
    v_add_f32_dpp v144, v144, v144 row_ror:8 row_mask:0xf bank_mask:0xf
    s_nop 1
    v_add_f32_dpp v144, v144, v144 row_ror:4 row_mask:0xf bank_mask:0xf
    s_nop 1
    v_add_f32_dpp v144, v144, v144 row_ror:2 row_mask:0xf bank_mask:0xf
    s_nop 1
    v_add_f32_dpp v144, v144, v144 row_ror:1 row_mask:0xf bank_mask:0xf
    v_mov_b32 v145, v144
    s_nop 1
    v_permlane16_swap_b32 v144, v145
    v_add_f32 v144, v144, v145
    v_mul_f32 v144, 0xbae38e39, v144
    v_mov_b32 v145, v144
    v_pk_add_f32 v[148:149], v[120:121], v[144:145]
    v_pk_mul_f32 v[146:147], v[148:149], v[148:149]
    v_pk_add_f32 v[150:151], v[122:123], v[144:145]
    v_pk_fma_f32 v[146:147], v[150:151], v[150:151], v[146:147]
    v_pk_add_f32 v[148:149], v[124:125], v[144:145]
    v_pk_fma_f32 v[146:147], v[148:149], v[148:149], v[146:147]
    v_pk_add_f32 v[150:151], v[126:127], v[144:145]
    v_pk_fma_f32 v[146:147], v[150:151], v[150:151], v[146:147]
    v_pk_add_f32 v[148:149], v[128:129], v[144:145]
    v_pk_fma_f32 v[146:147], v[148:149], v[148:149], v[146:147]
    v_pk_add_f32 v[150:151], v[130:131], v[144:145]
    v_pk_fma_f32 v[146:147], v[150:151], v[150:151], v[146:147]
    v_pk_add_f32 v[148:149], v[132:133], v[144:145]
    v_pk_fma_f32 v[146:147], v[148:149], v[148:149], v[146:147]
    v_pk_add_f32 v[150:151], v[134:135], v[144:145]
    v_pk_fma_f32 v[146:147], v[150:151], v[150:151], v[146:147]
    v_pk_add_f32 v[148:149], v[136:137], v[144:145]
    v_pk_fma_f32 v[146:147], v[148:149], v[148:149], v[146:147]
    v_pk_add_f32 v[150:151], v[138:139], v[144:145]
    v_pk_fma_f32 v[146:147], v[150:151], v[150:151], v[146:147]
    v_pk_add_f32 v[148:149], v[140:141], v[144:145]
    v_pk_fma_f32 v[146:147], v[148:149], v[148:149], v[146:147]
    v_pk_add_f32 v[150:151], v[142:143], v[144:145]
    v_pk_fma_f32 v[146:147], v[150:151], v[150:151], v[146:147]
    v_add_f32 v146, v146, v147
    v_mul_f32 v146, v146, v102
    s_nop 1
    v_add_f32_dpp v146, v146, v146 row_ror:8 row_mask:0xf bank_mask:0xf
    s_nop 1
    v_add_f32_dpp v146, v146, v146 row_ror:4 row_mask:0xf bank_mask:0xf
    s_nop 1
    v_add_f32_dpp v146, v146, v146 row_ror:2 row_mask:0xf bank_mask:0xf
    s_nop 1
    v_add_f32_dpp v146, v146, v146 row_ror:1 row_mask:0xf bank_mask:0xf
    v_mov_b32 v147, v146
    s_nop 1
    v_permlane16_swap_b32 v146, v147
    v_add_f32 v146, v146, v147
    v_mul_f32 v146, 0x3ae38e39, v146
    v_cvt_pk_bf16_f32 v144, v144, v144
    v_lshlrev_b32 v144, 16, v144
    v_cvt_pk_bf16_f32 v146, v146, v146
    v_lshlrev_b32 v146, 16, v146
    v_add_f32 v146, 0x3727c5ac, v146
    v_cvt_pk_bf16_f32 v146, v146, v146
    v_lshlrev_b32 v146, 16, v146
    v_sqrt_f32 v146, v146
    v_mov_b32 v145, v144
    v_cvt_pk_bf16_f32 v146, v146, v146
    v_lshlrev_b32 v146, 16, v146
    v_rcp_f32 v148, v146
    v_sub_f32 v146, 0, v146
    v_mov_b32 v147, v146
    v_mov_b32 v149, v148
    v_pk_add_f32 v[120:121], v[120:121], v[144:145]
    v_cvt_pk_bf16_f32 v150, v120, v121
    v_lshlrev_b32 v120, 16, v150
    v_and_b32 v121, 0xffff0000, v150
    v_pk_mul_f32 v[152:153], v[120:121], v[148:149]
    v_pk_fma_f32 v[120:121], v[152:153], v[146:147], v[120:121]
    v_pk_fma_f32 v[120:121], v[120:121], v[148:149], v[152:153]
    v_cvt_pk_bf16_f32 v104, v120, v121
    v_pk_add_f32 v[122:123], v[122:123], v[144:145]
    v_cvt_pk_bf16_f32 v150, v122, v123
    v_lshlrev_b32 v122, 16, v150
    v_and_b32 v123, 0xffff0000, v150
    v_pk_mul_f32 v[152:153], v[122:123], v[148:149]
    v_pk_fma_f32 v[122:123], v[152:153], v[146:147], v[122:123]
    v_pk_fma_f32 v[122:123], v[122:123], v[148:149], v[152:153]
    v_cvt_pk_bf16_f32 v105, v122, v123
    v_pk_add_f32 v[124:125], v[124:125], v[144:145]
    v_cvt_pk_bf16_f32 v150, v124, v125
    v_lshlrev_b32 v124, 16, v150
    v_and_b32 v125, 0xffff0000, v150
    v_pk_mul_f32 v[152:153], v[124:125], v[148:149]
    v_pk_fma_f32 v[124:125], v[152:153], v[146:147], v[124:125]
    v_pk_fma_f32 v[124:125], v[124:125], v[148:149], v[152:153]
    v_cvt_pk_bf16_f32 v106, v124, v125
    v_pk_add_f32 v[126:127], v[126:127], v[144:145]
    v_cvt_pk_bf16_f32 v150, v126, v127
    v_lshlrev_b32 v126, 16, v150
    v_and_b32 v127, 0xffff0000, v150
    v_pk_mul_f32 v[152:153], v[126:127], v[148:149]
    v_pk_fma_f32 v[126:127], v[152:153], v[146:147], v[126:127]
    v_pk_fma_f32 v[126:127], v[126:127], v[148:149], v[152:153]
    v_cvt_pk_bf16_f32 v107, v126, v127
    ds_write_b128 v158, v[104:107] offset:0
    v_pk_add_f32 v[128:129], v[128:129], v[144:145]
    v_cvt_pk_bf16_f32 v150, v128, v129
    v_lshlrev_b32 v128, 16, v150
    v_and_b32 v129, 0xffff0000, v150
    v_pk_mul_f32 v[152:153], v[128:129], v[148:149]
    v_pk_fma_f32 v[128:129], v[152:153], v[146:147], v[128:129]
    v_pk_fma_f32 v[128:129], v[128:129], v[148:149], v[152:153]
    v_cvt_pk_bf16_f32 v108, v128, v129
    v_pk_add_f32 v[130:131], v[130:131], v[144:145]
    v_cvt_pk_bf16_f32 v150, v130, v131
    v_lshlrev_b32 v130, 16, v150
    v_and_b32 v131, 0xffff0000, v150
    v_pk_mul_f32 v[152:153], v[130:131], v[148:149]
    v_pk_fma_f32 v[130:131], v[152:153], v[146:147], v[130:131]
    v_pk_fma_f32 v[130:131], v[130:131], v[148:149], v[152:153]
    v_cvt_pk_bf16_f32 v109, v130, v131
    v_pk_add_f32 v[132:133], v[132:133], v[144:145]
    v_cvt_pk_bf16_f32 v150, v132, v133
    v_lshlrev_b32 v132, 16, v150
    v_and_b32 v133, 0xffff0000, v150
    v_pk_mul_f32 v[152:153], v[132:133], v[148:149]
    v_pk_fma_f32 v[132:133], v[152:153], v[146:147], v[132:133]
    v_pk_fma_f32 v[132:133], v[132:133], v[148:149], v[152:153]
    v_cvt_pk_bf16_f32 v110, v132, v133
    v_pk_add_f32 v[134:135], v[134:135], v[144:145]
    v_cvt_pk_bf16_f32 v150, v134, v135
    v_lshlrev_b32 v134, 16, v150
    v_and_b32 v135, 0xffff0000, v150
    v_pk_mul_f32 v[152:153], v[134:135], v[148:149]
    v_pk_fma_f32 v[134:135], v[152:153], v[146:147], v[134:135]
    v_pk_fma_f32 v[134:135], v[134:135], v[148:149], v[152:153]
    v_cvt_pk_bf16_f32 v111, v134, v135
    ds_write_b128 v158, v[108:111] offset:3072
    v_pk_add_f32 v[136:137], v[136:137], v[144:145]
    v_cvt_pk_bf16_f32 v150, v136, v137
    v_lshlrev_b32 v136, 16, v150
    v_and_b32 v137, 0xffff0000, v150
    v_pk_mul_f32 v[152:153], v[136:137], v[148:149]
    v_pk_fma_f32 v[136:137], v[152:153], v[146:147], v[136:137]
    v_pk_fma_f32 v[136:137], v[136:137], v[148:149], v[152:153]
    v_cvt_pk_bf16_f32 v112, v136, v137
    v_pk_add_f32 v[138:139], v[138:139], v[144:145]
    v_cvt_pk_bf16_f32 v150, v138, v139
    v_lshlrev_b32 v138, 16, v150
    v_and_b32 v139, 0xffff0000, v150
    v_pk_mul_f32 v[152:153], v[138:139], v[148:149]
    v_pk_fma_f32 v[138:139], v[152:153], v[146:147], v[138:139]
    v_pk_fma_f32 v[138:139], v[138:139], v[148:149], v[152:153]
    v_cvt_pk_bf16_f32 v113, v138, v139
    v_pk_add_f32 v[140:141], v[140:141], v[144:145]
    v_cvt_pk_bf16_f32 v150, v140, v141
    v_lshlrev_b32 v140, 16, v150
    v_and_b32 v141, 0xffff0000, v150
    v_pk_mul_f32 v[152:153], v[140:141], v[148:149]
    v_pk_fma_f32 v[140:141], v[152:153], v[146:147], v[140:141]
    v_pk_fma_f32 v[140:141], v[140:141], v[148:149], v[152:153]
    v_cvt_pk_bf16_f32 v114, v140, v141
    v_pk_add_f32 v[142:143], v[142:143], v[144:145]
    v_cvt_pk_bf16_f32 v150, v142, v143
    v_lshlrev_b32 v142, 16, v150
    v_and_b32 v143, 0xffff0000, v150
    v_pk_mul_f32 v[152:153], v[142:143], v[148:149]
    v_pk_fma_f32 v[142:143], v[152:153], v[146:147], v[142:143]
    v_pk_fma_f32 v[142:143], v[142:143], v[148:149], v[152:153]
    v_cvt_pk_bf16_f32 v115, v142, v143
    ds_write_b128 v158, v[112:115] offset:6144
    v_lshrrev_b32 v97, 5, v0
    v_lshlrev_b32 v97, 12, v97
    v_bfe_u32 v98, v0, 3, 2
    v_lshl_add_u32 v97, v98, 8, v97
    v_and_b32 v98, 7, v0
    v_lshl_add_u32 v97, v98, 4, v97
    v_add_u32 v98, s45, v1
    v_add_u32 v98, 0x24000, v98
    s_lshr_b32 s3, s90, 3
    s_mul_i32 s3, s3, 73728
    s_bfe_u32 s4, s90, 0x20001
    s_lshl_b32 s4, s4, 10
    s_add_u32 s3, s3, s4
    s_and_b32 s4, s90, 1
    s_lshl_b32 s4, s4, 7
    s_add_u32 s3, s3, s4
    s_lshl_b32 s4, s40, 13
    s_add_u32 s3, s3, s4
    s_add_u32 s4, s3, 32768
    s_lshl_b32 s5, s40, 28
    s_add_u32 s5, s5, s4
    s_add_u32 s5, s5, 32768
    s_mov_b32 s96, s56
    s_mov_b32 s97, s57
    s_mov_b32 s98, 2359296
    s_mov_b32 s99, 0x00020000
    s_waitcnt lgkmcnt(0)
    s_barrier
    ds_read_b128 v[120:123], v98 offset:0
    ds_read_b128 v[124:127], v98 offset:4096
    ds_read_b128 v[128:131], v98 offset:8192
    s_lshl_b32 s49, s90, 8
    buffer_store_dword v156, v156, s[60:63], s49 offen sc1
    s_waitcnt lgkmcnt(2)
    buffer_store_dwordx4 v[120:123], v97, s[96:99], s3 offen sc1
    s_waitcnt lgkmcnt(1)
    buffer_store_dwordx4 v[124:127], v97, s[96:99], s4 offen sc1
    s_waitcnt lgkmcnt(0)
    buffer_store_dwordx4 v[128:131], v97, s[96:99], s5 offen sc1
    s_mul_i32 s7, s6, 73728
    v_lshrrev_b32 v12, 3, v0
    v_lshl_add_u32 v12, s40, 3, v12
    v_and_b32 v13, 7, v0
    v_lshrrev_b32 v14, 4, v0
    v_lshlrev_b32 v14, 1, v14
    v_xor_b32 v13, v13, v14
    v_lshlrev_b32 v13, 4, v13
    v_lshl_add_u32 v4, v12, 13, v13
    v_mul_u32_u24 v2, 9216, v12
    v_add_u32 v2, v2, v13
    s_add_u32 s32, s56, s7
    s_addc_u32 s33, s57, 0
    s_mov_b32 s34, 73728
    s_mov_b32 s35, 0x00020000
    s_mov_b32 s12, s10
    s_mov_b32 s13, s11
    s_lshr_b32 s3, s41, 1
    s_lshl_b32 s3, s3, 19
    s_add_u32 s8, s8, s3
    s_addc_u32 s9, s9, 0
    s_mov_b32 s10, 0x80000
    s_mov_b32 s11, 0x00020000
    s_add_u32 s12, s12, s3
    s_addc_u32 s13, s13, 0
    s_mov_b32 s14, 0x80000
    s_mov_b32 s15, 0x00020000
    s_and_b32 s3, s2, 7
    s_mul_i32 s5, s3, 1152
    s_lshl_b32 s4, s43, 7
    s_add_u32 s5, s5, s4
    s_add_u32 s24, s22, s5
    s_addc_u32 s25, s23, 0
    s_add_u32 s20, s20, s5
    s_addc_u32 s21, s21, 0
    s_sub_u32 s22, 5308416, s5
    s_mov_b32 s23, 0x00020000
    s_mov_b32 s26, s22
    s_mov_b32 s27, 0x00020000
    s_cmp_ge_u32 s40, 2
    s_cselect_b32 s28, s24, s20
    s_cselect_b32 s29, s25, s21
    s_mov_b32 s30, s22
    s_mov_b32 s31, 0x00020000
    s_cselect_b32 s89, 1024, 0
    s_and_b32 s4, s40, 1
    s_lshl_b32 s5, s4, 11
    s_add_u32 s89, s89, s5
    v_lshrrev_b32 v12, 1, v0
    v_lshl_add_u32 v12, s4, 5, v12
    v_mul_u32_u24 v12, 9216, v12
    v_and_b32 v13, 1, v0
    v_lshl_add_u32 v12, v13, 4, v12
    s_mul_i32 s4, s43, 96
    s_sub_u32 s7, 1024, s4
    v_add_u32 v3, s7, v12
    s_mul_i32 s4, s6, 1114112
    s_add_u32 s4, s4, 0x400000
    s_add_u32 s36, s56, s4
    s_addc_u32 s37, s57, 0
    s_mov_b32 s38, 1114112
    s_mov_b32 s39, 0x00020000
    s_lshl_b32 s44, s40, 12
    s_mul_i32 s3, s3, 18
    s_add_u32 s3, s3, 128
    s_lshl_b32 s4, s43, 1
    s_add_u32 s4, s4, s3
    s_lshl_b32 s52, s4, 12
    s_lshr_b32 s4, s43, 1
    s_add_u32 s4, s4, s3
    s_add_u32 s4, s4, 15
    s_lshl_b32 s53, s4, 12
    s_and_b32 s4, s43, 1
    s_lshl_b32 s4, s4, 9
    s_add_u32 s53, s53, s4
    s_mov_b32 s54, 0xbfb8aa3b
    s_mov_b32 s55, 0x3e0293ee
    v_lshrrev_b32 v15, 4, v0
    v_lshl_add_u32 v12, s40, 4, v15
    v_lshlrev_b32 v12, 8, v12
    v_and_b32 v13, 15, v0
    v_lshl_add_u32 v14, s40, 2, v15
    v_xor_b32 v14, v14, v13
    v_lshl_add_u32 v5, v14, 4, v12
    s_and_b32 s3, s40, 1
    s_lshl_b32 s3, s3, 3
    v_lshl_add_u32 v14, v15, 1, s3
    v_xor_b32 v14, v14, v13
    v_lshl_add_u32 v6, v14, 4, v12
    v_lshrrev_b32 v12, 2, v0
    v_lshlrev_b32 v12, 7, v12
    v_and_b32 v13, 3, v0
    v_bfe_u32 v14, v0, 3, 2
    v_lshlrev_b32 v14, 1, v14
    v_xor_b32 v13, v13, v14
    v_lshl_add_u32 v8, v13, 4, v12
    v_xor_b32 v9, 64, v8
    v_and_b32 v12, 15, v0
    v_lshrrev_b32 v13, 2, v12
    v_lshlrev_b32 v13, 12, v13
    v_and_b32 v14, 3, v0
    v_lshl_add_u32 v13, v14, 8, v13
    v_lshrrev_b32 v14, 4, v0
    v_xor_b32 v14, v14, v12
    v_lshl_add_u32 v48, v14, 4, v13
    v_xor_b32 v49, 64, v48
    v_xor_b32 v50, 128, v48
    v_xor_b32 v51, 192, v48
    v_lshrrev_b32 v12, 4, v0
    v_bfe_u32 v13, v0, 2, 2
    v_lshl_add_u32 v14, v12, 4, v13
    v_lshlrev_b32 v14, 8, v14
    v_and_b32 v15, 3, v0
    v_lshl_add_u32 v14, v15, 3, v14
    v_bfe_u32 v12, v0, 2, 3
    v_lshl_add_u32 v14, v12, 5, v14
    v_add_u32 v52, 0x18000, v14
    v_xor_b32 v53, 32, v52
    v_xor_b32 v54, 64, v52
    v_xor_b32 v55, 96, v52
    v_xor_b32 v56, 128, v52
    v_xor_b32 v57, 160, v52
    v_xor_b32 v58, 192, v52
    v_xor_b32 v59, 224, v52
    v_lshrrev_b32 v13, 2, v0
    v_lshl_add_u32 v13, v13, 5, s6
    v_mul_u32_u24 v13, 9216, v13
    v_and_b32 v14, 3, v0
    v_lshlrev_b32 v14, 9, v14
    v_min_u32 v14, s7, v14
    v_add_u32 v13, v13, v14
    v_cmp_gt_u32 vcc, 12, v0
    v_mov_b32 v15, 0x40000000
    v_mov_b32 v62, 0
    v_cndmask_b32 v60, v15, v13, vcc
    s_getpc_b64 s[4:5]
L_pc2:
    s_add_u32 s4, s4, L_att_last-L_pc2
    s_addc_u32 s5, s5, 0
    s_lshr_b32 s3, s2, 3
    s_lshl_b32 s3, s3, 2
    s_add_u32 s3, s3, s40
    s_lshl_b32 s58, s3, 10
    v_min_u32 v13, 7, v0
    v_lshl_add_u32 v13, v13, 7, s58
    v_min_u32 v13, L_slow_entry-L_att_last-4, v13
    v_mov_b32 v11, s5
    v_add_co_u32 v10, vcc, s4, v13
    s_nop 1
    v_addc_co_u32 v11, vcc, 0, v11, vcc
    s_waitcnt vmcnt(0)
    s_barrier
    v_add_u32 v157, 1, v157
    s_lshl_b32 s49, s90, 7
    s_add_u32 s49, s49, 65536
    s_lshl_b32 s3, s40, 28
    s_add_u32 s49, s49, s3
    buffer_store_dword v157, v156, s[60:63], s49 offen sc1
    s_mov_b32 s49, 0
    s_add_u32 m0, s45, 0
    s_nop 0
    buffer_load_dwordx4 v4, s[16:19], s49 offen lds
    s_add_u32 m0, s45, 3968
    s_nop 0
    buffer_load_dwordx4 v4, s[16:19], s49 offen offset:128 lds
    s_mov_b32 s49, 262144
    s_add_u32 m0, s45, 8192
    s_nop 0
    buffer_load_dwordx4 v4, s[16:19], s49 offen lds
    s_add_u32 m0, s45, 12160
    s_nop 0
    buffer_load_dwordx4 v4, s[16:19], s49 offen offset:128 lds
    s_mov_b32 s49, 524288
    s_add_u32 m0, s45, 16384
    s_nop 0
    buffer_load_dwordx4 v4, s[16:19], s49 offen lds
    s_add_u32 m0, s45, 20352
    s_nop 0
    buffer_load_dwordx4 v4, s[16:19], s49 offen offset:128 lds
    s_mov_b32 s49, 786432
    s_add_u32 m0, s45, 24576
    s_nop 0
    buffer_load_dwordx4 v4, s[16:19], s49 offen lds
    s_add_u32 m0, s45, 28544
    s_nop 0
    buffer_load_dwordx4 v4, s[16:19], s49 offen offset:128 lds
    s_mov_b32 s49, 1048576
    s_add_u32 m0, s45, 32768
    s_nop 0
    buffer_load_dwordx4 v4, s[16:19], s49 offen lds
    s_add_u32 m0, s45, 36736
    s_nop 0
    buffer_load_dwordx4 v4, s[16:19], s49 offen offset:128 lds
    s_mov_b32 s49, 1310720
    s_add_u32 m0, s45, 40960
    s_nop 0
    buffer_load_dwordx4 v4, s[16:19], s49 offen lds
    s_add_u32 m0, s45, 44928
    s_nop 0
    buffer_load_dwordx4 v4, s[16:19], s49 offen offset:128 lds
    s_mov_b32 s49, 1572864
    s_add_u32 m0, s45, 49152
    s_nop 0
    buffer_load_dwordx4 v4, s[16:19], s49 offen lds
    s_add_u32 m0, s45, 53120
    s_nop 0
    buffer_load_dwordx4 v4, s[16:19], s49 offen offset:128 lds
    s_mov_b32 s49, 1835008
    s_add_u32 m0, s45, 57344
    s_nop 0
    buffer_load_dwordx4 v4, s[16:19], s49 offen lds
    s_add_u32 m0, s45, 61312
    s_nop 0
    buffer_load_dwordx4 v4, s[16:19], s49 offen offset:128 lds
    v_and_b32 v97, 7, v0
    v_lshlrev_b32 v97, 7, v97
    s_lshl_b32 s49, s6, 10
    s_add_u32 s49, s49, 65536
    s_mov_b32 s4, 0x40000
L_xn_poll:
    buffer_load_dword v98, v97, s[60:63], s49 offen sc1
    s_waitcnt vmcnt(0)
    v_cmp_ne_u32 vcc, v98, v157
    s_sub_u32 s4, s4, 1
    s_cbranch_scc1 L_xn_ready
    s_cmp_lg_u64 vcc, 0
    s_cbranch_scc1 L_xn_poll
L_xn_ready:
    v_mov_b32 v61, v157
    s_mov_b32 s50, 0
    buffer_load_dwordx4 a[0:3], v1, s[32:35], s50 offen offset:0 sc1
    buffer_load_dwordx4 a[4:7], v1, s[32:35], s50 offen offset:1024 sc1
    buffer_load_dwordx4 a[8:11], v1, s[32:35], s50 offen offset:2048 sc1
    buffer_load_dwordx4 a[12:15], v1, s[32:35], s50 offen offset:3072 sc1
    s_mov_b32 s50, 4096
    buffer_load_dwordx4 a[16:19], v1, s[32:35], s50 offen offset:0 sc1
    buffer_load_dwordx4 a[20:23], v1, s[32:35], s50 offen offset:1024 sc1
    buffer_load_dwordx4 a[24:27], v1, s[32:35], s50 offen offset:2048 sc1
    buffer_load_dwordx4 a[28:31], v1, s[32:35], s50 offen offset:3072 sc1
    s_mov_b32 s50, 8192
    buffer_load_dwordx4 a[32:35], v1, s[32:35], s50 offen offset:0 sc1
    buffer_load_dwordx4 a[36:39], v1, s[32:35], s50 offen offset:1024 sc1
    buffer_load_dwordx4 a[40:43], v1, s[32:35], s50 offen offset:2048 sc1
    buffer_load_dwordx4 a[44:47], v1, s[32:35], s50 offen offset:3072 sc1
    s_mov_b32 s50, 12288
    buffer_load_dwordx4 a[48:51], v1, s[32:35], s50 offen offset:0 sc1
    buffer_load_dwordx4 a[52:55], v1, s[32:35], s50 offen offset:1024 sc1
    buffer_load_dwordx4 a[56:59], v1, s[32:35], s50 offen offset:2048 sc1
    buffer_load_dwordx4 a[60:63], v1, s[32:35], s50 offen offset:3072 sc1
    s_waitcnt vmcnt(30)
    s_barrier
    ds_read_b64_tr_b16 v[16:17], v8 offset:0
    ds_read_b64_tr_b16 v[18:19], v8 offset:2048
    ds_read_b64_tr_b16 v[20:21], v8 offset:8
    ds_read_b64_tr_b16 v[22:23], v8 offset:2056
    ds_read_b64_tr_b16 v[24:25], v9 offset:0
    ds_read_b64_tr_b16 v[26:27], v9 offset:2048
    ds_read_b64_tr_b16 v[28:29], v9 offset:8
    ds_read_b64_tr_b16 v[30:31], v9 offset:2056
    ds_read_b64_tr_b16 v[32:33], v8 offset:4096
    ds_read_b64_tr_b16 v[34:35], v8 offset:6144
    ds_read_b64_tr_b16 v[36:37], v8 offset:4104
    ds_read_b64_tr_b16 v[38:39], v8 offset:6152
    ds_read_b64_tr_b16 v[40:41], v9 offset:4096
    ds_read_b64_tr_b16 v[42:43], v9 offset:6144
    s_waitcnt vmcnt(12) lgkmcnt(10)
    v_mfma_f32_16x16x32_bf16 v[224:227], v[16:19], a[0:3], 0
    s_mov_b32 s50, 16384
    v_mfma_f32_16x16x32_bf16 v[228:231], v[16:19], a[4:7], 0
    buffer_load_dwordx4 a[64:67], v1, s[32:35], s50 offen offset:0 sc1
    v_mfma_f32_16x16x32_bf16 v[232:235], v[16:19], a[8:11], 0
    v_mfma_f32_16x16x32_bf16 v[236:239], v[16:19], a[12:15], 0
    ds_read_b64_tr_b16 v[44:45], v9 offset:4104
    v_mfma_f32_16x16x32_bf16 v[240:243], v[20:23], a[0:3], 0
    ds_read_b64_tr_b16 v[46:47], v9 offset:6152
    v_mfma_f32_16x16x32_bf16 v[244:247], v[20:23], a[4:7], 0
    buffer_load_dwordx4 a[68:71], v1, s[32:35], s50 offen offset:1024 sc1
    v_mfma_f32_16x16x32_bf16 v[248:251], v[20:23], a[8:11], 0
    s_waitcnt vmcnt(30)
    s_barrier
    v_mfma_f32_16x16x32_bf16 v[252:255], v[20:23], a[12:15], 0
    s_waitcnt lgkmcnt(8)
    ds_read_b64_tr_b16 v[16:17], v8 offset:8192
    v_mfma_f32_16x16x32_bf16 v[96:99], v[24:27], a[0:3], 0
    ds_read_b64_tr_b16 v[18:19], v8 offset:10240
    v_mfma_f32_16x16x32_bf16 v[100:103], v[24:27], a[4:7], 0
    buffer_load_dwordx4 a[72:75], v1, s[32:35], s50 offen offset:2048 sc1
    v_mfma_f32_16x16x32_bf16 v[104:107], v[24:27], a[8:11], 0
    v_mfma_f32_16x16x32_bf16 v[108:111], v[24:27], a[12:15], 0
    ds_read_b64_tr_b16 v[20:21], v8 offset:8200
    v_mfma_f32_16x16x32_bf16 v[112:115], v[28:31], a[0:3], 0
    ds_read_b64_tr_b16 v[22:23], v8 offset:10248
    v_mfma_f32_16x16x32_bf16 v[116:119], v[28:31], a[4:7], 0
    v_mfma_f32_16x16x32_bf16 v[120:123], v[28:31], a[8:11], 0
    buffer_load_dwordx4 a[76:79], v1, s[32:35], s50 offen offset:3072 sc1
    v_mfma_f32_16x16x32_bf16 v[124:127], v[28:31], a[12:15], 0
    s_waitcnt lgkmcnt(8)
    ds_read_b64_tr_b16 v[24:25], v9 offset:8192
    v_mfma_f32_16x16x32_bf16 v[128:131], v[32:35], a[0:3], 0
    s_mov_b32 s49, 2097152
    ds_read_b64_tr_b16 v[26:27], v9 offset:10240
    v_mfma_f32_16x16x32_bf16 v[132:135], v[32:35], a[4:7], 0
    s_add_u32 m0, s45, 65536
    v_mfma_f32_16x16x32_bf16 v[136:139], v[32:35], a[8:11], 0
    v_mfma_f32_16x16x32_bf16 v[140:143], v[32:35], a[12:15], 0
    ds_read_b64_tr_b16 v[28:29], v9 offset:8200
    v_mfma_f32_16x16x32_bf16 v[144:147], v[36:39], a[0:3], 0
    ds_read_b64_tr_b16 v[30:31], v9 offset:10248
    v_mfma_f32_16x16x32_bf16 v[148:151], v[36:39], a[4:7], 0
    buffer_load_dwordx4 v4, s[16:19], s49 offen lds
    v_mfma_f32_16x16x32_bf16 v[152:155], v[36:39], a[8:11], 0
    s_add_u32 m0, s45, 69504
    v_mfma_f32_16x16x32_bf16 v[156:159], v[36:39], a[12:15], 0
    s_waitcnt lgkmcnt(8)
    ds_read_b64_tr_b16 v[32:33], v8 offset:12288
    v_mfma_f32_16x16x32_bf16 v[160:163], v[40:43], a[0:3], 0
    ds_read_b64_tr_b16 v[34:35], v8 offset:14336
    v_mfma_f32_16x16x32_bf16 v[164:167], v[40:43], a[4:7], 0
    buffer_load_dwordx4 v4, s[16:19], s49 offen offset:128 lds
    v_mfma_f32_16x16x32_bf16 v[168:171], v[40:43], a[8:11], 0
    v_mfma_f32_16x16x32_bf16 v[172:175], v[40:43], a[12:15], 0
    s_mov_b32 s50, 20480
    ds_read_b64_tr_b16 v[36:37], v8 offset:12296
    v_mfma_f32_16x16x32_bf16 v[176:179], v[44:47], a[0:3], 0
    ds_read_b64_tr_b16 v[38:39], v8 offset:14344
    v_mfma_f32_16x16x32_bf16 v[180:183], v[44:47], a[4:7], 0
    buffer_load_dwordx4 a[80:83], v1, s[32:35], s50 offen offset:0 sc1
    v_mfma_f32_16x16x32_bf16 v[184:187], v[44:47], a[8:11], 0
    v_mfma_f32_16x16x32_bf16 v[188:191], v[44:47], a[12:15], 0
    s_waitcnt vmcnt(15) lgkmcnt(8)
    ds_read_b64_tr_b16 v[40:41], v9 offset:12288
    v_mfma_f32_16x16x32_bf16 v[224:227], v[16:19], a[16:19], v[224:227]
    ds_read_b64_tr_b16 v[42:43], v9 offset:14336
    v_mfma_f32_16x16x32_bf16 v[228:231], v[16:19], a[20:23], v[228:231]
    buffer_load_dwordx4 a[84:87], v1, s[32:35], s50 offen offset:1024 sc1
    v_mfma_f32_16x16x32_bf16 v[232:235], v[16:19], a[24:27], v[232:235]
    v_mfma_f32_16x16x32_bf16 v[236:239], v[16:19], a[28:31], v[236:239]
    ds_read_b64_tr_b16 v[44:45], v9 offset:12296
    v_mfma_f32_16x16x32_bf16 v[240:243], v[20:23], a[16:19], v[240:243]
    ds_read_b64_tr_b16 v[46:47], v9 offset:14344
    v_mfma_f32_16x16x32_bf16 v[244:247], v[20:23], a[20:23], v[244:247]
    v_mfma_f32_16x16x32_bf16 v[248:251], v[20:23], a[24:27], v[248:251]
    s_waitcnt vmcnt(32)
    s_barrier
    v_mfma_f32_16x16x32_bf16 v[252:255], v[20:23], a[28:31], v[252:255]
    s_waitcnt lgkmcnt(8)
    ds_read_b64_tr_b16 v[16:17], v8 offset:16384
    v_mfma_f32_16x16x32_bf16 v[96:99], v[24:27], a[16:19], v[96:99]
    ds_read_b64_tr_b16 v[18:19], v8 offset:18432
    v_mfma_f32_16x16x32_bf16 v[100:103], v[24:27], a[20:23], v[100:103]
    ds_read_b64_tr_b16 v[20:21], v8 offset:24576
    v_mfma_f32_16x16x32_bf16 v[104:107], v[24:27], a[24:27], v[104:107]
    ds_read_b64_tr_b16 v[22:23], v8 offset:26624
    v_mfma_f32_16x16x32_bf16 v[108:111], v[24:27], a[28:31], v[108:111]
    buffer_load_dwordx4 a[88:91], v1, s[32:35], s50 offen offset:2048 sc1
    v_mfma_f32_16x16x32_bf16 v[112:115], v[28:31], a[16:19], v[112:115]
    buffer_load_dwordx4 a[92:95], v1, s[32:35], s50 offen offset:3072 sc1
    v_mfma_f32_16x16x32_bf16 v[116:119], v[28:31], a[20:23], v[116:119]
    s_mov_b32 s49, 2359296
    s_add_u32 m0, s45, 73728
    v_mfma_f32_16x16x32_bf16 v[120:123], v[28:31], a[24:27], v[120:123]
    v_mfma_f32_16x16x32_bf16 v[124:127], v[28:31], a[28:31], v[124:127]
    s_waitcnt lgkmcnt(8)
    ds_read_b64_tr_b16 v[24:25], v8 offset:16392
    v_mfma_f32_16x16x32_bf16 v[128:131], v[32:35], a[16:19], v[128:131]
    ds_read_b64_tr_b16 v[26:27], v8 offset:18440
    v_mfma_f32_16x16x32_bf16 v[132:135], v[32:35], a[20:23], v[132:135]
    ds_read_b64_tr_b16 v[28:29], v8 offset:24584
    v_mfma_f32_16x16x32_bf16 v[136:139], v[32:35], a[24:27], v[136:139]
    ds_read_b64_tr_b16 v[30:31], v8 offset:26632
    v_mfma_f32_16x16x32_bf16 v[140:143], v[32:35], a[28:31], v[140:143]
    buffer_load_dwordx4 v4, s[16:19], s49 offen lds
    v_mfma_f32_16x16x32_bf16 v[144:147], v[36:39], a[16:19], v[144:147]
    s_add_u32 m0, s45, 77696
    v_mfma_f32_16x16x32_bf16 v[148:151], v[36:39], a[20:23], v[148:151]
    buffer_load_dwordx4 v4, s[16:19], s49 offen offset:128 lds
    v_mfma_f32_16x16x32_bf16 v[152:155], v[36:39], a[24:27], v[152:155]
    v_mfma_f32_16x16x32_bf16 v[156:159], v[36:39], a[28:31], v[156:159]
    s_waitcnt lgkmcnt(8)
    ds_read_b64_tr_b16 v[32:33], v9 offset:16384
    v_mfma_f32_16x16x32_bf16 v[160:163], v[40:43], a[16:19], v[160:163]
    s_mov_b32 s50, 24576
    ds_read_b64_tr_b16 v[34:35], v9 offset:18432
    v_mfma_f32_16x16x32_bf16 v[164:167], v[40:43], a[20:23], v[164:167]
    ds_read_b64_tr_b16 v[36:37], v9 offset:24576
    v_mfma_f32_16x16x32_bf16 v[168:171], v[40:43], a[24:27], v[168:171]
    ds_read_b64_tr_b16 v[38:39], v9 offset:26624
    v_mfma_f32_16x16x32_bf16 v[172:175], v[40:43], a[28:31], v[172:175]
    buffer_load_dwordx4 a[96:99], v1, s[32:35], s50 offen offset:0 sc1
    v_mfma_f32_16x16x32_bf16 v[176:179], v[44:47], a[16:19], v[176:179]
    v_mfma_f32_16x16x32_bf16 v[180:183], v[44:47], a[20:23], v[180:183]
    v_mfma_f32_16x16x32_bf16 v[184:187], v[44:47], a[24:27], v[184:187]
    buffer_load_dwordx4 a[100:103], v1, s[32:35], s50 offen offset:1024 sc1
    v_mfma_f32_16x16x32_bf16 v[188:191], v[44:47], a[28:31], v[188:191]
    s_waitcnt vmcnt(14) lgkmcnt(8)
    ds_read_b64_tr_b16 v[40:41], v9 offset:16392
    v_mfma_f32_16x16x32_bf16 v[224:227], v[16:19], a[32:35], v[224:227]
    ds_read_b64_tr_b16 v[42:43], v9 offset:18440
    v_mfma_f32_16x16x32_bf16 v[224:227], v[20:23], a[48:51], v[224:227]
    ds_read_b64_tr_b16 v[44:45], v9 offset:24584
    v_mfma_f32_16x16x32_bf16 v[228:231], v[16:19], a[36:39], v[228:231]
    ds_read_b64_tr_b16 v[46:47], v9 offset:26632
    v_mfma_f32_16x16x32_bf16 v[228:231], v[20:23], a[52:55], v[228:231]
    buffer_load_dwordx4 a[104:107], v1, s[32:35], s50 offen offset:2048 sc1
    v_mfma_f32_16x16x32_bf16 v[232:235], v[16:19], a[40:43], v[232:235]
    v_mfma_f32_16x16x32_bf16 v[232:235], v[20:23], a[56:59], v[232:235]
    v_mfma_f32_16x16x32_bf16 v[236:239], v[16:19], a[44:47], v[236:239]
    v_mfma_f32_16x16x32_bf16 v[236:239], v[20:23], a[60:63], v[236:239]
    s_waitcnt lgkmcnt(8)
    ds_read_b64_tr_b16 v[16:17], v8 offset:20480
    v_mfma_f32_16x16x32_bf16 v[240:243], v[24:27], a[32:35], v[240:243]
    ds_read_b64_tr_b16 v[18:19], v8 offset:22528
    v_mfma_f32_16x16x32_bf16 v[240:243], v[28:31], a[48:51], v[240:243]
    ds_read_b64_tr_b16 v[20:21], v8 offset:28672
    v_mfma_f32_16x16x32_bf16 v[244:247], v[24:27], a[36:39], v[244:247]
    ds_read_b64_tr_b16 v[22:23], v8 offset:30720
    v_mfma_f32_16x16x32_bf16 v[244:247], v[28:31], a[52:55], v[244:247]
    buffer_load_dwordx4 a[108:111], v1, s[32:35], s50 offen offset:3072 sc1
    v_mfma_f32_16x16x32_bf16 v[248:251], v[24:27], a[40:43], v[248:251]
    s_mov_b32 s49, 2621440
    s_add_u32 m0, s45, 81920
    v_mfma_f32_16x16x32_bf16 v[248:251], v[28:31], a[56:59], v[248:251]
    buffer_load_dwordx4 v4, s[16:19], s49 offen lds
    v_mfma_f32_16x16x32_bf16 v[252:255], v[24:27], a[44:47], v[252:255]
    v_mfma_f32_16x16x32_bf16 v[252:255], v[28:31], a[60:63], v[252:255]
    s_waitcnt lgkmcnt(8)
    ds_read_b64_tr_b16 v[24:25], v8 offset:20488
    v_mfma_f32_16x16x32_bf16 v[96:99], v[32:35], a[32:35], v[96:99]
    s_add_u32 m0, s45, 85888
    ds_read_b64_tr_b16 v[26:27], v8 offset:22536
    v_mfma_f32_16x16x32_bf16 v[96:99], v[36:39], a[48:51], v[96:99]
    ds_read_b64_tr_b16 v[28:29], v8 offset:28680
    v_mfma_f32_16x16x32_bf16 v[100:103], v[32:35], a[36:39], v[100:103]
    ds_read_b64_tr_b16 v[30:31], v8 offset:30728
    v_mfma_f32_16x16x32_bf16 v[100:103], v[36:39], a[52:55], v[100:103]
    buffer_load_dwordx4 v4, s[16:19], s49 offen offset:128 lds
    v_mfma_f32_16x16x32_bf16 v[104:107], v[32:35], a[40:43], v[104:107]
    s_mov_b32 s50, 28672
    v_mfma_f32_16x16x32_bf16 v[104:107], v[36:39], a[56:59], v[104:107]
    v_mfma_f32_16x16x32_bf16 v[108:111], v[32:35], a[44:47], v[108:111]
    v_mfma_f32_16x16x32_bf16 v[108:111], v[36:39], a[60:63], v[108:111]
    s_waitcnt lgkmcnt(8)
    ds_read_b64_tr_b16 v[32:33], v9 offset:20480
    v_mfma_f32_16x16x32_bf16 v[112:115], v[40:43], a[32:35], v[112:115]
    ds_read_b64_tr_b16 v[34:35], v9 offset:22528
    v_mfma_f32_16x16x32_bf16 v[112:115], v[44:47], a[48:51], v[112:115]
    ds_read_b64_tr_b16 v[36:37], v9 offset:28672
    v_mfma_f32_16x16x32_bf16 v[116:119], v[40:43], a[36:39], v[116:119]
    ds_read_b64_tr_b16 v[38:39], v9 offset:30720
    v_mfma_f32_16x16x32_bf16 v[116:119], v[44:47], a[52:55], v[116:119]
    buffer_load_dwordx4 a[112:115], v1, s[32:35], s50 offen offset:0 sc1
    v_mfma_f32_16x16x32_bf16 v[120:123], v[40:43], a[40:43], v[120:123]
    buffer_load_dwordx4 a[116:119], v1, s[32:35], s50 offen offset:1024 sc1
    v_mfma_f32_16x16x32_bf16 v[120:123], v[44:47], a[56:59], v[120:123]
    v_mfma_f32_16x16x32_bf16 v[124:127], v[40:43], a[44:47], v[124:127]
    v_mfma_f32_16x16x32_bf16 v[124:127], v[44:47], a[60:63], v[124:127]
    s_waitcnt lgkmcnt(8)
    ds_read_b64_tr_b16 v[40:41], v9 offset:20488
    v_mfma_f32_16x16x32_bf16 v[128:131], v[16:19], a[32:35], v[128:131]
    ds_read_b64_tr_b16 v[42:43], v9 offset:22536
    v_mfma_f32_16x16x32_bf16 v[128:131], v[20:23], a[48:51], v[128:131]
    ds_read_b64_tr_b16 v[44:45], v9 offset:28680
    v_mfma_f32_16x16x32_bf16 v[132:135], v[16:19], a[36:39], v[132:135]
    ds_read_b64_tr_b16 v[46:47], v9 offset:30728
    v_mfma_f32_16x16x32_bf16 v[132:135], v[20:23], a[52:55], v[132:135]
    buffer_load_dwordx4 a[120:123], v1, s[32:35], s50 offen offset:2048 sc1
    v_mfma_f32_16x16x32_bf16 v[136:139], v[16:19], a[40:43], v[136:139]
    v_mfma_f32_16x16x32_bf16 v[136:139], v[20:23], a[56:59], v[136:139]
    buffer_load_dwordx4 a[124:127], v1, s[32:35], s50 offen offset:3072 sc1
    v_mfma_f32_16x16x32_bf16 v[140:143], v[16:19], a[44:47], v[140:143]
    s_waitcnt vmcnt(42)
    s_barrier
    v_mfma_f32_16x16x32_bf16 v[140:143], v[20:23], a[60:63], v[140:143]
    s_waitcnt lgkmcnt(8)
    ds_read_b64_tr_b16 v[16:17], v8 offset:32768
    v_mfma_f32_16x16x32_bf16 v[144:147], v[24:27], a[32:35], v[144:147]
    s_mov_b32 s49, 2883584
    ds_read_b64_tr_b16 v[18:19], v8 offset:34816
    v_mfma_f32_16x16x32_bf16 v[144:147], v[28:31], a[48:51], v[144:147]
    s_add_u32 m0, s45, 90112
    ds_read_b64_tr_b16 v[20:21], v8 offset:40960
    v_mfma_f32_16x16x32_bf16 v[148:151], v[24:27], a[36:39], v[148:151]
    ds_read_b64_tr_b16 v[22:23], v8 offset:43008
    v_mfma_f32_16x16x32_bf16 v[148:151], v[28:31], a[52:55], v[148:151]
    buffer_load_dwordx4 v4, s[16:19], s49 offen lds
    v_mfma_f32_16x16x32_bf16 v[152:155], v[24:27], a[40:43], v[152:155]
    s_add_u32 m0, s45, 94080
    v_mfma_f32_16x16x32_bf16 v[152:155], v[28:31], a[56:59], v[152:155]
    v_mfma_f32_16x16x32_bf16 v[156:159], v[24:27], a[44:47], v[156:159]
    v_mfma_f32_16x16x32_bf16 v[156:159], v[28:31], a[60:63], v[156:159]
    s_waitcnt lgkmcnt(8)
    ds_read_b64_tr_b16 v[24:25], v8 offset:32776
    v_mfma_f32_16x16x32_bf16 v[160:163], v[32:35], a[32:35], v[160:163]
    ds_read_b64_tr_b16 v[26:27], v8 offset:34824
    v_mfma_f32_16x16x32_bf16 v[160:163], v[36:39], a[48:51], v[160:163]
    ds_read_b64_tr_b16 v[28:29], v8 offset:40968
    v_mfma_f32_16x16x32_bf16 v[164:167], v[32:35], a[36:39], v[164:167]
    ds_read_b64_tr_b16 v[30:31], v8 offset:43016
    v_mfma_f32_16x16x32_bf16 v[164:167], v[36:39], a[52:55], v[164:167]
    buffer_load_dwordx4 v4, s[16:19], s49 offen offset:128 lds
    v_mfma_f32_16x16x32_bf16 v[168:171], v[32:35], a[40:43], v[168:171]
    s_mov_b32 s50, 32768
    v_mfma_f32_16x16x32_bf16 v[168:171], v[36:39], a[56:59], v[168:171]
    buffer_load_dwordx4 a[128:131], v1, s[32:35], s50 offen offset:0 sc1
    v_mfma_f32_16x16x32_bf16 v[172:175], v[32:35], a[44:47], v[172:175]
    v_mfma_f32_16x16x32_bf16 v[172:175], v[36:39], a[60:63], v[172:175]
    s_waitcnt lgkmcnt(8)
    ds_read_b64_tr_b16 v[32:33], v9 offset:32768
    v_mfma_f32_16x16x32_bf16 v[176:179], v[40:43], a[32:35], v[176:179]
    ds_read_b64_tr_b16 v[34:35], v9 offset:34816
    v_mfma_f32_16x16x32_bf16 v[176:179], v[44:47], a[48:51], v[176:179]
    ds_read_b64_tr_b16 v[36:37], v9 offset:40960
    v_mfma_f32_16x16x32_bf16 v[180:183], v[40:43], a[36:39], v[180:183]
    ds_read_b64_tr_b16 v[38:39], v9 offset:43008
    v_mfma_f32_16x16x32_bf16 v[180:183], v[44:47], a[52:55], v[180:183]
    buffer_load_dwordx4 a[132:135], v1, s[32:35], s50 offen offset:1024 sc1
    v_mfma_f32_16x16x32_bf16 v[184:187], v[40:43], a[40:43], v[184:187]
    v_mfma_f32_16x16x32_bf16 v[184:187], v[44:47], a[56:59], v[184:187]
    buffer_load_dwordx4 a[136:139], v1, s[32:35], s50 offen offset:2048 sc1
    v_mfma_f32_16x16x32_bf16 v[188:191], v[40:43], a[44:47], v[188:191]
    v_mfma_f32_16x16x32_bf16 v[188:191], v[44:47], a[60:63], v[188:191]
    s_waitcnt vmcnt(17) lgkmcnt(8)
    ds_read_b64_tr_b16 v[40:41], v9 offset:32776
    v_mfma_f32_16x16x32_bf16 v[224:227], v[16:19], a[64:67], v[224:227]
    ds_read_b64_tr_b16 v[42:43], v9 offset:34824
    v_mfma_f32_16x16x32_bf16 v[224:227], v[20:23], a[80:83], v[224:227]
    ds_read_b64_tr_b16 v[44:45], v9 offset:40968
    v_mfma_f32_16x16x32_bf16 v[228:231], v[16:19], a[68:71], v[228:231]
    ds_read_b64_tr_b16 v[46:47], v9 offset:43016
    v_mfma_f32_16x16x32_bf16 v[228:231], v[20:23], a[84:87], v[228:231]
    buffer_load_dwordx4 a[140:143], v1, s[32:35], s50 offen offset:3072 sc1
    v_mfma_f32_16x16x32_bf16 v[232:235], v[16:19], a[72:75], v[232:235]
    s_mov_b32 s49, 3145728
    s_add_u32 m0, s45, 98304
    v_mfma_f32_16x16x32_bf16 v[232:235], v[20:23], a[88:91], v[232:235]
    v_mfma_f32_16x16x32_bf16 v[236:239], v[16:19], a[76:79], v[236:239]
    v_mfma_f32_16x16x32_bf16 v[236:239], v[20:23], a[92:95], v[236:239]
    s_waitcnt lgkmcnt(8)
    ds_read_b64_tr_b16 v[16:17], v8 offset:36864
    v_mfma_f32_16x16x32_bf16 v[240:243], v[24:27], a[64:67], v[240:243]
    ds_read_b64_tr_b16 v[18:19], v8 offset:38912
    v_mfma_f32_16x16x32_bf16 v[240:243], v[28:31], a[80:83], v[240:243]
    ds_read_b64_tr_b16 v[20:21], v8 offset:45056
    v_mfma_f32_16x16x32_bf16 v[244:247], v[24:27], a[68:71], v[244:247]
    ds_read_b64_tr_b16 v[22:23], v8 offset:47104
    v_mfma_f32_16x16x32_bf16 v[244:247], v[28:31], a[84:87], v[244:247]
    buffer_load_dwordx4 v4, s[16:19], s49 offen lds
    v_mfma_f32_16x16x32_bf16 v[248:251], v[24:27], a[72:75], v[248:251]
    s_add_u32 m0, s45, 102272
    v_mfma_f32_16x16x32_bf16 v[248:251], v[28:31], a[88:91], v[248:251]
    buffer_load_dwordx4 v4, s[16:19], s49 offen offset:128 lds
    v_mfma_f32_16x16x32_bf16 v[252:255], v[24:27], a[76:79], v[252:255]
    s_mov_b32 s50, 36864
    v_mfma_f32_16x16x32_bf16 v[252:255], v[28:31], a[92:95], v[252:255]
    s_waitcnt lgkmcnt(8)
    ds_read_b64_tr_b16 v[24:25], v8 offset:36872
    v_mfma_f32_16x16x32_bf16 v[96:99], v[32:35], a[64:67], v[96:99]
    ds_read_b64_tr_b16 v[26:27], v8 offset:38920
    v_mfma_f32_16x16x32_bf16 v[96:99], v[36:39], a[80:83], v[96:99]
    ds_read_b64_tr_b16 v[28:29], v8 offset:45064
    v_mfma_f32_16x16x32_bf16 v[100:103], v[32:35], a[68:71], v[100:103]
    ds_read_b64_tr_b16 v[30:31], v8 offset:47112
    v_mfma_f32_16x16x32_bf16 v[100:103], v[36:39], a[84:87], v[100:103]
    buffer_load_dwordx4 a[144:147], v1, s[32:35], s50 offen offset:0 sc1
    v_mfma_f32_16x16x32_bf16 v[104:107], v[32:35], a[72:75], v[104:107]
    v_mfma_f32_16x16x32_bf16 v[104:107], v[36:39], a[88:91], v[104:107]
    buffer_load_dwordx4 a[148:151], v1, s[32:35], s50 offen offset:1024 sc1
    v_mfma_f32_16x16x32_bf16 v[108:111], v[32:35], a[76:79], v[108:111]
    v_mfma_f32_16x16x32_bf16 v[108:111], v[36:39], a[92:95], v[108:111]
    s_waitcnt lgkmcnt(8)
    ds_read_b64_tr_b16 v[32:33], v9 offset:36864
    v_mfma_f32_16x16x32_bf16 v[112:115], v[40:43], a[64:67], v[112:115]
    ds_read_b64_tr_b16 v[34:35], v9 offset:38912
    v_mfma_f32_16x16x32_bf16 v[112:115], v[44:47], a[80:83], v[112:115]
    ds_read_b64_tr_b16 v[36:37], v9 offset:45056
    v_mfma_f32_16x16x32_bf16 v[116:119], v[40:43], a[68:71], v[116:119]
    ds_read_b64_tr_b16 v[38:39], v9 offset:47104
    v_mfma_f32_16x16x32_bf16 v[116:119], v[44:47], a[84:87], v[116:119]
    buffer_load_dwordx4 a[152:155], v1, s[32:35], s50 offen offset:2048 sc1
    v_mfma_f32_16x16x32_bf16 v[120:123], v[40:43], a[72:75], v[120:123]
    v_mfma_f32_16x16x32_bf16 v[120:123], v[44:47], a[88:91], v[120:123]
    v_mfma_f32_16x16x32_bf16 v[124:127], v[40:43], a[76:79], v[124:127]
    v_mfma_f32_16x16x32_bf16 v[124:127], v[44:47], a[92:95], v[124:127]
    s_waitcnt lgkmcnt(8)
    ds_read_b64_tr_b16 v[40:41], v9 offset:36872
    v_mfma_f32_16x16x32_bf16 v[128:131], v[16:19], a[64:67], v[128:131]
    ds_read_b64_tr_b16 v[42:43], v9 offset:38920
    v_mfma_f32_16x16x32_bf16 v[128:131], v[20:23], a[80:83], v[128:131]
    ds_read_b64_tr_b16 v[44:45], v9 offset:45064
    v_mfma_f32_16x16x32_bf16 v[132:135], v[16:19], a[68:71], v[132:135]
    ds_read_b64_tr_b16 v[46:47], v9 offset:47112
    v_mfma_f32_16x16x32_bf16 v[132:135], v[20:23], a[84:87], v[132:135]
    buffer_load_dwordx4 a[156:159], v1, s[32:35], s50 offen offset:3072 sc1
    v_mfma_f32_16x16x32_bf16 v[136:139], v[16:19], a[72:75], v[136:139]
    s_mov_b32 s49, 3407872
    s_add_u32 m0, s45, 106496
    v_mfma_f32_16x16x32_bf16 v[136:139], v[20:23], a[88:91], v[136:139]
    buffer_load_dwordx4 v4, s[16:19], s49 offen lds
    v_mfma_f32_16x16x32_bf16 v[140:143], v[16:19], a[76:79], v[140:143]
    s_waitcnt vmcnt(51)
    s_barrier
    s_add_u32 m0, s45, 110464
    v_mfma_f32_16x16x32_bf16 v[140:143], v[20:23], a[92:95], v[140:143]
    s_waitcnt lgkmcnt(8)
    ds_read_b64_tr_b16 v[16:17], v8 offset:49152
    v_mfma_f32_16x16x32_bf16 v[144:147], v[24:27], a[64:67], v[144:147]
    ds_read_b64_tr_b16 v[18:19], v8 offset:51200
    v_mfma_f32_16x16x32_bf16 v[144:147], v[28:31], a[80:83], v[144:147]
    ds_read_b64_tr_b16 v[20:21], v8 offset:57344
    v_mfma_f32_16x16x32_bf16 v[148:151], v[24:27], a[68:71], v[148:151]
    ds_read_b64_tr_b16 v[22:23], v8 offset:59392
    v_mfma_f32_16x16x32_bf16 v[148:151], v[28:31], a[84:87], v[148:151]
    buffer_load_dwordx4 v4, s[16:19], s49 offen offset:128 lds
    v_mfma_f32_16x16x32_bf16 v[152:155], v[24:27], a[72:75], v[152:155]
    s_mov_b32 s50, 40960
    v_mfma_f32_16x16x32_bf16 v[152:155], v[28:31], a[88:91], v[152:155]
    v_mfma_f32_16x16x32_bf16 v[156:159], v[24:27], a[76:79], v[156:159]
    buffer_load_dwordx4 a[160:163], v1, s[32:35], s50 offen offset:0 sc1
    v_mfma_f32_16x16x32_bf16 v[156:159], v[28:31], a[92:95], v[156:159]
    s_waitcnt lgkmcnt(8)
    ds_read_b64_tr_b16 v[24:25], v8 offset:49160
    v_mfma_f32_16x16x32_bf16 v[160:163], v[32:35], a[64:67], v[160:163]
    ds_read_b64_tr_b16 v[26:27], v8 offset:51208
    v_mfma_f32_16x16x32_bf16 v[160:163], v[36:39], a[80:83], v[160:163]
    ds_read_b64_tr_b16 v[28:29], v8 offset:57352
    v_mfma_f32_16x16x32_bf16 v[164:167], v[32:35], a[68:71], v[164:167]
    ds_read_b64_tr_b16 v[30:31], v8 offset:59400
    v_mfma_f32_16x16x32_bf16 v[164:167], v[36:39], a[84:87], v[164:167]
    buffer_load_dwordx4 a[164:167], v1, s[32:35], s50 offen offset:1024 sc1
    v_mfma_f32_16x16x32_bf16 v[168:171], v[32:35], a[72:75], v[168:171]
    v_mfma_f32_16x16x32_bf16 v[168:171], v[36:39], a[88:91], v[168:171]
    v_mfma_f32_16x16x32_bf16 v[172:175], v[32:35], a[76:79], v[172:175]
    v_mfma_f32_16x16x32_bf16 v[172:175], v[36:39], a[92:95], v[172:175]
    s_waitcnt lgkmcnt(8)
    ds_read_b64_tr_b16 v[32:33], v9 offset:49152
    v_mfma_f32_16x16x32_bf16 v[176:179], v[40:43], a[64:67], v[176:179]
    ds_read_b64_tr_b16 v[34:35], v9 offset:51200
    v_mfma_f32_16x16x32_bf16 v[176:179], v[44:47], a[80:83], v[176:179]
    ds_read_b64_tr_b16 v[36:37], v9 offset:57344
    v_mfma_f32_16x16x32_bf16 v[180:183], v[40:43], a[68:71], v[180:183]
    ds_read_b64_tr_b16 v[38:39], v9 offset:59392
    v_mfma_f32_16x16x32_bf16 v[180:183], v[44:47], a[84:87], v[180:183]
    buffer_load_dwordx4 a[168:171], v1, s[32:35], s50 offen offset:2048 sc1
    v_mfma_f32_16x16x32_bf16 v[184:187], v[40:43], a[72:75], v[184:187]
    buffer_load_dwordx4 a[172:175], v1, s[32:35], s50 offen offset:3072 sc1
    v_mfma_f32_16x16x32_bf16 v[184:187], v[44:47], a[88:91], v[184:187]
    v_mfma_f32_16x16x32_bf16 v[188:191], v[40:43], a[76:79], v[188:191]
    s_mov_b32 s49, 3670016
    s_add_u32 m0, s45, 114688
    v_mfma_f32_16x16x32_bf16 v[188:191], v[44:47], a[92:95], v[188:191]
    s_waitcnt vmcnt(18) lgkmcnt(8)
    ds_read_b64_tr_b16 v[40:41], v9 offset:49160
    v_mfma_f32_16x16x32_bf16 v[224:227], v[16:19], a[96:99], v[224:227]
    ds_read_b64_tr_b16 v[42:43], v9 offset:51208
    v_mfma_f32_16x16x32_bf16 v[224:227], v[20:23], a[112:115], v[224:227]
    ds_read_b64_tr_b16 v[44:45], v9 offset:57352
    v_mfma_f32_16x16x32_bf16 v[228:231], v[16:19], a[100:103], v[228:231]
    ds_read_b64_tr_b16 v[46:47], v9 offset:59400
    v_mfma_f32_16x16x32_bf16 v[228:231], v[20:23], a[116:119], v[228:231]
    buffer_load_dwordx4 v4, s[16:19], s49 offen lds
    v_mfma_f32_16x16x32_bf16 v[232:235], v[16:19], a[104:107], v[232:235]
    s_add_u32 m0, s45, 118656
    v_mfma_f32_16x16x32_bf16 v[232:235], v[20:23], a[120:123], v[232:235]
    v_mfma_f32_16x16x32_bf16 v[236:239], v[16:19], a[108:111], v[236:239]
    buffer_load_dwordx4 v4, s[16:19], s49 offen offset:128 lds
    v_mfma_f32_16x16x32_bf16 v[236:239], v[20:23], a[124:127], v[236:239]
    s_waitcnt lgkmcnt(8)
    ds_read_b64_tr_b16 v[16:17], v8 offset:53248
    v_mfma_f32_16x16x32_bf16 v[240:243], v[24:27], a[96:99], v[240:243]
    s_mov_b32 s50, 45056
    ds_read_b64_tr_b16 v[18:19], v8 offset:55296
    v_mfma_f32_16x16x32_bf16 v[240:243], v[28:31], a[112:115], v[240:243]
    ds_read_b64_tr_b16 v[20:21], v8 offset:61440
    v_mfma_f32_16x16x32_bf16 v[244:247], v[24:27], a[100:103], v[244:247]
    ds_read_b64_tr_b16 v[22:23], v8 offset:63488
    v_mfma_f32_16x16x32_bf16 v[244:247], v[28:31], a[116:119], v[244:247]
    buffer_load_dwordx4 a[176:179], v1, s[32:35], s50 offen offset:0 sc1
    v_mfma_f32_16x16x32_bf16 v[248:251], v[24:27], a[104:107], v[248:251]
    v_mfma_f32_16x16x32_bf16 v[248:251], v[28:31], a[120:123], v[248:251]
    v_mfma_f32_16x16x32_bf16 v[252:255], v[24:27], a[108:111], v[252:255]
    v_mfma_f32_16x16x32_bf16 v[252:255], v[28:31], a[124:127], v[252:255]
    s_waitcnt lgkmcnt(8)
    ds_read_b64_tr_b16 v[24:25], v8 offset:53256
    v_mfma_f32_16x16x32_bf16 v[96:99], v[32:35], a[96:99], v[96:99]
    ds_read_b64_tr_b16 v[26:27], v8 offset:55304
    v_mfma_f32_16x16x32_bf16 v[96:99], v[36:39], a[112:115], v[96:99]
    ds_read_b64_tr_b16 v[28:29], v8 offset:61448
    v_mfma_f32_16x16x32_bf16 v[100:103], v[32:35], a[100:103], v[100:103]
    ds_read_b64_tr_b16 v[30:31], v8 offset:63496
    v_mfma_f32_16x16x32_bf16 v[100:103], v[36:39], a[116:119], v[100:103]
    buffer_load_dwordx4 a[180:183], v1, s[32:35], s50 offen offset:1024 sc1
    v_mfma_f32_16x16x32_bf16 v[104:107], v[32:35], a[104:107], v[104:107]
    buffer_load_dwordx4 a[184:187], v1, s[32:35], s50 offen offset:2048 sc1
    v_mfma_f32_16x16x32_bf16 v[104:107], v[36:39], a[120:123], v[104:107]
    v_mfma_f32_16x16x32_bf16 v[108:111], v[32:35], a[108:111], v[108:111]
    v_mfma_f32_16x16x32_bf16 v[108:111], v[36:39], a[124:127], v[108:111]
    s_waitcnt lgkmcnt(8)
    ds_read_b64_tr_b16 v[32:33], v9 offset:53248
    v_mfma_f32_16x16x32_bf16 v[112:115], v[40:43], a[96:99], v[112:115]
    ds_read_b64_tr_b16 v[34:35], v9 offset:55296
    v_mfma_f32_16x16x32_bf16 v[112:115], v[44:47], a[112:115], v[112:115]
    ds_read_b64_tr_b16 v[36:37], v9 offset:61440
    v_mfma_f32_16x16x32_bf16 v[116:119], v[40:43], a[100:103], v[116:119]
    ds_read_b64_tr_b16 v[38:39], v9 offset:63488
    v_mfma_f32_16x16x32_bf16 v[116:119], v[44:47], a[116:119], v[116:119]
    buffer_load_dwordx4 a[188:191], v1, s[32:35], s50 offen offset:3072 sc1
    v_mfma_f32_16x16x32_bf16 v[120:123], v[40:43], a[104:107], v[120:123]
    s_mov_b32 s49, 3932160
    s_add_u32 m0, s45, 122880
    v_mfma_f32_16x16x32_bf16 v[120:123], v[44:47], a[120:123], v[120:123]
    v_mfma_f32_16x16x32_bf16 v[124:127], v[40:43], a[108:111], v[124:127]
    buffer_load_dwordx4 v4, s[16:19], s49 offen lds
    v_mfma_f32_16x16x32_bf16 v[124:127], v[44:47], a[124:127], v[124:127]
    s_waitcnt lgkmcnt(8)
    ds_read_b64_tr_b16 v[40:41], v9 offset:53256
    v_mfma_f32_16x16x32_bf16 v[128:131], v[16:19], a[96:99], v[128:131]
    ds_read_b64_tr_b16 v[42:43], v9 offset:55304
    v_add_u32 v8, 0x10000, v8
    v_mfma_f32_16x16x32_bf16 v[128:131], v[20:23], a[112:115], v[128:131]
    s_add_u32 m0, s45, 126848
    ds_read_b64_tr_b16 v[44:45], v9 offset:61448
    v_mfma_f32_16x16x32_bf16 v[132:135], v[16:19], a[100:103], v[132:135]
    ds_read_b64_tr_b16 v[46:47], v9 offset:63496
    v_mfma_f32_16x16x32_bf16 v[132:135], v[20:23], a[116:119], v[132:135]
    buffer_load_dwordx4 v4, s[16:19], s49 offen offset:128 lds
    v_mfma_f32_16x16x32_bf16 v[136:139], v[16:19], a[104:107], v[136:139]
    v_mfma_f32_16x16x32_bf16 v[136:139], v[20:23], a[120:123], v[136:139]
    v_mfma_f32_16x16x32_bf16 v[140:143], v[16:19], a[108:111], v[140:143]
    s_waitcnt vmcnt(36)
    s_barrier
    s_mov_b32 s50, 49152
    v_mfma_f32_16x16x32_bf16 v[140:143], v[20:23], a[124:127], v[140:143]
    s_waitcnt lgkmcnt(8)
    ds_read_b64_tr_b16 v[16:17], v8 offset:0
    v_mfma_f32_16x16x32_bf16 v[144:147], v[24:27], a[96:99], v[144:147]
    ds_read_b64_tr_b16 v[18:19], v8 offset:2048
    v_mfma_f32_16x16x32_bf16 v[144:147], v[28:31], a[112:115], v[144:147]
    ds_read_b64_tr_b16 v[20:21], v8 offset:8192
    v_mfma_f32_16x16x32_bf16 v[148:151], v[24:27], a[100:103], v[148:151]
    ds_read_b64_tr_b16 v[22:23], v8 offset:10240
    v_mfma_f32_16x16x32_bf16 v[148:151], v[28:31], a[116:119], v[148:151]
    buffer_load_dwordx4 a[192:195], v1, s[32:35], s50 offen offset:0 sc1
    v_mfma_f32_16x16x32_bf16 v[152:155], v[24:27], a[104:107], v[152:155]
    buffer_load_dwordx4 a[196:199], v1, s[32:35], s50 offen offset:1024 sc1
    v_mfma_f32_16x16x32_bf16 v[152:155], v[28:31], a[120:123], v[152:155]
    v_mfma_f32_16x16x32_bf16 v[156:159], v[24:27], a[108:111], v[156:159]
    v_mfma_f32_16x16x32_bf16 v[156:159], v[28:31], a[124:127], v[156:159]
    s_waitcnt lgkmcnt(8)
    ds_read_b64_tr_b16 v[24:25], v8 offset:8
    v_mfma_f32_16x16x32_bf16 v[160:163], v[32:35], a[96:99], v[160:163]
    ds_read_b64_tr_b16 v[26:27], v8 offset:2056
    v_add_u32 v9, 0x10000, v9
    v_mfma_f32_16x16x32_bf16 v[160:163], v[36:39], a[112:115], v[160:163]
    ds_read_b64_tr_b16 v[28:29], v8 offset:8200
    v_mfma_f32_16x16x32_bf16 v[164:167], v[32:35], a[100:103], v[164:167]
    ds_read_b64_tr_b16 v[30:31], v8 offset:10248
    v_mfma_f32_16x16x32_bf16 v[164:167], v[36:39], a[116:119], v[164:167]
    buffer_load_dwordx4 a[200:203], v1, s[32:35], s50 offen offset:2048 sc1
    v_mfma_f32_16x16x32_bf16 v[168:171], v[32:35], a[104:107], v[168:171]
    v_mfma_f32_16x16x32_bf16 v[168:171], v[36:39], a[120:123], v[168:171]
    v_mfma_f32_16x16x32_bf16 v[172:175], v[32:35], a[108:111], v[172:175]
    buffer_load_dwordx4 a[204:207], v1, s[32:35], s50 offen offset:3072 sc1
    v_mfma_f32_16x16x32_bf16 v[172:175], v[36:39], a[124:127], v[172:175]
    s_waitcnt lgkmcnt(8)
    ds_read_b64_tr_b16 v[32:33], v9 offset:0
    v_mfma_f32_16x16x32_bf16 v[176:179], v[40:43], a[96:99], v[176:179]
    s_mov_b32 s49, 4194304
    ds_read_b64_tr_b16 v[34:35], v9 offset:2048
    v_mfma_f32_16x16x32_bf16 v[176:179], v[44:47], a[112:115], v[176:179]
    s_add_u32 m0, s45, 131072
    ds_read_b64_tr_b16 v[36:37], v9 offset:8192
    v_mfma_f32_16x16x32_bf16 v[180:183], v[40:43], a[100:103], v[180:183]
    ds_read_b64_tr_b16 v[38:39], v9 offset:10240
    v_mfma_f32_16x16x32_bf16 v[180:183], v[44:47], a[116:119], v[180:183]
    buffer_load_dwordx4 v4, s[16:19], s49 offen lds
    v_mfma_f32_16x16x32_bf16 v[184:187], v[40:43], a[104:107], v[184:187]
    v_mfma_f32_16x16x32_bf16 v[184:187], v[44:47], a[120:123], v[184:187]
    s_add_u32 m0, s45, 135040
    v_mfma_f32_16x16x32_bf16 v[188:191], v[40:43], a[108:111], v[188:191]
    v_mfma_f32_16x16x32_bf16 v[188:191], v[44:47], a[124:127], v[188:191]
    s_waitcnt vmcnt(19) lgkmcnt(8)
    ds_read_b64_tr_b16 v[40:41], v9 offset:8
    v_mfma_f32_16x16x32_bf16 v[224:227], v[16:19], a[128:131], v[224:227]
    ds_read_b64_tr_b16 v[42:43], v9 offset:2056
    v_mfma_f32_16x16x32_bf16 v[224:227], v[20:23], a[144:147], v[224:227]
    ds_read_b64_tr_b16 v[44:45], v9 offset:8200
    v_mfma_f32_16x16x32_bf16 v[228:231], v[16:19], a[132:135], v[228:231]
    ds_read_b64_tr_b16 v[46:47], v9 offset:10248
    v_mfma_f32_16x16x32_bf16 v[228:231], v[20:23], a[148:151], v[228:231]
    buffer_load_dwordx4 v4, s[16:19], s49 offen offset:128 lds
    v_mfma_f32_16x16x32_bf16 v[232:235], v[16:19], a[136:139], v[232:235]
    s_mov_b32 s50, 53248
    v_mfma_f32_16x16x32_bf16 v[232:235], v[20:23], a[152:155], v[232:235]
    buffer_load_dwordx4 a[208:211], v1, s[32:35], s50 offen offset:0 sc1
    v_mfma_f32_16x16x32_bf16 v[236:239], v[16:19], a[140:143], v[236:239]
    v_mfma_f32_16x16x32_bf16 v[236:239], v[20:23], a[156:159], v[236:239]
    s_waitcnt lgkmcnt(8)
    ds_read_b64_tr_b16 v[16:17], v8 offset:4096
    v_mfma_f32_16x16x32_bf16 v[240:243], v[24:27], a[128:131], v[240:243]
    ds_read_b64_tr_b16 v[18:19], v8 offset:6144
    v_mfma_f32_16x16x32_bf16 v[240:243], v[28:31], a[144:147], v[240:243]
    ds_read_b64_tr_b16 v[20:21], v8 offset:12288
    v_mfma_f32_16x16x32_bf16 v[244:247], v[24:27], a[132:135], v[244:247]
    ds_read_b64_tr_b16 v[22:23], v8 offset:14336
    v_mfma_f32_16x16x32_bf16 v[244:247], v[28:31], a[148:151], v[244:247]
    buffer_load_dwordx4 a[212:215], v1, s[32:35], s50 offen offset:1024 sc1
    v_mfma_f32_16x16x32_bf16 v[248:251], v[24:27], a[136:139], v[248:251]
    v_mfma_f32_16x16x32_bf16 v[248:251], v[28:31], a[152:155], v[248:251]
    v_mfma_f32_16x16x32_bf16 v[252:255], v[24:27], a[140:143], v[252:255]
    buffer_load_dwordx4 a[216:219], v1, s[32:35], s50 offen offset:2048 sc1
    v_mfma_f32_16x16x32_bf16 v[252:255], v[28:31], a[156:159], v[252:255]
    s_waitcnt lgkmcnt(8)
    ds_read_b64_tr_b16 v[24:25], v8 offset:4104
    v_mfma_f32_16x16x32_bf16 v[96:99], v[32:35], a[128:131], v[96:99]
    ds_read_b64_tr_b16 v[26:27], v8 offset:6152
    v_mfma_f32_16x16x32_bf16 v[96:99], v[36:39], a[144:147], v[96:99]
    ds_read_b64_tr_b16 v[28:29], v8 offset:12296
    v_mfma_f32_16x16x32_bf16 v[100:103], v[32:35], a[132:135], v[100:103]
    ds_read_b64_tr_b16 v[30:31], v8 offset:14344
    v_mfma_f32_16x16x32_bf16 v[100:103], v[36:39], a[148:151], v[100:103]
    buffer_load_dwordx4 a[220:223], v1, s[32:35], s50 offen offset:3072 sc1
    v_mfma_f32_16x16x32_bf16 v[104:107], v[32:35], a[136:139], v[104:107]
    v_mfma_f32_16x16x32_bf16 v[104:107], v[36:39], a[152:155], v[104:107]
    s_mov_b32 s49, 4456448
    s_add_u32 m0, s45, 139264
    v_mfma_f32_16x16x32_bf16 v[108:111], v[32:35], a[140:143], v[108:111]
    v_mfma_f32_16x16x32_bf16 v[108:111], v[36:39], a[156:159], v[108:111]
    s_waitcnt lgkmcnt(8)
    ds_read_b64_tr_b16 v[32:33], v9 offset:4096
    v_mfma_f32_16x16x32_bf16 v[112:115], v[40:43], a[128:131], v[112:115]
    ds_read_b64_tr_b16 v[34:35], v9 offset:6144
    v_mfma_f32_16x16x32_bf16 v[112:115], v[44:47], a[144:147], v[112:115]
    ds_read_b64_tr_b16 v[36:37], v9 offset:12288
    v_mfma_f32_16x16x32_bf16 v[116:119], v[40:43], a[132:135], v[116:119]
    ds_read_b64_tr_b16 v[38:39], v9 offset:14336
    v_mfma_f32_16x16x32_bf16 v[116:119], v[44:47], a[148:151], v[116:119]
    buffer_load_dwordx4 v4, s[16:19], s49 offen lds
    v_mfma_f32_16x16x32_bf16 v[120:123], v[40:43], a[136:139], v[120:123]
    s_add_u32 m0, s45, 143232
    v_mfma_f32_16x16x32_bf16 v[120:123], v[44:47], a[152:155], v[120:123]
    buffer_load_dwordx4 v4, s[16:19], s49 offen offset:128 lds
    v_mfma_f32_16x16x32_bf16 v[124:127], v[40:43], a[140:143], v[124:127]
    v_mfma_f32_16x16x32_bf16 v[124:127], v[44:47], a[156:159], v[124:127]
    s_waitcnt lgkmcnt(8)
    ds_read_b64_tr_b16 v[40:41], v9 offset:4104
    v_mfma_f32_16x16x32_bf16 v[128:131], v[16:19], a[128:131], v[128:131]
    s_mov_b32 s50, 57344
    ds_read_b64_tr_b16 v[42:43], v9 offset:6152
    v_mfma_f32_16x16x32_bf16 v[128:131], v[20:23], a[144:147], v[128:131]
    ds_read_b64_tr_b16 v[44:45], v9 offset:12296
    v_mfma_f32_16x16x32_bf16 v[132:135], v[16:19], a[132:135], v[132:135]
    ds_read_b64_tr_b16 v[46:47], v9 offset:14344
    v_mfma_f32_16x16x32_bf16 v[132:135], v[20:23], a[148:151], v[132:135]
    buffer_load_dwordx4 a[224:227], v1, s[32:35], s50 offen offset:0 sc1
    v_mfma_f32_16x16x32_bf16 v[136:139], v[16:19], a[136:139], v[136:139]
    v_mfma_f32_16x16x32_bf16 v[136:139], v[20:23], a[152:155], v[136:139]
    v_mfma_f32_16x16x32_bf16 v[140:143], v[16:19], a[140:143], v[140:143]
    s_waitcnt vmcnt(37)
    s_barrier
    v_mfma_f32_16x16x32_bf16 v[140:143], v[20:23], a[156:159], v[140:143]
    s_waitcnt lgkmcnt(8)
    ds_read_b64_tr_b16 v[16:17], v8 offset:16384
    v_mfma_f32_16x16x32_bf16 v[144:147], v[24:27], a[128:131], v[144:147]
    ds_read_b64_tr_b16 v[18:19], v8 offset:18432
    v_mfma_f32_16x16x32_bf16 v[144:147], v[28:31], a[144:147], v[144:147]
    ds_read_b64_tr_b16 v[20:21], v8 offset:24576
    v_mfma_f32_16x16x32_bf16 v[148:151], v[24:27], a[132:135], v[148:151]
    ds_read_b64_tr_b16 v[22:23], v8 offset:26624
    v_mfma_f32_16x16x32_bf16 v[148:151], v[28:31], a[148:151], v[148:151]
    buffer_load_dwordx4 a[228:231], v1, s[32:35], s50 offen offset:1024 sc1
    v_mfma_f32_16x16x32_bf16 v[152:155], v[24:27], a[136:139], v[152:155]
    buffer_load_dwordx4 a[232:235], v1, s[32:35], s50 offen offset:2048 sc1
    v_mfma_f32_16x16x32_bf16 v[152:155], v[28:31], a[152:155], v[152:155]
    v_mfma_f32_16x16x32_bf16 v[156:159], v[24:27], a[140:143], v[156:159]
    v_mfma_f32_16x16x32_bf16 v[156:159], v[28:31], a[156:159], v[156:159]
    s_waitcnt lgkmcnt(8)
    ds_read_b64_tr_b16 v[24:25], v8 offset:16392
    v_mfma_f32_16x16x32_bf16 v[160:163], v[32:35], a[128:131], v[160:163]
    ds_read_b64_tr_b16 v[26:27], v8 offset:18440
    v_mfma_f32_16x16x32_bf16 v[160:163], v[36:39], a[144:147], v[160:163]
    ds_read_b64_tr_b16 v[28:29], v8 offset:24584
    v_mfma_f32_16x16x32_bf16 v[164:167], v[32:35], a[132:135], v[164:167]
    ds_read_b64_tr_b16 v[30:31], v8 offset:26632
    v_mfma_f32_16x16x32_bf16 v[164:167], v[36:39], a[148:151], v[164:167]
    buffer_load_dwordx4 a[236:239], v1, s[32:35], s50 offen offset:3072 sc1
    v_mfma_f32_16x16x32_bf16 v[168:171], v[32:35], a[136:139], v[168:171]
    s_mov_b32 s50, 61440
    v_mfma_f32_16x16x32_bf16 v[168:171], v[36:39], a[152:155], v[168:171]
    buffer_load_dwordx4 a[240:243], v1, s[32:35], s50 offen offset:0 sc1
    v_mfma_f32_16x16x32_bf16 v[172:175], v[32:35], a[140:143], v[172:175]
    v_mfma_f32_16x16x32_bf16 v[172:175], v[36:39], a[156:159], v[172:175]
    s_waitcnt lgkmcnt(8)
    ds_read_b64_tr_b16 v[32:33], v9 offset:16384
    v_mfma_f32_16x16x32_bf16 v[176:179], v[40:43], a[128:131], v[176:179]
    ds_read_b64_tr_b16 v[34:35], v9 offset:18432
    v_mfma_f32_16x16x32_bf16 v[176:179], v[44:47], a[144:147], v[176:179]
    ds_read_b64_tr_b16 v[36:37], v9 offset:24576
    v_mfma_f32_16x16x32_bf16 v[180:183], v[40:43], a[132:135], v[180:183]
    ds_read_b64_tr_b16 v[38:39], v9 offset:26624
    v_mfma_f32_16x16x32_bf16 v[180:183], v[44:47], a[148:151], v[180:183]
    buffer_load_dwordx4 a[244:247], v1, s[32:35], s50 offen offset:1024 sc1
    v_mfma_f32_16x16x32_bf16 v[184:187], v[40:43], a[136:139], v[184:187]
    v_mfma_f32_16x16x32_bf16 v[184:187], v[44:47], a[152:155], v[184:187]
    v_mfma_f32_16x16x32_bf16 v[188:191], v[40:43], a[140:143], v[188:191]
    v_mfma_f32_16x16x32_bf16 v[188:191], v[44:47], a[156:159], v[188:191]
    s_waitcnt vmcnt(20) lgkmcnt(8)
    ds_read_b64_tr_b16 v[40:41], v9 offset:16392
    v_mfma_f32_16x16x32_bf16 v[224:227], v[16:19], a[160:163], v[224:227]
    ds_read_b64_tr_b16 v[42:43], v9 offset:18440
    v_mfma_f32_16x16x32_bf16 v[224:227], v[20:23], a[176:179], v[224:227]
    ds_read_b64_tr_b16 v[44:45], v9 offset:24584
    v_accvgpr_write_b32 a0, 0
    v_mfma_f32_16x16x32_bf16 v[228:231], v[16:19], a[164:167], v[228:231]
    ds_read_b64_tr_b16 v[46:47], v9 offset:26632
    v_accvgpr_write_b32 a1, 0
    v_mfma_f32_16x16x32_bf16 v[228:231], v[20:23], a[180:183], v[228:231]
    buffer_load_dwordx4 a[248:251], v1, s[32:35], s50 offen offset:2048 sc1
    v_mfma_f32_16x16x32_bf16 v[232:235], v[16:19], a[168:171], v[232:235]
    buffer_load_dwordx4 a[252:255], v1, s[32:35], s50 offen offset:3072 sc1
    v_mfma_f32_16x16x32_bf16 v[232:235], v[20:23], a[184:187], v[232:235]
    s_mov_b32 s50, 65536
    v_accvgpr_write_b32 a2, 0
    v_accvgpr_write_b32 a3, 0
    v_mfma_f32_16x16x32_bf16 v[236:239], v[16:19], a[172:175], v[236:239]
    v_accvgpr_write_b32 a4, 0
    v_accvgpr_write_b32 a5, 0
    v_mfma_f32_16x16x32_bf16 v[236:239], v[20:23], a[188:191], v[236:239]
    s_waitcnt lgkmcnt(8)
    ds_read_b64_tr_b16 v[16:17], v8 offset:20480
    v_mfma_f32_16x16x32_bf16 v[240:243], v[24:27], a[160:163], v[240:243]
    ds_read_b64_tr_b16 v[18:19], v8 offset:22528
    v_accvgpr_write_b32 a6, 0
    v_mfma_f32_16x16x32_bf16 v[240:243], v[28:31], a[176:179], v[240:243]
    ds_read_b64_tr_b16 v[20:21], v8 offset:28672
    v_accvgpr_write_b32 a7, 0
    v_mfma_f32_16x16x32_bf16 v[244:247], v[24:27], a[164:167], v[244:247]
    ds_read_b64_tr_b16 v[22:23], v8 offset:30720
    v_accvgpr_write_b32 a8, 0
    v_mfma_f32_16x16x32_bf16 v[244:247], v[28:31], a[180:183], v[244:247]
    buffer_load_dwordx4 v[64:67], v1, s[32:35], s50 offen offset:0 sc1
    v_mfma_f32_16x16x32_bf16 v[248:251], v[24:27], a[168:171], v[248:251]
    v_accvgpr_write_b32 a9, 0
    v_accvgpr_write_b32 a10, 0
    v_mfma_f32_16x16x32_bf16 v[248:251], v[28:31], a[184:187], v[248:251]
    buffer_load_dwordx4 v[68:71], v1, s[32:35], s50 offen offset:1024 sc1
    v_mfma_f32_16x16x32_bf16 v[252:255], v[24:27], a[172:175], v[252:255]
    v_accvgpr_write_b32 a11, 0
    v_accvgpr_write_b32 a12, 0
    v_mfma_f32_16x16x32_bf16 v[252:255], v[28:31], a[188:191], v[252:255]
    s_waitcnt lgkmcnt(8)
    ds_read_b64_tr_b16 v[24:25], v8 offset:20488
    v_mfma_f32_16x16x32_bf16 v[96:99], v[32:35], a[160:163], v[96:99]
    ds_read_b64_tr_b16 v[26:27], v8 offset:22536
    v_accvgpr_write_b32 a13, 0
    v_mfma_f32_16x16x32_bf16 v[96:99], v[36:39], a[176:179], v[96:99]
    ds_read_b64_tr_b16 v[28:29], v8 offset:28680
    v_accvgpr_write_b32 a14, 0
    v_mfma_f32_16x16x32_bf16 v[100:103], v[32:35], a[164:167], v[100:103]
    ds_read_b64_tr_b16 v[30:31], v8 offset:30728
    v_accvgpr_write_b32 a15, 0
    v_mfma_f32_16x16x32_bf16 v[100:103], v[36:39], a[180:183], v[100:103]
    buffer_load_dwordx4 v[72:75], v1, s[32:35], s50 offen offset:2048 sc1
    v_mfma_f32_16x16x32_bf16 v[104:107], v[32:35], a[168:171], v[104:107]
    v_accvgpr_write_b32 a16, 0
    v_accvgpr_write_b32 a17, 0
    v_mfma_f32_16x16x32_bf16 v[104:107], v[36:39], a[184:187], v[104:107]
    v_accvgpr_write_b32 a18, 0
    v_accvgpr_write_b32 a19, 0
    v_mfma_f32_16x16x32_bf16 v[108:111], v[32:35], a[172:175], v[108:111]
    v_accvgpr_write_b32 a20, 0
    v_accvgpr_write_b32 a21, 0
    v_mfma_f32_16x16x32_bf16 v[108:111], v[36:39], a[188:191], v[108:111]
    s_waitcnt lgkmcnt(8)
    ds_read_b64_tr_b16 v[32:33], v9 offset:20480
    v_mfma_f32_16x16x32_bf16 v[112:115], v[40:43], a[160:163], v[112:115]
    ds_read_b64_tr_b16 v[34:35], v9 offset:22528
    v_accvgpr_write_b32 a22, 0
    v_mfma_f32_16x16x32_bf16 v[112:115], v[44:47], a[176:179], v[112:115]
    ds_read_b64_tr_b16 v[36:37], v9 offset:28672
    v_accvgpr_write_b32 a23, 0
    v_mfma_f32_16x16x32_bf16 v[116:119], v[40:43], a[164:167], v[116:119]
    ds_read_b64_tr_b16 v[38:39], v9 offset:30720
    v_accvgpr_write_b32 a24, 0
    v_mfma_f32_16x16x32_bf16 v[116:119], v[44:47], a[180:183], v[116:119]
    buffer_load_dwordx4 v[76:79], v1, s[32:35], s50 offen offset:3072 sc1
    v_mfma_f32_16x16x32_bf16 v[120:123], v[40:43], a[168:171], v[120:123]
    s_mov_b32 s50, 69632
    v_accvgpr_write_b32 a25, 0
    v_accvgpr_write_b32 a26, 0
    v_mfma_f32_16x16x32_bf16 v[120:123], v[44:47], a[184:187], v[120:123]
    buffer_load_dwordx4 v[80:83], v1, s[32:35], s50 offen offset:0 sc1
    v_mfma_f32_16x16x32_bf16 v[124:127], v[40:43], a[172:175], v[124:127]
    v_accvgpr_write_b32 a27, 0
    v_accvgpr_write_b32 a28, 0
    v_mfma_f32_16x16x32_bf16 v[124:127], v[44:47], a[188:191], v[124:127]
    s_waitcnt lgkmcnt(8)
    ds_read_b64_tr_b16 v[40:41], v9 offset:20488
    v_mfma_f32_16x16x32_bf16 v[128:131], v[16:19], a[160:163], v[128:131]
    ds_read_b64_tr_b16 v[42:43], v9 offset:22536
    v_accvgpr_write_b32 a29, 0
    v_mfma_f32_16x16x32_bf16 v[128:131], v[20:23], a[176:179], v[128:131]
    ds_read_b64_tr_b16 v[44:45], v9 offset:28680
    v_accvgpr_write_b32 a30, 0
    v_mfma_f32_16x16x32_bf16 v[132:135], v[16:19], a[164:167], v[132:135]
    ds_read_b64_tr_b16 v[46:47], v9 offset:30728
    v_accvgpr_write_b32 a31, 0
    v_mfma_f32_16x16x32_bf16 v[132:135], v[20:23], a[180:183], v[132:135]
    buffer_load_dwordx4 v[84:87], v1, s[32:35], s50 offen offset:1024 sc1
    v_mfma_f32_16x16x32_bf16 v[136:139], v[16:19], a[168:171], v[136:139]
    v_accvgpr_write_b32 a32, 0
    v_accvgpr_write_b32 a33, 0
    v_mfma_f32_16x16x32_bf16 v[136:139], v[20:23], a[184:187], v[136:139]
    buffer_load_dwordx4 v[88:91], v1, s[32:35], s50 offen offset:2048 sc1
    v_mfma_f32_16x16x32_bf16 v[140:143], v[16:19], a[172:175], v[140:143]
    s_waitcnt vmcnt(39)
    s_barrier
    v_accvgpr_write_b32 a34, 0
    v_mfma_f32_16x16x32_bf16 v[140:143], v[20:23], a[188:191], v[140:143]
    s_waitcnt lgkmcnt(8)
    ds_read_b64_tr_b16 v[16:17], v8 offset:32768
    v_mfma_f32_16x16x32_bf16 v[144:147], v[24:27], a[160:163], v[144:147]
    ds_read_b64_tr_b16 v[18:19], v8 offset:34816
    v_accvgpr_write_b32 a35, 0
    v_mfma_f32_16x16x32_bf16 v[144:147], v[28:31], a[176:179], v[144:147]
    ds_read_b64_tr_b16 v[20:21], v8 offset:40960
    v_accvgpr_write_b32 a36, 0
    v_mfma_f32_16x16x32_bf16 v[148:151], v[24:27], a[164:167], v[148:151]
    ds_read_b64_tr_b16 v[22:23], v8 offset:43008
    v_accvgpr_write_b32 a37, 0
    v_mfma_f32_16x16x32_bf16 v[148:151], v[28:31], a[180:183], v[148:151]
    buffer_load_dwordx4 v[92:95], v1, s[32:35], s50 offen offset:3072 sc1
    v_mfma_f32_16x16x32_bf16 v[152:155], v[24:27], a[168:171], v[152:155]
    s_or_b32 s3, s40, s41
    s_lshl_b32 s3, s3, 20
    s_add_u32 s91, s91, s3
    v_mfma_f32_16x16x32_bf16 v[152:155], v[28:31], a[184:187], v[152:155]
    buffer_store_dword v61, v62, s[60:63], s91 offen sc1
    v_mfma_f32_16x16x32_bf16 v[156:159], v[24:27], a[172:175], v[156:159]
    s_add_u32 m0, s44, 0
    s_mov_b32 s49, 0
    v_accvgpr_write_b32 a38, 0
    v_mfma_f32_16x16x32_bf16 v[156:159], v[28:31], a[188:191], v[156:159]
    s_waitcnt lgkmcnt(8)
    ds_read_b64_tr_b16 v[24:25], v8 offset:32776
    v_mfma_f32_16x16x32_bf16 v[160:163], v[32:35], a[160:163], v[160:163]
    ds_read_b64_tr_b16 v[26:27], v8 offset:34824
    v_accvgpr_write_b32 a39, 0
    v_mfma_f32_16x16x32_bf16 v[160:163], v[36:39], a[176:179], v[160:163]
    ds_read_b64_tr_b16 v[28:29], v8 offset:40968
    v_accvgpr_write_b32 a40, 0
    v_mfma_f32_16x16x32_bf16 v[164:167], v[32:35], a[164:167], v[164:167]
    ds_read_b64_tr_b16 v[30:31], v8 offset:43016
    v_accvgpr_write_b32 a41, 0
    v_mfma_f32_16x16x32_bf16 v[164:167], v[36:39], a[180:183], v[164:167]
    buffer_load_dwordx4 v5, s[8:11], s49 offen offset:0 lds
    v_mfma_f32_16x16x32_bf16 v[168:171], v[32:35], a[168:171], v[168:171]
    v_accvgpr_write_b32 a42, 0
    v_accvgpr_write_b32 a43, 0
    v_mfma_f32_16x16x32_bf16 v[168:171], v[36:39], a[184:187], v[168:171]
    buffer_load_dwordx4 v5, s[8:11], s49 offen offset:1024 lds
    v_mfma_f32_16x16x32_bf16 v[172:175], v[32:35], a[172:175], v[172:175]
    v_accvgpr_write_b32 a44, 0
    v_accvgpr_write_b32 a45, 0
    v_mfma_f32_16x16x32_bf16 v[172:175], v[36:39], a[188:191], v[172:175]
    s_waitcnt lgkmcnt(8)
    ds_read_b64_tr_b16 v[32:33], v9 offset:32768
    v_mfma_f32_16x16x32_bf16 v[176:179], v[40:43], a[160:163], v[176:179]
    ds_read_b64_tr_b16 v[34:35], v9 offset:34816
    v_accvgpr_write_b32 a46, 0
    v_mfma_f32_16x16x32_bf16 v[176:179], v[44:47], a[176:179], v[176:179]
    ds_read_b64_tr_b16 v[36:37], v9 offset:40960
    v_accvgpr_write_b32 a47, 0
    v_mfma_f32_16x16x32_bf16 v[180:183], v[40:43], a[164:167], v[180:183]
    ds_read_b64_tr_b16 v[38:39], v9 offset:43008
    v_accvgpr_write_b32 a48, 0
    v_mfma_f32_16x16x32_bf16 v[180:183], v[44:47], a[180:183], v[180:183]
    v_accvgpr_write_b32 a49, 0
    v_accvgpr_write_b32 a50, 0
    v_mfma_f32_16x16x32_bf16 v[184:187], v[40:43], a[168:171], v[184:187]
    buffer_load_dwordx4 v5, s[8:11], s49 offen offset:2048 lds
    v_mfma_f32_16x16x32_bf16 v[184:187], v[44:47], a[184:187], v[184:187]
    v_accvgpr_write_b32 a51, 0
    v_accvgpr_write_b32 a52, 0
    v_mfma_f32_16x16x32_bf16 v[188:191], v[40:43], a[172:175], v[188:191]
    v_accvgpr_write_b32 a53, 0
    v_accvgpr_write_b32 a54, 0
    v_mfma_f32_16x16x32_bf16 v[188:191], v[44:47], a[188:191], v[188:191]
    s_waitcnt vmcnt(22) lgkmcnt(8)
    ds_read_b64_tr_b16 v[40:41], v9 offset:32776
    v_mfma_f32_16x16x32_bf16 v[224:227], v[16:19], a[192:195], v[224:227]
    ds_read_b64_tr_b16 v[42:43], v9 offset:34824
    v_accvgpr_write_b32 a55, 0
    v_mfma_f32_16x16x32_bf16 v[224:227], v[20:23], a[208:211], v[224:227]
    ds_read_b64_tr_b16 v[44:45], v9 offset:40968
    v_accvgpr_write_b32 a56, 0
    v_mfma_f32_16x16x32_bf16 v[228:231], v[16:19], a[196:199], v[228:231]
    ds_read_b64_tr_b16 v[46:47], v9 offset:43016
    v_accvgpr_write_b32 a57, 0
    v_mfma_f32_16x16x32_bf16 v[228:231], v[20:23], a[212:215], v[228:231]
    buffer_load_dwordx4 v5, s[8:11], s49 offen offset:3072 lds
    v_mfma_f32_16x16x32_bf16 v[232:235], v[16:19], a[200:203], v[232:235]
    v_accvgpr_write_b32 a58, 0
    v_accvgpr_write_b32 a59, 0
    v_mfma_f32_16x16x32_bf16 v[232:235], v[20:23], a[216:219], v[232:235]
    v_accvgpr_write_b32 a60, 0
    v_accvgpr_write_b32 a61, 0
    v_mfma_f32_16x16x32_bf16 v[236:239], v[16:19], a[204:207], v[236:239]
    v_accvgpr_write_b32 a62, 0
    v_accvgpr_write_b32 a63, 0
    v_mfma_f32_16x16x32_bf16 v[236:239], v[20:23], a[220:223], v[236:239]
    s_waitcnt lgkmcnt(8)
    ds_read_b64_tr_b16 v[16:17], v8 offset:36864
    v_mfma_f32_16x16x32_bf16 v[240:243], v[24:27], a[192:195], v[240:243]
    s_add_u32 m0, s44, 16384
    ds_read_b64_tr_b16 v[18:19], v8 offset:38912
    v_mfma_f32_16x16x32_bf16 v[240:243], v[28:31], a[208:211], v[240:243]
    s_mov_b32 s49, 16384
    ds_read_b64_tr_b16 v[20:21], v8 offset:45056
    v_mfma_f32_16x16x32_bf16 v[244:247], v[24:27], a[196:199], v[244:247]
    ds_read_b64_tr_b16 v[22:23], v8 offset:47104
    v_accvgpr_write_b32 a64, 0
    v_mfma_f32_16x16x32_bf16 v[244:247], v[28:31], a[212:215], v[244:247]
    buffer_load_dwordx4 v5, s[8:11], s49 offen offset:0 lds
    v_mfma_f32_16x16x32_bf16 v[248:251], v[24:27], a[200:203], v[248:251]
    v_accvgpr_write_b32 a65, 0
    v_accvgpr_write_b32 a66, 0
    v_mfma_f32_16x16x32_bf16 v[248:251], v[28:31], a[216:219], v[248:251]
    v_accvgpr_write_b32 a67, 0
    v_accvgpr_write_b32 a68, 0
    v_mfma_f32_16x16x32_bf16 v[252:255], v[24:27], a[204:207], v[252:255]
    v_accvgpr_write_b32 a69, 0
    v_accvgpr_write_b32 a70, 0
    v_mfma_f32_16x16x32_bf16 v[252:255], v[28:31], a[220:223], v[252:255]
    s_waitcnt lgkmcnt(8)
    ds_read_b64_tr_b16 v[24:25], v8 offset:36872
    v_mfma_f32_16x16x32_bf16 v[96:99], v[32:35], a[192:195], v[96:99]
    ds_read_b64_tr_b16 v[26:27], v8 offset:38920
    v_accvgpr_write_b32 a71, 0
    v_mfma_f32_16x16x32_bf16 v[96:99], v[36:39], a[208:211], v[96:99]
    ds_read_b64_tr_b16 v[28:29], v8 offset:45064
    v_accvgpr_write_b32 a72, 0
    v_mfma_f32_16x16x32_bf16 v[100:103], v[32:35], a[196:199], v[100:103]
    ds_read_b64_tr_b16 v[30:31], v8 offset:47112
    v_accvgpr_write_b32 a73, 0
    v_mfma_f32_16x16x32_bf16 v[100:103], v[36:39], a[212:215], v[100:103]
    buffer_load_dwordx4 v5, s[8:11], s49 offen offset:1024 lds
    v_mfma_f32_16x16x32_bf16 v[104:107], v[32:35], a[200:203], v[104:107]
    v_accvgpr_write_b32 a74, 0
    v_accvgpr_write_b32 a75, 0
    v_mfma_f32_16x16x32_bf16 v[104:107], v[36:39], a[216:219], v[104:107]
    v_accvgpr_write_b32 a76, 0
    v_accvgpr_write_b32 a77, 0
    v_mfma_f32_16x16x32_bf16 v[108:111], v[32:35], a[204:207], v[108:111]
    v_accvgpr_write_b32 a78, 0
    v_accvgpr_write_b32 a79, 0
    v_mfma_f32_16x16x32_bf16 v[108:111], v[36:39], a[220:223], v[108:111]
    s_waitcnt lgkmcnt(8)
    ds_read_b64_tr_b16 v[32:33], v9 offset:36864
    v_mfma_f32_16x16x32_bf16 v[112:115], v[40:43], a[192:195], v[112:115]
    ds_read_b64_tr_b16 v[34:35], v9 offset:38912
    v_accvgpr_write_b32 a80, 0
    v_mfma_f32_16x16x32_bf16 v[112:115], v[44:47], a[208:211], v[112:115]
    ds_read_b64_tr_b16 v[36:37], v9 offset:45056
    v_accvgpr_write_b32 a81, 0
    v_mfma_f32_16x16x32_bf16 v[116:119], v[40:43], a[196:199], v[116:119]
    ds_read_b64_tr_b16 v[38:39], v9 offset:47104
    v_accvgpr_write_b32 a82, 0
    v_mfma_f32_16x16x32_bf16 v[116:119], v[44:47], a[212:215], v[116:119]
    buffer_load_dwordx4 v5, s[8:11], s49 offen offset:2048 lds
    v_mfma_f32_16x16x32_bf16 v[120:123], v[40:43], a[200:203], v[120:123]
    v_accvgpr_write_b32 a83, 0
    v_accvgpr_write_b32 a84, 0
    v_mfma_f32_16x16x32_bf16 v[120:123], v[44:47], a[216:219], v[120:123]
    v_accvgpr_write_b32 a85, 0
    v_accvgpr_write_b32 a86, 0
    v_mfma_f32_16x16x32_bf16 v[124:127], v[40:43], a[204:207], v[124:127]
    v_accvgpr_write_b32 a87, 0
    v_accvgpr_write_b32 a88, 0
    v_mfma_f32_16x16x32_bf16 v[124:127], v[44:47], a[220:223], v[124:127]
    s_waitcnt lgkmcnt(8)
    ds_read_b64_tr_b16 v[40:41], v9 offset:36872
    v_mfma_f32_16x16x32_bf16 v[128:131], v[16:19], a[192:195], v[128:131]
    ds_read_b64_tr_b16 v[42:43], v9 offset:38920
    v_accvgpr_write_b32 a89, 0
    v_mfma_f32_16x16x32_bf16 v[128:131], v[20:23], a[208:211], v[128:131]
    ds_read_b64_tr_b16 v[44:45], v9 offset:45064
    v_accvgpr_write_b32 a90, 0
    v_mfma_f32_16x16x32_bf16 v[132:135], v[16:19], a[196:199], v[132:135]
    ds_read_b64_tr_b16 v[46:47], v9 offset:47112
    v_accvgpr_write_b32 a91, 0
    v_mfma_f32_16x16x32_bf16 v[132:135], v[20:23], a[212:215], v[132:135]
    buffer_load_dwordx4 v5, s[8:11], s49 offen offset:3072 lds
    v_mfma_f32_16x16x32_bf16 v[136:139], v[16:19], a[200:203], v[136:139]
    s_add_u32 m0, s44, 147456
    s_mov_b32 s49, 0
    v_accvgpr_write_b32 a92, 0
    v_mfma_f32_16x16x32_bf16 v[136:139], v[20:23], a[216:219], v[136:139]
    v_accvgpr_write_b32 a93, 0
    v_accvgpr_write_b32 a94, 0
    v_mfma_f32_16x16x32_bf16 v[140:143], v[16:19], a[204:207], v[140:143]
    s_waitcnt vmcnt(25)
    s_barrier
    v_accvgpr_write_b32 a95, 0
    v_mfma_f32_16x16x32_bf16 v[140:143], v[20:23], a[220:223], v[140:143]
    s_waitcnt lgkmcnt(8)
    ds_read_b64_tr_b16 v[16:17], v8 offset:49152
    v_mfma_f32_16x16x32_bf16 v[144:147], v[24:27], a[192:195], v[144:147]
    ds_read_b64_tr_b16 v[18:19], v8 offset:51200
    v_accvgpr_write_b32 a96, 0
    v_mfma_f32_16x16x32_bf16 v[144:147], v[28:31], a[208:211], v[144:147]
    ds_read_b64_tr_b16 v[20:21], v8 offset:57344
    v_accvgpr_write_b32 a97, 0
    v_mfma_f32_16x16x32_bf16 v[148:151], v[24:27], a[196:199], v[148:151]
    ds_read_b64_tr_b16 v[22:23], v8 offset:59392
    v_add_u32 v8, 0x10000, v8
    v_mfma_f32_16x16x32_bf16 v[148:151], v[28:31], a[212:215], v[148:151]
    buffer_load_dwordx4 v6, s[12:15], s49 offen offset:0 lds
    v_mfma_f32_16x16x32_bf16 v[152:155], v[24:27], a[200:203], v[152:155]
    v_accvgpr_write_b32 a98, 0
    v_accvgpr_write_b32 a99, 0
    v_mfma_f32_16x16x32_bf16 v[152:155], v[28:31], a[216:219], v[152:155]
    buffer_load_dwordx4 v6, s[12:15], s49 offen offset:1024 lds
    v_mfma_f32_16x16x32_bf16 v[156:159], v[24:27], a[204:207], v[156:159]
    ds_read_b64_tr_b16 v[24:25], v8 offset:0
    v_accvgpr_write_b32 a100, 0
    v_mfma_f32_16x16x32_bf16 v[156:159], v[28:31], a[220:223], v[156:159]
    s_waitcnt lgkmcnt(9)
    ds_read_b64_tr_b16 v[26:27], v8 offset:2048
    v_mfma_f32_16x16x32_bf16 v[160:163], v[32:35], a[192:195], v[160:163]
    ds_read_b64_tr_b16 v[28:29], v8 offset:8192
    v_accvgpr_write_b32 a101, 0
    v_mfma_f32_16x16x32_bf16 v[160:163], v[36:39], a[208:211], v[160:163]
    ds_read_b64_tr_b16 v[30:31], v8 offset:10240
    v_add_u32 v8, 0xffffc000, v8
    v_mfma_f32_16x16x32_bf16 v[164:167], v[32:35], a[196:199], v[164:167]
    v_accvgpr_write_b32 a102, 0
    v_accvgpr_write_b32 a103, 0
    v_mfma_f32_16x16x32_bf16 v[164:167], v[36:39], a[212:215], v[164:167]
    v_accvgpr_write_b32 a104, 0
    v_accvgpr_write_b32 a105, 0
    v_mfma_f32_16x16x32_bf16 v[168:171], v[32:35], a[200:203], v[168:171]
    buffer_load_dwordx4 v6, s[12:15], s49 offen offset:2048 lds
    v_mfma_f32_16x16x32_bf16 v[168:171], v[36:39], a[216:219], v[168:171]
    v_accvgpr_write_b32 a106, 0
    v_accvgpr_write_b32 a107, 0
    v_mfma_f32_16x16x32_bf16 v[172:175], v[32:35], a[204:207], v[172:175]
    v_accvgpr_write_b32 a108, 0
    v_accvgpr_write_b32 a109, 0
    v_mfma_f32_16x16x32_bf16 v[172:175], v[36:39], a[220:223], v[172:175]
    s_waitcnt lgkmcnt(8)
    ds_read_b64_tr_b16 v[32:33], v8 offset:8
    v_mfma_f32_16x16x32_bf16 v[176:179], v[40:43], a[192:195], v[176:179]
    ds_read_b64_tr_b16 v[34:35], v8 offset:2056
    v_accvgpr_write_b32 a110, 0
    v_mfma_f32_16x16x32_bf16 v[176:179], v[44:47], a[208:211], v[176:179]
    ds_read_b64_tr_b16 v[36:37], v8 offset:8200
    v_accvgpr_write_b32 a111, 0
    v_mfma_f32_16x16x32_bf16 v[180:183], v[40:43], a[196:199], v[180:183]
    ds_read_b64_tr_b16 v[38:39], v8 offset:10248
    v_accvgpr_write_b32 a112, 0
    v_mfma_f32_16x16x32_bf16 v[180:183], v[44:47], a[212:215], v[180:183]
    buffer_load_dwordx4 v6, s[12:15], s49 offen offset:3072 lds
    v_mfma_f32_16x16x32_bf16 v[184:187], v[40:43], a[200:203], v[184:187]
    v_accvgpr_write_b32 a113, 0
    v_accvgpr_write_b32 a114, 0
    v_mfma_f32_16x16x32_bf16 v[184:187], v[44:47], a[216:219], v[184:187]
    v_accvgpr_write_b32 a115, 0
    v_accvgpr_write_b32 a116, 0
    v_mfma_f32_16x16x32_bf16 v[188:191], v[40:43], a[204:207], v[188:191]
    ds_read_b64_tr_b16 v[40:41], v8 offset:16392
    v_accvgpr_write_b32 a117, 0
    v_mfma_f32_16x16x32_bf16 v[188:191], v[44:47], a[220:223], v[188:191]
    s_waitcnt vmcnt(13) lgkmcnt(5)
    ds_read_b64_tr_b16 v[42:43], v8 offset:18440
    v_mfma_f32_16x16x32_bf16 v[224:227], v[16:19], a[224:227], v[224:227]
    s_add_u32 m0, s44, 32768
    ds_read_b64_tr_b16 v[44:45], v8 offset:24584
    v_mfma_f32_16x16x32_bf16 v[224:227], v[20:23], a[240:243], v[224:227]
    s_mov_b32 s49, 32768
    ds_read_b64_tr_b16 v[46:47], v8 offset:26632
    v_mfma_f32_16x16x32_bf16 v[224:227], v[24:27], v[64:67], v[224:227]
    buffer_load_dwordx4 v5, s[8:11], s49 offen offset:0 lds
    v_mfma_f32_16x16x32_bf16 v[224:227], v[28:31], v[80:83], v[224:227]
    v_accvgpr_write_b32 a118, 0
    v_accvgpr_write_b32 a119, 0
    v_mfma_f32_16x16x32_bf16 v[228:231], v[16:19], a[228:231], v[228:231]
    v_accvgpr_write_b32 a120, 0
    v_accvgpr_write_b32 a121, 0
    v_mfma_f32_16x16x32_bf16 v[228:231], v[20:23], a[244:247], v[228:231]
    v_accvgpr_write_b32 a122, 0
    v_accvgpr_write_b32 a123, 0
    v_mfma_f32_16x16x32_bf16 v[228:231], v[24:27], v[68:71], v[228:231]
    v_accvgpr_write_b32 a124, 0
    v_accvgpr_write_b32 a125, 0
    v_mfma_f32_16x16x32_bf16 v[228:231], v[28:31], v[84:87], v[228:231]
    v_accvgpr_write_b32 a126, 0
    v_accvgpr_write_b32 a127, 0
    v_mfma_f32_16x16x32_bf16 v[232:235], v[16:19], a[232:235], v[232:235]
    v_accvgpr_write_b32 a128, 0
    v_accvgpr_write_b32 a129, 0
    v_mfma_f32_16x16x32_bf16 v[232:235], v[20:23], a[248:251], v[232:235]
    buffer_load_dwordx4 v5, s[8:11], s49 offen offset:1024 lds
    v_mfma_f32_16x16x32_bf16 v[232:235], v[24:27], v[72:75], v[232:235]
    v_accvgpr_write_b32 a130, 0
    v_accvgpr_write_b32 a131, 0
    v_mfma_f32_16x16x32_bf16 v[232:235], v[28:31], v[88:91], v[232:235]
    v_accvgpr_write_b32 a132, 0
    v_accvgpr_write_b32 a133, 0
    v_mfma_f32_16x16x32_bf16 v[236:239], v[16:19], a[236:239], v[236:239]
    ds_read_b64_tr_b16 v[16:17], v9 offset:49152
    v_accvgpr_write_b32 a134, 0
    v_mfma_f32_16x16x32_bf16 v[236:239], v[20:23], a[252:255], v[236:239]
    ds_read_b64_tr_b16 v[18:19], v9 offset:51200
    v_accvgpr_write_b32 a135, 0
    v_mfma_f32_16x16x32_bf16 v[236:239], v[24:27], v[76:79], v[236:239]
    ds_read_b64_tr_b16 v[20:21], v9 offset:57344
    v_accvgpr_write_b32 a136, 0
    v_mfma_f32_16x16x32_bf16 v[236:239], v[28:31], v[92:95], v[236:239]
    s_waitcnt lgkmcnt(3)
    ds_read_b64_tr_b16 v[22:23], v9 offset:59392
    v_mfma_f32_16x16x32_bf16 v[240:243], v[32:35], a[224:227], v[240:243]
    v_add_u32 v9, 0x10000, v9
    v_accvgpr_write_b32 a137, 0
    v_mfma_f32_16x16x32_bf16 v[240:243], v[36:39], a[240:243], v[240:243]
    ds_read_b64_tr_b16 v[24:25], v9 offset:0
    v_accvgpr_write_b32 a138, 0
    v_mfma_f32_16x16x32_bf16 v[240:243], v[40:43], v[64:67], v[240:243]
    ds_read_b64_tr_b16 v[26:27], v9 offset:2048
    v_accvgpr_write_b32 a139, 0
    v_mfma_f32_16x16x32_bf16 v[240:243], v[44:47], v[80:83], v[240:243]
    ds_read_b64_tr_b16 v[28:29], v9 offset:8192
    v_accvgpr_write_b32 a140, 0
    v_mfma_f32_16x16x32_bf16 v[244:247], v[32:35], a[228:231], v[244:247]
    ds_read_b64_tr_b16 v[30:31], v9 offset:10240
    v_add_u32 v9, 0xffffc000, v9
    v_mfma_f32_16x16x32_bf16 v[244:247], v[36:39], a[244:247], v[244:247]
    buffer_load_dwordx4 v5, s[8:11], s49 offen offset:2048 lds
    v_mfma_f32_16x16x32_bf16 v[244:247], v[40:43], v[68:71], v[244:247]
    v_accvgpr_write_b32 a141, 0
    v_accvgpr_write_b32 a142, 0
    v_mfma_f32_16x16x32_bf16 v[244:247], v[44:47], v[84:87], v[244:247]
    buffer_load_dwordx4 v5, s[8:11], s49 offen offset:3072 lds
    v_mfma_f32_16x16x32_bf16 v[248:251], v[32:35], a[232:235], v[248:251]
    v_accvgpr_write_b32 a143, 0
    v_mov_b32 v12, 0x3f803f80
    v_mfma_f32_16x16x32_bf16 v[248:251], v[36:39], a[248:251], v[248:251]
    v_and_b32 v13, 3, v0
    v_add_u32 v13, -2, v13
    v_mfma_f32_16x16x32_bf16 v[248:251], v[40:43], v[72:75], v[248:251]
    v_ashrrev_i32 v13, 31, v13
    v_and_b32 v12, v12, v13
    v_mfma_f32_16x16x32_bf16 v[248:251], v[44:47], v[88:91], v[248:251]
    v_accvgpr_write_b32 a144, v12
    v_accvgpr_write_b32 a145, v12
    v_mfma_f32_16x16x32_bf16 v[252:255], v[32:35], a[236:239], v[252:255]
    ds_read_b64_tr_b16 v[32:33], v9 offset:8
    v_accvgpr_write_b32 a146, v12
    v_mfma_f32_16x16x32_bf16 v[252:255], v[36:39], a[252:255], v[252:255]
    ds_read_b64_tr_b16 v[34:35], v9 offset:2056
    v_accvgpr_write_b32 a147, v12
    v_mfma_f32_16x16x32_bf16 v[252:255], v[40:43], v[76:79], v[252:255]
    ds_read_b64_tr_b16 v[36:37], v9 offset:8200
    v_mfma_f32_16x16x32_bf16 v[252:255], v[44:47], v[92:95], v[252:255]
    s_waitcnt lgkmcnt(3)
    ds_read_b64_tr_b16 v[38:39], v9 offset:10248
    v_mfma_f32_16x16x32_bf16 v[96:99], v[16:19], a[224:227], v[96:99]
    ds_read_b64_tr_b16 v[40:41], v9 offset:16392
    v_mfma_f32_16x16x32_bf16 v[96:99], v[20:23], a[240:243], v[96:99]
    ds_read_b64_tr_b16 v[42:43], v9 offset:18440
    v_mfma_f32_16x16x32_bf16 v[96:99], v[24:27], v[64:67], v[96:99]
    ds_read_b64_tr_b16 v[44:45], v9 offset:24584
    v_mfma_f32_16x16x32_bf16 v[96:99], v[28:31], v[80:83], v[96:99]
    ds_read_b64_tr_b16 v[46:47], v9 offset:26632
    v_mfma_f32_16x16x32_bf16 v[100:103], v[16:19], a[228:231], v[100:103]
    v_mfma_f32_16x16x32_bf16 v[100:103], v[20:23], a[244:247], v[100:103]
    v_mfma_f32_16x16x32_bf16 v[100:103], v[24:27], v[68:71], v[100:103]
    v_mfma_f32_16x16x32_bf16 v[100:103], v[28:31], v[84:87], v[100:103]
    v_mfma_f32_16x16x32_bf16 v[104:107], v[16:19], a[232:235], v[104:107]
    v_mul_f32 v224, s55, v224
    v_mul_f32 v225, s55, v225
    v_mfma_f32_16x16x32_bf16 v[104:107], v[20:23], a[248:251], v[104:107]
    v_mul_f32 v226, s55, v226
    v_mul_f32 v227, s55, v227
    v_mfma_f32_16x16x32_bf16 v[104:107], v[24:27], v[72:75], v[104:107]
    v_mul_f32 v240, s55, v240
    v_mul_f32 v241, s55, v241
    v_mfma_f32_16x16x32_bf16 v[104:107], v[28:31], v[88:91], v[104:107]
    v_mul_f32 v242, s55, v242
    v_mul_f32 v243, s55, v243
    v_mfma_f32_16x16x32_bf16 v[108:111], v[16:19], a[236:239], v[108:111]
    ds_read_b64_tr_b16 v[16:17], v8 offset:4096
    v_cvt_pk_bf16_f32 v224, v224, v225
    v_mfma_f32_16x16x32_bf16 v[108:111], v[20:23], a[252:255], v[108:111]
    ds_read_b64_tr_b16 v[18:19], v8 offset:6144
    v_cvt_pk_bf16_f32 v225, v226, v227
    v_mfma_f32_16x16x32_bf16 v[108:111], v[24:27], v[76:79], v[108:111]
    ds_read_b64_tr_b16 v[20:21], v8 offset:12288
    v_cvt_pk_bf16_f32 v226, v240, v241
    v_mfma_f32_16x16x32_bf16 v[108:111], v[28:31], v[92:95], v[108:111]
    s_waitcnt lgkmcnt(3)
    ds_read_b64_tr_b16 v[22:23], v8 offset:14336
    v_mfma_f32_16x16x32_bf16 v[112:115], v[32:35], a[224:227], v[112:115]
    ds_read_b64_tr_b16 v[24:25], v8 offset:20480
    v_cvt_pk_bf16_f32 v227, v242, v243
    v_mfma_f32_16x16x32_bf16 v[112:115], v[36:39], a[240:243], v[112:115]
    ds_read_b64_tr_b16 v[26:27], v8 offset:22528
    v_mul_f32 v228, s55, v228
    v_mfma_f32_16x16x32_bf16 v[112:115], v[40:43], v[64:67], v[112:115]
    ds_read_b64_tr_b16 v[28:29], v8 offset:28672
    v_mul_f32 v229, s55, v229
    v_mfma_f32_16x16x32_bf16 v[112:115], v[44:47], v[80:83], v[112:115]
    ds_read_b64_tr_b16 v[30:31], v8 offset:30720
    v_mul_f32 v230, s55, v230
    v_mfma_f32_16x16x32_bf16 v[116:119], v[32:35], a[228:231], v[116:119]
    v_mul_f32 v231, s55, v231
    v_mul_f32 v244, s55, v244
    v_mfma_f32_16x16x32_bf16 v[116:119], v[36:39], a[244:247], v[116:119]
    v_mul_f32 v245, s55, v245
    v_mul_f32 v246, s55, v246
    v_mfma_f32_16x16x32_bf16 v[116:119], v[40:43], v[68:71], v[116:119]
    v_mul_f32 v247, s55, v247
    v_cvt_pk_bf16_f32 v228, v228, v229
    v_mfma_f32_16x16x32_bf16 v[116:119], v[44:47], v[84:87], v[116:119]
    v_cvt_pk_bf16_f32 v229, v230, v231
    v_cvt_pk_bf16_f32 v230, v244, v245
    v_mfma_f32_16x16x32_bf16 v[120:123], v[32:35], a[232:235], v[120:123]
    v_cvt_pk_bf16_f32 v231, v246, v247
    v_mul_f32 v232, s55, v232
    v_mfma_f32_16x16x32_bf16 v[120:123], v[36:39], a[248:251], v[120:123]
    v_mul_f32 v233, s55, v233
    v_mul_f32 v234, s55, v234
    v_mfma_f32_16x16x32_bf16 v[120:123], v[40:43], v[72:75], v[120:123]
    v_mul_f32 v235, s55, v235
    v_mul_f32 v248, s55, v248
    v_mfma_f32_16x16x32_bf16 v[120:123], v[44:47], v[88:91], v[120:123]
    v_mul_f32 v249, s55, v249
    v_mul_f32 v250, s55, v250
    v_mfma_f32_16x16x32_bf16 v[124:127], v[32:35], a[236:239], v[124:127]
    ds_read_b64_tr_b16 v[32:33], v8 offset:4104
    v_mul_f32 v251, s55, v251
    v_mfma_f32_16x16x32_bf16 v[124:127], v[36:39], a[252:255], v[124:127]
    ds_read_b64_tr_b16 v[34:35], v8 offset:6152
    v_cvt_pk_bf16_f32 v232, v232, v233
    v_mfma_f32_16x16x32_bf16 v[124:127], v[40:43], v[76:79], v[124:127]
    ds_read_b64_tr_b16 v[36:37], v8 offset:12296
    v_cvt_pk_bf16_f32 v233, v234, v235
    v_mfma_f32_16x16x32_bf16 v[124:127], v[44:47], v[92:95], v[124:127]
    s_waitcnt lgkmcnt(3)
    ds_read_b64_tr_b16 v[38:39], v8 offset:14344
    v_mfma_f32_16x16x32_bf16 v[128:131], v[16:19], a[224:227], v[128:131]
    ds_read_b64_tr_b16 v[40:41], v8 offset:20488
    v_cvt_pk_bf16_f32 v234, v248, v249
    v_mfma_f32_16x16x32_bf16 v[128:131], v[20:23], a[240:243], v[128:131]
    ds_read_b64_tr_b16 v[42:43], v8 offset:22536
    v_cvt_pk_bf16_f32 v235, v250, v251
    v_mfma_f32_16x16x32_bf16 v[128:131], v[24:27], v[64:67], v[128:131]
    ds_read_b64_tr_b16 v[44:45], v8 offset:28680
    v_mul_f32 v236, s55, v236
    v_mfma_f32_16x16x32_bf16 v[128:131], v[28:31], v[80:83], v[128:131]
    ds_read_b64_tr_b16 v[46:47], v8 offset:30728
    v_mul_f32 v237, s55, v237
    v_mfma_f32_16x16x32_bf16 v[132:135], v[16:19], a[228:231], v[132:135]
    v_mul_f32 v238, s55, v238
    v_mul_f32 v239, s55, v239
    v_mfma_f32_16x16x32_bf16 v[132:135], v[20:23], a[244:247], v[132:135]
    v_mul_f32 v252, s55, v252
    v_mul_f32 v253, s55, v253
    v_mfma_f32_16x16x32_bf16 v[132:135], v[24:27], v[68:71], v[132:135]
    v_mul_f32 v254, s55, v254
    v_mul_f32 v255, s55, v255
    v_mfma_f32_16x16x32_bf16 v[132:135], v[28:31], v[84:87], v[132:135]
    v_cvt_pk_bf16_f32 v236, v236, v237
    v_cvt_pk_bf16_f32 v237, v238, v239
    v_mfma_f32_16x16x32_bf16 v[136:139], v[16:19], a[232:235], v[136:139]
    v_cvt_pk_bf16_f32 v238, v252, v253
    v_cvt_pk_bf16_f32 v239, v254, v255
    v_mfma_f32_16x16x32_bf16 v[136:139], v[20:23], a[248:251], v[136:139]
    v_mul_f32 v96, s55, v96
    v_mul_f32 v97, s55, v97
    v_mfma_f32_16x16x32_bf16 v[136:139], v[24:27], v[72:75], v[136:139]
    v_mul_f32 v98, s55, v98
    v_mul_f32 v99, s55, v99
    v_mfma_f32_16x16x32_bf16 v[136:139], v[28:31], v[88:91], v[136:139]
    v_mul_f32 v112, s55, v112
    v_mul_f32 v113, s55, v113
    v_mfma_f32_16x16x32_bf16 v[140:143], v[16:19], a[236:239], v[140:143]
    ds_read_b64_tr_b16 v[16:17], v9 offset:4096
    v_mul_f32 v114, s55, v114
    v_mfma_f32_16x16x32_bf16 v[140:143], v[20:23], a[252:255], v[140:143]
    ds_read_b64_tr_b16 v[18:19], v9 offset:6144
    v_mul_f32 v115, s55, v115
    v_mfma_f32_16x16x32_bf16 v[140:143], v[24:27], v[76:79], v[140:143]
    ds_read_b64_tr_b16 v[20:21], v9 offset:12288
    v_cvt_pk_bf16_f32 v96, v96, v97
    v_mfma_f32_16x16x32_bf16 v[140:143], v[28:31], v[92:95], v[140:143]
    s_waitcnt lgkmcnt(3)
    ds_read_b64_tr_b16 v[22:23], v9 offset:14336
    v_mfma_f32_16x16x32_bf16 v[144:147], v[32:35], a[224:227], v[144:147]
    ds_read_b64_tr_b16 v[24:25], v9 offset:20480
    v_cvt_pk_bf16_f32 v97, v98, v99
    v_mfma_f32_16x16x32_bf16 v[144:147], v[36:39], a[240:243], v[144:147]
    ds_read_b64_tr_b16 v[26:27], v9 offset:22528
    v_cvt_pk_bf16_f32 v98, v112, v113
    v_mfma_f32_16x16x32_bf16 v[144:147], v[40:43], v[64:67], v[144:147]
    ds_read_b64_tr_b16 v[28:29], v9 offset:28672
    v_cvt_pk_bf16_f32 v99, v114, v115
    v_mfma_f32_16x16x32_bf16 v[144:147], v[44:47], v[80:83], v[144:147]
    ds_read_b64_tr_b16 v[30:31], v9 offset:30720
    v_mul_f32 v100, s55, v100
    v_mfma_f32_16x16x32_bf16 v[148:151], v[32:35], a[228:231], v[148:151]
    v_mul_f32 v101, s55, v101
    v_mul_f32 v102, s55, v102
    v_mfma_f32_16x16x32_bf16 v[148:151], v[36:39], a[244:247], v[148:151]
    v_mul_f32 v103, s55, v103
    v_mul_f32 v116, s55, v116
    v_mfma_f32_16x16x32_bf16 v[148:151], v[40:43], v[68:71], v[148:151]
    v_mul_f32 v117, s55, v117
    v_mul_f32 v118, s55, v118
    v_mfma_f32_16x16x32_bf16 v[148:151], v[44:47], v[84:87], v[148:151]
    v_mul_f32 v119, s55, v119
    v_cvt_pk_bf16_f32 v100, v100, v101
    v_mfma_f32_16x16x32_bf16 v[152:155], v[32:35], a[232:235], v[152:155]
    v_cvt_pk_bf16_f32 v101, v102, v103
    v_cvt_pk_bf16_f32 v102, v116, v117
    v_mfma_f32_16x16x32_bf16 v[152:155], v[36:39], a[248:251], v[152:155]
    v_cvt_pk_bf16_f32 v103, v118, v119
    v_mul_f32 v104, s55, v104
    v_mfma_f32_16x16x32_bf16 v[152:155], v[40:43], v[72:75], v[152:155]
    v_mul_f32 v105, s55, v105
    v_mul_f32 v106, s55, v106
    v_mfma_f32_16x16x32_bf16 v[152:155], v[44:47], v[88:91], v[152:155]
    v_mul_f32 v107, s55, v107
    v_mul_f32 v120, s55, v120
    v_mfma_f32_16x16x32_bf16 v[156:159], v[32:35], a[236:239], v[156:159]
    ds_read_b64_tr_b16 v[32:33], v9 offset:4104
    v_mul_f32 v121, s55, v121
    v_mfma_f32_16x16x32_bf16 v[156:159], v[36:39], a[252:255], v[156:159]
    ds_read_b64_tr_b16 v[34:35], v9 offset:6152
    v_mul_f32 v122, s55, v122
    v_mfma_f32_16x16x32_bf16 v[156:159], v[40:43], v[76:79], v[156:159]
    ds_read_b64_tr_b16 v[36:37], v9 offset:12296
    v_mul_f32 v123, s55, v123
    v_mfma_f32_16x16x32_bf16 v[156:159], v[44:47], v[92:95], v[156:159]
    s_waitcnt lgkmcnt(3)
    ds_read_b64_tr_b16 v[38:39], v9 offset:14344
    v_mfma_f32_16x16x32_bf16 v[160:163], v[16:19], a[224:227], v[160:163]
    ds_read_b64_tr_b16 v[40:41], v9 offset:20488
    v_cvt_pk_bf16_f32 v104, v104, v105
    v_mfma_f32_16x16x32_bf16 v[160:163], v[20:23], a[240:243], v[160:163]
    ds_read_b64_tr_b16 v[42:43], v9 offset:22536
    v_cvt_pk_bf16_f32 v105, v106, v107
    v_mfma_f32_16x16x32_bf16 v[160:163], v[24:27], v[64:67], v[160:163]
    ds_read_b64_tr_b16 v[44:45], v9 offset:28680
    v_cvt_pk_bf16_f32 v106, v120, v121
    v_mfma_f32_16x16x32_bf16 v[160:163], v[28:31], v[80:83], v[160:163]
    ds_read_b64_tr_b16 v[46:47], v9 offset:30728
    v_cvt_pk_bf16_f32 v107, v122, v123
    v_mfma_f32_16x16x32_bf16 v[164:167], v[16:19], a[228:231], v[164:167]
    v_mul_f32 v108, s55, v108
    v_mul_f32 v109, s55, v109
    v_mfma_f32_16x16x32_bf16 v[164:167], v[20:23], a[244:247], v[164:167]
    v_mul_f32 v110, s55, v110
    v_mul_f32 v111, s55, v111
    v_mfma_f32_16x16x32_bf16 v[164:167], v[24:27], v[68:71], v[164:167]
    v_mul_f32 v124, s55, v124
    v_mul_f32 v125, s55, v125
    v_mfma_f32_16x16x32_bf16 v[164:167], v[28:31], v[84:87], v[164:167]
    v_mul_f32 v126, s55, v126
    v_mul_f32 v127, s55, v127
    v_mfma_f32_16x16x32_bf16 v[168:171], v[16:19], a[232:235], v[168:171]
    v_cvt_pk_bf16_f32 v108, v108, v109
    v_cvt_pk_bf16_f32 v109, v110, v111
    v_mfma_f32_16x16x32_bf16 v[168:171], v[20:23], a[248:251], v[168:171]
    v_cvt_pk_bf16_f32 v110, v124, v125
    v_cvt_pk_bf16_f32 v111, v126, v127
    v_mfma_f32_16x16x32_bf16 v[168:171], v[24:27], v[72:75], v[168:171]
    v_mul_f32 v128, s55, v128
    v_mul_f32 v129, s55, v129
    v_mfma_f32_16x16x32_bf16 v[168:171], v[28:31], v[88:91], v[168:171]
    v_mul_f32 v130, s55, v130
    v_mul_f32 v131, s55, v131
    v_mfma_f32_16x16x32_bf16 v[172:175], v[16:19], a[236:239], v[172:175]
    v_mul_f32 v144, s55, v144
    v_mul_f32 v145, s55, v145
    v_mfma_f32_16x16x32_bf16 v[172:175], v[20:23], a[252:255], v[172:175]
    v_mul_f32 v146, s55, v146
    v_mul_f32 v147, s55, v147
    v_mfma_f32_16x16x32_bf16 v[172:175], v[24:27], v[76:79], v[172:175]
    s_waitcnt vmcnt(12)
    s_barrier
    v_cvt_pk_bf16_f32 v128, v128, v129
    v_mfma_f32_16x16x32_bf16 v[172:175], v[28:31], v[92:95], v[172:175]
    s_waitcnt lgkmcnt(0)
    ds_read_b128 v[16:19], v48 offset:0
    v_mfma_f32_16x16x32_bf16 v[176:179], v[32:35], a[224:227], v[176:179]
    ds_read_b128 v[20:23], v48 offset:1024
    v_cvt_pk_bf16_f32 v129, v130, v131
    v_mfma_f32_16x16x32_bf16 v[176:179], v[36:39], a[240:243], v[176:179]
    ds_read_b128 v[24:27], v48 offset:2048
    v_cvt_pk_bf16_f32 v130, v144, v145
    v_mfma_f32_16x16x32_bf16 v[176:179], v[40:43], v[64:67], v[176:179]
    v_cvt_pk_bf16_f32 v131, v146, v147
    v_mul_f32 v132, s55, v132
    v_mfma_f32_16x16x32_bf16 v[176:179], v[44:47], v[80:83], v[176:179]
    ds_read_b128 v[28:31], v48 offset:3072
    v_mul_f32 v133, s55, v133
    v_mfma_f32_16x16x32_bf16 v[180:183], v[32:35], a[228:231], v[180:183]
    v_mul_f32 v134, s55, v134
    v_mul_f32 v135, s55, v135
    v_mfma_f32_16x16x32_bf16 v[180:183], v[36:39], a[244:247], v[180:183]
    v_mul_f32 v148, s55, v148
    v_mul_f32 v149, s55, v149
    v_mfma_f32_16x16x32_bf16 v[180:183], v[40:43], v[68:71], v[180:183]
    v_mul_f32 v150, s55, v150
    v_mul_f32 v151, s55, v151
    v_mfma_f32_16x16x32_bf16 v[180:183], v[44:47], v[84:87], v[180:183]
    v_cvt_pk_bf16_f32 v132, v132, v133
    v_cvt_pk_bf16_f32 v133, v134, v135
    v_mfma_f32_16x16x32_bf16 v[184:187], v[32:35], a[232:235], v[184:187]
    v_cvt_pk_bf16_f32 v134, v148, v149
    v_cvt_pk_bf16_f32 v135, v150, v151
    v_mfma_f32_16x16x32_bf16 v[184:187], v[36:39], a[248:251], v[184:187]
    v_mul_f32 v136, s55, v136
    v_mul_f32 v137, s55, v137
    v_mfma_f32_16x16x32_bf16 v[184:187], v[40:43], v[72:75], v[184:187]
    v_mul_f32 v138, s55, v138
    v_mul_f32 v139, s55, v139
    v_mfma_f32_16x16x32_bf16 v[184:187], v[44:47], v[88:91], v[184:187]
    v_mul_f32 v152, s55, v152
    v_mul_f32 v153, s55, v153
    v_mfma_f32_16x16x32_bf16 v[188:191], v[32:35], a[236:239], v[188:191]
    ds_read_b128 v[32:35], v49 offset:0
    v_mul_f32 v154, s55, v154
    v_mfma_f32_16x16x32_bf16 v[188:191], v[36:39], a[252:255], v[188:191]
    ds_read_b128 v[36:39], v49 offset:1024
    v_mul_f32 v155, s55, v155
    v_mfma_f32_16x16x32_bf16 v[188:191], v[40:43], v[76:79], v[188:191]
    v_cvt_pk_bf16_f32 v136, v136, v137
    v_cvt_pk_bf16_f32 v137, v138, v139
    v_mfma_f32_16x16x32_bf16 v[188:191], v[44:47], v[92:95], v[188:191]
    s_waitcnt lgkmcnt(4)
    ds_read_b128 v[40:43], v49 offset:2048
    v_mfma_f32_16x16x32_bf16 v[192:195], v[16:19], v[224:227], 0
    v_cvt_pk_bf16_f32 v138, v152, v153
    v_cvt_pk_bf16_f32 v139, v154, v155
    v_mfma_f32_16x16x32_bf16 v[200:203], v[16:19], v[228:231], 0
    v_mul_f32 v140, s55, v140
    v_mul_f32 v141, s55, v141
    v_mfma_f32_16x16x32_bf16 v[208:211], v[16:19], v[232:235], 0
    v_mul_f32 v142, s55, v142
    v_mul_f32 v143, s55, v143
    v_mfma_f32_16x16x32_bf16 v[216:219], v[16:19], v[236:239], 0
    ds_read_b128 v[44:47], v49 offset:3072
    v_mul_f32 v156, s55, v156
    v_mfma_f32_16x16x32_bf16 v[196:199], v[20:23], v[224:227], 0
    v_mul_f32 v157, s55, v157
    v_mul_f32 v158, s55, v158
    v_mfma_f32_16x16x32_bf16 v[204:207], v[20:23], v[228:231], 0
    v_mul_f32 v159, s55, v159
    v_cvt_pk_bf16_f32 v140, v140, v141
    v_mfma_f32_16x16x32_bf16 v[212:215], v[20:23], v[232:235], 0
    v_cvt_pk_bf16_f32 v141, v142, v143
    v_cvt_pk_bf16_f32 v142, v156, v157
    v_mfma_f32_16x16x32_bf16 v[220:223], v[20:23], v[236:239], 0
    s_waitcnt lgkmcnt(4)
    ds_read_b128 v[16:19], v50 offset:0
    v_mfma_f32_16x16x32_bf16 v[240:243], v[24:27], v[224:227], 0
    v_cvt_pk_bf16_f32 v143, v158, v159
    v_mul_f32 v160, s55, v160
    v_mfma_f32_16x16x32_bf16 v[248:251], v[24:27], v[228:231], 0
    v_mul_f32 v161, s55, v161
    v_mul_f32 v162, s55, v162
    v_mfma_f32_16x16x32_bf16 v[112:115], v[24:27], v[232:235], 0
    v_mul_f32 v163, s55, v163
    v_mul_f32 v176, s55, v176
    v_mfma_f32_16x16x32_bf16 v[120:123], v[24:27], v[236:239], 0
    ds_read_b128 v[20:23], v50 offset:1024
    v_mul_f32 v177, s55, v177
    v_mfma_f32_16x16x32_bf16 v[244:247], v[28:31], v[224:227], 0
    v_mul_f32 v178, s55, v178
    v_mul_f32 v179, s55, v179
    v_mfma_f32_16x16x32_bf16 v[252:255], v[28:31], v[228:231], 0
    v_cvt_pk_bf16_f32 v160, v160, v161
    v_cvt_pk_bf16_f32 v161, v162, v163
    v_mfma_f32_16x16x32_bf16 v[116:119], v[28:31], v[232:235], 0
    v_cvt_pk_bf16_f32 v162, v176, v177
    v_cvt_pk_bf16_f32 v163, v178, v179
    v_mfma_f32_16x16x32_bf16 v[124:127], v[28:31], v[236:239], 0
    s_waitcnt lgkmcnt(4)
    ds_read_b128 v[24:27], v50 offset:2048
    v_mfma_f32_16x16x32_bf16 v[192:195], v[32:35], v[96:99], v[192:195]
    v_mul_f32 v164, s55, v164
    v_mul_f32 v165, s55, v165
    v_mfma_f32_16x16x32_bf16 v[200:203], v[32:35], v[100:103], v[200:203]
    v_mul_f32 v166, s55, v166
    v_mul_f32 v167, s55, v167
    v_mfma_f32_16x16x32_bf16 v[208:211], v[32:35], v[104:107], v[208:211]
    v_mul_f32 v180, s55, v180
    v_mul_f32 v181, s55, v181
    v_mfma_f32_16x16x32_bf16 v[216:219], v[32:35], v[108:111], v[216:219]
    ds_read_b128 v[28:31], v50 offset:3072
    v_mul_f32 v182, s55, v182
    v_mfma_f32_16x16x32_bf16 v[196:199], v[36:39], v[96:99], v[196:199]
    v_mul_f32 v183, s55, v183
    v_cvt_pk_bf16_f32 v164, v164, v165
    v_mfma_f32_16x16x32_bf16 v[204:207], v[36:39], v[100:103], v[204:207]
    v_cvt_pk_bf16_f32 v165, v166, v167
    v_cvt_pk_bf16_f32 v166, v180, v181
    v_mfma_f32_16x16x32_bf16 v[212:215], v[36:39], v[104:107], v[212:215]
    v_cvt_pk_bf16_f32 v167, v182, v183
    v_mul_f32 v168, s55, v168
    v_mfma_f32_16x16x32_bf16 v[220:223], v[36:39], v[108:111], v[220:223]
    s_waitcnt lgkmcnt(4)
    ds_read_b128 v[32:35], v51 offset:0
    v_mfma_f32_16x16x32_bf16 v[240:243], v[40:43], v[96:99], v[240:243]
    v_mul_f32 v169, s55, v169
    v_mul_f32 v170, s55, v170
    v_mfma_f32_16x16x32_bf16 v[248:251], v[40:43], v[100:103], v[248:251]
    v_mul_f32 v171, s55, v171
    v_mul_f32 v184, s55, v184
    v_mfma_f32_16x16x32_bf16 v[112:115], v[40:43], v[104:107], v[112:115]
    v_mul_f32 v185, s55, v185
    v_mul_f32 v186, s55, v186
    v_mfma_f32_16x16x32_bf16 v[120:123], v[40:43], v[108:111], v[120:123]
    ds_read_b128 v[36:39], v51 offset:1024
    v_mul_f32 v187, s55, v187
    v_mfma_f32_16x16x32_bf16 v[244:247], v[44:47], v[96:99], v[244:247]
    v_cvt_pk_bf16_f32 v168, v168, v169
    v_cvt_pk_bf16_f32 v169, v170, v171
    v_mfma_f32_16x16x32_bf16 v[252:255], v[44:47], v[100:103], v[252:255]
    v_cvt_pk_bf16_f32 v170, v184, v185
    v_cvt_pk_bf16_f32 v171, v186, v187
    v_mfma_f32_16x16x32_bf16 v[116:119], v[44:47], v[104:107], v[116:119]
    v_mul_f32 v172, s55, v172
    v_mul_f32 v173, s55, v173
    v_mfma_f32_16x16x32_bf16 v[124:127], v[44:47], v[108:111], v[124:127]
    s_waitcnt lgkmcnt(4)
    ds_read_b128 v[40:43], v51 offset:2048
    v_mfma_f32_16x16x32_bf16 v[192:195], v[16:19], v[128:131], v[192:195]
    v_mul_f32 v174, s55, v174
    v_mul_f32 v175, s55, v175
    v_mfma_f32_16x16x32_bf16 v[200:203], v[16:19], v[132:135], v[200:203]
    v_mul_f32 v188, s55, v188
    v_mul_f32 v189, s55, v189
    v_mfma_f32_16x16x32_bf16 v[208:211], v[16:19], v[136:139], v[208:211]
    v_mul_f32 v190, s55, v190
    v_mul_f32 v191, s55, v191
    v_mfma_f32_16x16x32_bf16 v[216:219], v[16:19], v[140:143], v[216:219]
    ds_read_b128 v[44:47], v51 offset:3072
    v_cvt_pk_bf16_f32 v172, v172, v173
    v_mfma_f32_16x16x32_bf16 v[196:199], v[20:23], v[128:131], v[196:199]
    v_cvt_pk_bf16_f32 v173, v174, v175
    v_cvt_pk_bf16_f32 v174, v188, v189
    v_mfma_f32_16x16x32_bf16 v[204:207], v[20:23], v[132:135], v[204:207]
    v_cvt_pk_bf16_f32 v175, v190, v191
    v_mfma_f32_16x16x32_bf16 v[212:215], v[20:23], v[136:139], v[212:215]
    v_mfma_f32_16x16x32_bf16 v[220:223], v[20:23], v[140:143], v[220:223]
    s_waitcnt lgkmcnt(4)
    v_mfma_f32_16x16x32_bf16 v[240:243], v[24:27], v[128:131], v[240:243]
    v_mfma_f32_16x16x32_bf16 v[248:251], v[24:27], v[132:135], v[248:251]
    v_mfma_f32_16x16x32_bf16 v[112:115], v[24:27], v[136:139], v[112:115]
    v_mfma_f32_16x16x32_bf16 v[120:123], v[24:27], v[140:143], v[120:123]
    v_mfma_f32_16x16x32_bf16 v[244:247], v[28:31], v[128:131], v[244:247]
    v_mfma_f32_16x16x32_bf16 v[252:255], v[28:31], v[132:135], v[252:255]
    v_mfma_f32_16x16x32_bf16 v[116:119], v[28:31], v[136:139], v[116:119]
    v_mfma_f32_16x16x32_bf16 v[124:127], v[28:31], v[140:143], v[124:127]
    s_waitcnt lgkmcnt(2)
    v_mfma_f32_16x16x32_bf16 v[192:195], v[32:35], v[160:163], v[192:195]
    v_mfma_f32_16x16x32_bf16 v[200:203], v[32:35], v[164:167], v[200:203]
    v_mfma_f32_16x16x32_bf16 v[208:211], v[32:35], v[168:171], v[208:211]
    v_mfma_f32_16x16x32_bf16 v[216:219], v[32:35], v[172:175], v[216:219]
    v_mfma_f32_16x16x32_bf16 v[196:199], v[36:39], v[160:163], v[196:199]
    v_mfma_f32_16x16x32_bf16 v[204:207], v[36:39], v[164:167], v[204:207]
    v_mfma_f32_16x16x32_bf16 v[212:215], v[36:39], v[168:171], v[212:215]
    v_mfma_f32_16x16x32_bf16 v[220:223], v[36:39], v[172:175], v[220:223]
    s_waitcnt lgkmcnt(0)
    v_mfma_f32_16x16x32_bf16 v[240:243], v[40:43], v[160:163], v[240:243]
    v_mfma_f32_16x16x32_bf16 v[248:251], v[40:43], v[164:167], v[248:251]
    v_mfma_f32_16x16x32_bf16 v[112:115], v[40:43], v[168:171], v[112:115]
    v_mfma_f32_16x16x32_bf16 v[120:123], v[40:43], v[172:175], v[120:123]
    v_mfma_f32_16x16x32_bf16 v[244:247], v[44:47], v[160:163], v[244:247]
    v_mfma_f32_16x16x32_bf16 v[252:255], v[44:47], v[164:167], v[252:255]
    v_mfma_f32_16x16x32_bf16 v[116:119], v[44:47], v[168:171], v[116:119]
    v_mfma_f32_16x16x32_bf16 v[124:127], v[44:47], v[172:175], v[124:127]
    s_waitcnt vmcnt(4)
    s_barrier
    ds_read_b128 a[148:151], v48 offset:16384
    ds_read_b128 a[152:155], v49 offset:16384
    ds_read_b128 a[156:159], v50 offset:16384
    ds_read_b128 a[160:163], v51 offset:16384
    ds_read_b128 a[164:167], v48 offset:17408
    ds_read_b128 a[168:171], v49 offset:17408
    ds_read_b128 a[172:175], v50 offset:17408
    ds_read_b128 a[176:179], v51 offset:17408
    s_bfe_u32 s6, s2, 0x20001
    s_and_b32 s3, s2, 1
    s_xor_b32 s3, s3, 1
    s_lshl_b32 s3, s3, 2
    s_or_b32 s6, s6, s3
    s_mul_i32 s4, s43, 288
    s_bitcmp1_b32 s6, 2
    s_cselect_b32 s16, s94, s92
    s_cselect_b32 s17, s95, s93
    s_cselect_b32 s5, 9, 8
    s_mul_i32 s18, s5, 589824
    s_add_u32 s16, s16, s4
    s_addc_u32 s17, s17, 0
    s_sub_u32 s18, s18, s4
    s_sub_u32 s58, s58, s4
    s_and_b32 s3, s2, 6
    s_mul_i32 s5, s5, 73728
    s_mul_i32 s3, s3, s5
    s_add_u32 s58, s58, s3
    s_add_u32 s96, s58, s5
    s_mov_b32 s97, 4293197824
    s_load_dwordx2 s[92:93], s[0:1], 0
    s_load_dwordx2 s[94:95], s[0:1], 72
    v_and_b32 v63, 1, v0
    v_mov_b32 v12, 0xaaaaaaaa
    v_mul_lo_u32 v63, v63, v12
    v_add_u32 v63, 0x44444444, v63
    s_add_u32 m0, s44, 98304
    s_mov_b32 s49, 16384
    v_max3_f32 v32, v192, v193, v194
    v_max3_f32 v32, v32, v195, v196
    buffer_load_dwordx4 v6, s[12:15], s49 offen offset:0 lds
    v_max3_f32 v32, v32, v197, v198
    v_max3_f32 v32, v32, v199, v240
    v_max3_f32 v32, v32, v241, v242
    v_max3_f32 v32, v32, v243, v244
    v_max3_f32 v32, v32, v245, v246
    v_max_f32 v32, v32, v247
    v_max3_f32 v33, v200, v201, v202
    v_max3_f32 v33, v33, v203, v204
    v_max3_f32 v33, v33, v205, v206
    v_max3_f32 v33, v33, v207, v248
    v_max3_f32 v33, v33, v249, v250
    v_max3_f32 v33, v33, v251, v252
    v_max3_f32 v33, v33, v253, v254
    v_max_f32 v33, v33, v255
    v_max3_f32 v34, v208, v209, v210
    v_max3_f32 v34, v34, v211, v212
    v_max3_f32 v34, v34, v213, v214
    v_max3_f32 v34, v34, v215, v112
    v_max3_f32 v34, v34, v113, v114
    buffer_load_dwordx4 v6, s[12:15], s49 offen offset:1024 lds
    v_max3_f32 v34, v34, v115, v116
    v_max3_f32 v34, v34, v117, v118
    v_max_f32 v34, v34, v119
    v_max3_f32 v35, v216, v217, v218
    v_max3_f32 v35, v35, v219, v220
    v_max3_f32 v35, v35, v221, v222
    v_max3_f32 v35, v35, v223, v120
    v_max3_f32 v35, v35, v121, v122
    v_max3_f32 v35, v35, v123, v124
    v_max3_f32 v35, v35, v125, v126
    v_max_f32 v35, v35, v127
    v_mov_b32 v36, v32
    v_mov_b32 v37, v33
    v_mov_b32 v38, v34
    v_mov_b32 v39, v35
    s_nop 0
    v_permlane32_swap_b32 v32, v36
    v_permlane32_swap_b32 v33, v37
    v_permlane32_swap_b32 v34, v38
    v_permlane32_swap_b32 v35, v39
    buffer_load_dwordx4 v6, s[12:15], s49 offen offset:2048 lds
    v_max_f32 v32, v32, v36
    v_max_f32 v33, v33, v37
    v_max_f32 v34, v34, v38
    v_max_f32 v35, v35, v39
    v_mov_b32 v36, v32
    v_mov_b32 v37, v33
    v_mov_b32 v38, v34
    v_mov_b32 v39, v35
    s_nop 0
    v_permlane16_swap_b32 v32, v36
    v_permlane16_swap_b32 v33, v37
    v_permlane16_swap_b32 v34, v38
    v_permlane16_swap_b32 v35, v39
    v_max_f32 v32, v32, v36
    v_max_f32 v33, v33, v37
    v_max_f32 v34, v34, v38
    v_max_f32 v35, v35, v39
    v_sub_f32 v16, 0, v32
    v_sub_f32 v17, 0, v32
    buffer_load_dwordx4 v6, s[12:15], s49 offen offset:3072 lds
    v_sub_f32 v18, 0, v32
    v_sub_f32 v19, 0, v32
    v_sub_f32 v20, 0, v33
    v_sub_f32 v21, 0, v33
    v_sub_f32 v22, 0, v33
    v_sub_f32 v23, 0, v33
    v_sub_f32 v24, 0, v34
    v_sub_f32 v25, 0, v34
    v_sub_f32 v26, 0, v34
    v_sub_f32 v27, 0, v34
    v_sub_f32 v28, 0, v35
    v_sub_f32 v29, 0, v35
    v_sub_f32 v30, 0, v35
    v_sub_f32 v31, 0, v35
    v_sub_f32 v192, v192, v32
    v_sub_f32 v193, v193, v32
    v_sub_f32 v194, v194, v32
    v_sub_f32 v195, v195, v32
    s_add_u32 m0, s44, 49152
    s_mov_b32 s49, 49152
    v_sub_f32 v196, v196, v32
    v_sub_f32 v197, v197, v32
    buffer_load_dwordx4 v5, s[8:11], s49 offen offset:0 lds
    v_sub_f32 v198, v198, v32
    v_sub_f32 v199, v199, v32
    v_sub_f32 v200, v200, v33
    v_sub_f32 v201, v201, v33
    v_sub_f32 v202, v202, v33
    v_sub_f32 v203, v203, v33
    v_sub_f32 v204, v204, v33
    v_sub_f32 v205, v205, v33
    v_sub_f32 v206, v206, v33
    v_sub_f32 v207, v207, v33
    v_sub_f32 v208, v208, v34
    v_sub_f32 v209, v209, v34
    v_sub_f32 v210, v210, v34
    v_sub_f32 v211, v211, v34
    v_sub_f32 v212, v212, v34
    v_sub_f32 v213, v213, v34
    v_sub_f32 v214, v214, v34
    v_sub_f32 v215, v215, v34
    v_sub_f32 v216, v216, v35
    buffer_load_dwordx4 v5, s[8:11], s49 offen offset:1024 lds
    v_sub_f32 v217, v217, v35
    v_sub_f32 v218, v218, v35
    v_sub_f32 v219, v219, v35
    v_sub_f32 v220, v220, v35
    v_sub_f32 v221, v221, v35
    v_sub_f32 v222, v222, v35
    v_sub_f32 v223, v223, v35
    v_exp_f32 v192, v192
    v_sub_f32 v240, v240, v32
    v_exp_f32 v193, v193
    v_sub_f32 v241, v241, v32
    v_exp_f32 v194, v194
    v_sub_f32 v242, v242, v32
    v_exp_f32 v195, v195
    v_sub_f32 v243, v243, v32
    v_exp_f32 v196, v196
    v_sub_f32 v244, v244, v32
    v_exp_f32 v197, v197
    v_sub_f32 v245, v245, v32
    v_exp_f32 v198, v198
    buffer_load_dwordx4 v5, s[8:11], s49 offen offset:2048 lds
    v_sub_f32 v246, v246, v32
    v_exp_f32 v199, v199
    v_sub_f32 v247, v247, v32
    v_exp_f32 v200, v200
    v_sub_f32 v248, v248, v33
    v_exp_f32 v201, v201
    v_sub_f32 v249, v249, v33
    v_exp_f32 v202, v202
    v_sub_f32 v250, v250, v33
    v_exp_f32 v203, v203
    v_sub_f32 v251, v251, v33
    v_exp_f32 v204, v204
    v_sub_f32 v252, v252, v33
    v_exp_f32 v205, v205
    v_sub_f32 v253, v253, v33
    v_exp_f32 v206, v206
    v_sub_f32 v254, v254, v33
    v_exp_f32 v207, v207
    v_sub_f32 v255, v255, v33
    buffer_load_dwordx4 v5, s[8:11], s49 offen offset:3072 lds
    v_exp_f32 v208, v208
    v_sub_f32 v112, v112, v34
    v_exp_f32 v209, v209
    v_sub_f32 v113, v113, v34
    v_exp_f32 v210, v210
    v_sub_f32 v114, v114, v34
    v_exp_f32 v211, v211
    v_sub_f32 v115, v115, v34
    v_exp_f32 v212, v212
    v_sub_f32 v116, v116, v34
    v_exp_f32 v213, v213
    v_sub_f32 v117, v117, v34
    v_exp_f32 v214, v214
    v_sub_f32 v118, v118, v34
    v_exp_f32 v215, v215
    v_sub_f32 v119, v119, v34
    v_exp_f32 v216, v216
    v_sub_f32 v120, v120, v35
    s_add_u32 m0, s44, 114688
    s_mov_b32 s49, 32768
    v_exp_f32 v217, v217
    v_sub_f32 v121, v121, v35
    buffer_load_dwordx4 v6, s[12:15], s49 offen offset:0 lds
    v_exp_f32 v218, v218
    v_sub_f32 v122, v122, v35
    v_exp_f32 v219, v219
    v_sub_f32 v123, v123, v35
    v_exp_f32 v220, v220
    v_sub_f32 v124, v124, v35
    v_exp_f32 v221, v221
    v_sub_f32 v125, v125, v35
    v_exp_f32 v222, v222
    v_sub_f32 v126, v126, v35
    v_exp_f32 v223, v223
    v_sub_f32 v127, v127, v35
    v_exp_f32 v240, v240
    v_exp_f32 v241, v241
    v_cvt_pk_bf16_f32 v144, v192, v193
    v_exp_f32 v242, v242
    v_exp_f32 v243, v243
    v_cvt_pk_bf16_f32 v145, v194, v195
    v_exp_f32 v244, v244
    buffer_load_dwordx4 v6, s[12:15], s49 offen offset:1024 lds
    v_exp_f32 v245, v245
    v_cvt_pk_bf16_f32 v146, v196, v197
    v_exp_f32 v246, v246
    v_exp_f32 v247, v247
    v_cvt_pk_bf16_f32 v147, v198, v199
    v_exp_f32 v248, v248
    v_exp_f32 v249, v249
    v_cvt_pk_bf16_f32 v152, v200, v201
    v_exp_f32 v250, v250
    v_exp_f32 v251, v251
    v_cvt_pk_bf16_f32 v153, v202, v203
    v_exp_f32 v252, v252
    v_exp_f32 v253, v253
    v_cvt_pk_bf16_f32 v154, v204, v205
    v_exp_f32 v254, v254
    v_exp_f32 v255, v255
    v_cvt_pk_bf16_f32 v155, v206, v207
    v_exp_f32 v112, v112
    v_exp_f32 v113, v113
    v_cvt_pk_bf16_f32 v176, v208, v209
    buffer_load_dwordx4 v6, s[12:15], s49 offen offset:2048 lds
    v_exp_f32 v114, v114
    v_exp_f32 v115, v115
    v_cvt_pk_bf16_f32 v177, v210, v211
    v_exp_f32 v116, v116
    v_exp_f32 v117, v117
    v_cvt_pk_bf16_f32 v178, v212, v213
    v_exp_f32 v118, v118
    v_exp_f32 v119, v119
    v_cvt_pk_bf16_f32 v179, v214, v215
    v_exp_f32 v120, v120
    v_exp_f32 v121, v121
    v_cvt_pk_bf16_f32 v184, v216, v217
    v_exp_f32 v122, v122
    v_exp_f32 v123, v123
    v_cvt_pk_bf16_f32 v185, v218, v219
    v_exp_f32 v124, v124
    v_exp_f32 v125, v125
    v_cvt_pk_bf16_f32 v186, v220, v221
    v_exp_f32 v126, v126
    buffer_load_dwordx4 v6, s[12:15], s49 offen offset:3072 lds
    v_exp_f32 v127, v127
    v_cvt_pk_bf16_f32 v187, v222, v223
    v_cvt_pk_bf16_f32 v148, v240, v241
    v_cvt_pk_bf16_f32 v149, v242, v243
    v_cvt_pk_bf16_f32 v150, v244, v245
    v_cvt_pk_bf16_f32 v151, v246, v247
    v_cvt_pk_bf16_f32 v156, v248, v249
    v_cvt_pk_bf16_f32 v157, v250, v251
    v_cvt_pk_bf16_f32 v158, v252, v253
    v_cvt_pk_bf16_f32 v159, v254, v255
    v_cvt_pk_bf16_f32 v180, v112, v113
    v_cvt_pk_bf16_f32 v181, v114, v115
    v_cvt_pk_bf16_f32 v182, v116, v117
    v_cvt_pk_bf16_f32 v183, v118, v119
    v_cvt_pk_bf16_f32 v188, v120, v121
    v_cvt_pk_bf16_f32 v189, v122, v123
    v_cvt_pk_bf16_f32 v190, v124, v125
    v_cvt_pk_bf16_f32 v191, v126, v127
    v_add_u32 v5, 16384, v5
    s_mov_b32 s47, 49152
    s_mov_b32 s48, 8
    s_add_u32 s86, s45, 65536
    s_add_u32 s88, s45, 90112
    s_mov_b32 s87, 4128768
    s_waitcnt lgkmcnt(0)
    s_mov_b32 s0, s6
.p2align 3
L_att:
    v_mfma_f32_16x16x32_bf16 v[192:195], a[148:151], v[224:227], v[16:19]
    s_add_u32 m0, s44, 0
    v_mfma_f32_16x16x32_bf16 v[192:195], a[152:155], v[96:99], v[192:195]
    buffer_load_dwordx4 v5, s[8:11], s47 offen offset:0 lds
    v_mfma_f32_16x16x32_bf16 v[192:195], a[156:159], v[128:131], v[192:195]
    v_mfma_f32_16x16x32_bf16 v[192:195], a[160:163], v[160:163], v[192:195]
    buffer_load_dwordx4 v5, s[8:11], s47 offen offset:1024 lds
    v_smfmac_f32_16x16x64_bf16 a[128:131], a[144:147], v[144:151], v63
    v_smfmac_f32_16x16x64_bf16 a[132:135], a[144:147], v[152:159], v63
    ds_read_b128 a[180:183], v48 offset:18432
    v_smfmac_f32_16x16x64_bf16 a[136:139], a[144:147], v[176:183], v63
    v_smfmac_f32_16x16x64_bf16 a[140:143], a[144:147], v[184:191], v63
    ds_read_b128 a[184:187], v49 offset:18432
    v_mfma_f32_16x16x32_bf16 v[200:203], a[148:151], v[228:231], v[20:23]
    buffer_load_dwordx4 v5, s[8:11], s47 offen offset:2048 lds
    v_mfma_f32_16x16x32_bf16 v[200:203], a[152:155], v[100:103], v[200:203]
    ds_read_b128 a[188:191], v50 offset:18432
    v_mfma_f32_16x16x32_bf16 v[200:203], a[156:159], v[132:135], v[200:203]
    buffer_load_dwordx4 v5, s[8:11], s47 offen offset:3072 lds
    v_mfma_f32_16x16x32_bf16 v[200:203], a[160:163], v[164:167], v[200:203]
    ds_read_b128 a[192:195], v51 offset:18432
    v_mfma_f32_16x16x32_bf16 v[208:211], a[148:151], v[232:235], v[24:27]
    v_exp_f32 v192, v192
    v_mfma_f32_16x16x32_bf16 v[208:211], a[152:155], v[104:107], v[208:211]
    ds_read_b128 a[196:199], v48 offset:19456
    v_mfma_f32_16x16x32_bf16 v[208:211], a[156:159], v[136:139], v[208:211]
    v_exp_f32 v193, v193
    v_mfma_f32_16x16x32_bf16 v[208:211], a[160:163], v[168:171], v[208:211]
    ds_read_b128 a[200:203], v49 offset:19456
    v_cvt_pk_bf16_f32 v32, v192, v193
    v_mfma_f32_16x16x32_bf16 v[216:219], a[148:151], v[236:239], v[28:31]
    v_exp_f32 v194, v194
    v_mfma_f32_16x16x32_bf16 v[216:219], a[152:155], v[108:111], v[216:219]
    ds_read_b128 a[204:207], v50 offset:19456
    v_mfma_f32_16x16x32_bf16 v[216:219], a[156:159], v[140:143], v[216:219]
    v_exp_f32 v195, v195
    v_mfma_f32_16x16x32_bf16 v[216:219], a[160:163], v[172:175], v[216:219]
    ds_read_b128 a[208:211], v51 offset:19456
    v_cvt_pk_bf16_f32 v33, v194, v195
    v_mfma_f32_16x16x32_bf16 v[196:199], a[164:167], v[224:227], v[16:19]
    v_exp_f32 v200, v200
    v_mfma_f32_16x16x32_bf16 v[196:199], a[168:171], v[96:99], v[196:199]
    ds_read_b64_tr_b16 a[148:149], v52 offset:49152
    v_mfma_f32_16x16x32_bf16 v[196:199], a[172:175], v[128:131], v[196:199]
    v_exp_f32 v201, v201
    v_mfma_f32_16x16x32_bf16 v[196:199], a[176:179], v[160:163], v[196:199]
    ds_read_b64_tr_b16 a[150:151], v52 offset:50176
    v_cvt_pk_bf16_f32 v40, v200, v201
    v_mfma_f32_16x16x32_bf16 v[204:207], a[164:167], v[228:231], v[20:23]
    v_exp_f32 v202, v202
    v_mfma_f32_16x16x32_bf16 v[204:207], a[168:171], v[100:103], v[204:207]
    ds_read_b64_tr_b16 a[152:153], v52 offset:51200
    v_mfma_f32_16x16x32_bf16 v[204:207], a[172:175], v[132:135], v[204:207]
    v_exp_f32 v203, v203
    v_mfma_f32_16x16x32_bf16 v[204:207], a[176:179], v[164:167], v[204:207]
    ds_read_b64_tr_b16 a[154:155], v52 offset:52224
    v_cvt_pk_bf16_f32 v41, v202, v203
    v_mfma_f32_16x16x32_bf16 v[212:215], a[164:167], v[232:235], v[24:27]
    v_exp_f32 v208, v208
    v_mfma_f32_16x16x32_bf16 v[212:215], a[168:171], v[104:107], v[212:215]
    ds_read_b64_tr_b16 a[156:157], v53 offset:49152
    v_mfma_f32_16x16x32_bf16 v[212:215], a[172:175], v[136:139], v[212:215]
    v_exp_f32 v209, v209
    v_mfma_f32_16x16x32_bf16 v[212:215], a[176:179], v[168:171], v[212:215]
    ds_read_b64_tr_b16 a[158:159], v53 offset:50176
    v_cvt_pk_bf16_f32 v80, v208, v209
    v_mfma_f32_16x16x32_bf16 v[220:223], a[164:167], v[236:239], v[28:31]
    v_exp_f32 v210, v210
    v_mfma_f32_16x16x32_bf16 v[220:223], a[168:171], v[108:111], v[220:223]
    ds_read_b64_tr_b16 a[160:161], v53 offset:51200
    v_mfma_f32_16x16x32_bf16 v[220:223], a[172:175], v[140:143], v[220:223]
    s_waitcnt lgkmcnt(7)
    v_exp_f32 v211, v211
    v_mfma_f32_16x16x32_bf16 v[220:223], a[176:179], v[172:175], v[220:223]
    ds_read_b64_tr_b16 a[162:163], v53 offset:52224
    v_cvt_pk_bf16_f32 v81, v210, v211
    v_mfma_f32_16x16x32_bf16 v[240:243], a[180:183], v[224:227], v[16:19]
    v_exp_f32 v216, v216
    v_mfma_f32_16x16x32_bf16 v[240:243], a[184:187], v[96:99], v[240:243]
    ds_read_b64_tr_b16 a[164:165], v54 offset:49152
    v_mfma_f32_16x16x32_bf16 v[240:243], a[188:191], v[128:131], v[240:243]
    v_exp_f32 v217, v217
    v_mfma_f32_16x16x32_bf16 v[240:243], a[192:195], v[160:163], v[240:243]
    ds_read_b64_tr_b16 a[166:167], v54 offset:50176
    v_cvt_pk_bf16_f32 v88, v216, v217
    v_mfma_f32_16x16x32_bf16 v[248:251], a[180:183], v[228:231], v[20:23]
    v_exp_f32 v218, v218
    v_mfma_f32_16x16x32_bf16 v[248:251], a[184:187], v[100:103], v[248:251]
    ds_read_b64_tr_b16 a[168:169], v54 offset:51200
    v_mfma_f32_16x16x32_bf16 v[248:251], a[188:191], v[132:135], v[248:251]
    v_exp_f32 v219, v219
    v_mfma_f32_16x16x32_bf16 v[248:251], a[192:195], v[164:167], v[248:251]
    ds_read_b64_tr_b16 a[170:171], v54 offset:52224
    v_cvt_pk_bf16_f32 v89, v218, v219
    v_mfma_f32_16x16x32_bf16 v[112:115], a[180:183], v[232:235], v[24:27]
    v_exp_f32 v196, v196
    v_mfma_f32_16x16x32_bf16 v[112:115], a[184:187], v[104:107], v[112:115]
    ds_read_b64_tr_b16 a[172:173], v55 offset:49152
    v_mfma_f32_16x16x32_bf16 v[112:115], a[188:191], v[136:139], v[112:115]
    v_exp_f32 v197, v197
    v_mfma_f32_16x16x32_bf16 v[112:115], a[192:195], v[168:171], v[112:115]
    ds_read_b64_tr_b16 a[174:175], v55 offset:50176
    v_cvt_pk_bf16_f32 v34, v196, v197
    v_mfma_f32_16x16x32_bf16 v[120:123], a[180:183], v[236:239], v[28:31]
    v_exp_f32 v198, v198
    v_mfma_f32_16x16x32_bf16 v[120:123], a[184:187], v[108:111], v[120:123]
    ds_read_b64_tr_b16 a[176:177], v55 offset:51200
    v_mfma_f32_16x16x32_bf16 v[120:123], a[188:191], v[140:143], v[120:123]
    v_exp_f32 v199, v199
    v_mfma_f32_16x16x32_bf16 v[120:123], a[192:195], v[172:175], v[120:123]
    ds_read_b64_tr_b16 a[178:179], v55 offset:52224
    v_cvt_pk_bf16_f32 v35, v198, v199
    v_mfma_f32_16x16x32_bf16 v[244:247], a[196:199], v[224:227], v[16:19]
    v_exp_f32 v204, v204
    v_mfma_f32_16x16x32_bf16 v[244:247], a[200:203], v[96:99], v[244:247]
    ds_read_b64_tr_b16 a[180:181], v56 offset:49152
    v_mfma_f32_16x16x32_bf16 v[244:247], a[204:207], v[128:131], v[244:247]
    v_exp_f32 v205, v205
    v_mfma_f32_16x16x32_bf16 v[244:247], a[208:211], v[160:163], v[244:247]
    ds_read_b64_tr_b16 a[182:183], v56 offset:50176
    v_cvt_pk_bf16_f32 v42, v204, v205
    v_mfma_f32_16x16x32_bf16 v[252:255], a[196:199], v[228:231], v[20:23]
    v_exp_f32 v206, v206
    v_mfma_f32_16x16x32_bf16 v[252:255], a[200:203], v[100:103], v[252:255]
    ds_read_b64_tr_b16 a[184:185], v56 offset:51200
    v_mfma_f32_16x16x32_bf16 v[252:255], a[204:207], v[132:135], v[252:255]
    v_exp_f32 v207, v207
    v_mfma_f32_16x16x32_bf16 v[252:255], a[208:211], v[164:167], v[252:255]
    ds_read_b64_tr_b16 a[186:187], v56 offset:52224
    v_cvt_pk_bf16_f32 v43, v206, v207
    v_mfma_f32_16x16x32_bf16 v[116:119], a[196:199], v[232:235], v[24:27]
    v_exp_f32 v212, v212
    v_mfma_f32_16x16x32_bf16 v[116:119], a[200:203], v[104:107], v[116:119]
    ds_read_b64_tr_b16 a[188:189], v57 offset:49152
    v_mfma_f32_16x16x32_bf16 v[116:119], a[204:207], v[136:139], v[116:119]
    v_exp_f32 v213, v213
    v_mfma_f32_16x16x32_bf16 v[116:119], a[208:211], v[168:171], v[116:119]
    ds_read_b64_tr_b16 a[190:191], v57 offset:50176
    v_cvt_pk_bf16_f32 v82, v212, v213
    v_mfma_f32_16x16x32_bf16 v[124:127], a[196:199], v[236:239], v[28:31]
    v_exp_f32 v214, v214
    v_mfma_f32_16x16x32_bf16 v[124:127], a[200:203], v[108:111], v[124:127]
    ds_read_b64_tr_b16 a[192:193], v57 offset:51200
    v_mfma_f32_16x16x32_bf16 v[124:127], a[204:207], v[140:143], v[124:127]
    s_waitcnt lgkmcnt(15)
    v_exp_f32 v215, v215
    v_mfma_f32_16x16x32_bf16 v[124:127], a[208:211], v[172:175], v[124:127]
    ds_read_b64_tr_b16 a[194:195], v57 offset:52224
    v_cvt_pk_bf16_f32 v83, v214, v215
    v_mfma_f32_16x16x32_bf16 a[0:3], a[148:151], v[144:147], a[0:3]
    v_exp_f32 v220, v220
    v_mfma_f32_16x16x32_bf16 a[0:3], a[152:155], v[148:151], a[0:3]
    ds_read_b64_tr_b16 a[196:197], v58 offset:49152
    v_mfma_f32_16x16x32_bf16 a[4:7], a[148:151], v[152:155], a[4:7]
    v_exp_f32 v221, v221
    v_mfma_f32_16x16x32_bf16 a[4:7], a[152:155], v[156:159], a[4:7]
    ds_read_b64_tr_b16 a[198:199], v58 offset:50176
    v_cvt_pk_bf16_f32 v90, v220, v221
    v_mfma_f32_16x16x32_bf16 a[8:11], a[148:151], v[176:179], a[8:11]
    v_exp_f32 v222, v222
    v_mfma_f32_16x16x32_bf16 a[8:11], a[152:155], v[180:183], a[8:11]
    ds_read_b64_tr_b16 a[200:201], v58 offset:51200
    v_mfma_f32_16x16x32_bf16 a[12:15], a[148:151], v[184:187], a[12:15]
    v_exp_f32 v223, v223
    v_mfma_f32_16x16x32_bf16 a[12:15], a[152:155], v[188:191], a[12:15]
    ds_read_b64_tr_b16 a[202:203], v58 offset:52224
    v_cvt_pk_bf16_f32 v91, v222, v223
    v_mfma_f32_16x16x32_bf16 a[16:19], a[156:159], v[144:147], a[16:19]
    v_exp_f32 v240, v240
    v_mfma_f32_16x16x32_bf16 a[16:19], a[160:163], v[148:151], a[16:19]
    ds_read_b64_tr_b16 a[204:205], v59 offset:49152
    v_mfma_f32_16x16x32_bf16 a[20:23], a[156:159], v[152:155], a[20:23]
    v_exp_f32 v241, v241
    v_mfma_f32_16x16x32_bf16 a[20:23], a[160:163], v[156:159], a[20:23]
    ds_read_b64_tr_b16 a[206:207], v59 offset:50176
    v_cvt_pk_bf16_f32 v36, v240, v241
    v_mfma_f32_16x16x32_bf16 a[24:27], a[156:159], v[176:179], a[24:27]
    s_waitcnt lgkmcnt(6)
    v_exp_f32 v242, v242
    v_mfma_f32_16x16x32_bf16 a[24:27], a[160:163], v[180:183], a[24:27]
    ds_read_b64_tr_b16 a[208:209], v59 offset:51200
    v_mfma_f32_16x16x32_bf16 a[28:31], a[156:159], v[184:187], a[28:31]
    s_waitcnt vmcnt(12)
    v_exp_f32 v243, v243
    v_mfma_f32_16x16x32_bf16 a[28:31], a[160:163], v[188:191], a[28:31]
    ds_read_b64_tr_b16 a[210:211], v59 offset:52224
    v_cvt_pk_bf16_f32 v37, v242, v243
    v_mfma_f32_16x16x32_bf16 a[32:35], a[164:167], v[144:147], a[32:35]
    s_barrier
    v_exp_f32 v248, v248
    v_mfma_f32_16x16x32_bf16 a[32:35], a[168:171], v[148:151], a[32:35]
    ds_read_b128 a[148:151], v48 offset:32768
    v_mfma_f32_16x16x32_bf16 a[36:39], a[164:167], v[152:155], a[36:39]
    v_exp_f32 v249, v249
    v_mfma_f32_16x16x32_bf16 a[36:39], a[168:171], v[156:159], a[36:39]
    ds_read_b128 a[152:155], v49 offset:32768
    v_cvt_pk_bf16_f32 v44, v248, v249
    v_mfma_f32_16x16x32_bf16 a[40:43], a[164:167], v[176:179], a[40:43]
    v_exp_f32 v250, v250
    v_mfma_f32_16x16x32_bf16 a[40:43], a[168:171], v[180:183], a[40:43]
    ds_read_b128 a[156:159], v50 offset:32768
    v_mfma_f32_16x16x32_bf16 a[44:47], a[164:167], v[184:187], a[44:47]
    v_exp_f32 v251, v251
    v_mfma_f32_16x16x32_bf16 a[44:47], a[168:171], v[188:191], a[44:47]
    ds_read_b128 a[160:163], v51 offset:32768
    v_cvt_pk_bf16_f32 v45, v250, v251
    v_mfma_f32_16x16x32_bf16 a[48:51], a[172:175], v[144:147], a[48:51]
    s_add_u32 m0, s44, 131072
    v_exp_f32 v112, v112
    v_mfma_f32_16x16x32_bf16 a[48:51], a[176:179], v[148:151], a[48:51]
    buffer_load_dwordx4 v6, s[12:15], s47 offen offset:0 lds
    v_mfma_f32_16x16x32_bf16 a[52:55], a[172:175], v[152:155], a[52:55]
    v_exp_f32 v113, v113
    v_mfma_f32_16x16x32_bf16 a[52:55], a[176:179], v[156:159], a[52:55]
    v_exp_f32 v114, v114
    v_mfma_f32_16x16x32_bf16 a[56:59], a[172:175], v[176:179], a[56:59]
    v_exp_f32 v115, v115
    v_mfma_f32_16x16x32_bf16 a[56:59], a[176:179], v[180:183], a[56:59]
    buffer_load_dwordx4 v6, s[12:15], s47 offen offset:1024 lds
    v_mfma_f32_16x16x32_bf16 a[60:63], a[172:175], v[184:187], a[60:63]
    v_exp_f32 v120, v120
    v_mfma_f32_16x16x32_bf16 a[60:63], a[176:179], v[188:191], a[60:63]
    v_exp_f32 v121, v121
    v_mfma_f32_16x16x32_bf16 a[64:67], a[180:183], v[144:147], a[64:67]
    v_exp_f32 v122, v122
    v_mfma_f32_16x16x32_bf16 a[64:67], a[184:187], v[148:151], a[64:67]
    ds_read_b128 a[164:167], v48 offset:33792
    v_cvt_pk_bf16_f32 v84, v112, v113
    v_mfma_f32_16x16x32_bf16 a[68:71], a[180:183], v[152:155], a[68:71]
    v_exp_f32 v123, v123
    v_mfma_f32_16x16x32_bf16 a[68:71], a[184:187], v[156:159], a[68:71]
    ds_read_b128 a[168:171], v49 offset:33792
    v_cvt_pk_bf16_f32 v85, v114, v115
    v_mfma_f32_16x16x32_bf16 a[72:75], a[180:183], v[176:179], a[72:75]
    v_exp_f32 v244, v244
    v_mfma_f32_16x16x32_bf16 a[72:75], a[184:187], v[180:183], a[72:75]
    ds_read_b128 a[172:175], v50 offset:33792
    v_cvt_pk_bf16_f32 v92, v120, v121
    v_mfma_f32_16x16x32_bf16 a[76:79], a[180:183], v[184:187], a[76:79]
    v_exp_f32 v245, v245
    v_mfma_f32_16x16x32_bf16 a[76:79], a[184:187], v[188:191], a[76:79]
    ds_read_b128 a[176:179], v51 offset:33792
    v_cvt_pk_bf16_f32 v93, v122, v123
    v_mfma_f32_16x16x32_bf16 a[80:83], a[188:191], v[144:147], a[80:83]
    v_exp_f32 v246, v246
    v_mfma_f32_16x16x32_bf16 a[80:83], a[192:195], v[148:151], a[80:83]
    buffer_load_dwordx4 v6, s[12:15], s47 offen offset:2048 lds
    v_mfma_f32_16x16x32_bf16 a[84:87], a[188:191], v[152:155], a[84:87]
    v_exp_f32 v247, v247
    v_mfma_f32_16x16x32_bf16 a[84:87], a[192:195], v[156:159], a[84:87]
    v_exp_f32 v252, v252
    v_mfma_f32_16x16x32_bf16 a[88:91], a[188:191], v[176:179], a[88:91]
    v_exp_f32 v253, v253
    v_mfma_f32_16x16x32_bf16 a[88:91], a[192:195], v[180:183], a[88:91]
    buffer_load_dwordx4 v6, s[12:15], s47 offen offset:3072 lds
    v_mfma_f32_16x16x32_bf16 a[92:95], a[188:191], v[184:187], a[92:95]
    s_waitcnt lgkmcnt(4)
    s_add_u32 s47, s47, 16384
    v_cvt_pk_bf16_f32 v38, v244, v245
    v_mfma_f32_16x16x32_bf16 a[92:95], a[192:195], v[188:191], a[92:95]
    buffer_load_dword v13, v60, s[20:23], s97 offen
    v_mfma_f32_16x16x32_bf16 a[96:99], a[196:199], v[144:147], a[96:99]
    v_exp_f32 v254, v254
    v_mfma_f32_16x16x32_bf16 a[96:99], a[200:203], v[148:151], a[96:99]
    buffer_load_dword v13, v60, s[24:27], s97 offen
    v_mfma_f32_16x16x32_bf16 a[100:103], a[196:199], v[152:155], a[100:103]
    s_add_u32 s97, s97, 884736
    v_exp_f32 v255, v255
    v_mfma_f32_16x16x32_bf16 a[100:103], a[200:203], v[156:159], a[100:103]
    v_exp_f32 v116, v116
    v_mfma_f32_16x16x32_bf16 a[104:107], a[196:199], v[176:179], a[104:107]
    v_exp_f32 v117, v117
    v_mfma_f32_16x16x32_bf16 a[104:107], a[200:203], v[180:183], a[104:107]
    v_exp_f32 v118, v118
    v_mfma_f32_16x16x32_bf16 a[108:111], a[196:199], v[184:187], a[108:111]
    v_exp_f32 v119, v119
    v_mfma_f32_16x16x32_bf16 a[108:111], a[200:203], v[188:191], a[108:111]
    v_exp_f32 v124, v124
    v_mfma_f32_16x16x32_bf16 a[112:115], a[204:207], v[144:147], a[112:115]
    v_exp_f32 v125, v125
    v_mfma_f32_16x16x32_bf16 a[112:115], a[208:211], v[148:151], a[112:115]
    v_exp_f32 v126, v126
    v_mfma_f32_16x16x32_bf16 a[116:119], a[204:207], v[152:155], a[116:119]
    v_exp_f32 v127, v127
    v_mfma_f32_16x16x32_bf16 a[116:119], a[208:211], v[156:159], a[116:119]
    v_cvt_pk_bf16_f32 v39, v246, v247
    v_cvt_pk_bf16_f32 v46, v252, v253
    v_mfma_f32_16x16x32_bf16 a[120:123], a[204:207], v[176:179], a[120:123]
    v_cvt_pk_bf16_f32 v47, v254, v255
    v_cvt_pk_bf16_f32 v86, v116, v117
    v_mfma_f32_16x16x32_bf16 a[120:123], a[208:211], v[180:183], a[120:123]
    v_cvt_pk_bf16_f32 v87, v118, v119
    v_cvt_pk_bf16_f32 v94, v124, v125
    v_mfma_f32_16x16x32_bf16 a[124:127], a[204:207], v[184:187], a[124:127]
    s_waitcnt lgkmcnt(0)
    v_cvt_pk_bf16_f32 v95, v126, v127
    v_mfma_f32_16x16x32_bf16 a[124:127], a[208:211], v[188:191], a[124:127]
    v_mfma_f32_16x16x32_bf16 v[192:195], a[148:151], v[224:227], v[16:19]
    s_add_u32 m0, s44, 16384
    v_mfma_f32_16x16x32_bf16 v[192:195], a[152:155], v[96:99], v[192:195]
    buffer_load_dwordx4 v5, s[8:11], s47 offen offset:0 lds
    v_mfma_f32_16x16x32_bf16 v[192:195], a[156:159], v[128:131], v[192:195]
    v_mfma_f32_16x16x32_bf16 v[192:195], a[160:163], v[160:163], v[192:195]
    buffer_load_dwordx4 v5, s[8:11], s47 offen offset:1024 lds
    v_smfmac_f32_16x16x64_bf16 a[128:131], a[144:147], v[32:39], v63
    v_smfmac_f32_16x16x64_bf16 a[132:135], a[144:147], v[40:47], v63
    ds_read_b128 a[180:183], v48 offset:34816
    v_smfmac_f32_16x16x64_bf16 a[136:139], a[144:147], v[80:87], v63
    v_smfmac_f32_16x16x64_bf16 a[140:143], a[144:147], v[88:95], v63
    ds_read_b128 a[184:187], v49 offset:34816
    v_mfma_f32_16x16x32_bf16 v[200:203], a[148:151], v[228:231], v[20:23]
    buffer_load_dwordx4 v5, s[8:11], s47 offen offset:2048 lds
    v_mfma_f32_16x16x32_bf16 v[200:203], a[152:155], v[100:103], v[200:203]
    ds_read_b128 a[188:191], v50 offset:34816
    v_mfma_f32_16x16x32_bf16 v[200:203], a[156:159], v[132:135], v[200:203]
    buffer_load_dwordx4 v5, s[8:11], s47 offen offset:3072 lds
    v_mfma_f32_16x16x32_bf16 v[200:203], a[160:163], v[164:167], v[200:203]
    ds_read_b128 a[192:195], v51 offset:34816
    v_mfma_f32_16x16x32_bf16 v[208:211], a[148:151], v[232:235], v[24:27]
    v_exp_f32 v192, v192
    v_mfma_f32_16x16x32_bf16 v[208:211], a[152:155], v[104:107], v[208:211]
    ds_read_b128 a[196:199], v48 offset:35840
    v_mfma_f32_16x16x32_bf16 v[208:211], a[156:159], v[136:139], v[208:211]
    v_exp_f32 v193, v193
    v_mfma_f32_16x16x32_bf16 v[208:211], a[160:163], v[168:171], v[208:211]
    ds_read_b128 a[200:203], v49 offset:35840
    v_cvt_pk_bf16_f32 v144, v192, v193
    v_mfma_f32_16x16x32_bf16 v[216:219], a[148:151], v[236:239], v[28:31]
    v_exp_f32 v194, v194
    v_mfma_f32_16x16x32_bf16 v[216:219], a[152:155], v[108:111], v[216:219]
    ds_read_b128 a[204:207], v50 offset:35840
    v_mfma_f32_16x16x32_bf16 v[216:219], a[156:159], v[140:143], v[216:219]
    v_exp_f32 v195, v195
    v_mfma_f32_16x16x32_bf16 v[216:219], a[160:163], v[172:175], v[216:219]
    ds_read_b128 a[208:211], v51 offset:35840
    v_cvt_pk_bf16_f32 v145, v194, v195
    v_mfma_f32_16x16x32_bf16 v[196:199], a[164:167], v[224:227], v[16:19]
    v_exp_f32 v200, v200
    v_mfma_f32_16x16x32_bf16 v[196:199], a[168:171], v[96:99], v[196:199]
    ds_read_b64_tr_b16 a[148:149], v52 offset:0
    v_mfma_f32_16x16x32_bf16 v[196:199], a[172:175], v[128:131], v[196:199]
    v_exp_f32 v201, v201
    v_mfma_f32_16x16x32_bf16 v[196:199], a[176:179], v[160:163], v[196:199]
    ds_read_b64_tr_b16 a[150:151], v52 offset:1024
    v_cvt_pk_bf16_f32 v152, v200, v201
    v_mfma_f32_16x16x32_bf16 v[204:207], a[164:167], v[228:231], v[20:23]
    v_exp_f32 v202, v202
    v_mfma_f32_16x16x32_bf16 v[204:207], a[168:171], v[100:103], v[204:207]
    ds_read_b64_tr_b16 a[152:153], v52 offset:2048
    v_mfma_f32_16x16x32_bf16 v[204:207], a[172:175], v[132:135], v[204:207]
    v_exp_f32 v203, v203
    v_mfma_f32_16x16x32_bf16 v[204:207], a[176:179], v[164:167], v[204:207]
    ds_read_b64_tr_b16 a[154:155], v52 offset:3072
    v_cvt_pk_bf16_f32 v153, v202, v203
    v_mfma_f32_16x16x32_bf16 v[212:215], a[164:167], v[232:235], v[24:27]
    v_exp_f32 v208, v208
    v_mfma_f32_16x16x32_bf16 v[212:215], a[168:171], v[104:107], v[212:215]
    ds_read_b64_tr_b16 a[156:157], v53 offset:0
    v_mfma_f32_16x16x32_bf16 v[212:215], a[172:175], v[136:139], v[212:215]
    v_exp_f32 v209, v209
    v_mfma_f32_16x16x32_bf16 v[212:215], a[176:179], v[168:171], v[212:215]
    ds_read_b64_tr_b16 a[158:159], v53 offset:1024
    v_cvt_pk_bf16_f32 v176, v208, v209
    v_mfma_f32_16x16x32_bf16 v[220:223], a[164:167], v[236:239], v[28:31]
    v_exp_f32 v210, v210
    v_mfma_f32_16x16x32_bf16 v[220:223], a[168:171], v[108:111], v[220:223]
    ds_read_b64_tr_b16 a[160:161], v53 offset:2048
    v_mfma_f32_16x16x32_bf16 v[220:223], a[172:175], v[140:143], v[220:223]
    s_waitcnt lgkmcnt(7)
    v_exp_f32 v211, v211
    v_mfma_f32_16x16x32_bf16 v[220:223], a[176:179], v[172:175], v[220:223]
    ds_read_b64_tr_b16 a[162:163], v53 offset:3072
    v_cvt_pk_bf16_f32 v177, v210, v211
    v_mfma_f32_16x16x32_bf16 v[240:243], a[180:183], v[224:227], v[16:19]
    v_exp_f32 v216, v216
    v_mfma_f32_16x16x32_bf16 v[240:243], a[184:187], v[96:99], v[240:243]
    ds_read_b64_tr_b16 a[164:165], v54 offset:0
    v_mfma_f32_16x16x32_bf16 v[240:243], a[188:191], v[128:131], v[240:243]
    v_exp_f32 v217, v217
    v_mfma_f32_16x16x32_bf16 v[240:243], a[192:195], v[160:163], v[240:243]
    ds_read_b64_tr_b16 a[166:167], v54 offset:1024
    v_cvt_pk_bf16_f32 v184, v216, v217
    v_mfma_f32_16x16x32_bf16 v[248:251], a[180:183], v[228:231], v[20:23]
    v_exp_f32 v218, v218
    v_mfma_f32_16x16x32_bf16 v[248:251], a[184:187], v[100:103], v[248:251]
    ds_read_b64_tr_b16 a[168:169], v54 offset:2048
    v_mfma_f32_16x16x32_bf16 v[248:251], a[188:191], v[132:135], v[248:251]
    v_exp_f32 v219, v219
    v_mfma_f32_16x16x32_bf16 v[248:251], a[192:195], v[164:167], v[248:251]
    ds_read_b64_tr_b16 a[170:171], v54 offset:3072
    v_cvt_pk_bf16_f32 v185, v218, v219
    v_mfma_f32_16x16x32_bf16 v[112:115], a[180:183], v[232:235], v[24:27]
    v_exp_f32 v196, v196
    v_mfma_f32_16x16x32_bf16 v[112:115], a[184:187], v[104:107], v[112:115]
    ds_read_b64_tr_b16 a[172:173], v55 offset:0
    v_mfma_f32_16x16x32_bf16 v[112:115], a[188:191], v[136:139], v[112:115]
    v_exp_f32 v197, v197
    v_mfma_f32_16x16x32_bf16 v[112:115], a[192:195], v[168:171], v[112:115]
    ds_read_b64_tr_b16 a[174:175], v55 offset:1024
    v_cvt_pk_bf16_f32 v146, v196, v197
    v_mfma_f32_16x16x32_bf16 v[120:123], a[180:183], v[236:239], v[28:31]
    v_exp_f32 v198, v198
    v_mfma_f32_16x16x32_bf16 v[120:123], a[184:187], v[108:111], v[120:123]
    ds_read_b64_tr_b16 a[176:177], v55 offset:2048
    v_mfma_f32_16x16x32_bf16 v[120:123], a[188:191], v[140:143], v[120:123]
    v_exp_f32 v199, v199
    v_mfma_f32_16x16x32_bf16 v[120:123], a[192:195], v[172:175], v[120:123]
    ds_read_b64_tr_b16 a[178:179], v55 offset:3072
    v_cvt_pk_bf16_f32 v147, v198, v199
    v_mfma_f32_16x16x32_bf16 v[244:247], a[196:199], v[224:227], v[16:19]
    v_exp_f32 v204, v204
    v_mfma_f32_16x16x32_bf16 v[244:247], a[200:203], v[96:99], v[244:247]
    ds_read_b64_tr_b16 a[180:181], v56 offset:0
    v_mfma_f32_16x16x32_bf16 v[244:247], a[204:207], v[128:131], v[244:247]
    v_exp_f32 v205, v205
    v_mfma_f32_16x16x32_bf16 v[244:247], a[208:211], v[160:163], v[244:247]
    ds_read_b64_tr_b16 a[182:183], v56 offset:1024
    v_cvt_pk_bf16_f32 v154, v204, v205
    v_mfma_f32_16x16x32_bf16 v[252:255], a[196:199], v[228:231], v[20:23]
    v_exp_f32 v206, v206
    v_mfma_f32_16x16x32_bf16 v[252:255], a[200:203], v[100:103], v[252:255]
    ds_read_b64_tr_b16 a[184:185], v56 offset:2048
    v_mfma_f32_16x16x32_bf16 v[252:255], a[204:207], v[132:135], v[252:255]
    v_exp_f32 v207, v207
    v_mfma_f32_16x16x32_bf16 v[252:255], a[208:211], v[164:167], v[252:255]
    ds_read_b64_tr_b16 a[186:187], v56 offset:3072
    v_cvt_pk_bf16_f32 v155, v206, v207
    v_mfma_f32_16x16x32_bf16 v[116:119], a[196:199], v[232:235], v[24:27]
    v_exp_f32 v212, v212
    v_mfma_f32_16x16x32_bf16 v[116:119], a[200:203], v[104:107], v[116:119]
    ds_read_b64_tr_b16 a[188:189], v57 offset:0
    v_mfma_f32_16x16x32_bf16 v[116:119], a[204:207], v[136:139], v[116:119]
    v_exp_f32 v213, v213
    v_mfma_f32_16x16x32_bf16 v[116:119], a[208:211], v[168:171], v[116:119]
    ds_read_b64_tr_b16 a[190:191], v57 offset:1024
    v_cvt_pk_bf16_f32 v178, v212, v213
    v_mfma_f32_16x16x32_bf16 v[124:127], a[196:199], v[236:239], v[28:31]
    v_exp_f32 v214, v214
    v_mfma_f32_16x16x32_bf16 v[124:127], a[200:203], v[108:111], v[124:127]
    ds_read_b64_tr_b16 a[192:193], v57 offset:2048
    v_mfma_f32_16x16x32_bf16 v[124:127], a[204:207], v[140:143], v[124:127]
    s_waitcnt lgkmcnt(15)
    v_exp_f32 v215, v215
    v_mfma_f32_16x16x32_bf16 v[124:127], a[208:211], v[172:175], v[124:127]
    ds_read_b64_tr_b16 a[194:195], v57 offset:3072
    v_cvt_pk_bf16_f32 v179, v214, v215
    v_mfma_f32_16x16x32_bf16 a[0:3], a[148:151], v[32:35], a[0:3]
    v_exp_f32 v220, v220
    v_mfma_f32_16x16x32_bf16 a[0:3], a[152:155], v[36:39], a[0:3]
    ds_read_b64_tr_b16 a[196:197], v58 offset:0
    v_mfma_f32_16x16x32_bf16 a[4:7], a[148:151], v[40:43], a[4:7]
    v_exp_f32 v221, v221
    v_mfma_f32_16x16x32_bf16 a[4:7], a[152:155], v[44:47], a[4:7]
    ds_read_b64_tr_b16 a[198:199], v58 offset:1024
    v_cvt_pk_bf16_f32 v186, v220, v221
    v_mfma_f32_16x16x32_bf16 a[8:11], a[148:151], v[80:83], a[8:11]
    v_exp_f32 v222, v222
    v_mfma_f32_16x16x32_bf16 a[8:11], a[152:155], v[84:87], a[8:11]
    ds_read_b64_tr_b16 a[200:201], v58 offset:2048
    v_mfma_f32_16x16x32_bf16 a[12:15], a[148:151], v[88:91], a[12:15]
    v_exp_f32 v223, v223
    v_mfma_f32_16x16x32_bf16 a[12:15], a[152:155], v[92:95], a[12:15]
    ds_read_b64_tr_b16 a[202:203], v58 offset:3072
    v_cvt_pk_bf16_f32 v187, v222, v223
    v_mfma_f32_16x16x32_bf16 a[16:19], a[156:159], v[32:35], a[16:19]
    v_exp_f32 v240, v240
    v_mfma_f32_16x16x32_bf16 a[16:19], a[160:163], v[36:39], a[16:19]
    ds_read_b64_tr_b16 a[204:205], v59 offset:0
    v_mfma_f32_16x16x32_bf16 a[20:23], a[156:159], v[40:43], a[20:23]
    v_exp_f32 v241, v241
    v_mfma_f32_16x16x32_bf16 a[20:23], a[160:163], v[44:47], a[20:23]
    ds_read_b64_tr_b16 a[206:207], v59 offset:1024
    v_cvt_pk_bf16_f32 v148, v240, v241
    v_mfma_f32_16x16x32_bf16 a[24:27], a[156:159], v[80:83], a[24:27]
    s_waitcnt lgkmcnt(6)
    v_exp_f32 v242, v242
    v_mfma_f32_16x16x32_bf16 a[24:27], a[160:163], v[84:87], a[24:27]
    ds_read_b64_tr_b16 a[208:209], v59 offset:2048
    v_mfma_f32_16x16x32_bf16 a[28:31], a[156:159], v[88:91], a[28:31]
    s_waitcnt vmcnt(12)
    v_exp_f32 v243, v243
    v_mfma_f32_16x16x32_bf16 a[28:31], a[160:163], v[92:95], a[28:31]
    ds_read_b64_tr_b16 a[210:211], v59 offset:3072
    v_cvt_pk_bf16_f32 v149, v242, v243
    v_mfma_f32_16x16x32_bf16 a[32:35], a[164:167], v[32:35], a[32:35]
    s_barrier
    v_exp_f32 v248, v248
    v_mfma_f32_16x16x32_bf16 a[32:35], a[168:171], v[36:39], a[32:35]
    ds_read_b128 a[148:151], v48 offset:49152
    v_mfma_f32_16x16x32_bf16 a[36:39], a[164:167], v[40:43], a[36:39]
    v_exp_f32 v249, v249
    v_mfma_f32_16x16x32_bf16 a[36:39], a[168:171], v[44:47], a[36:39]
    ds_read_b128 a[152:155], v49 offset:49152
    v_cvt_pk_bf16_f32 v156, v248, v249
    v_mfma_f32_16x16x32_bf16 a[40:43], a[164:167], v[80:83], a[40:43]
    v_exp_f32 v250, v250
    v_mfma_f32_16x16x32_bf16 a[40:43], a[168:171], v[84:87], a[40:43]
    ds_read_b128 a[156:159], v50 offset:49152
    v_mfma_f32_16x16x32_bf16 a[44:47], a[164:167], v[88:91], a[44:47]
    v_exp_f32 v251, v251
    v_mfma_f32_16x16x32_bf16 a[44:47], a[168:171], v[92:95], a[44:47]
    ds_read_b128 a[160:163], v51 offset:49152
    v_cvt_pk_bf16_f32 v157, v250, v251
    v_mfma_f32_16x16x32_bf16 a[48:51], a[172:175], v[32:35], a[48:51]
    s_add_u32 m0, s44, 147456
    v_exp_f32 v112, v112
    v_mfma_f32_16x16x32_bf16 a[48:51], a[176:179], v[36:39], a[48:51]
    buffer_load_dwordx4 v6, s[12:15], s47 offen offset:0 lds
    v_mfma_f32_16x16x32_bf16 a[52:55], a[172:175], v[40:43], a[52:55]
    v_exp_f32 v113, v113
    v_mfma_f32_16x16x32_bf16 a[52:55], a[176:179], v[44:47], a[52:55]
    v_exp_f32 v114, v114
    v_mfma_f32_16x16x32_bf16 a[56:59], a[172:175], v[80:83], a[56:59]
    v_exp_f32 v115, v115
    v_mfma_f32_16x16x32_bf16 a[56:59], a[176:179], v[84:87], a[56:59]
    buffer_load_dwordx4 v6, s[12:15], s47 offen offset:1024 lds
    v_mfma_f32_16x16x32_bf16 a[60:63], a[172:175], v[88:91], a[60:63]
    v_exp_f32 v120, v120
    v_mfma_f32_16x16x32_bf16 a[60:63], a[176:179], v[92:95], a[60:63]
    v_exp_f32 v121, v121
    v_mfma_f32_16x16x32_bf16 a[64:67], a[180:183], v[32:35], a[64:67]
    v_exp_f32 v122, v122
    v_mfma_f32_16x16x32_bf16 a[64:67], a[184:187], v[36:39], a[64:67]
    ds_read_b128 a[164:167], v48 offset:50176
    v_cvt_pk_bf16_f32 v180, v112, v113
    v_mfma_f32_16x16x32_bf16 a[68:71], a[180:183], v[40:43], a[68:71]
    v_exp_f32 v123, v123
    v_mfma_f32_16x16x32_bf16 a[68:71], a[184:187], v[44:47], a[68:71]
    ds_read_b128 a[168:171], v49 offset:50176
    v_cvt_pk_bf16_f32 v181, v114, v115
    v_mfma_f32_16x16x32_bf16 a[72:75], a[180:183], v[80:83], a[72:75]
    v_exp_f32 v244, v244
    v_mfma_f32_16x16x32_bf16 a[72:75], a[184:187], v[84:87], a[72:75]
    ds_read_b128 a[172:175], v50 offset:50176
    v_cvt_pk_bf16_f32 v188, v120, v121
    v_mfma_f32_16x16x32_bf16 a[76:79], a[180:183], v[88:91], a[76:79]
    v_exp_f32 v245, v245
    v_mfma_f32_16x16x32_bf16 a[76:79], a[184:187], v[92:95], a[76:79]
    ds_read_b128 a[176:179], v51 offset:50176
    v_cvt_pk_bf16_f32 v189, v122, v123
    v_mfma_f32_16x16x32_bf16 a[80:83], a[188:191], v[32:35], a[80:83]
    v_exp_f32 v246, v246
    v_mfma_f32_16x16x32_bf16 a[80:83], a[192:195], v[36:39], a[80:83]
    buffer_load_dwordx4 v6, s[12:15], s47 offen offset:2048 lds
    v_mfma_f32_16x16x32_bf16 a[84:87], a[188:191], v[40:43], a[84:87]
    v_exp_f32 v247, v247
    v_mfma_f32_16x16x32_bf16 a[84:87], a[192:195], v[44:47], a[84:87]
    v_exp_f32 v252, v252
    v_mfma_f32_16x16x32_bf16 a[88:91], a[188:191], v[80:83], a[88:91]
    v_exp_f32 v253, v253
    v_mfma_f32_16x16x32_bf16 a[88:91], a[192:195], v[84:87], a[88:91]
    buffer_load_dwordx4 v6, s[12:15], s47 offen offset:3072 lds
    v_mfma_f32_16x16x32_bf16 a[92:95], a[188:191], v[88:91], a[92:95]
    s_waitcnt lgkmcnt(4)
    s_add_u32 s47, s47, 16384
    v_cvt_pk_bf16_f32 v150, v244, v245
    v_mfma_f32_16x16x32_bf16 a[92:95], a[192:195], v[92:95], a[92:95]
    buffer_load_dword v13, v1, s[16:19], s58 offen
    v_mfma_f32_16x16x32_bf16 a[96:99], a[196:199], v[32:35], a[96:99]
    s_add_u32 s58, s58, 0x14000
    v_exp_f32 v254, v254
    v_mfma_f32_16x16x32_bf16 a[96:99], a[200:203], v[36:39], a[96:99]
    buffer_load_dword v13, v1, s[16:19], s96 offen
    v_mfma_f32_16x16x32_bf16 a[100:103], a[196:199], v[40:43], a[100:103]
    s_add_u32 s96, s96, 0x14000
    v_exp_f32 v255, v255
    v_mfma_f32_16x16x32_bf16 a[100:103], a[200:203], v[44:47], a[100:103]
    v_exp_f32 v116, v116
    v_mfma_f32_16x16x32_bf16 a[104:107], a[196:199], v[80:83], a[104:107]
    v_exp_f32 v117, v117
    v_mfma_f32_16x16x32_bf16 a[104:107], a[200:203], v[84:87], a[104:107]
    v_exp_f32 v118, v118
    v_mfma_f32_16x16x32_bf16 a[108:111], a[196:199], v[88:91], a[108:111]
    v_exp_f32 v119, v119
    v_mfma_f32_16x16x32_bf16 a[108:111], a[200:203], v[92:95], a[108:111]
    v_exp_f32 v124, v124
    v_mfma_f32_16x16x32_bf16 a[112:115], a[204:207], v[32:35], a[112:115]
    v_exp_f32 v125, v125
    v_mfma_f32_16x16x32_bf16 a[112:115], a[208:211], v[36:39], a[112:115]
    v_exp_f32 v126, v126
    v_mfma_f32_16x16x32_bf16 a[116:119], a[204:207], v[40:43], a[116:119]
    v_exp_f32 v127, v127
    v_mfma_f32_16x16x32_bf16 a[116:119], a[208:211], v[44:47], a[116:119]
    v_cvt_pk_bf16_f32 v151, v246, v247
    v_cvt_pk_bf16_f32 v158, v252, v253
    v_mfma_f32_16x16x32_bf16 a[120:123], a[204:207], v[80:83], a[120:123]
    v_cvt_pk_bf16_f32 v159, v254, v255
    v_cvt_pk_bf16_f32 v182, v116, v117
    v_mfma_f32_16x16x32_bf16 a[120:123], a[208:211], v[84:87], a[120:123]
    v_cvt_pk_bf16_f32 v183, v118, v119
    v_cvt_pk_bf16_f32 v190, v124, v125
    v_mfma_f32_16x16x32_bf16 a[124:127], a[204:207], v[88:91], a[124:127]
    s_waitcnt lgkmcnt(0)
    v_cvt_pk_bf16_f32 v191, v126, v127
    v_mfma_f32_16x16x32_bf16 a[124:127], a[208:211], v[92:95], a[124:127]
    v_mfma_f32_16x16x32_bf16 v[192:195], a[148:151], v[224:227], v[16:19]
    s_add_u32 m0, s44, 32768
    v_mfma_f32_16x16x32_bf16 v[192:195], a[152:155], v[96:99], v[192:195]
    buffer_load_dwordx4 v5, s[8:11], s47 offen offset:0 lds
    v_mfma_f32_16x16x32_bf16 v[192:195], a[156:159], v[128:131], v[192:195]
    v_mfma_f32_16x16x32_bf16 v[192:195], a[160:163], v[160:163], v[192:195]
    buffer_load_dwordx4 v5, s[8:11], s47 offen offset:1024 lds
    v_smfmac_f32_16x16x64_bf16 a[128:131], a[144:147], v[144:151], v63
    v_smfmac_f32_16x16x64_bf16 a[132:135], a[144:147], v[152:159], v63
    ds_read_b128 a[180:183], v48 offset:51200
    v_smfmac_f32_16x16x64_bf16 a[136:139], a[144:147], v[176:183], v63
    v_smfmac_f32_16x16x64_bf16 a[140:143], a[144:147], v[184:191], v63
    ds_read_b128 a[184:187], v49 offset:51200
    v_mfma_f32_16x16x32_bf16 v[200:203], a[148:151], v[228:231], v[20:23]
    buffer_load_dwordx4 v5, s[8:11], s47 offen offset:2048 lds
    v_mfma_f32_16x16x32_bf16 v[200:203], a[152:155], v[100:103], v[200:203]
    ds_read_b128 a[188:191], v50 offset:51200
    v_mfma_f32_16x16x32_bf16 v[200:203], a[156:159], v[132:135], v[200:203]
    buffer_load_dwordx4 v5, s[8:11], s47 offen offset:3072 lds
    v_mfma_f32_16x16x32_bf16 v[200:203], a[160:163], v[164:167], v[200:203]
    ds_read_b128 a[192:195], v51 offset:51200
    v_mfma_f32_16x16x32_bf16 v[208:211], a[148:151], v[232:235], v[24:27]
    v_exp_f32 v192, v192
    v_mfma_f32_16x16x32_bf16 v[208:211], a[152:155], v[104:107], v[208:211]
    ds_read_b128 a[196:199], v48 offset:52224
    v_mfma_f32_16x16x32_bf16 v[208:211], a[156:159], v[136:139], v[208:211]
    v_exp_f32 v193, v193
    v_mfma_f32_16x16x32_bf16 v[208:211], a[160:163], v[168:171], v[208:211]
    ds_read_b128 a[200:203], v49 offset:52224
    v_cvt_pk_bf16_f32 v32, v192, v193
    v_mfma_f32_16x16x32_bf16 v[216:219], a[148:151], v[236:239], v[28:31]
    v_exp_f32 v194, v194
    v_mfma_f32_16x16x32_bf16 v[216:219], a[152:155], v[108:111], v[216:219]
    ds_read_b128 a[204:207], v50 offset:52224
    v_mfma_f32_16x16x32_bf16 v[216:219], a[156:159], v[140:143], v[216:219]
    v_exp_f32 v195, v195
    v_mfma_f32_16x16x32_bf16 v[216:219], a[160:163], v[172:175], v[216:219]
    ds_read_b128 a[208:211], v51 offset:52224
    v_cvt_pk_bf16_f32 v33, v194, v195
    v_mfma_f32_16x16x32_bf16 v[196:199], a[164:167], v[224:227], v[16:19]
    v_exp_f32 v200, v200
    v_mfma_f32_16x16x32_bf16 v[196:199], a[168:171], v[96:99], v[196:199]
    ds_read_b64_tr_b16 a[148:149], v52 offset:16384
    v_mfma_f32_16x16x32_bf16 v[196:199], a[172:175], v[128:131], v[196:199]
    v_exp_f32 v201, v201
    v_mfma_f32_16x16x32_bf16 v[196:199], a[176:179], v[160:163], v[196:199]
    ds_read_b64_tr_b16 a[150:151], v52 offset:17408
    v_cvt_pk_bf16_f32 v40, v200, v201
    v_mfma_f32_16x16x32_bf16 v[204:207], a[164:167], v[228:231], v[20:23]
    v_exp_f32 v202, v202
    v_mfma_f32_16x16x32_bf16 v[204:207], a[168:171], v[100:103], v[204:207]
    ds_read_b64_tr_b16 a[152:153], v52 offset:18432
    v_mfma_f32_16x16x32_bf16 v[204:207], a[172:175], v[132:135], v[204:207]
    v_exp_f32 v203, v203
    v_mfma_f32_16x16x32_bf16 v[204:207], a[176:179], v[164:167], v[204:207]
    ds_read_b64_tr_b16 a[154:155], v52 offset:19456
    v_cvt_pk_bf16_f32 v41, v202, v203
    v_mfma_f32_16x16x32_bf16 v[212:215], a[164:167], v[232:235], v[24:27]
    v_exp_f32 v208, v208
    v_mfma_f32_16x16x32_bf16 v[212:215], a[168:171], v[104:107], v[212:215]
    ds_read_b64_tr_b16 a[156:157], v53 offset:16384
    v_mfma_f32_16x16x32_bf16 v[212:215], a[172:175], v[136:139], v[212:215]
    v_exp_f32 v209, v209
    v_mfma_f32_16x16x32_bf16 v[212:215], a[176:179], v[168:171], v[212:215]
    ds_read_b64_tr_b16 a[158:159], v53 offset:17408
    v_cvt_pk_bf16_f32 v80, v208, v209
    v_mfma_f32_16x16x32_bf16 v[220:223], a[164:167], v[236:239], v[28:31]
    v_exp_f32 v210, v210
    v_mfma_f32_16x16x32_bf16 v[220:223], a[168:171], v[108:111], v[220:223]
    ds_read_b64_tr_b16 a[160:161], v53 offset:18432
    v_mfma_f32_16x16x32_bf16 v[220:223], a[172:175], v[140:143], v[220:223]
    s_waitcnt lgkmcnt(7)
    v_exp_f32 v211, v211
    v_mfma_f32_16x16x32_bf16 v[220:223], a[176:179], v[172:175], v[220:223]
    ds_read_b64_tr_b16 a[162:163], v53 offset:19456
    v_cvt_pk_bf16_f32 v81, v210, v211
    v_mfma_f32_16x16x32_bf16 v[240:243], a[180:183], v[224:227], v[16:19]
    v_exp_f32 v216, v216
    v_mfma_f32_16x16x32_bf16 v[240:243], a[184:187], v[96:99], v[240:243]
    ds_read_b64_tr_b16 a[164:165], v54 offset:16384
    v_mfma_f32_16x16x32_bf16 v[240:243], a[188:191], v[128:131], v[240:243]
    v_exp_f32 v217, v217
    v_mfma_f32_16x16x32_bf16 v[240:243], a[192:195], v[160:163], v[240:243]
    ds_read_b64_tr_b16 a[166:167], v54 offset:17408
    v_cvt_pk_bf16_f32 v88, v216, v217
    v_mfma_f32_16x16x32_bf16 v[248:251], a[180:183], v[228:231], v[20:23]
    v_exp_f32 v218, v218
    v_mfma_f32_16x16x32_bf16 v[248:251], a[184:187], v[100:103], v[248:251]
    ds_read_b64_tr_b16 a[168:169], v54 offset:18432
    v_mfma_f32_16x16x32_bf16 v[248:251], a[188:191], v[132:135], v[248:251]
    v_exp_f32 v219, v219
    v_mfma_f32_16x16x32_bf16 v[248:251], a[192:195], v[164:167], v[248:251]
    ds_read_b64_tr_b16 a[170:171], v54 offset:19456
    v_cvt_pk_bf16_f32 v89, v218, v219
    v_mfma_f32_16x16x32_bf16 v[112:115], a[180:183], v[232:235], v[24:27]
    v_exp_f32 v196, v196
    v_mfma_f32_16x16x32_bf16 v[112:115], a[184:187], v[104:107], v[112:115]
    ds_read_b64_tr_b16 a[172:173], v55 offset:16384
    v_mfma_f32_16x16x32_bf16 v[112:115], a[188:191], v[136:139], v[112:115]
    v_exp_f32 v197, v197
    v_mfma_f32_16x16x32_bf16 v[112:115], a[192:195], v[168:171], v[112:115]
    ds_read_b64_tr_b16 a[174:175], v55 offset:17408
    v_cvt_pk_bf16_f32 v34, v196, v197
    v_mfma_f32_16x16x32_bf16 v[120:123], a[180:183], v[236:239], v[28:31]
    v_exp_f32 v198, v198
    v_mfma_f32_16x16x32_bf16 v[120:123], a[184:187], v[108:111], v[120:123]
    ds_read_b64_tr_b16 a[176:177], v55 offset:18432
    v_mfma_f32_16x16x32_bf16 v[120:123], a[188:191], v[140:143], v[120:123]
    v_exp_f32 v199, v199
    v_mfma_f32_16x16x32_bf16 v[120:123], a[192:195], v[172:175], v[120:123]
    ds_read_b64_tr_b16 a[178:179], v55 offset:19456
    v_cvt_pk_bf16_f32 v35, v198, v199
    v_mfma_f32_16x16x32_bf16 v[244:247], a[196:199], v[224:227], v[16:19]
    v_exp_f32 v204, v204
    v_mfma_f32_16x16x32_bf16 v[244:247], a[200:203], v[96:99], v[244:247]
    ds_read_b64_tr_b16 a[180:181], v56 offset:16384
    v_mfma_f32_16x16x32_bf16 v[244:247], a[204:207], v[128:131], v[244:247]
    v_exp_f32 v205, v205
    v_mfma_f32_16x16x32_bf16 v[244:247], a[208:211], v[160:163], v[244:247]
    ds_read_b64_tr_b16 a[182:183], v56 offset:17408
    v_cvt_pk_bf16_f32 v42, v204, v205
    v_mfma_f32_16x16x32_bf16 v[252:255], a[196:199], v[228:231], v[20:23]
    v_exp_f32 v206, v206
    v_mfma_f32_16x16x32_bf16 v[252:255], a[200:203], v[100:103], v[252:255]
    ds_read_b64_tr_b16 a[184:185], v56 offset:18432
    v_mfma_f32_16x16x32_bf16 v[252:255], a[204:207], v[132:135], v[252:255]
    v_exp_f32 v207, v207
    v_mfma_f32_16x16x32_bf16 v[252:255], a[208:211], v[164:167], v[252:255]
    ds_read_b64_tr_b16 a[186:187], v56 offset:19456
    v_cvt_pk_bf16_f32 v43, v206, v207
    v_mfma_f32_16x16x32_bf16 v[116:119], a[196:199], v[232:235], v[24:27]
    v_exp_f32 v212, v212
    v_mfma_f32_16x16x32_bf16 v[116:119], a[200:203], v[104:107], v[116:119]
    ds_read_b64_tr_b16 a[188:189], v57 offset:16384
    v_mfma_f32_16x16x32_bf16 v[116:119], a[204:207], v[136:139], v[116:119]
    v_exp_f32 v213, v213
    v_mfma_f32_16x16x32_bf16 v[116:119], a[208:211], v[168:171], v[116:119]
    ds_read_b64_tr_b16 a[190:191], v57 offset:17408
    v_cvt_pk_bf16_f32 v82, v212, v213
    v_mfma_f32_16x16x32_bf16 v[124:127], a[196:199], v[236:239], v[28:31]
    v_exp_f32 v214, v214
    v_mfma_f32_16x16x32_bf16 v[124:127], a[200:203], v[108:111], v[124:127]
    ds_read_b64_tr_b16 a[192:193], v57 offset:18432
    v_mfma_f32_16x16x32_bf16 v[124:127], a[204:207], v[140:143], v[124:127]
    s_waitcnt lgkmcnt(15)
    v_exp_f32 v215, v215
    v_mfma_f32_16x16x32_bf16 v[124:127], a[208:211], v[172:175], v[124:127]
    ds_read_b64_tr_b16 a[194:195], v57 offset:19456
    v_cvt_pk_bf16_f32 v83, v214, v215
    v_mfma_f32_16x16x32_bf16 a[0:3], a[148:151], v[144:147], a[0:3]
    v_exp_f32 v220, v220
    v_mfma_f32_16x16x32_bf16 a[0:3], a[152:155], v[148:151], a[0:3]
    ds_read_b64_tr_b16 a[196:197], v58 offset:16384
    v_mfma_f32_16x16x32_bf16 a[4:7], a[148:151], v[152:155], a[4:7]
    v_exp_f32 v221, v221
    v_mfma_f32_16x16x32_bf16 a[4:7], a[152:155], v[156:159], a[4:7]
    ds_read_b64_tr_b16 a[198:199], v58 offset:17408
    v_cvt_pk_bf16_f32 v90, v220, v221
    v_mfma_f32_16x16x32_bf16 a[8:11], a[148:151], v[176:179], a[8:11]
    v_exp_f32 v222, v222
    v_mfma_f32_16x16x32_bf16 a[8:11], a[152:155], v[180:183], a[8:11]
    ds_read_b64_tr_b16 a[200:201], v58 offset:18432
    v_mfma_f32_16x16x32_bf16 a[12:15], a[148:151], v[184:187], a[12:15]
    v_exp_f32 v223, v223
    v_mfma_f32_16x16x32_bf16 a[12:15], a[152:155], v[188:191], a[12:15]
    ds_read_b64_tr_b16 a[202:203], v58 offset:19456
    v_cvt_pk_bf16_f32 v91, v222, v223
    v_mfma_f32_16x16x32_bf16 a[16:19], a[156:159], v[144:147], a[16:19]
    v_exp_f32 v240, v240
    v_mfma_f32_16x16x32_bf16 a[16:19], a[160:163], v[148:151], a[16:19]
    ds_read_b64_tr_b16 a[204:205], v59 offset:16384
    v_mfma_f32_16x16x32_bf16 a[20:23], a[156:159], v[152:155], a[20:23]
    v_exp_f32 v241, v241
    v_mfma_f32_16x16x32_bf16 a[20:23], a[160:163], v[156:159], a[20:23]
    ds_read_b64_tr_b16 a[206:207], v59 offset:17408
    v_cvt_pk_bf16_f32 v36, v240, v241
    v_mfma_f32_16x16x32_bf16 a[24:27], a[156:159], v[176:179], a[24:27]
    s_waitcnt lgkmcnt(6)
    v_exp_f32 v242, v242
    v_mfma_f32_16x16x32_bf16 a[24:27], a[160:163], v[180:183], a[24:27]
    ds_read_b64_tr_b16 a[208:209], v59 offset:18432
    v_mfma_f32_16x16x32_bf16 a[28:31], a[156:159], v[184:187], a[28:31]
    s_waitcnt vmcnt(12)
    v_exp_f32 v243, v243
    v_mfma_f32_16x16x32_bf16 a[28:31], a[160:163], v[188:191], a[28:31]
    ds_read_b64_tr_b16 a[210:211], v59 offset:19456
    v_cvt_pk_bf16_f32 v37, v242, v243
    v_mfma_f32_16x16x32_bf16 a[32:35], a[164:167], v[144:147], a[32:35]
    s_barrier
    v_exp_f32 v248, v248
    v_mfma_f32_16x16x32_bf16 a[32:35], a[168:171], v[148:151], a[32:35]
    ds_read_b128 a[148:151], v48 offset:0
    v_mfma_f32_16x16x32_bf16 a[36:39], a[164:167], v[152:155], a[36:39]
    v_exp_f32 v249, v249
    v_mfma_f32_16x16x32_bf16 a[36:39], a[168:171], v[156:159], a[36:39]
    ds_read_b128 a[152:155], v49 offset:0
    v_cvt_pk_bf16_f32 v44, v248, v249
    v_mfma_f32_16x16x32_bf16 a[40:43], a[164:167], v[176:179], a[40:43]
    v_exp_f32 v250, v250
    v_mfma_f32_16x16x32_bf16 a[40:43], a[168:171], v[180:183], a[40:43]
    ds_read_b128 a[156:159], v50 offset:0
    v_mfma_f32_16x16x32_bf16 a[44:47], a[164:167], v[184:187], a[44:47]
    v_exp_f32 v251, v251
    v_mfma_f32_16x16x32_bf16 a[44:47], a[168:171], v[188:191], a[44:47]
    ds_read_b128 a[160:163], v51 offset:0
    v_cvt_pk_bf16_f32 v45, v250, v251
    v_mfma_f32_16x16x32_bf16 a[48:51], a[172:175], v[144:147], a[48:51]
    s_add_u32 m0, s44, 98304
    v_exp_f32 v112, v112
    v_mfma_f32_16x16x32_bf16 a[48:51], a[176:179], v[148:151], a[48:51]
    buffer_load_dwordx4 v6, s[12:15], s47 offen offset:0 lds
    v_mfma_f32_16x16x32_bf16 a[52:55], a[172:175], v[152:155], a[52:55]
    v_exp_f32 v113, v113
    v_mfma_f32_16x16x32_bf16 a[52:55], a[176:179], v[156:159], a[52:55]
    v_exp_f32 v114, v114
    v_mfma_f32_16x16x32_bf16 a[56:59], a[172:175], v[176:179], a[56:59]
    v_exp_f32 v115, v115
    v_mfma_f32_16x16x32_bf16 a[56:59], a[176:179], v[180:183], a[56:59]
    buffer_load_dwordx4 v6, s[12:15], s47 offen offset:1024 lds
    v_mfma_f32_16x16x32_bf16 a[60:63], a[172:175], v[184:187], a[60:63]
    v_exp_f32 v120, v120
    v_mfma_f32_16x16x32_bf16 a[60:63], a[176:179], v[188:191], a[60:63]
    v_exp_f32 v121, v121
    v_mfma_f32_16x16x32_bf16 a[64:67], a[180:183], v[144:147], a[64:67]
    v_exp_f32 v122, v122
    v_mfma_f32_16x16x32_bf16 a[64:67], a[184:187], v[148:151], a[64:67]
    ds_read_b128 a[164:167], v48 offset:1024
    v_cvt_pk_bf16_f32 v84, v112, v113
    v_mfma_f32_16x16x32_bf16 a[68:71], a[180:183], v[152:155], a[68:71]
    v_exp_f32 v123, v123
    v_mfma_f32_16x16x32_bf16 a[68:71], a[184:187], v[156:159], a[68:71]
    ds_read_b128 a[168:171], v49 offset:1024
    v_cvt_pk_bf16_f32 v85, v114, v115
    v_mfma_f32_16x16x32_bf16 a[72:75], a[180:183], v[176:179], a[72:75]
    v_exp_f32 v244, v244
    v_mfma_f32_16x16x32_bf16 a[72:75], a[184:187], v[180:183], a[72:75]
    ds_read_b128 a[172:175], v50 offset:1024
    v_cvt_pk_bf16_f32 v92, v120, v121
    v_mfma_f32_16x16x32_bf16 a[76:79], a[180:183], v[184:187], a[76:79]
    v_exp_f32 v245, v245
    v_mfma_f32_16x16x32_bf16 a[76:79], a[184:187], v[188:191], a[76:79]
    ds_read_b128 a[176:179], v51 offset:1024
    v_cvt_pk_bf16_f32 v93, v122, v123
    v_mfma_f32_16x16x32_bf16 a[80:83], a[188:191], v[144:147], a[80:83]
    v_exp_f32 v246, v246
    v_mfma_f32_16x16x32_bf16 a[80:83], a[192:195], v[148:151], a[80:83]
    buffer_load_dwordx4 v6, s[12:15], s47 offen offset:2048 lds
    v_mfma_f32_16x16x32_bf16 a[84:87], a[188:191], v[152:155], a[84:87]
    v_exp_f32 v247, v247
    v_mfma_f32_16x16x32_bf16 a[84:87], a[192:195], v[156:159], a[84:87]
    v_exp_f32 v252, v252
    v_mfma_f32_16x16x32_bf16 a[88:91], a[188:191], v[176:179], a[88:91]
    v_exp_f32 v253, v253
    v_mfma_f32_16x16x32_bf16 a[88:91], a[192:195], v[180:183], a[88:91]
    buffer_load_dwordx4 v6, s[12:15], s47 offen offset:3072 lds
    v_mfma_f32_16x16x32_bf16 a[92:95], a[188:191], v[184:187], a[92:95]
    s_waitcnt lgkmcnt(4)
    s_add_u32 s47, s47, 16384
    v_cvt_pk_bf16_f32 v38, v244, v245
    v_mfma_f32_16x16x32_bf16 a[92:95], a[192:195], v[188:191], a[92:95]
    global_load_dword v13, v[10:11], off
    v_mfma_f32_16x16x32_bf16 a[96:99], a[196:199], v[144:147], a[96:99]
    v_exp_f32 v254, v254
    v_mfma_f32_16x16x32_bf16 a[96:99], a[200:203], v[148:151], a[96:99]
    v_exp_f32 v255, v255
    v_mfma_f32_16x16x32_bf16 a[100:103], a[196:199], v[152:155], a[100:103]
    v_exp_f32 v116, v116
    v_mfma_f32_16x16x32_bf16 a[100:103], a[200:203], v[156:159], a[100:103]
    v_exp_f32 v117, v117
    v_mfma_f32_16x16x32_bf16 a[104:107], a[196:199], v[176:179], a[104:107]
    v_exp_f32 v118, v118
    v_mfma_f32_16x16x32_bf16 a[104:107], a[200:203], v[180:183], a[104:107]
    v_exp_f32 v119, v119
    v_mfma_f32_16x16x32_bf16 a[108:111], a[196:199], v[184:187], a[108:111]
    v_exp_f32 v124, v124
    v_mfma_f32_16x16x32_bf16 a[108:111], a[200:203], v[188:191], a[108:111]
    v_exp_f32 v125, v125
    v_mfma_f32_16x16x32_bf16 a[112:115], a[204:207], v[144:147], a[112:115]
    v_exp_f32 v126, v126
    v_mfma_f32_16x16x32_bf16 a[112:115], a[208:211], v[148:151], a[112:115]
    v_exp_f32 v127, v127
    v_mfma_f32_16x16x32_bf16 a[116:119], a[204:207], v[152:155], a[116:119]
    s_sub_u32 s48, s48, 1
    v_cvt_pk_bf16_f32 v39, v246, v247
    v_cvt_pk_bf16_f32 v46, v252, v253
    v_mfma_f32_16x16x32_bf16 a[116:119], a[208:211], v[156:159], a[116:119]
    v_cvt_pk_bf16_f32 v47, v254, v255
    v_cvt_pk_bf16_f32 v86, v116, v117
    v_mfma_f32_16x16x32_bf16 a[120:123], a[204:207], v[176:179], a[120:123]
    s_cmp_eq_u32 s48, 0
    v_cvt_pk_bf16_f32 v87, v118, v119
    v_cvt_pk_bf16_f32 v94, v124, v125
    v_mfma_f32_16x16x32_bf16 a[120:123], a[208:211], v[180:183], a[120:123]
    v_cvt_pk_bf16_f32 v95, v126, v127
    v_mfma_f32_16x16x32_bf16 a[124:127], a[204:207], v[184:187], a[124:127]
    s_waitcnt lgkmcnt(0)
    v_mfma_f32_16x16x32_bf16 a[124:127], a[208:211], v[188:191], a[124:127]
    s_cbranch_scc1 L_att_last
    v_mfma_f32_16x16x32_bf16 v[192:195], a[148:151], v[224:227], v[16:19]
    s_add_u32 m0, s44, 49152
    v_mfma_f32_16x16x32_bf16 v[192:195], a[152:155], v[96:99], v[192:195]
    buffer_load_dwordx4 v5, s[8:11], s47 offen offset:0 lds
    v_mfma_f32_16x16x32_bf16 v[192:195], a[156:159], v[128:131], v[192:195]
    v_mfma_f32_16x16x32_bf16 v[192:195], a[160:163], v[160:163], v[192:195]
    buffer_load_dwordx4 v5, s[8:11], s47 offen offset:1024 lds
    v_smfmac_f32_16x16x64_bf16 a[128:131], a[144:147], v[32:39], v63
    v_smfmac_f32_16x16x64_bf16 a[132:135], a[144:147], v[40:47], v63
    ds_read_b128 a[180:183], v48 offset:2048
    v_smfmac_f32_16x16x64_bf16 a[136:139], a[144:147], v[80:87], v63
    v_smfmac_f32_16x16x64_bf16 a[140:143], a[144:147], v[88:95], v63
    ds_read_b128 a[184:187], v49 offset:2048
    v_mfma_f32_16x16x32_bf16 v[200:203], a[148:151], v[228:231], v[20:23]
    buffer_load_dwordx4 v5, s[8:11], s47 offen offset:2048 lds
    v_mfma_f32_16x16x32_bf16 v[200:203], a[152:155], v[100:103], v[200:203]
    ds_read_b128 a[188:191], v50 offset:2048
    v_mfma_f32_16x16x32_bf16 v[200:203], a[156:159], v[132:135], v[200:203]
    buffer_load_dwordx4 v5, s[8:11], s47 offen offset:3072 lds
    v_mfma_f32_16x16x32_bf16 v[200:203], a[160:163], v[164:167], v[200:203]
    ds_read_b128 a[192:195], v51 offset:2048
    v_mfma_f32_16x16x32_bf16 v[208:211], a[148:151], v[232:235], v[24:27]
    v_exp_f32 v192, v192
    v_mfma_f32_16x16x32_bf16 v[208:211], a[152:155], v[104:107], v[208:211]
    ds_read_b128 a[196:199], v48 offset:3072
    v_mfma_f32_16x16x32_bf16 v[208:211], a[156:159], v[136:139], v[208:211]
    v_exp_f32 v193, v193
    v_mfma_f32_16x16x32_bf16 v[208:211], a[160:163], v[168:171], v[208:211]
    ds_read_b128 a[200:203], v49 offset:3072
    v_cvt_pk_bf16_f32 v144, v192, v193
    v_mfma_f32_16x16x32_bf16 v[216:219], a[148:151], v[236:239], v[28:31]
    v_exp_f32 v194, v194
    v_mfma_f32_16x16x32_bf16 v[216:219], a[152:155], v[108:111], v[216:219]
    ds_read_b128 a[204:207], v50 offset:3072
    v_mfma_f32_16x16x32_bf16 v[216:219], a[156:159], v[140:143], v[216:219]
    v_exp_f32 v195, v195
    v_mfma_f32_16x16x32_bf16 v[216:219], a[160:163], v[172:175], v[216:219]
    ds_read_b128 a[208:211], v51 offset:3072
    v_cvt_pk_bf16_f32 v145, v194, v195
    v_mfma_f32_16x16x32_bf16 v[196:199], a[164:167], v[224:227], v[16:19]
    v_exp_f32 v200, v200
    v_mfma_f32_16x16x32_bf16 v[196:199], a[168:171], v[96:99], v[196:199]
    ds_read_b64_tr_b16 a[148:149], v52 offset:32768
    v_mfma_f32_16x16x32_bf16 v[196:199], a[172:175], v[128:131], v[196:199]
    v_exp_f32 v201, v201
    v_mfma_f32_16x16x32_bf16 v[196:199], a[176:179], v[160:163], v[196:199]
    ds_read_b64_tr_b16 a[150:151], v52 offset:33792
    v_cvt_pk_bf16_f32 v152, v200, v201
    v_mfma_f32_16x16x32_bf16 v[204:207], a[164:167], v[228:231], v[20:23]
    v_exp_f32 v202, v202
    v_mfma_f32_16x16x32_bf16 v[204:207], a[168:171], v[100:103], v[204:207]
    ds_read_b64_tr_b16 a[152:153], v52 offset:34816
    v_mfma_f32_16x16x32_bf16 v[204:207], a[172:175], v[132:135], v[204:207]
    v_exp_f32 v203, v203
    v_mfma_f32_16x16x32_bf16 v[204:207], a[176:179], v[164:167], v[204:207]
    ds_read_b64_tr_b16 a[154:155], v52 offset:35840
    v_cvt_pk_bf16_f32 v153, v202, v203
    v_mfma_f32_16x16x32_bf16 v[212:215], a[164:167], v[232:235], v[24:27]
    v_exp_f32 v208, v208
    v_mfma_f32_16x16x32_bf16 v[212:215], a[168:171], v[104:107], v[212:215]
    ds_read_b64_tr_b16 a[156:157], v53 offset:32768
    v_mfma_f32_16x16x32_bf16 v[212:215], a[172:175], v[136:139], v[212:215]
    v_exp_f32 v209, v209
    v_mfma_f32_16x16x32_bf16 v[212:215], a[176:179], v[168:171], v[212:215]
    ds_read_b64_tr_b16 a[158:159], v53 offset:33792
    v_cvt_pk_bf16_f32 v176, v208, v209
    v_mfma_f32_16x16x32_bf16 v[220:223], a[164:167], v[236:239], v[28:31]
    v_exp_f32 v210, v210
    v_mfma_f32_16x16x32_bf16 v[220:223], a[168:171], v[108:111], v[220:223]
    ds_read_b64_tr_b16 a[160:161], v53 offset:34816
    v_mfma_f32_16x16x32_bf16 v[220:223], a[172:175], v[140:143], v[220:223]
    s_waitcnt lgkmcnt(7)
    v_exp_f32 v211, v211
    v_mfma_f32_16x16x32_bf16 v[220:223], a[176:179], v[172:175], v[220:223]
    ds_read_b64_tr_b16 a[162:163], v53 offset:35840
    v_cvt_pk_bf16_f32 v177, v210, v211
    v_mfma_f32_16x16x32_bf16 v[240:243], a[180:183], v[224:227], v[16:19]
    v_exp_f32 v216, v216
    v_mfma_f32_16x16x32_bf16 v[240:243], a[184:187], v[96:99], v[240:243]
    ds_read_b64_tr_b16 a[164:165], v54 offset:32768
    v_mfma_f32_16x16x32_bf16 v[240:243], a[188:191], v[128:131], v[240:243]
    v_exp_f32 v217, v217
    v_mfma_f32_16x16x32_bf16 v[240:243], a[192:195], v[160:163], v[240:243]
    ds_read_b64_tr_b16 a[166:167], v54 offset:33792
    v_cvt_pk_bf16_f32 v184, v216, v217
    v_mfma_f32_16x16x32_bf16 v[248:251], a[180:183], v[228:231], v[20:23]
    v_exp_f32 v218, v218
    v_mfma_f32_16x16x32_bf16 v[248:251], a[184:187], v[100:103], v[248:251]
    ds_read_b64_tr_b16 a[168:169], v54 offset:34816
    v_mfma_f32_16x16x32_bf16 v[248:251], a[188:191], v[132:135], v[248:251]
    v_exp_f32 v219, v219
    v_mfma_f32_16x16x32_bf16 v[248:251], a[192:195], v[164:167], v[248:251]
    ds_read_b64_tr_b16 a[170:171], v54 offset:35840
    v_cvt_pk_bf16_f32 v185, v218, v219
    v_mfma_f32_16x16x32_bf16 v[112:115], a[180:183], v[232:235], v[24:27]
    v_exp_f32 v196, v196
    v_mfma_f32_16x16x32_bf16 v[112:115], a[184:187], v[104:107], v[112:115]
    ds_read_b64_tr_b16 a[172:173], v55 offset:32768
    v_mfma_f32_16x16x32_bf16 v[112:115], a[188:191], v[136:139], v[112:115]
    v_exp_f32 v197, v197
    v_mfma_f32_16x16x32_bf16 v[112:115], a[192:195], v[168:171], v[112:115]
    ds_read_b64_tr_b16 a[174:175], v55 offset:33792
    v_cvt_pk_bf16_f32 v146, v196, v197
    v_mfma_f32_16x16x32_bf16 v[120:123], a[180:183], v[236:239], v[28:31]
    v_exp_f32 v198, v198
    v_mfma_f32_16x16x32_bf16 v[120:123], a[184:187], v[108:111], v[120:123]
    ds_read_b64_tr_b16 a[176:177], v55 offset:34816
    v_mfma_f32_16x16x32_bf16 v[120:123], a[188:191], v[140:143], v[120:123]
    v_exp_f32 v199, v199
    v_mfma_f32_16x16x32_bf16 v[120:123], a[192:195], v[172:175], v[120:123]
    ds_read_b64_tr_b16 a[178:179], v55 offset:35840
    v_cvt_pk_bf16_f32 v147, v198, v199
    v_mfma_f32_16x16x32_bf16 v[244:247], a[196:199], v[224:227], v[16:19]
    v_exp_f32 v204, v204
    v_mfma_f32_16x16x32_bf16 v[244:247], a[200:203], v[96:99], v[244:247]
    ds_read_b64_tr_b16 a[180:181], v56 offset:32768
    v_mfma_f32_16x16x32_bf16 v[244:247], a[204:207], v[128:131], v[244:247]
    v_exp_f32 v205, v205
    v_mfma_f32_16x16x32_bf16 v[244:247], a[208:211], v[160:163], v[244:247]
    ds_read_b64_tr_b16 a[182:183], v56 offset:33792
    v_cvt_pk_bf16_f32 v154, v204, v205
    v_mfma_f32_16x16x32_bf16 v[252:255], a[196:199], v[228:231], v[20:23]
    v_exp_f32 v206, v206
    v_mfma_f32_16x16x32_bf16 v[252:255], a[200:203], v[100:103], v[252:255]
    ds_read_b64_tr_b16 a[184:185], v56 offset:34816
    v_mfma_f32_16x16x32_bf16 v[252:255], a[204:207], v[132:135], v[252:255]
    v_exp_f32 v207, v207
    v_mfma_f32_16x16x32_bf16 v[252:255], a[208:211], v[164:167], v[252:255]
    ds_read_b64_tr_b16 a[186:187], v56 offset:35840
    v_cvt_pk_bf16_f32 v155, v206, v207
    v_mfma_f32_16x16x32_bf16 v[116:119], a[196:199], v[232:235], v[24:27]
    v_exp_f32 v212, v212
    v_mfma_f32_16x16x32_bf16 v[116:119], a[200:203], v[104:107], v[116:119]
    ds_read_b64_tr_b16 a[188:189], v57 offset:32768
    v_mfma_f32_16x16x32_bf16 v[116:119], a[204:207], v[136:139], v[116:119]
    v_exp_f32 v213, v213
    v_mfma_f32_16x16x32_bf16 v[116:119], a[208:211], v[168:171], v[116:119]
    ds_read_b64_tr_b16 a[190:191], v57 offset:33792
    v_cvt_pk_bf16_f32 v178, v212, v213
    v_mfma_f32_16x16x32_bf16 v[124:127], a[196:199], v[236:239], v[28:31]
    v_exp_f32 v214, v214
    v_mfma_f32_16x16x32_bf16 v[124:127], a[200:203], v[108:111], v[124:127]
    ds_read_b64_tr_b16 a[192:193], v57 offset:34816
    v_mfma_f32_16x16x32_bf16 v[124:127], a[204:207], v[140:143], v[124:127]
    s_waitcnt lgkmcnt(15)
    v_exp_f32 v215, v215
    v_mfma_f32_16x16x32_bf16 v[124:127], a[208:211], v[172:175], v[124:127]
    ds_read_b64_tr_b16 a[194:195], v57 offset:35840
    v_cvt_pk_bf16_f32 v179, v214, v215
    v_mfma_f32_16x16x32_bf16 a[0:3], a[148:151], v[32:35], a[0:3]
    v_exp_f32 v220, v220
    v_mfma_f32_16x16x32_bf16 a[0:3], a[152:155], v[36:39], a[0:3]
    ds_read_b64_tr_b16 a[196:197], v58 offset:32768
    v_mfma_f32_16x16x32_bf16 a[4:7], a[148:151], v[40:43], a[4:7]
    v_exp_f32 v221, v221
    v_mfma_f32_16x16x32_bf16 a[4:7], a[152:155], v[44:47], a[4:7]
    ds_read_b64_tr_b16 a[198:199], v58 offset:33792
    v_cvt_pk_bf16_f32 v186, v220, v221
    v_mfma_f32_16x16x32_bf16 a[8:11], a[148:151], v[80:83], a[8:11]
    v_exp_f32 v222, v222
    v_mfma_f32_16x16x32_bf16 a[8:11], a[152:155], v[84:87], a[8:11]
    ds_read_b64_tr_b16 a[200:201], v58 offset:34816
    v_mfma_f32_16x16x32_bf16 a[12:15], a[148:151], v[88:91], a[12:15]
    v_exp_f32 v223, v223
    v_mfma_f32_16x16x32_bf16 a[12:15], a[152:155], v[92:95], a[12:15]
    ds_read_b64_tr_b16 a[202:203], v58 offset:35840
    v_cvt_pk_bf16_f32 v187, v222, v223
    v_mfma_f32_16x16x32_bf16 a[16:19], a[156:159], v[32:35], a[16:19]
    v_exp_f32 v240, v240
    v_mfma_f32_16x16x32_bf16 a[16:19], a[160:163], v[36:39], a[16:19]
    ds_read_b64_tr_b16 a[204:205], v59 offset:32768
    v_mfma_f32_16x16x32_bf16 a[20:23], a[156:159], v[40:43], a[20:23]
    v_exp_f32 v241, v241
    v_mfma_f32_16x16x32_bf16 a[20:23], a[160:163], v[44:47], a[20:23]
    ds_read_b64_tr_b16 a[206:207], v59 offset:33792
    v_cvt_pk_bf16_f32 v148, v240, v241
    v_mfma_f32_16x16x32_bf16 a[24:27], a[156:159], v[80:83], a[24:27]
    s_waitcnt lgkmcnt(6)
    v_exp_f32 v242, v242
    v_mfma_f32_16x16x32_bf16 a[24:27], a[160:163], v[84:87], a[24:27]
    ds_read_b64_tr_b16 a[208:209], v59 offset:34816
    v_mfma_f32_16x16x32_bf16 a[28:31], a[156:159], v[88:91], a[28:31]
    s_waitcnt vmcnt(12)
    v_exp_f32 v243, v243
    v_mfma_f32_16x16x32_bf16 a[28:31], a[160:163], v[92:95], a[28:31]
    ds_read_b64_tr_b16 a[210:211], v59 offset:35840
    v_cvt_pk_bf16_f32 v149, v242, v243
    v_mfma_f32_16x16x32_bf16 a[32:35], a[164:167], v[32:35], a[32:35]
    s_barrier
    v_exp_f32 v248, v248
    v_mfma_f32_16x16x32_bf16 a[32:35], a[168:171], v[36:39], a[32:35]
    ds_read_b128 a[148:151], v48 offset:16384
    v_mfma_f32_16x16x32_bf16 a[36:39], a[164:167], v[40:43], a[36:39]
    v_exp_f32 v249, v249
    v_mfma_f32_16x16x32_bf16 a[36:39], a[168:171], v[44:47], a[36:39]
    ds_read_b128 a[152:155], v49 offset:16384
    v_cvt_pk_bf16_f32 v156, v248, v249
    v_mfma_f32_16x16x32_bf16 a[40:43], a[164:167], v[80:83], a[40:43]
    v_exp_f32 v250, v250
    v_mfma_f32_16x16x32_bf16 a[40:43], a[168:171], v[84:87], a[40:43]
    ds_read_b128 a[156:159], v50 offset:16384
    v_mfma_f32_16x16x32_bf16 a[44:47], a[164:167], v[88:91], a[44:47]
    v_exp_f32 v251, v251
    v_mfma_f32_16x16x32_bf16 a[44:47], a[168:171], v[92:95], a[44:47]
    ds_read_b128 a[160:163], v51 offset:16384
    v_cvt_pk_bf16_f32 v157, v250, v251
    v_mfma_f32_16x16x32_bf16 a[48:51], a[172:175], v[32:35], a[48:51]
    s_add_u32 m0, s44, 114688
    v_exp_f32 v112, v112
    v_mfma_f32_16x16x32_bf16 a[48:51], a[176:179], v[36:39], a[48:51]
    buffer_load_dwordx4 v6, s[12:15], s47 offen offset:0 lds
    v_mfma_f32_16x16x32_bf16 a[52:55], a[172:175], v[40:43], a[52:55]
    v_exp_f32 v113, v113
    v_mfma_f32_16x16x32_bf16 a[52:55], a[176:179], v[44:47], a[52:55]
    v_exp_f32 v114, v114
    v_mfma_f32_16x16x32_bf16 a[56:59], a[172:175], v[80:83], a[56:59]
    v_exp_f32 v115, v115
    v_mfma_f32_16x16x32_bf16 a[56:59], a[176:179], v[84:87], a[56:59]
    buffer_load_dwordx4 v6, s[12:15], s47 offen offset:1024 lds
    v_mfma_f32_16x16x32_bf16 a[60:63], a[172:175], v[88:91], a[60:63]
    v_exp_f32 v120, v120
    v_mfma_f32_16x16x32_bf16 a[60:63], a[176:179], v[92:95], a[60:63]
    v_exp_f32 v121, v121
    v_mfma_f32_16x16x32_bf16 a[64:67], a[180:183], v[32:35], a[64:67]
    v_exp_f32 v122, v122
    v_mfma_f32_16x16x32_bf16 a[64:67], a[184:187], v[36:39], a[64:67]
    ds_read_b128 a[164:167], v48 offset:17408
    v_cvt_pk_bf16_f32 v180, v112, v113
    v_mfma_f32_16x16x32_bf16 a[68:71], a[180:183], v[40:43], a[68:71]
    v_exp_f32 v123, v123
    v_mfma_f32_16x16x32_bf16 a[68:71], a[184:187], v[44:47], a[68:71]
    ds_read_b128 a[168:171], v49 offset:17408
    v_cvt_pk_bf16_f32 v181, v114, v115
    v_mfma_f32_16x16x32_bf16 a[72:75], a[180:183], v[80:83], a[72:75]
    v_exp_f32 v244, v244
    v_mfma_f32_16x16x32_bf16 a[72:75], a[184:187], v[84:87], a[72:75]
    ds_read_b128 a[172:175], v50 offset:17408
    v_cvt_pk_bf16_f32 v188, v120, v121
    v_mfma_f32_16x16x32_bf16 a[76:79], a[180:183], v[88:91], a[76:79]
    v_exp_f32 v245, v245
    v_mfma_f32_16x16x32_bf16 a[76:79], a[184:187], v[92:95], a[76:79]
    ds_read_b128 a[176:179], v51 offset:17408
    v_cvt_pk_bf16_f32 v189, v122, v123
    v_mfma_f32_16x16x32_bf16 a[80:83], a[188:191], v[32:35], a[80:83]
    v_exp_f32 v246, v246
    v_mfma_f32_16x16x32_bf16 a[80:83], a[192:195], v[36:39], a[80:83]
    buffer_load_dwordx4 v6, s[12:15], s47 offen offset:2048 lds
    v_mfma_f32_16x16x32_bf16 a[84:87], a[188:191], v[40:43], a[84:87]
    v_exp_f32 v247, v247
    v_mfma_f32_16x16x32_bf16 a[84:87], a[192:195], v[44:47], a[84:87]
    v_exp_f32 v252, v252
    v_mfma_f32_16x16x32_bf16 a[88:91], a[188:191], v[80:83], a[88:91]
    v_exp_f32 v253, v253
    v_mfma_f32_16x16x32_bf16 a[88:91], a[192:195], v[84:87], a[88:91]
    buffer_load_dwordx4 v6, s[12:15], s47 offen offset:3072 lds
    v_mfma_f32_16x16x32_bf16 a[92:95], a[188:191], v[88:91], a[92:95]
    s_waitcnt lgkmcnt(4)
    s_add_u32 s47, s47, 16384
    s_add_u32 m0, s86, 0
    v_mfma_f32_16x16x32_bf16 a[92:95], a[192:195], v[92:95], a[92:95]
    buffer_load_dwordx4 v2, s[20:23], s87 offen lds
    v_mfma_f32_16x16x32_bf16 a[96:99], a[196:199], v[32:35], a[96:99]
    s_add_u32 m0, s86, 4096
    v_exp_f32 v254, v254
    v_mfma_f32_16x16x32_bf16 a[96:99], a[200:203], v[36:39], a[96:99]
    buffer_load_dwordx4 v2, s[24:27], s87 offen lds
    v_mfma_f32_16x16x32_bf16 a[100:103], a[196:199], v[40:43], a[100:103]
    s_add_u32 s86, s86, 8192
    v_exp_f32 v255, v255
    v_mfma_f32_16x16x32_bf16 a[100:103], a[200:203], v[44:47], a[100:103]
    v_exp_f32 v116, v116
    v_mfma_f32_16x16x32_bf16 a[104:107], a[196:199], v[80:83], a[104:107]
    s_min_u32 s86, s86, s88
    v_exp_f32 v117, v117
    v_mfma_f32_16x16x32_bf16 a[104:107], a[200:203], v[84:87], a[104:107]
    v_exp_f32 v118, v118
    v_mfma_f32_16x16x32_bf16 a[108:111], a[196:199], v[88:91], a[108:111]
    s_add_u32 s87, s87, 294912
    v_exp_f32 v119, v119
    v_mfma_f32_16x16x32_bf16 a[108:111], a[200:203], v[92:95], a[108:111]
    v_exp_f32 v124, v124
    v_mfma_f32_16x16x32_bf16 a[112:115], a[204:207], v[32:35], a[112:115]
    s_min_u32 s87, s87, 5013504
    v_exp_f32 v125, v125
    v_mfma_f32_16x16x32_bf16 a[112:115], a[208:211], v[36:39], a[112:115]
    v_exp_f32 v126, v126
    v_mfma_f32_16x16x32_bf16 a[116:119], a[204:207], v[40:43], a[116:119]
    v_exp_f32 v127, v127
    v_mfma_f32_16x16x32_bf16 a[116:119], a[208:211], v[44:47], a[116:119]
    v_cvt_pk_bf16_f32 v150, v244, v245
    v_cvt_pk_bf16_f32 v151, v246, v247
    v_mfma_f32_16x16x32_bf16 a[120:123], a[204:207], v[80:83], a[120:123]
    v_cvt_pk_bf16_f32 v158, v252, v253
    v_cvt_pk_bf16_f32 v159, v254, v255
    v_mfma_f32_16x16x32_bf16 a[120:123], a[208:211], v[84:87], a[120:123]
    v_cvt_pk_bf16_f32 v182, v116, v117
    v_cvt_pk_bf16_f32 v183, v118, v119
    v_mfma_f32_16x16x32_bf16 a[124:127], a[204:207], v[88:91], a[124:127]
    s_waitcnt lgkmcnt(0)
    v_cvt_pk_bf16_f32 v190, v124, v125
    v_cvt_pk_bf16_f32 v191, v126, v127
    v_mfma_f32_16x16x32_bf16 a[124:127], a[208:211], v[92:95], a[124:127]
    s_branch L_att
L_att_last:
    ds_read_b64_tr_b16 a[180:181], v52 offset:32768
    ds_read_b64_tr_b16 a[182:183], v52 offset:33792
    ds_read_b64_tr_b16 a[184:185], v52 offset:34816
    ds_read_b64_tr_b16 a[186:187], v52 offset:35840
    ds_read_b64_tr_b16 a[188:189], v53 offset:32768
    ds_read_b64_tr_b16 a[190:191], v53 offset:33792
    ds_read_b64_tr_b16 a[192:193], v53 offset:34816
    ds_read_b64_tr_b16 a[194:195], v53 offset:35840
    s_waitcnt vmcnt(0)
    s_barrier
    v_smfmac_f32_16x16x64_bf16 a[128:131], a[144:147], v[32:39], v63
    ds_read_b64_tr_b16 a[196:197], v54 offset:32768
    v_smfmac_f32_16x16x64_bf16 a[132:135], a[144:147], v[40:47], v63
    ds_read_b64_tr_b16 a[198:199], v54 offset:33792
    v_smfmac_f32_16x16x64_bf16 a[136:139], a[144:147], v[80:87], v63
    ds_read_b64_tr_b16 a[200:201], v54 offset:34816
    v_smfmac_f32_16x16x64_bf16 a[140:143], a[144:147], v[88:95], v63
    s_waitcnt lgkmcnt(3)
    ds_read_b64_tr_b16 a[202:203], v54 offset:35840
    v_mfma_f32_16x16x32_bf16 a[0:3], a[180:183], v[32:35], a[0:3]
    ds_read_b64_tr_b16 a[204:205], v55 offset:32768
    v_mfma_f32_16x16x32_bf16 a[0:3], a[184:187], v[36:39], a[0:3]
    ds_read_b64_tr_b16 a[206:207], v55 offset:33792
    v_mfma_f32_16x16x32_bf16 a[4:7], a[180:183], v[40:43], a[4:7]
    ds_read_b64_tr_b16 a[208:209], v55 offset:34816
    v_mfma_f32_16x16x32_bf16 a[4:7], a[184:187], v[44:47], a[4:7]
    ds_read_b64_tr_b16 a[210:211], v55 offset:35840
    v_mfma_f32_16x16x32_bf16 a[8:11], a[180:183], v[80:83], a[8:11]
    s_mov_b32 s49, 0
    s_add_u32 m0, s45, 98304
    v_mfma_f32_16x16x32_bf16 a[8:11], a[184:187], v[84:87], a[8:11]
    buffer_load_dwordx4 v2, s[20:23], s49 offen lds
    v_mfma_f32_16x16x32_bf16 a[12:15], a[180:183], v[88:91], a[12:15]
    s_add_u32 m0, s45, 102400
    v_mfma_f32_16x16x32_bf16 a[12:15], a[184:187], v[92:95], a[12:15]
    v_mfma_f32_16x16x32_bf16 a[16:19], a[188:191], v[32:35], a[16:19]
    v_mfma_f32_16x16x32_bf16 a[16:19], a[192:195], v[36:39], a[16:19]
    buffer_load_dwordx4 v2, s[24:27], s49 offen lds
    v_mfma_f32_16x16x32_bf16 a[20:23], a[188:191], v[40:43], a[20:23]
    s_mov_b32 s50, 0
    v_mfma_f32_16x16x32_bf16 a[20:23], a[192:195], v[44:47], a[20:23]
    v_mfma_f32_16x16x32_bf16 a[24:27], a[188:191], v[80:83], a[24:27]
    v_mfma_f32_16x16x32_bf16 a[24:27], a[192:195], v[84:87], a[24:27]
    v_accvgpr_read_b32 v16, a128
    v_accvgpr_read_b32 v17, a132
    v_mfma_f32_16x16x32_bf16 a[28:31], a[188:191], v[88:91], a[28:31]
    v_accvgpr_read_b32 v18, a136
    v_accvgpr_read_b32 v19, a140
    v_mfma_f32_16x16x32_bf16 a[28:31], a[192:195], v[92:95], a[28:31]
    s_waitcnt lgkmcnt(0)
    v_accvgpr_read_b32 v20, a129
    v_accvgpr_read_b32 v21, a133
    v_mfma_f32_16x16x32_bf16 a[32:35], a[196:199], v[32:35], a[32:35]
    ds_read_b64_tr_b16 a[180:181], v56 offset:32768
    v_accvgpr_read_b32 v22, a137
    v_mfma_f32_16x16x32_bf16 a[32:35], a[200:203], v[36:39], a[32:35]
    ds_read_b64_tr_b16 a[182:183], v56 offset:33792
    v_accvgpr_read_b32 v23, a141
    v_mfma_f32_16x16x32_bf16 a[36:39], a[196:199], v[40:43], a[36:39]
    ds_read_b64_tr_b16 a[184:185], v56 offset:34816
    v_add_f32 v16, v16, v20
    v_mfma_f32_16x16x32_bf16 a[36:39], a[200:203], v[44:47], a[36:39]
    ds_read_b64_tr_b16 a[186:187], v56 offset:35840
    v_add_f32 v17, v17, v21
    v_mfma_f32_16x16x32_bf16 a[40:43], a[196:199], v[80:83], a[40:43]
    ds_read_b64_tr_b16 a[188:189], v57 offset:32768
    v_add_f32 v18, v18, v22
    v_mfma_f32_16x16x32_bf16 a[40:43], a[200:203], v[84:87], a[40:43]
    ds_read_b64_tr_b16 a[190:191], v57 offset:33792
    v_add_f32 v19, v19, v23
    v_mfma_f32_16x16x32_bf16 a[44:47], a[196:199], v[88:91], a[44:47]
    ds_read_b64_tr_b16 a[192:193], v57 offset:34816
    v_add_f32 v21, v16, v17
    v_mfma_f32_16x16x32_bf16 a[44:47], a[200:203], v[92:95], a[44:47]
    ds_read_b64_tr_b16 a[194:195], v57 offset:35840
    v_add_f32 v22, v18, v19
    v_mfma_f32_16x16x32_bf16 a[48:51], a[204:207], v[32:35], a[48:51]
    v_add_f32 v21, v21, v22
    v_mov_b32 v23, 0x5d800000
    v_mfma_f32_16x16x32_bf16 a[48:51], a[208:211], v[36:39], a[48:51]
    v_cmp_nle_f32 vcc, v21, v23
    v_mfma_f32_16x16x32_bf16 a[52:55], a[204:207], v[40:43], a[52:55]
    buffer_load_dwordx4 a[148:151], v1, s[32:35], s50 offen offset:0 sc1
    v_mfma_f32_16x16x32_bf16 a[52:55], a[208:211], v[44:47], a[52:55]
    v_mfma_f32_16x16x32_bf16 a[56:59], a[204:207], v[80:83], a[56:59]
    buffer_load_dwordx4 a[152:155], v1, s[32:35], s50 offen offset:1024 sc1
    v_mfma_f32_16x16x32_bf16 a[56:59], a[208:211], v[84:87], a[56:59]
    v_mfma_f32_16x16x32_bf16 a[60:63], a[204:207], v[88:91], a[60:63]
    buffer_load_dwordx4 a[156:159], v1, s[32:35], s50 offen offset:2048 sc1
    v_mfma_f32_16x16x32_bf16 a[60:63], a[208:211], v[92:95], a[60:63]
    s_waitcnt lgkmcnt(0)
    v_mfma_f32_16x16x32_bf16 a[64:67], a[180:183], v[32:35], a[64:67]
    ds_read_b64_tr_b16 a[196:197], v58 offset:32768
    v_mfma_f32_16x16x32_bf16 a[64:67], a[184:187], v[36:39], a[64:67]
    ds_read_b64_tr_b16 a[198:199], v58 offset:33792
    v_mfma_f32_16x16x32_bf16 a[68:71], a[180:183], v[40:43], a[68:71]
    ds_read_b64_tr_b16 a[200:201], v58 offset:34816
    v_mfma_f32_16x16x32_bf16 a[68:71], a[184:187], v[44:47], a[68:71]
    ds_read_b64_tr_b16 a[202:203], v58 offset:35840
    v_mfma_f32_16x16x32_bf16 a[72:75], a[180:183], v[80:83], a[72:75]
    ds_read_b64_tr_b16 a[204:205], v59 offset:32768
    v_mfma_f32_16x16x32_bf16 a[72:75], a[184:187], v[84:87], a[72:75]
    ds_read_b64_tr_b16 a[206:207], v59 offset:33792
    v_mfma_f32_16x16x32_bf16 a[76:79], a[180:183], v[88:91], a[76:79]
    ds_read_b64_tr_b16 a[208:209], v59 offset:34816
    v_mfma_f32_16x16x32_bf16 a[76:79], a[184:187], v[92:95], a[76:79]
    ds_read_b64_tr_b16 a[210:211], v59 offset:35840
    v_mfma_f32_16x16x32_bf16 a[80:83], a[188:191], v[32:35], a[80:83]
    buffer_load_dwordx4 a[160:163], v1, s[32:35], s50 offen offset:3072 sc1
    v_mfma_f32_16x16x32_bf16 a[80:83], a[192:195], v[36:39], a[80:83]
    s_mov_b32 s49, 294912
    s_add_u32 m0, s45, 106496
    v_mfma_f32_16x16x32_bf16 a[84:87], a[188:191], v[40:43], a[84:87]
    buffer_load_dwordx4 v2, s[20:23], s49 offen lds
    v_mfma_f32_16x16x32_bf16 a[84:87], a[192:195], v[44:47], a[84:87]
    s_add_u32 m0, s45, 110592
    v_mfma_f32_16x16x32_bf16 a[88:91], a[188:191], v[80:83], a[88:91]
    buffer_load_dwordx4 v2, s[24:27], s49 offen lds
    v_mfma_f32_16x16x32_bf16 a[88:91], a[192:195], v[84:87], a[88:91]
    s_mov_b32 s50, 4096
    v_mfma_f32_16x16x32_bf16 a[92:95], a[188:191], v[88:91], a[92:95]
    buffer_load_dwordx4 a[164:167], v1, s[32:35], s50 offen offset:0 sc1
    v_mfma_f32_16x16x32_bf16 a[92:95], a[192:195], v[92:95], a[92:95]
    s_waitcnt lgkmcnt(0)
    v_mfma_f32_16x16x32_bf16 a[96:99], a[196:199], v[32:35], a[96:99]
    buffer_load_dwordx4 a[168:171], v1, s[32:35], s50 offen offset:1024 sc1
    v_mfma_f32_16x16x32_bf16 a[96:99], a[200:203], v[36:39], a[96:99]
    s_lshl_b32 s4, s40, 2
    s_add_u32 s4, s4, 0x24000
    v_mfma_f32_16x16x32_bf16 a[100:103], a[196:199], v[40:43], a[100:103]
    buffer_load_dwordx4 a[172:175], v1, s[32:35], s50 offen offset:2048 sc1
    v_mfma_f32_16x16x32_bf16 a[100:103], a[200:203], v[44:47], a[100:103]
    s_cmp_lg_u64 vcc, 0
    s_cselect_b32 s3, 1, 0
    v_mfma_f32_16x16x32_bf16 a[104:107], a[196:199], v[80:83], a[104:107]
    v_mov_b32 v24, s3
    v_mov_b32 v25, s4
    v_mfma_f32_16x16x32_bf16 a[104:107], a[200:203], v[84:87], a[104:107]
    ds_write_b32 v25, v24
    v_mfma_f32_16x16x32_bf16 a[108:111], a[196:199], v[88:91], a[108:111]
    buffer_load_dwordx4 a[176:179], v1, s[32:35], s50 offen offset:3072 sc1
    v_mfma_f32_16x16x32_bf16 a[108:111], a[200:203], v[92:95], a[108:111]
    s_mov_b32 s49, 589824
    s_add_u32 m0, s45, 114688
    v_mov_b32 v25, 0x24000
    v_mfma_f32_16x16x32_bf16 a[112:115], a[204:207], v[32:35], a[112:115]
    buffer_load_dwordx4 v2, s[20:23], s49 offen lds
    v_mfma_f32_16x16x32_bf16 a[112:115], a[208:211], v[36:39], a[112:115]
    s_waitcnt lgkmcnt(0)
    s_barrier
    s_add_u32 m0, s45, 118784
    v_mfma_f32_16x16x32_bf16 a[116:119], a[204:207], v[40:43], a[116:119]
    buffer_load_dwordx4 v2, s[24:27], s49 offen lds
    v_mfma_f32_16x16x32_bf16 a[116:119], a[208:211], v[44:47], a[116:119]
    ds_read_b128 v[24:27], v25
    v_mfma_f32_16x16x32_bf16 a[120:123], a[204:207], v[80:83], a[120:123]
    v_mfma_f32_16x16x32_bf16 a[120:123], a[208:211], v[84:87], a[120:123]
    v_mfma_f32_16x16x32_bf16 a[124:127], a[204:207], v[88:91], a[124:127]
    v_mfma_f32_16x16x32_bf16 a[124:127], a[208:211], v[92:95], a[124:127]
    s_waitcnt lgkmcnt(0)
    v_or3_b32 v24, v24, v25, v26
    v_or_b32 v24, v24, v27
    s_lshl_b32 s59, s41, 14
    v_readfirstlane_b32 s3, v24
    s_cmp_lg_u32 s3, 0
    s_cbranch_scc1 L_slow_entry
L_att_fin:
    v_mov_b32 v4, v10
    v_mov_b32 v5, v11
    v_lshrrev_b32 v12, 2, v0
    v_lshlrev_b32 v12, 7, v12
    v_and_b32 v13, 3, v0
    v_lshl_add_u32 v12, v13, 3, v12
    v_bfe_u32 v14, v0, 3, 2
    v_xor_b32 v15, 0, v14
    v_lshl_add_u32 v8, v15, 5, v12
    v_xor_b32 v15, 1, v14
    v_lshl_add_u32 v9, v15, 5, v12
    v_xor_b32 v15, 2, v14
    v_lshl_add_u32 v10, v15, 5, v12
    v_xor_b32 v15, 3, v14
    v_lshl_add_u32 v11, v15, 5, v12
    v_lshlrev_b32 v7, 3, v0
    v_lshlrev_b32 v6, 20, v0
    s_lshl_b32 s86, s40, 28
    v_rcp_f32 v12, v16
    v_rcp_f32 v13, v17
    v_rcp_f32 v14, v18
    v_rcp_f32 v15, v19
    v_mov_b32 v24, v12
    v_mov_b32 v25, v12
    v_mov_b32 v26, v13
    v_mov_b32 v27, v13
    v_mov_b32 v28, v14
    v_mov_b32 v29, v14
    v_mov_b32 v30, v15
    v_mov_b32 v31, v15
    v_accvgpr_read_b32 v16, a0
    v_accvgpr_read_b32 v17, a1
    v_accvgpr_read_b32 v18, a2
    v_accvgpr_read_b32 v19, a3
    v_accvgpr_read_b32 v20, a16
    v_accvgpr_read_b32 v21, a17
    v_accvgpr_read_b32 v22, a18
    v_accvgpr_read_b32 v23, a19
    v_pk_mul_f32 v[16:17], v[16:17], v[24:25]
    v_pk_mul_f32 v[18:19], v[18:19], v[24:25]
    v_pk_mul_f32 v[20:21], v[20:21], v[24:25]
    v_pk_mul_f32 v[22:23], v[22:23], v[24:25]
    v_cvt_pk_bf16_f32 v224, v16, v17
    v_cvt_pk_bf16_f32 v225, v18, v19
    v_cvt_pk_bf16_f32 v226, v20, v21
    v_cvt_pk_bf16_f32 v227, v22, v23
    s_mov_b32 s50, 8192
    s_nop 0
    buffer_load_dwordx4 a[212:215], v1, s[32:35], s50 offen offset:0 sc1
    v_accvgpr_read_b32 v16, a4
    v_accvgpr_read_b32 v17, a5
    v_accvgpr_read_b32 v18, a6
    v_accvgpr_read_b32 v19, a7
    v_accvgpr_read_b32 v20, a20
    v_accvgpr_read_b32 v21, a21
    v_accvgpr_read_b32 v22, a22
    v_accvgpr_read_b32 v23, a23
    v_pk_mul_f32 v[16:17], v[16:17], v[26:27]
    v_pk_mul_f32 v[18:19], v[18:19], v[26:27]
    v_pk_mul_f32 v[20:21], v[20:21], v[26:27]
    v_pk_mul_f32 v[22:23], v[22:23], v[26:27]
    v_cvt_pk_bf16_f32 v228, v16, v17
    v_cvt_pk_bf16_f32 v229, v18, v19
    v_cvt_pk_bf16_f32 v230, v20, v21
    v_cvt_pk_bf16_f32 v231, v22, v23
    s_nop 0
    buffer_load_dwordx4 a[216:219], v1, s[32:35], s50 offen offset:1024 sc1
    s_nop 0
    buffer_load_dwordx4 a[220:223], v1, s[32:35], s50 offen offset:2048 sc1
    v_accvgpr_read_b32 v16, a8
    v_accvgpr_read_b32 v17, a9
    v_accvgpr_read_b32 v18, a10
    v_accvgpr_read_b32 v19, a11
    v_accvgpr_read_b32 v20, a24
    v_accvgpr_read_b32 v21, a25
    v_accvgpr_read_b32 v22, a26
    v_accvgpr_read_b32 v23, a27
    v_pk_mul_f32 v[16:17], v[16:17], v[28:29]
    v_pk_mul_f32 v[18:19], v[18:19], v[28:29]
    v_pk_mul_f32 v[20:21], v[20:21], v[28:29]
    v_pk_mul_f32 v[22:23], v[22:23], v[28:29]
    v_cvt_pk_bf16_f32 v232, v16, v17
    v_cvt_pk_bf16_f32 v233, v18, v19
    v_cvt_pk_bf16_f32 v234, v20, v21
    v_cvt_pk_bf16_f32 v235, v22, v23
    s_nop 0
    buffer_load_dwordx4 a[128:131], v1, s[32:35], s50 offen offset:3072 sc1
    s_mov_b32 s50, 69632
    s_nop 0
    buffer_load_dwordx4 v[80:83], v1, s[32:35], s50 offen offset:0 sc1
    v_accvgpr_read_b32 v16, a12
    v_accvgpr_read_b32 v17, a13
    v_accvgpr_read_b32 v18, a14
    v_accvgpr_read_b32 v19, a15
    v_accvgpr_read_b32 v20, a28
    v_accvgpr_read_b32 v21, a29
    v_accvgpr_read_b32 v22, a30
    v_accvgpr_read_b32 v23, a31
    v_pk_mul_f32 v[16:17], v[16:17], v[30:31]
    v_pk_mul_f32 v[18:19], v[18:19], v[30:31]
    v_pk_mul_f32 v[20:21], v[20:21], v[30:31]
    v_pk_mul_f32 v[22:23], v[22:23], v[30:31]
    v_cvt_pk_bf16_f32 v236, v16, v17
    v_cvt_pk_bf16_f32 v237, v18, v19
    v_cvt_pk_bf16_f32 v238, v20, v21
    v_cvt_pk_bf16_f32 v239, v22, v23
    s_nop 0
    buffer_load_dwordx4 v[84:87], v1, s[32:35], s50 offen offset:1024 sc1
    s_nop 0
    buffer_load_dwordx4 v[88:91], v1, s[32:35], s50 offen offset:2048 sc1
    v_accvgpr_read_b32 v16, a32
    v_accvgpr_read_b32 v17, a33
    v_accvgpr_read_b32 v18, a34
    v_accvgpr_read_b32 v19, a35
    v_accvgpr_read_b32 v20, a48
    v_accvgpr_read_b32 v21, a49
    v_accvgpr_read_b32 v22, a50
    v_accvgpr_read_b32 v23, a51
    v_pk_mul_f32 v[16:17], v[16:17], v[24:25]
    v_pk_mul_f32 v[18:19], v[18:19], v[24:25]
    v_pk_mul_f32 v[20:21], v[20:21], v[24:25]
    v_pk_mul_f32 v[22:23], v[22:23], v[24:25]
    v_cvt_pk_bf16_f32 v240, v16, v17
    v_cvt_pk_bf16_f32 v241, v18, v19
    v_cvt_pk_bf16_f32 v242, v20, v21
    v_cvt_pk_bf16_f32 v243, v22, v23
    s_nop 0
    buffer_load_dwordx4 v[92:95], v1, s[32:35], s50 offen offset:3072 sc1
    v_accvgpr_read_b32 v16, a36
    v_accvgpr_read_b32 v17, a37
    v_accvgpr_read_b32 v18, a38
    v_accvgpr_read_b32 v19, a39
    v_accvgpr_read_b32 v20, a52
    v_accvgpr_read_b32 v21, a53
    v_accvgpr_read_b32 v22, a54
    v_accvgpr_read_b32 v23, a55
    v_pk_mul_f32 v[16:17], v[16:17], v[26:27]
    v_pk_mul_f32 v[18:19], v[18:19], v[26:27]
    v_pk_mul_f32 v[20:21], v[20:21], v[26:27]
    v_pk_mul_f32 v[22:23], v[22:23], v[26:27]
    v_cvt_pk_bf16_f32 v48, v16, v17
    v_cvt_pk_bf16_f32 v49, v18, v19
    v_cvt_pk_bf16_f32 v50, v20, v21
    v_cvt_pk_bf16_f32 v51, v22, v23
    s_mov_b32 s49, 884736
    s_add_u32 m0, s45, 122880
    s_nop 0
    buffer_load_dwordx4 v2, s[20:23], s49 offen lds
    s_add_u32 m0, s45, 126976
    s_nop 0
    buffer_load_dwordx4 v2, s[24:27], s49 offen lds
    v_accvgpr_read_b32 v16, a40
    v_accvgpr_read_b32 v17, a41
    v_accvgpr_read_b32 v18, a42
    v_accvgpr_read_b32 v19, a43
    v_accvgpr_read_b32 v20, a56
    v_accvgpr_read_b32 v21, a57
    v_accvgpr_read_b32 v22, a58
    v_accvgpr_read_b32 v23, a59
    v_pk_mul_f32 v[16:17], v[16:17], v[28:29]
    v_pk_mul_f32 v[18:19], v[18:19], v[28:29]
    v_pk_mul_f32 v[20:21], v[20:21], v[28:29]
    v_pk_mul_f32 v[22:23], v[22:23], v[28:29]
    v_cvt_pk_bf16_f32 v52, v16, v17
    v_cvt_pk_bf16_f32 v53, v18, v19
    v_cvt_pk_bf16_f32 v54, v20, v21
    v_cvt_pk_bf16_f32 v55, v22, v23
    s_mov_b32 s50, 12288
    s_nop 0
    buffer_load_dwordx4 a[132:135], v1, s[32:35], s50 offen offset:0 sc1
    s_nop 0
    buffer_load_dwordx4 a[136:139], v1, s[32:35], s50 offen offset:1024 sc1
    v_accvgpr_read_b32 v16, a44
    v_accvgpr_read_b32 v17, a45
    v_accvgpr_read_b32 v18, a46
    v_accvgpr_read_b32 v19, a47
    v_accvgpr_read_b32 v20, a60
    v_accvgpr_read_b32 v21, a61
    v_accvgpr_read_b32 v22, a62
    v_accvgpr_read_b32 v23, a63
    v_pk_mul_f32 v[16:17], v[16:17], v[30:31]
    v_pk_mul_f32 v[18:19], v[18:19], v[30:31]
    v_pk_mul_f32 v[20:21], v[20:21], v[30:31]
    v_pk_mul_f32 v[22:23], v[22:23], v[30:31]
    v_cvt_pk_bf16_f32 v56, v16, v17
    v_cvt_pk_bf16_f32 v57, v18, v19
    v_cvt_pk_bf16_f32 v58, v20, v21
    v_cvt_pk_bf16_f32 v59, v22, v23
    s_nop 0
    buffer_load_dwordx4 a[140:143], v1, s[32:35], s50 offen offset:2048 sc1
    s_nop 0
    buffer_load_dwordx4 a[144:147], v1, s[32:35], s50 offen offset:3072 sc1
    s_waitcnt vmcnt(63)
    s_barrier
    v_add_u32 v8, 0x10000, v8
    ds_read_b64_tr_b16 v[16:17], v8 offset:0
    ds_read_b64_tr_b16 v[18:19], v8 offset:2048
    ds_read_b64_tr_b16 v[20:21], v8 offset:8192
    ds_read_b64_tr_b16 v[22:23], v8 offset:10240
    ds_read_b64_tr_b16 v[24:25], v8 offset:4096
    ds_read_b64_tr_b16 v[26:27], v8 offset:6144
    ds_read_b64_tr_b16 v[28:29], v8 offset:12288
    ds_read_b64_tr_b16 v[30:31], v8 offset:14336
    v_add_u32 v9, 0x10000, v9
    ds_read_b64_tr_b16 v[32:33], v9 offset:0
    ds_read_b64_tr_b16 v[34:35], v9 offset:2048
    ds_read_b64_tr_b16 v[36:37], v9 offset:8192
    ds_read_b64_tr_b16 v[38:39], v9 offset:10240
    ds_read_b64_tr_b16 v[40:41], v9 offset:4096
    ds_read_b64_tr_b16 v[42:43], v9 offset:6144
    v_add_u32 v10, 0x10000, v10
    s_waitcnt lgkmcnt(10)
    v_mfma_f32_16x16x32_bf16 v[96:99], v[16:19], a[224:227], 0
    ds_read_b64_tr_b16 v[44:45], v9 offset:12288
    v_mfma_f32_16x16x32_bf16 v[96:99], v[20:23], a[240:243], v[96:99]
    ds_read_b64_tr_b16 v[46:47], v9 offset:14336
    v_accvgpr_read_b32 v60, a64
    v_mfma_f32_16x16x32_bf16 v[100:103], v[16:19], a[228:231], 0
    buffer_store_dwordx4 v[224:227], v1, s[36:39], s59 offen offset:0 sc1
    v_mfma_f32_16x16x32_bf16 v[100:103], v[20:23], a[244:247], v[100:103]
    v_accvgpr_read_b32 v61, a65
    v_accvgpr_read_b32 v62, a66
    v_mfma_f32_16x16x32_bf16 v[104:107], v[16:19], a[232:235], 0
    v_accvgpr_read_b32 v63, a67
    v_mul_f32 v60, v60, v12
    v_mfma_f32_16x16x32_bf16 v[104:107], v[20:23], a[248:251], v[104:107]
    v_mul_f32 v61, v61, v12
    v_mul_f32 v62, v62, v12
    v_mfma_f32_16x16x32_bf16 v[108:111], v[16:19], a[236:239], 0
    v_mul_f32 v63, v63, v12
    v_accvgpr_read_b32 v252, a80
    v_mfma_f32_16x16x32_bf16 v[108:111], v[20:23], a[252:255], v[108:111]
    s_waitcnt lgkmcnt(8)
    ds_read_b64_tr_b16 v[16:17], v10 offset:0
    v_mfma_f32_16x16x32_bf16 v[112:115], v[24:27], a[224:227], 0
    ds_read_b64_tr_b16 v[18:19], v10 offset:2048
    v_accvgpr_read_b32 v253, a81
    v_mfma_f32_16x16x32_bf16 v[112:115], v[28:31], a[240:243], v[112:115]
    ds_read_b64_tr_b16 v[20:21], v10 offset:8192
    v_accvgpr_read_b32 v254, a82
    v_mfma_f32_16x16x32_bf16 v[116:119], v[24:27], a[228:231], 0
    ds_read_b64_tr_b16 v[22:23], v10 offset:10240
    v_accvgpr_read_b32 v255, a83
    v_mfma_f32_16x16x32_bf16 v[116:119], v[28:31], a[244:247], v[116:119]
    v_mul_f32 v252, v252, v12
    v_mul_f32 v253, v253, v12
    v_mfma_f32_16x16x32_bf16 v[120:123], v[24:27], a[232:235], 0
    buffer_store_dwordx4 v[228:231], v1, s[36:39], s59 offen offset:1024 sc1
    v_mfma_f32_16x16x32_bf16 v[120:123], v[28:31], a[248:251], v[120:123]
    v_mul_f32 v254, v254, v12
    v_mul_f32 v255, v255, v12
    v_mfma_f32_16x16x32_bf16 v[124:127], v[24:27], a[236:239], 0
    v_cvt_pk_bf16_f32 v60, v60, v61
    v_cvt_pk_bf16_f32 v61, v62, v63
    v_mfma_f32_16x16x32_bf16 v[124:127], v[28:31], a[252:255], v[124:127]
    s_waitcnt lgkmcnt(8)
    ds_read_b64_tr_b16 v[24:25], v10 offset:4096
    v_mfma_f32_16x16x32_bf16 v[128:131], v[32:35], a[224:227], 0
    ds_read_b64_tr_b16 v[26:27], v10 offset:6144
    v_add_u32 v11, 0x10000, v11
    v_mfma_f32_16x16x32_bf16 v[128:131], v[36:39], a[240:243], v[128:131]
    ds_read_b64_tr_b16 v[28:29], v10 offset:12288
    v_cvt_pk_bf16_f32 v62, v252, v253
    v_mfma_f32_16x16x32_bf16 v[132:135], v[32:35], a[228:231], 0
    ds_read_b64_tr_b16 v[30:31], v10 offset:14336
    v_cvt_pk_bf16_f32 v63, v254, v255
    v_mfma_f32_16x16x32_bf16 v[132:135], v[36:39], a[244:247], v[132:135]
    v_accvgpr_read_b32 v244, a68
    v_accvgpr_read_b32 v245, a69
    v_mfma_f32_16x16x32_bf16 v[136:139], v[32:35], a[232:235], 0
    v_accvgpr_read_b32 v246, a70
    v_accvgpr_read_b32 v247, a71
    v_mfma_f32_16x16x32_bf16 v[136:139], v[36:39], a[248:251], v[136:139]
    v_mul_f32 v244, v244, v13
    v_mul_f32 v245, v245, v13
    v_mfma_f32_16x16x32_bf16 v[140:143], v[32:35], a[236:239], 0
    buffer_store_dwordx4 v[232:235], v1, s[36:39], s59 offen offset:2048 sc1
    v_mfma_f32_16x16x32_bf16 v[140:143], v[36:39], a[252:255], v[140:143]
    s_waitcnt lgkmcnt(8)
    ds_read_b64_tr_b16 v[32:33], v11 offset:0
    v_mfma_f32_16x16x32_bf16 v[144:147], v[40:43], a[224:227], 0
    ds_read_b64_tr_b16 v[34:35], v11 offset:2048
    v_mul_f32 v246, v246, v13
    v_mfma_f32_16x16x32_bf16 v[144:147], v[44:47], a[240:243], v[144:147]
    ds_read_b64_tr_b16 v[36:37], v11 offset:8192
    v_mul_f32 v247, v247, v13
    v_mfma_f32_16x16x32_bf16 v[148:151], v[40:43], a[228:231], 0
    ds_read_b64_tr_b16 v[38:39], v11 offset:10240
    v_accvgpr_read_b32 v252, a84
    v_mfma_f32_16x16x32_bf16 v[148:151], v[44:47], a[244:247], v[148:151]
    v_accvgpr_read_b32 v253, a85
    v_accvgpr_read_b32 v254, a86
    v_mfma_f32_16x16x32_bf16 v[152:155], v[40:43], a[232:235], 0
    v_accvgpr_read_b32 v255, a87
    v_mul_f32 v252, v252, v13
    v_mfma_f32_16x16x32_bf16 v[152:155], v[44:47], a[248:251], v[152:155]
    v_mul_f32 v253, v253, v13
    v_mul_f32 v254, v254, v13
    v_mfma_f32_16x16x32_bf16 v[156:159], v[40:43], a[236:239], 0
    v_mul_f32 v255, v255, v13
    v_cvt_pk_bf16_f32 v244, v244, v245
    v_mfma_f32_16x16x32_bf16 v[156:159], v[44:47], a[252:255], v[156:159]
    s_waitcnt lgkmcnt(8)
    ds_read_b64_tr_b16 v[40:41], v11 offset:4096
    v_mfma_f32_16x16x32_bf16 v[160:163], v[16:19], a[224:227], 0
    ds_read_b64_tr_b16 v[42:43], v11 offset:6144
    v_cvt_pk_bf16_f32 v245, v246, v247
    v_mfma_f32_16x16x32_bf16 v[160:163], v[20:23], a[240:243], v[160:163]
    ds_read_b64_tr_b16 v[44:45], v11 offset:12288
    v_cvt_pk_bf16_f32 v246, v252, v253
    v_mfma_f32_16x16x32_bf16 v[164:167], v[16:19], a[228:231], 0
    ds_read_b64_tr_b16 v[46:47], v11 offset:14336
    v_cvt_pk_bf16_f32 v247, v254, v255
    v_mfma_f32_16x16x32_bf16 v[164:167], v[20:23], a[244:247], v[164:167]
    buffer_store_dwordx4 v[236:239], v1, s[36:39], s59 offen offset:3072 sc1
    v_mfma_f32_16x16x32_bf16 v[168:171], v[16:19], a[232:235], 0
    v_accvgpr_read_b32 v248, a72
    v_accvgpr_read_b32 v249, a73
    v_mfma_f32_16x16x32_bf16 v[168:171], v[20:23], a[248:251], v[168:171]
    v_accvgpr_read_b32 v250, a74
    v_accvgpr_read_b32 v251, a75
    v_mfma_f32_16x16x32_bf16 v[172:175], v[16:19], a[236:239], 0
    s_add_u32 s59, s59, 4096
    v_mul_f32 v248, v248, v14
    v_mul_f32 v249, v249, v14
    v_mfma_f32_16x16x32_bf16 v[172:175], v[20:23], a[252:255], v[172:175]
    s_waitcnt lgkmcnt(8)
    ds_read_b64_tr_b16 v[16:17], v8 offset:16384
    v_mfma_f32_16x16x32_bf16 v[176:179], v[24:27], a[224:227], 0
    ds_read_b64_tr_b16 v[18:19], v8 offset:18432
    v_mul_f32 v250, v250, v14
    v_mfma_f32_16x16x32_bf16 v[176:179], v[28:31], a[240:243], v[176:179]
    ds_read_b64_tr_b16 v[20:21], v8 offset:24576
    v_mul_f32 v251, v251, v14
    v_mfma_f32_16x16x32_bf16 v[180:183], v[24:27], a[228:231], 0
    ds_read_b64_tr_b16 v[22:23], v8 offset:26624
    v_accvgpr_read_b32 v252, a88
    v_mfma_f32_16x16x32_bf16 v[180:183], v[28:31], a[244:247], v[180:183]
    buffer_store_dwordx4 v[240:243], v1, s[36:39], s59 offen offset:0 sc1
    v_mfma_f32_16x16x32_bf16 v[184:187], v[24:27], a[232:235], 0
    v_accvgpr_read_b32 v253, a89
    v_accvgpr_read_b32 v254, a90
    v_mfma_f32_16x16x32_bf16 v[184:187], v[28:31], a[248:251], v[184:187]
    v_accvgpr_read_b32 v255, a91
    v_mul_f32 v252, v252, v14
    v_mfma_f32_16x16x32_bf16 v[188:191], v[24:27], a[236:239], 0
    v_mul_f32 v253, v253, v14
    v_mul_f32 v254, v254, v14
    v_mfma_f32_16x16x32_bf16 v[188:191], v[28:31], a[252:255], v[188:191]
    s_waitcnt lgkmcnt(8)
    ds_read_b64_tr_b16 v[24:25], v8 offset:20480
    v_mfma_f32_16x16x32_bf16 v[192:195], v[32:35], a[224:227], 0
    s_mov_b32 s49, 1179648
    ds_read_b64_tr_b16 v[26:27], v8 offset:22528
    v_mfma_f32_16x16x32_bf16 v[192:195], v[36:39], a[240:243], v[192:195]
    s_add_u32 m0, s45, 131072
    ds_read_b64_tr_b16 v[28:29], v8 offset:28672
    v_mfma_f32_16x16x32_bf16 v[196:199], v[32:35], a[228:231], 0
    ds_read_b64_tr_b16 v[30:31], v8 offset:30720
    v_mul_f32 v255, v255, v14
    v_mfma_f32_16x16x32_bf16 v[196:199], v[36:39], a[244:247], v[196:199]
    buffer_load_dwordx4 v2, s[20:23], s49 offen lds
    v_mfma_f32_16x16x32_bf16 v[200:203], v[32:35], a[232:235], 0
    s_add_u32 m0, s45, 135168
    v_cvt_pk_bf16_f32 v248, v248, v249
    v_cvt_pk_bf16_f32 v249, v250, v251
    v_mfma_f32_16x16x32_bf16 v[200:203], v[36:39], a[248:251], v[200:203]
    v_cvt_pk_bf16_f32 v250, v252, v253
    v_cvt_pk_bf16_f32 v251, v254, v255
    v_mfma_f32_16x16x32_bf16 v[204:207], v[32:35], a[236:239], 0
    buffer_load_dwordx4 v2, s[24:27], s49 offen lds
    v_mfma_f32_16x16x32_bf16 v[204:207], v[36:39], a[252:255], v[204:207]
    s_waitcnt lgkmcnt(8)
    ds_read_b64_tr_b16 v[32:33], v9 offset:16384
    v_mfma_f32_16x16x32_bf16 v[208:211], v[40:43], a[224:227], 0
    s_mov_b32 s50, 16384
    ds_read_b64_tr_b16 v[34:35], v9 offset:18432
    v_mfma_f32_16x16x32_bf16 v[208:211], v[44:47], a[240:243], v[208:211]
    ds_read_b64_tr_b16 v[36:37], v9 offset:24576
    v_accvgpr_read_b32 v224, a76
    v_mfma_f32_16x16x32_bf16 v[212:215], v[40:43], a[228:231], 0
    ds_read_b64_tr_b16 v[38:39], v9 offset:26624
    v_accvgpr_read_b32 v225, a77
    v_mfma_f32_16x16x32_bf16 v[212:215], v[44:47], a[244:247], v[212:215]
    buffer_load_dwordx4 a[180:183], v1, s[32:35], s50 offen offset:0 sc1
    v_mfma_f32_16x16x32_bf16 v[216:219], v[40:43], a[232:235], 0
    v_accvgpr_read_b32 v226, a78
    v_accvgpr_read_b32 v227, a79
    v_mfma_f32_16x16x32_bf16 v[216:219], v[44:47], a[248:251], v[216:219]
    v_mul_f32 v224, v224, v15
    v_mul_f32 v225, v225, v15
    v_mfma_f32_16x16x32_bf16 v[220:223], v[40:43], a[236:239], 0
    v_mul_f32 v226, v226, v15
    v_mul_f32 v227, v227, v15
    v_mfma_f32_16x16x32_bf16 v[220:223], v[44:47], a[252:255], v[220:223]
    s_waitcnt vmcnt(14) lgkmcnt(8)
    ds_read_b64_tr_b16 v[40:41], v9 offset:20480
    v_mfma_f32_16x16x32_bf16 v[96:99], v[16:19], v[64:67], v[96:99]
    ds_read_b64_tr_b16 v[42:43], v9 offset:22528
    v_accvgpr_read_b32 v252, a92
    v_mfma_f32_16x16x32_bf16 v[96:99], v[20:23], v[80:83], v[96:99]
    ds_read_b64_tr_b16 v[44:45], v9 offset:28672
    v_accvgpr_read_b32 v253, a93
    v_mfma_f32_16x16x32_bf16 v[100:103], v[16:19], v[68:71], v[100:103]
    ds_read_b64_tr_b16 v[46:47], v9 offset:30720
    v_accvgpr_read_b32 v254, a94
    v_mfma_f32_16x16x32_bf16 v[100:103], v[20:23], v[84:87], v[100:103]
    buffer_load_dwordx4 a[184:187], v1, s[32:35], s50 offen offset:1024 sc1
    v_mfma_f32_16x16x32_bf16 v[104:107], v[16:19], v[72:75], v[104:107]
    buffer_load_dwordx4 a[188:191], v1, s[32:35], s50 offen offset:2048 sc1
    v_mfma_f32_16x16x32_bf16 v[104:107], v[20:23], v[88:91], v[104:107]
    v_accvgpr_read_b32 v255, a95
    v_mul_f32 v252, v252, v15
    v_mfma_f32_16x16x32_bf16 v[108:111], v[16:19], v[76:79], v[108:111]
    v_mul_f32 v253, v253, v15
    v_mul_f32 v254, v254, v15
    v_mfma_f32_16x16x32_bf16 v[108:111], v[20:23], v[92:95], v[108:111]
    s_waitcnt lgkmcnt(8)
    ds_read_b64_tr_b16 v[16:17], v10 offset:16384
    v_mfma_f32_16x16x32_bf16 v[112:115], v[24:27], v[64:67], v[112:115]
    ds_read_b64_tr_b16 v[18:19], v10 offset:18432
    v_mul_f32 v255, v255, v15
    v_mfma_f32_16x16x32_bf16 v[112:115], v[28:31], v[80:83], v[112:115]
    ds_read_b64_tr_b16 v[20:21], v10 offset:24576
    v_cvt_pk_bf16_f32 v224, v224, v225
    v_mfma_f32_16x16x32_bf16 v[116:119], v[24:27], v[68:71], v[116:119]
    ds_read_b64_tr_b16 v[22:23], v10 offset:26624
    v_cvt_pk_bf16_f32 v225, v226, v227
    v_mfma_f32_16x16x32_bf16 v[116:119], v[28:31], v[84:87], v[116:119]
    buffer_load_dwordx4 a[192:195], v1, s[32:35], s50 offen offset:3072 sc1
    v_mfma_f32_16x16x32_bf16 v[120:123], v[24:27], v[72:75], v[120:123]
    s_mov_b32 s49, 1474560
    s_add_u32 m0, s45, 139264
    v_cvt_pk_bf16_f32 v226, v252, v253
    v_mfma_f32_16x16x32_bf16 v[120:123], v[28:31], v[88:91], v[120:123]
    buffer_load_dwordx4 v2, s[20:23], s49 offen lds
    v_mfma_f32_16x16x32_bf16 v[124:127], v[24:27], v[76:79], v[124:127]
    s_add_u32 m0, s45, 143360
    v_cvt_pk_bf16_f32 v227, v254, v255
    v_mfma_f32_16x16x32_bf16 v[124:127], v[28:31], v[92:95], v[124:127]
    s_waitcnt lgkmcnt(8)
    ds_read_b64_tr_b16 v[24:25], v10 offset:20480
    v_mfma_f32_16x16x32_bf16 v[128:131], v[32:35], v[64:67], v[128:131]
    ds_read_b64_tr_b16 v[26:27], v10 offset:22528
    v_accvgpr_read_b32 v228, a96
    v_mfma_f32_16x16x32_bf16 v[128:131], v[36:39], v[80:83], v[128:131]
    ds_read_b64_tr_b16 v[28:29], v10 offset:28672
    v_accvgpr_read_b32 v229, a97
    v_mfma_f32_16x16x32_bf16 v[132:135], v[32:35], v[68:71], v[132:135]
    ds_read_b64_tr_b16 v[30:31], v10 offset:30720
    v_accvgpr_read_b32 v230, a98
    v_mfma_f32_16x16x32_bf16 v[132:135], v[36:39], v[84:87], v[132:135]
    buffer_load_dwordx4 v2, s[24:27], s49 offen lds
    v_mfma_f32_16x16x32_bf16 v[136:139], v[32:35], v[72:75], v[136:139]
    s_mov_b32 s50, 20480
    v_accvgpr_read_b32 v231, a99
    v_mul_f32 v228, v228, v12
    v_mfma_f32_16x16x32_bf16 v[136:139], v[36:39], v[88:91], v[136:139]
    buffer_load_dwordx4 a[196:199], v1, s[32:35], s50 offen offset:0 sc1
    v_mfma_f32_16x16x32_bf16 v[140:143], v[32:35], v[76:79], v[140:143]
    v_mul_f32 v229, v229, v12
    v_mul_f32 v230, v230, v12
    v_mfma_f32_16x16x32_bf16 v[140:143], v[36:39], v[92:95], v[140:143]
    s_waitcnt lgkmcnt(8)
    ds_read_b64_tr_b16 v[32:33], v11 offset:16384
    v_mfma_f32_16x16x32_bf16 v[144:147], v[40:43], v[64:67], v[144:147]
    ds_read_b64_tr_b16 v[34:35], v11 offset:18432
    v_mul_f32 v231, v231, v12
    v_mfma_f32_16x16x32_bf16 v[144:147], v[44:47], v[80:83], v[144:147]
    ds_read_b64_tr_b16 v[36:37], v11 offset:24576
    v_accvgpr_read_b32 v252, a112
    v_mfma_f32_16x16x32_bf16 v[148:151], v[40:43], v[68:71], v[148:151]
    ds_read_b64_tr_b16 v[38:39], v11 offset:26624
    v_accvgpr_read_b32 v253, a113
    v_mfma_f32_16x16x32_bf16 v[148:151], v[44:47], v[84:87], v[148:151]
    buffer_load_dwordx4 a[200:203], v1, s[32:35], s50 offen offset:1024 sc1
    v_mfma_f32_16x16x32_bf16 v[152:155], v[40:43], v[72:75], v[152:155]
    v_accvgpr_read_b32 v254, a114
    v_accvgpr_read_b32 v255, a115
    v_mfma_f32_16x16x32_bf16 v[152:155], v[44:47], v[88:91], v[152:155]
    buffer_load_dwordx4 a[204:207], v1, s[32:35], s50 offen offset:2048 sc1
    v_mfma_f32_16x16x32_bf16 v[156:159], v[40:43], v[76:79], v[156:159]
    v_mul_f32 v252, v252, v12
    v_mul_f32 v253, v253, v12
    v_mfma_f32_16x16x32_bf16 v[156:159], v[44:47], v[92:95], v[156:159]
    s_waitcnt lgkmcnt(8)
    ds_read_b64_tr_b16 v[40:41], v11 offset:20480
    v_mfma_f32_16x16x32_bf16 v[160:163], v[16:19], v[64:67], v[160:163]
    ds_read_b64_tr_b16 v[42:43], v11 offset:22528
    v_mul_f32 v254, v254, v12
    v_mfma_f32_16x16x32_bf16 v[160:163], v[20:23], v[80:83], v[160:163]
    ds_read_b64_tr_b16 v[44:45], v11 offset:28672
    v_mul_f32 v255, v255, v12
    v_mfma_f32_16x16x32_bf16 v[164:167], v[16:19], v[68:71], v[164:167]
    ds_read_b64_tr_b16 v[46:47], v11 offset:30720
    v_cvt_pk_bf16_f32 v228, v228, v229
    v_mfma_f32_16x16x32_bf16 v[164:167], v[20:23], v[84:87], v[164:167]
    buffer_load_dwordx4 a[208:211], v1, s[32:35], s50 offen offset:3072 sc1
    v_mfma_f32_16x16x32_bf16 v[168:171], v[16:19], v[72:75], v[168:171]
    s_mov_b32 s49, 1769472
    s_add_u32 m0, s45, 147456
    v_cvt_pk_bf16_f32 v229, v230, v231
    v_mfma_f32_16x16x32_bf16 v[168:171], v[20:23], v[88:91], v[168:171]
    v_cvt_pk_bf16_f32 v230, v252, v253
    v_cvt_pk_bf16_f32 v231, v254, v255
    v_mfma_f32_16x16x32_bf16 v[172:175], v[16:19], v[76:79], v[172:175]
    s_waitcnt vmcnt(37)
    s_barrier
    v_accvgpr_read_b32 v232, a100
    v_mfma_f32_16x16x32_bf16 v[172:175], v[20:23], v[92:95], v[172:175]
    s_waitcnt lgkmcnt(8)
    ds_read_b64_tr_b16 v[16:17], v8 offset:32768
    v_mfma_f32_16x16x32_bf16 v[176:179], v[24:27], v[64:67], v[176:179]
    ds_read_b64_tr_b16 v[18:19], v8 offset:34816
    v_accvgpr_read_b32 v233, a101
    v_mfma_f32_16x16x32_bf16 v[176:179], v[28:31], v[80:83], v[176:179]
    ds_read_b64_tr_b16 v[20:21], v8 offset:40960
    v_accvgpr_read_b32 v234, a102
    v_mfma_f32_16x16x32_bf16 v[180:183], v[24:27], v[68:71], v[180:183]
    ds_read_b64_tr_b16 v[22:23], v8 offset:43008
    v_accvgpr_read_b32 v235, a103
    v_mfma_f32_16x16x32_bf16 v[180:183], v[28:31], v[84:87], v[180:183]
    buffer_load_dwordx4 v2, s[20:23], s49 offen lds
    v_mfma_f32_16x16x32_bf16 v[184:187], v[24:27], v[72:75], v[184:187]
    s_add_u32 m0, s45, 151552
    v_mul_f32 v232, v232, v13
    v_mul_f32 v233, v233, v13
    v_mfma_f32_16x16x32_bf16 v[184:187], v[28:31], v[88:91], v[184:187]
    buffer_load_dwordx4 v2, s[24:27], s49 offen lds
    v_mfma_f32_16x16x32_bf16 v[188:191], v[24:27], v[76:79], v[188:191]
    s_mov_b32 s50, 24576
    v_mul_f32 v234, v234, v13
    v_mul_f32 v235, v235, v13
    v_mfma_f32_16x16x32_bf16 v[188:191], v[28:31], v[92:95], v[188:191]
    s_waitcnt lgkmcnt(8)
    ds_read_b64_tr_b16 v[24:25], v8 offset:36864
    v_mfma_f32_16x16x32_bf16 v[192:195], v[32:35], v[64:67], v[192:195]
    ds_read_b64_tr_b16 v[26:27], v8 offset:38912
    v_accvgpr_read_b32 v252, a116
    v_mfma_f32_16x16x32_bf16 v[192:195], v[36:39], v[80:83], v[192:195]
    ds_read_b64_tr_b16 v[28:29], v8 offset:45056
    v_accvgpr_read_b32 v253, a117
    v_mfma_f32_16x16x32_bf16 v[196:199], v[32:35], v[68:71], v[196:199]
    ds_read_b64_tr_b16 v[30:31], v8 offset:47104
    v_accvgpr_read_b32 v254, a118
    v_mfma_f32_16x16x32_bf16 v[196:199], v[36:39], v[84:87], v[196:199]
    buffer_load_dwordx4 a[0:3], v1, s[32:35], s50 offen offset:0 sc1
    v_mfma_f32_16x16x32_bf16 v[200:203], v[32:35], v[72:75], v[200:203]
    buffer_load_dwordx4 a[4:7], v1, s[32:35], s50 offen offset:1024 sc1
    v_mfma_f32_16x16x32_bf16 v[200:203], v[36:39], v[88:91], v[200:203]
    v_accvgpr_read_b32 v255, a119
    v_mul_f32 v252, v252, v13
    v_mfma_f32_16x16x32_bf16 v[204:207], v[32:35], v[76:79], v[204:207]
    v_mul_f32 v253, v253, v13
    v_mul_f32 v254, v254, v13
    v_mfma_f32_16x16x32_bf16 v[204:207], v[36:39], v[92:95], v[204:207]
    s_waitcnt lgkmcnt(8)
    ds_read_b64_tr_b16 v[32:33], v9 offset:32768
    v_mfma_f32_16x16x32_bf16 v[208:211], v[40:43], v[64:67], v[208:211]
    ds_read_b64_tr_b16 v[34:35], v9 offset:34816
    v_mul_f32 v255, v255, v13
    v_mfma_f32_16x16x32_bf16 v[208:211], v[44:47], v[80:83], v[208:211]
    ds_read_b64_tr_b16 v[36:37], v9 offset:40960
    v_cvt_pk_bf16_f32 v232, v232, v233
    v_mfma_f32_16x16x32_bf16 v[212:215], v[40:43], v[68:71], v[212:215]
    ds_read_b64_tr_b16 v[38:39], v9 offset:43008
    v_cvt_pk_bf16_f32 v233, v234, v235
    v_mfma_f32_16x16x32_bf16 v[212:215], v[44:47], v[84:87], v[212:215]
    buffer_load_dwordx4 a[8:11], v1, s[32:35], s50 offen offset:2048 sc1
    v_mfma_f32_16x16x32_bf16 v[216:219], v[40:43], v[72:75], v[216:219]
    buffer_load_dwordx4 a[12:15], v1, s[32:35], s50 offen offset:3072 sc1
    v_mfma_f32_16x16x32_bf16 v[216:219], v[44:47], v[88:91], v[216:219]
    s_mov_b32 s49, 2064384
    s_add_u32 m0, s45, 155648
    v_cvt_pk_bf16_f32 v234, v252, v253
    v_mfma_f32_16x16x32_bf16 v[220:223], v[40:43], v[76:79], v[220:223]
    v_cvt_pk_bf16_f32 v235, v254, v255
    v_accvgpr_read_b32 v236, a104
    v_mfma_f32_16x16x32_bf16 v[220:223], v[44:47], v[92:95], v[220:223]
    s_waitcnt vmcnt(39) lgkmcnt(8)
    ds_read_b64_tr_b16 v[40:41], v9 offset:36864
    v_mfma_f32_16x16x32_bf16 v[96:99], v[16:19], a[148:151], v[96:99]
    ds_read_b64_tr_b16 v[42:43], v9 offset:38912
    v_accvgpr_read_b32 v237, a105
    v_mfma_f32_16x16x32_bf16 v[96:99], v[20:23], a[164:167], v[96:99]
    ds_read_b64_tr_b16 v[44:45], v9 offset:45056
    v_accvgpr_read_b32 v238, a106
    v_mfma_f32_16x16x32_bf16 v[100:103], v[16:19], a[152:155], v[100:103]
    ds_read_b64_tr_b16 v[46:47], v9 offset:47104
    v_accvgpr_read_b32 v239, a107
    v_mfma_f32_16x16x32_bf16 v[100:103], v[20:23], a[168:171], v[100:103]
    buffer_load_dwordx4 v2, s[20:23], s49 offen lds
    v_mfma_f32_16x16x32_bf16 v[104:107], v[16:19], a[156:159], v[104:107]
    s_add_u32 m0, s45, 159744
    v_mul_f32 v236, v236, v14
    v_mul_f32 v237, v237, v14
    v_mfma_f32_16x16x32_bf16 v[104:107], v[20:23], a[172:175], v[104:107]
    buffer_load_dwordx4 v2, s[24:27], s49 offen lds
    v_mfma_f32_16x16x32_bf16 v[108:111], v[16:19], a[160:163], v[108:111]
    s_mov_b32 s50, 28672
    v_mul_f32 v238, v238, v14
    v_mul_f32 v239, v239, v14
    v_mfma_f32_16x16x32_bf16 v[108:111], v[20:23], a[176:179], v[108:111]
    s_waitcnt lgkmcnt(8)
    ds_read_b64_tr_b16 v[16:17], v10 offset:32768
    v_mfma_f32_16x16x32_bf16 v[112:115], v[24:27], a[148:151], v[112:115]
    ds_read_b64_tr_b16 v[18:19], v10 offset:34816
    v_accvgpr_read_b32 v252, a120
    v_mfma_f32_16x16x32_bf16 v[112:115], v[28:31], a[164:167], v[112:115]
    ds_read_b64_tr_b16 v[20:21], v10 offset:40960
    v_accvgpr_read_b32 v253, a121
    v_mfma_f32_16x16x32_bf16 v[116:119], v[24:27], a[152:155], v[116:119]
    ds_read_b64_tr_b16 v[22:23], v10 offset:43008
    v_accvgpr_read_b32 v254, a122
    v_mfma_f32_16x16x32_bf16 v[116:119], v[28:31], a[168:171], v[116:119]
    buffer_load_dwordx4 a[16:19], v1, s[32:35], s50 offen offset:0 sc1
    v_mfma_f32_16x16x32_bf16 v[120:123], v[24:27], a[156:159], v[120:123]
    v_accvgpr_read_b32 v255, a123
    v_mul_f32 v252, v252, v14
    v_mfma_f32_16x16x32_bf16 v[120:123], v[28:31], a[172:175], v[120:123]
    buffer_load_dwordx4 a[20:23], v1, s[32:35], s50 offen offset:1024 sc1
    v_mfma_f32_16x16x32_bf16 v[124:127], v[24:27], a[160:163], v[124:127]
    v_mul_f32 v253, v253, v14
    v_mul_f32 v254, v254, v14
    v_mfma_f32_16x16x32_bf16 v[124:127], v[28:31], a[176:179], v[124:127]
    s_waitcnt lgkmcnt(8)
    ds_read_b64_tr_b16 v[24:25], v10 offset:36864
    v_mfma_f32_16x16x32_bf16 v[128:131], v[32:35], a[148:151], v[128:131]
    ds_read_b64_tr_b16 v[26:27], v10 offset:38912
    v_mul_f32 v255, v255, v14
    v_mfma_f32_16x16x32_bf16 v[128:131], v[36:39], a[164:167], v[128:131]
    ds_read_b64_tr_b16 v[28:29], v10 offset:45056
    v_cvt_pk_bf16_f32 v236, v236, v237
    v_mfma_f32_16x16x32_bf16 v[132:135], v[32:35], a[152:155], v[132:135]
    ds_read_b64_tr_b16 v[30:31], v10 offset:47104
    v_cvt_pk_bf16_f32 v237, v238, v239
    v_mfma_f32_16x16x32_bf16 v[132:135], v[36:39], a[168:171], v[132:135]
    buffer_load_dwordx4 a[24:27], v1, s[32:35], s50 offen offset:2048 sc1
    v_mfma_f32_16x16x32_bf16 v[136:139], v[32:35], a[156:159], v[136:139]
    v_cvt_pk_bf16_f32 v238, v252, v253
    v_cvt_pk_bf16_f32 v239, v254, v255
    v_mfma_f32_16x16x32_bf16 v[136:139], v[36:39], a[172:175], v[136:139]
    buffer_load_dwordx4 a[28:31], v1, s[32:35], s50 offen offset:3072 sc1
    v_mfma_f32_16x16x32_bf16 v[140:143], v[32:35], a[160:163], v[140:143]
    v_accvgpr_read_b32 v240, a108
    v_accvgpr_read_b32 v241, a109
    v_mfma_f32_16x16x32_bf16 v[140:143], v[36:39], a[176:179], v[140:143]
    s_waitcnt lgkmcnt(8)
    ds_read_b64_tr_b16 v[32:33], v11 offset:32768
    v_mfma_f32_16x16x32_bf16 v[144:147], v[40:43], a[148:151], v[144:147]
    s_mov_b32 s49, 2359296
    ds_read_b64_tr_b16 v[34:35], v11 offset:34816
    v_mfma_f32_16x16x32_bf16 v[144:147], v[44:47], a[164:167], v[144:147]
    s_add_u32 m0, s45, 0
    ds_read_b64_tr_b16 v[36:37], v11 offset:40960
    v_mfma_f32_16x16x32_bf16 v[148:151], v[40:43], a[152:155], v[148:151]
    ds_read_b64_tr_b16 v[38:39], v11 offset:43008
    v_accvgpr_read_b32 v242, a110
    v_mfma_f32_16x16x32_bf16 v[148:151], v[44:47], a[168:171], v[148:151]
    buffer_load_dwordx4 v2, s[20:23], s49 offen lds
    v_mfma_f32_16x16x32_bf16 v[152:155], v[40:43], a[156:159], v[152:155]
    s_add_u32 m0, s45, 4096
    v_accvgpr_read_b32 v243, a111
    v_mul_f32 v240, v240, v15
    v_mfma_f32_16x16x32_bf16 v[152:155], v[44:47], a[172:175], v[152:155]
    v_mul_f32 v241, v241, v15
    v_mul_f32 v242, v242, v15
    v_mfma_f32_16x16x32_bf16 v[156:159], v[40:43], a[160:163], v[156:159]
    buffer_load_dwordx4 v2, s[24:27], s49 offen lds
    v_mfma_f32_16x16x32_bf16 v[156:159], v[44:47], a[176:179], v[156:159]
    s_waitcnt lgkmcnt(8)
    ds_read_b64_tr_b16 v[40:41], v11 offset:36864
    v_mfma_f32_16x16x32_bf16 v[160:163], v[16:19], a[148:151], v[160:163]
    s_mov_b32 s50, 32768
    ds_read_b64_tr_b16 v[42:43], v11 offset:38912
    v_mfma_f32_16x16x32_bf16 v[160:163], v[20:23], a[164:167], v[160:163]
    ds_read_b64_tr_b16 v[44:45], v11 offset:45056
    v_mul_f32 v243, v243, v15
    v_mfma_f32_16x16x32_bf16 v[164:167], v[16:19], a[152:155], v[164:167]
    ds_read_b64_tr_b16 v[46:47], v11 offset:47104
    v_accvgpr_read_b32 v252, a124
    v_mfma_f32_16x16x32_bf16 v[164:167], v[20:23], a[168:171], v[164:167]
    buffer_load_dwordx4 a[32:35], v1, s[32:35], s50 offen offset:0 sc1
    v_mfma_f32_16x16x32_bf16 v[168:171], v[16:19], a[156:159], v[168:171]
    v_accvgpr_read_b32 v253, a125
    v_accvgpr_read_b32 v254, a126
    v_mfma_f32_16x16x32_bf16 v[168:171], v[20:23], a[172:175], v[168:171]
    v_accvgpr_read_b32 v255, a127
    v_mul_f32 v252, v252, v15
    v_mfma_f32_16x16x32_bf16 v[172:175], v[16:19], a[160:163], v[172:175]
    s_waitcnt vmcnt(36)
    s_barrier
    v_mul_f32 v253, v253, v15
    v_mfma_f32_16x16x32_bf16 v[172:175], v[20:23], a[176:179], v[172:175]
    s_waitcnt lgkmcnt(8)
    ds_read_b64_tr_b16 v[16:17], v8 offset:49152
    v_mfma_f32_16x16x32_bf16 v[176:179], v[24:27], a[148:151], v[176:179]
    ds_read_b64_tr_b16 v[18:19], v8 offset:51200
    v_mul_f32 v254, v254, v15
    v_mfma_f32_16x16x32_bf16 v[176:179], v[28:31], a[164:167], v[176:179]
    ds_read_b64_tr_b16 v[20:21], v8 offset:57344
    v_mul_f32 v255, v255, v15
    v_mfma_f32_16x16x32_bf16 v[180:183], v[24:27], a[152:155], v[180:183]
    ds_read_b64_tr_b16 v[22:23], v8 offset:59392
    v_cvt_pk_bf16_f32 v240, v240, v241
    v_mfma_f32_16x16x32_bf16 v[180:183], v[28:31], a[168:171], v[180:183]
    buffer_load_dwordx4 a[36:39], v1, s[32:35], s50 offen offset:1024 sc1
    v_mfma_f32_16x16x32_bf16 v[184:187], v[24:27], a[156:159], v[184:187]
    buffer_load_dwordx4 a[40:43], v1, s[32:35], s50 offen offset:2048 sc1
    v_mfma_f32_16x16x32_bf16 v[184:187], v[28:31], a[172:175], v[184:187]
    v_cvt_pk_bf16_f32 v241, v242, v243
    v_cvt_pk_bf16_f32 v242, v252, v253
    v_mfma_f32_16x16x32_bf16 v[188:191], v[24:27], a[160:163], v[188:191]
    v_cvt_pk_bf16_f32 v243, v254, v255
    v_mfma_f32_16x16x32_bf16 v[188:191], v[28:31], a[176:179], v[188:191]
    s_waitcnt lgkmcnt(8)
    ds_read_b64_tr_b16 v[24:25], v8 offset:53248
    v_mfma_f32_16x16x32_bf16 v[192:195], v[32:35], a[148:151], v[192:195]
    ds_read_b64_tr_b16 v[26:27], v8 offset:55296
    v_mfma_f32_16x16x32_bf16 v[192:195], v[36:39], a[164:167], v[192:195]
    ds_read_b64_tr_b16 v[28:29], v8 offset:61440
    v_mfma_f32_16x16x32_bf16 v[196:199], v[32:35], a[152:155], v[196:199]
    ds_read_b64_tr_b16 v[30:31], v8 offset:63488
    v_mfma_f32_16x16x32_bf16 v[196:199], v[36:39], a[168:171], v[196:199]
    buffer_load_dwordx4 a[44:47], v1, s[32:35], s50 offen offset:3072 sc1
    v_mfma_f32_16x16x32_bf16 v[200:203], v[32:35], a[156:159], v[200:203]
    s_mov_b32 s49, 2654208
    s_add_u32 m0, s45, 8192
    v_mfma_f32_16x16x32_bf16 v[200:203], v[36:39], a[172:175], v[200:203]
    buffer_load_dwordx4 v2, s[20:23], s49 offen lds
    v_mfma_f32_16x16x32_bf16 v[204:207], v[32:35], a[160:163], v[204:207]
    s_add_u32 m0, s45, 12288
    v_mfma_f32_16x16x32_bf16 v[204:207], v[36:39], a[176:179], v[204:207]
    s_waitcnt lgkmcnt(8)
    ds_read_b64_tr_b16 v[32:33], v9 offset:49152
    v_mfma_f32_16x16x32_bf16 v[208:211], v[40:43], a[148:151], v[208:211]
    ds_read_b64_tr_b16 v[34:35], v9 offset:51200
    v_mfma_f32_16x16x32_bf16 v[208:211], v[44:47], a[164:167], v[208:211]
    ds_read_b64_tr_b16 v[36:37], v9 offset:57344
    v_mfma_f32_16x16x32_bf16 v[212:215], v[40:43], a[152:155], v[212:215]
    ds_read_b64_tr_b16 v[38:39], v9 offset:59392
    v_mfma_f32_16x16x32_bf16 v[212:215], v[44:47], a[168:171], v[212:215]
    buffer_load_dwordx4 v2, s[24:27], s49 offen lds
    v_mfma_f32_16x16x32_bf16 v[216:219], v[40:43], a[156:159], v[216:219]
    s_mov_b32 s50, 36864
    v_mfma_f32_16x16x32_bf16 v[216:219], v[44:47], a[172:175], v[216:219]
    buffer_load_dwordx4 a[48:51], v1, s[32:35], s50 offen offset:0 sc1
    v_mfma_f32_16x16x32_bf16 v[220:223], v[40:43], a[160:163], v[220:223]
    v_mfma_f32_16x16x32_bf16 v[220:223], v[44:47], a[176:179], v[220:223]
    s_waitcnt vmcnt(38) lgkmcnt(8)
    ds_read_b64_tr_b16 v[40:41], v9 offset:53248
    v_mfma_f32_16x16x32_bf16 v[96:99], v[16:19], a[212:215], v[96:99]
    ds_read_b64_tr_b16 v[42:43], v9 offset:55296
    v_mfma_f32_16x16x32_bf16 v[96:99], v[20:23], a[132:135], v[96:99]
    ds_read_b64_tr_b16 v[44:45], v9 offset:61440
    v_mfma_f32_16x16x32_bf16 v[100:103], v[16:19], a[216:219], v[100:103]
    ds_read_b64_tr_b16 v[46:47], v9 offset:63488
    v_mfma_f32_16x16x32_bf16 v[100:103], v[20:23], a[136:139], v[100:103]
    buffer_load_dwordx4 a[52:55], v1, s[32:35], s50 offen offset:1024 sc1
    v_mfma_f32_16x16x32_bf16 v[104:107], v[16:19], a[220:223], v[104:107]
    v_mfma_f32_16x16x32_bf16 v[104:107], v[20:23], a[140:143], v[104:107]
    buffer_load_dwordx4 a[56:59], v1, s[32:35], s50 offen offset:2048 sc1
    v_mfma_f32_16x16x32_bf16 v[108:111], v[16:19], a[128:131], v[108:111]
    v_mfma_f32_16x16x32_bf16 v[108:111], v[20:23], a[144:147], v[108:111]
    s_waitcnt lgkmcnt(8)
    ds_read_b64_tr_b16 v[16:17], v10 offset:49152
    v_mfma_f32_16x16x32_bf16 v[112:115], v[24:27], a[212:215], v[112:115]
    ds_read_b64_tr_b16 v[18:19], v10 offset:51200
    v_mfma_f32_16x16x32_bf16 v[112:115], v[28:31], a[132:135], v[112:115]
    ds_read_b64_tr_b16 v[20:21], v10 offset:57344
    v_mfma_f32_16x16x32_bf16 v[116:119], v[24:27], a[216:219], v[116:119]
    ds_read_b64_tr_b16 v[22:23], v10 offset:59392
    v_mfma_f32_16x16x32_bf16 v[116:119], v[28:31], a[136:139], v[116:119]
    buffer_load_dwordx4 a[60:63], v1, s[32:35], s50 offen offset:3072 sc1
    v_mfma_f32_16x16x32_bf16 v[120:123], v[24:27], a[220:223], v[120:123]
    s_mov_b32 s49, 2949120
    s_add_u32 m0, s45, 16384
    v_mfma_f32_16x16x32_bf16 v[120:123], v[28:31], a[140:143], v[120:123]
    v_mfma_f32_16x16x32_bf16 v[124:127], v[24:27], a[128:131], v[124:127]
    buffer_load_dwordx4 v2, s[20:23], s49 offen lds
    v_mfma_f32_16x16x32_bf16 v[124:127], v[28:31], a[144:147], v[124:127]
    s_waitcnt lgkmcnt(8)
    ds_read_b64_tr_b16 v[24:25], v10 offset:53248
    v_mfma_f32_16x16x32_bf16 v[128:131], v[32:35], a[212:215], v[128:131]
    s_add_u32 m0, s45, 20480
    ds_read_b64_tr_b16 v[26:27], v10 offset:55296
    v_mfma_f32_16x16x32_bf16 v[128:131], v[36:39], a[132:135], v[128:131]
    ds_read_b64_tr_b16 v[28:29], v10 offset:61440
    v_mfma_f32_16x16x32_bf16 v[132:135], v[32:35], a[216:219], v[132:135]
    ds_read_b64_tr_b16 v[30:31], v10 offset:63488
    v_mfma_f32_16x16x32_bf16 v[132:135], v[36:39], a[136:139], v[132:135]
    buffer_load_dwordx4 v2, s[24:27], s49 offen lds
    v_mfma_f32_16x16x32_bf16 v[136:139], v[32:35], a[220:223], v[136:139]
    s_mov_b32 s50, 40960
    v_mfma_f32_16x16x32_bf16 v[136:139], v[36:39], a[140:143], v[136:139]
    v_mfma_f32_16x16x32_bf16 v[140:143], v[32:35], a[128:131], v[140:143]
    buffer_load_dwordx4 a[64:67], v1, s[32:35], s50 offen offset:0 sc1
    v_mfma_f32_16x16x32_bf16 v[140:143], v[36:39], a[144:147], v[140:143]
    s_waitcnt lgkmcnt(8)
    ds_read_b64_tr_b16 v[32:33], v11 offset:49152
    v_mfma_f32_16x16x32_bf16 v[144:147], v[40:43], a[212:215], v[144:147]
    ds_read_b64_tr_b16 v[34:35], v11 offset:51200
    v_mfma_f32_16x16x32_bf16 v[144:147], v[44:47], a[132:135], v[144:147]
    ds_read_b64_tr_b16 v[36:37], v11 offset:57344
    v_mfma_f32_16x16x32_bf16 v[148:151], v[40:43], a[216:219], v[148:151]
    ds_read_b64_tr_b16 v[38:39], v11 offset:59392
    v_mfma_f32_16x16x32_bf16 v[148:151], v[44:47], a[136:139], v[148:151]
    buffer_load_dwordx4 a[68:71], v1, s[32:35], s50 offen offset:1024 sc1
    v_mfma_f32_16x16x32_bf16 v[152:155], v[40:43], a[220:223], v[152:155]
    v_mfma_f32_16x16x32_bf16 v[152:155], v[44:47], a[140:143], v[152:155]
    v_mfma_f32_16x16x32_bf16 v[156:159], v[40:43], a[128:131], v[156:159]
    v_mfma_f32_16x16x32_bf16 v[156:159], v[44:47], a[144:147], v[156:159]
    s_waitcnt lgkmcnt(8)
    ds_read_b64_tr_b16 v[40:41], v11 offset:53248
    v_mfma_f32_16x16x32_bf16 v[160:163], v[16:19], a[212:215], v[160:163]
    ds_read_b64_tr_b16 v[42:43], v11 offset:55296
    v_add_u32 v8, 0x10000, v8
    v_mfma_f32_16x16x32_bf16 v[160:163], v[20:23], a[132:135], v[160:163]
    ds_read_b64_tr_b16 v[44:45], v11 offset:61440
    v_mfma_f32_16x16x32_bf16 v[164:167], v[16:19], a[216:219], v[164:167]
    ds_read_b64_tr_b16 v[46:47], v11 offset:63488
    v_mfma_f32_16x16x32_bf16 v[164:167], v[20:23], a[136:139], v[164:167]
    buffer_load_dwordx4 a[72:75], v1, s[32:35], s50 offen offset:2048 sc1
    v_mfma_f32_16x16x32_bf16 v[168:171], v[16:19], a[220:223], v[168:171]
    buffer_load_dwordx4 a[76:79], v1, s[32:35], s50 offen offset:3072 sc1
    v_mfma_f32_16x16x32_bf16 v[168:171], v[20:23], a[140:143], v[168:171]
    v_mfma_f32_16x16x32_bf16 v[172:175], v[16:19], a[128:131], v[172:175]
    s_waitcnt vmcnt(34)
    s_barrier
    s_mov_b32 s49, 3244032
    v_mfma_f32_16x16x32_bf16 v[172:175], v[20:23], a[144:147], v[172:175]
    s_waitcnt lgkmcnt(8)
    ds_read_b64_tr_b16 v[16:17], v8 offset:0
    v_mfma_f32_16x16x32_bf16 v[176:179], v[24:27], a[212:215], v[176:179]
    s_add_u32 m0, s45, 24576
    ds_read_b64_tr_b16 v[18:19], v8 offset:2048
    v_mfma_f32_16x16x32_bf16 v[176:179], v[28:31], a[132:135], v[176:179]
    ds_read_b64_tr_b16 v[20:21], v8 offset:8192
    v_mfma_f32_16x16x32_bf16 v[180:183], v[24:27], a[216:219], v[180:183]
    ds_read_b64_tr_b16 v[22:23], v8 offset:10240
    v_mfma_f32_16x16x32_bf16 v[180:183], v[28:31], a[136:139], v[180:183]
    buffer_load_dwordx4 v2, s[20:23], s49 offen lds
    v_mfma_f32_16x16x32_bf16 v[184:187], v[24:27], a[220:223], v[184:187]
    s_add_u32 m0, s45, 28672
    v_mfma_f32_16x16x32_bf16 v[184:187], v[28:31], a[140:143], v[184:187]
    buffer_load_dwordx4 v2, s[24:27], s49 offen lds
    v_mfma_f32_16x16x32_bf16 v[188:191], v[24:27], a[128:131], v[188:191]
    s_mov_b32 s50, 45056
    v_mfma_f32_16x16x32_bf16 v[188:191], v[28:31], a[144:147], v[188:191]
    s_waitcnt lgkmcnt(8)
    ds_read_b64_tr_b16 v[24:25], v8 offset:4096
    v_mfma_f32_16x16x32_bf16 v[192:195], v[32:35], a[212:215], v[192:195]
    ds_read_b64_tr_b16 v[26:27], v8 offset:6144
    v_add_u32 v9, 0x10000, v9
    v_mfma_f32_16x16x32_bf16 v[192:195], v[36:39], a[132:135], v[192:195]
    ds_read_b64_tr_b16 v[28:29], v8 offset:12288
    v_mfma_f32_16x16x32_bf16 v[196:199], v[32:35], a[216:219], v[196:199]
    ds_read_b64_tr_b16 v[30:31], v8 offset:14336
    v_mfma_f32_16x16x32_bf16 v[196:199], v[36:39], a[136:139], v[196:199]
    buffer_load_dwordx4 a[80:83], v1, s[32:35], s50 offen offset:0 sc1
    v_mfma_f32_16x16x32_bf16 v[200:203], v[32:35], a[220:223], v[200:203]
    v_mfma_f32_16x16x32_bf16 v[200:203], v[36:39], a[140:143], v[200:203]
    buffer_load_dwordx4 a[84:87], v1, s[32:35], s50 offen offset:1024 sc1
    v_mfma_f32_16x16x32_bf16 v[204:207], v[32:35], a[128:131], v[204:207]
    v_mfma_f32_16x16x32_bf16 v[204:207], v[36:39], a[144:147], v[204:207]
    s_waitcnt lgkmcnt(8)
    ds_read_b64_tr_b16 v[32:33], v9 offset:0
    v_mfma_f32_16x16x32_bf16 v[208:211], v[40:43], a[212:215], v[208:211]
    ds_read_b64_tr_b16 v[34:35], v9 offset:2048
    v_mfma_f32_16x16x32_bf16 v[208:211], v[44:47], a[132:135], v[208:211]
    ds_read_b64_tr_b16 v[36:37], v9 offset:8192
    v_mfma_f32_16x16x32_bf16 v[212:215], v[40:43], a[216:219], v[212:215]
    ds_read_b64_tr_b16 v[38:39], v9 offset:10240
    v_mfma_f32_16x16x32_bf16 v[212:215], v[44:47], a[136:139], v[212:215]
    buffer_load_dwordx4 a[88:91], v1, s[32:35], s50 offen offset:2048 sc1
    v_mfma_f32_16x16x32_bf16 v[216:219], v[40:43], a[220:223], v[216:219]
    v_mfma_f32_16x16x32_bf16 v[216:219], v[44:47], a[140:143], v[216:219]
    buffer_load_dwordx4 a[92:95], v1, s[32:35], s50 offen offset:3072 sc1
    v_mfma_f32_16x16x32_bf16 v[220:223], v[40:43], a[128:131], v[220:223]
    v_mfma_f32_16x16x32_bf16 v[220:223], v[44:47], a[144:147], v[220:223]
    s_waitcnt vmcnt(36) lgkmcnt(8)
    ds_read_b64_tr_b16 v[40:41], v9 offset:4096
    v_mfma_f32_16x16x32_bf16 v[96:99], v[16:19], a[180:183], v[96:99]
    ds_read_b64_tr_b16 v[42:43], v9 offset:6144
    v_add_u32 v10, 0x10000, v10
    v_mfma_f32_16x16x32_bf16 v[96:99], v[20:23], a[196:199], v[96:99]
    s_mov_b32 s49, 3538944
    ds_read_b64_tr_b16 v[44:45], v9 offset:12288
    v_mfma_f32_16x16x32_bf16 v[100:103], v[16:19], a[184:187], v[100:103]
    s_add_u32 m0, s45, 32768
    ds_read_b64_tr_b16 v[46:47], v9 offset:14336
    v_mfma_f32_16x16x32_bf16 v[100:103], v[20:23], a[200:203], v[100:103]
    buffer_load_dwordx4 v2, s[20:23], s49 offen lds
    v_mfma_f32_16x16x32_bf16 v[104:107], v[16:19], a[188:191], v[104:107]
    s_add_u32 m0, s45, 36864
    v_mfma_f32_16x16x32_bf16 v[104:107], v[20:23], a[204:207], v[104:107]
    v_mfma_f32_16x16x32_bf16 v[108:111], v[16:19], a[192:195], v[108:111]
    buffer_load_dwordx4 v2, s[24:27], s49 offen lds
    v_mfma_f32_16x16x32_bf16 v[108:111], v[20:23], a[208:211], v[108:111]
    s_waitcnt lgkmcnt(8)
    ds_read_b64_tr_b16 v[16:17], v10 offset:0
    v_mfma_f32_16x16x32_bf16 v[112:115], v[24:27], a[180:183], v[112:115]
    s_mov_b32 s50, 49152
    ds_read_b64_tr_b16 v[18:19], v10 offset:2048
    v_mfma_f32_16x16x32_bf16 v[112:115], v[28:31], a[196:199], v[112:115]
    ds_read_b64_tr_b16 v[20:21], v10 offset:8192
    v_mfma_f32_16x16x32_bf16 v[116:119], v[24:27], a[184:187], v[116:119]
    ds_read_b64_tr_b16 v[22:23], v10 offset:10240
    v_mfma_f32_16x16x32_bf16 v[116:119], v[28:31], a[200:203], v[116:119]
    buffer_load_dwordx4 a[96:99], v1, s[32:35], s50 offen offset:0 sc1
    v_mfma_f32_16x16x32_bf16 v[120:123], v[24:27], a[188:191], v[120:123]
    v_mfma_f32_16x16x32_bf16 v[120:123], v[28:31], a[204:207], v[120:123]
    v_mfma_f32_16x16x32_bf16 v[124:127], v[24:27], a[192:195], v[124:127]
    v_mfma_f32_16x16x32_bf16 v[124:127], v[28:31], a[208:211], v[124:127]
    s_waitcnt lgkmcnt(8)
    ds_read_b64_tr_b16 v[24:25], v10 offset:4096
    v_mfma_f32_16x16x32_bf16 v[128:131], v[32:35], a[180:183], v[128:131]
    ds_read_b64_tr_b16 v[26:27], v10 offset:6144
    v_add_u32 v11, 0x10000, v11
    v_mfma_f32_16x16x32_bf16 v[128:131], v[36:39], a[196:199], v[128:131]
    ds_read_b64_tr_b16 v[28:29], v10 offset:12288
    v_mfma_f32_16x16x32_bf16 v[132:135], v[32:35], a[184:187], v[132:135]
    ds_read_b64_tr_b16 v[30:31], v10 offset:14336
    v_mfma_f32_16x16x32_bf16 v[132:135], v[36:39], a[200:203], v[132:135]
    buffer_load_dwordx4 a[100:103], v1, s[32:35], s50 offen offset:1024 sc1
    v_mfma_f32_16x16x32_bf16 v[136:139], v[32:35], a[188:191], v[136:139]
    buffer_load_dwordx4 a[104:107], v1, s[32:35], s50 offen offset:2048 sc1
    v_mfma_f32_16x16x32_bf16 v[136:139], v[36:39], a[204:207], v[136:139]
    v_mfma_f32_16x16x32_bf16 v[140:143], v[32:35], a[192:195], v[140:143]
    v_mfma_f32_16x16x32_bf16 v[140:143], v[36:39], a[208:211], v[140:143]
    s_waitcnt lgkmcnt(8)
    ds_read_b64_tr_b16 v[32:33], v11 offset:0
    v_mfma_f32_16x16x32_bf16 v[144:147], v[40:43], a[180:183], v[144:147]
    ds_read_b64_tr_b16 v[34:35], v11 offset:2048
    v_mfma_f32_16x16x32_bf16 v[144:147], v[44:47], a[196:199], v[144:147]
    ds_read_b64_tr_b16 v[36:37], v11 offset:8192
    v_mfma_f32_16x16x32_bf16 v[148:151], v[40:43], a[184:187], v[148:151]
    ds_read_b64_tr_b16 v[38:39], v11 offset:10240
    v_mfma_f32_16x16x32_bf16 v[148:151], v[44:47], a[200:203], v[148:151]
    buffer_load_dwordx4 a[108:111], v1, s[32:35], s50 offen offset:3072 sc1
    v_mfma_f32_16x16x32_bf16 v[152:155], v[40:43], a[188:191], v[152:155]
    s_mov_b32 s49, 3833856
    s_add_u32 m0, s45, 40960
    v_mfma_f32_16x16x32_bf16 v[152:155], v[44:47], a[204:207], v[152:155]
    buffer_load_dwordx4 v2, s[20:23], s49 offen lds
    v_mfma_f32_16x16x32_bf16 v[156:159], v[40:43], a[192:195], v[156:159]
    s_add_u32 m0, s45, 45056
    v_mfma_f32_16x16x32_bf16 v[156:159], v[44:47], a[208:211], v[156:159]
    s_waitcnt lgkmcnt(8)
    ds_read_b64_tr_b16 v[40:41], v11 offset:4096
    v_mfma_f32_16x16x32_bf16 v[160:163], v[16:19], a[180:183], v[160:163]
    ds_read_b64_tr_b16 v[42:43], v11 offset:6144
    v_mfma_f32_16x16x32_bf16 v[160:163], v[20:23], a[196:199], v[160:163]
    ds_read_b64_tr_b16 v[44:45], v11 offset:12288
    v_mfma_f32_16x16x32_bf16 v[164:167], v[16:19], a[184:187], v[164:167]
    ds_read_b64_tr_b16 v[46:47], v11 offset:14336
    v_mfma_f32_16x16x32_bf16 v[164:167], v[20:23], a[200:203], v[164:167]
    buffer_load_dwordx4 v2, s[24:27], s49 offen lds
    v_mfma_f32_16x16x32_bf16 v[168:171], v[16:19], a[188:191], v[168:171]
    s_mov_b32 s50, 53248
    v_mfma_f32_16x16x32_bf16 v[168:171], v[20:23], a[204:207], v[168:171]
    buffer_load_dwordx4 a[112:115], v1, s[32:35], s50 offen offset:0 sc1
    v_mfma_f32_16x16x32_bf16 v[172:175], v[16:19], a[192:195], v[172:175]
    s_waitcnt vmcnt(37)
    s_barrier
    v_mfma_f32_16x16x32_bf16 v[172:175], v[20:23], a[208:211], v[172:175]
    s_waitcnt lgkmcnt(8)
    ds_read_b64_tr_b16 v[16:17], v8 offset:16384
    v_mfma_f32_16x16x32_bf16 v[176:179], v[24:27], a[180:183], v[176:179]
    ds_read_b64_tr_b16 v[18:19], v8 offset:18432
    v_mfma_f32_16x16x32_bf16 v[176:179], v[28:31], a[196:199], v[176:179]
    ds_read_b64_tr_b16 v[20:21], v8 offset:24576
    v_mfma_f32_16x16x32_bf16 v[180:183], v[24:27], a[184:187], v[180:183]
    ds_read_b64_tr_b16 v[22:23], v8 offset:26624
    v_mfma_f32_16x16x32_bf16 v[180:183], v[28:31], a[200:203], v[180:183]
    buffer_load_dwordx4 a[116:119], v1, s[32:35], s50 offen offset:1024 sc1
    v_mfma_f32_16x16x32_bf16 v[184:187], v[24:27], a[188:191], v[184:187]
    s_and_b32 s5, s0, 3
    s_lshl_b32 s3, s42, 5
    s_add_u32 s3, s3, s5
    v_mfma_f32_16x16x32_bf16 v[184:187], v[28:31], a[204:207], v[184:187]
    buffer_load_dwordx4 a[120:123], v1, s[32:35], s50 offen offset:2048 sc1
    v_mfma_f32_16x16x32_bf16 v[188:191], v[24:27], a[192:195], v[188:191]
    s_lshl_b32 s51, s3, 8
    s_and_b32 s6, s2, 7
    s_lshl_b32 s3, s42, 5
    v_mfma_f32_16x16x32_bf16 v[188:191], v[28:31], a[208:211], v[188:191]
    s_waitcnt lgkmcnt(8)
    ds_read_b64_tr_b16 v[24:25], v8 offset:20480
    v_mfma_f32_16x16x32_bf16 v[192:195], v[32:35], a[180:183], v[192:195]
    ds_read_b64_tr_b16 v[26:27], v8 offset:22528
    v_mfma_f32_16x16x32_bf16 v[192:195], v[36:39], a[196:199], v[192:195]
    ds_read_b64_tr_b16 v[28:29], v8 offset:28672
    v_mfma_f32_16x16x32_bf16 v[196:199], v[32:35], a[184:187], v[196:199]
    ds_read_b64_tr_b16 v[30:31], v8 offset:30720
    v_mfma_f32_16x16x32_bf16 v[196:199], v[36:39], a[200:203], v[196:199]
    buffer_load_dwordx4 a[124:127], v1, s[32:35], s50 offen offset:3072 sc1
    v_mfma_f32_16x16x32_bf16 v[200:203], v[32:35], a[188:191], v[200:203]
    s_mov_b32 s49, 4129280
    s_add_u32 m0, s45, 49152
    v_mfma_f32_16x16x32_bf16 v[200:203], v[36:39], a[204:207], v[200:203]
    buffer_load_dwordx4 v2, s[20:23], s49 offen lds
    v_mfma_f32_16x16x32_bf16 v[204:207], v[32:35], a[192:195], v[204:207]
    s_add_u32 m0, s45, 53248
    v_mfma_f32_16x16x32_bf16 v[204:207], v[36:39], a[208:211], v[204:207]
    s_waitcnt lgkmcnt(8)
    ds_read_b64_tr_b16 v[32:33], v9 offset:16384
    v_mfma_f32_16x16x32_bf16 v[208:211], v[40:43], a[180:183], v[208:211]
    ds_read_b64_tr_b16 v[34:35], v9 offset:18432
    v_mfma_f32_16x16x32_bf16 v[208:211], v[44:47], a[196:199], v[208:211]
    ds_read_b64_tr_b16 v[36:37], v9 offset:24576
    v_mfma_f32_16x16x32_bf16 v[212:215], v[40:43], a[184:187], v[212:215]
    ds_read_b64_tr_b16 v[38:39], v9 offset:26624
    v_mfma_f32_16x16x32_bf16 v[212:215], v[44:47], a[200:203], v[212:215]
    buffer_load_dwordx4 v2, s[24:27], s49 offen lds
    v_mfma_f32_16x16x32_bf16 v[216:219], v[40:43], a[188:191], v[216:219]
    s_mov_b32 s49, 4424192
    s_add_u32 m0, s45, 57344
    v_mfma_f32_16x16x32_bf16 v[216:219], v[44:47], a[204:207], v[216:219]
    s_add_u32 s3, s3, s6
    s_add_u32 s3, s3, 8
    s_lshl_b32 s96, s3, 8
    v_mfma_f32_16x16x32_bf16 v[220:223], v[40:43], a[192:195], v[220:223]
    buffer_load_dwordx4 v2, s[20:23], s49 offen lds
    v_mfma_f32_16x16x32_bf16 v[220:223], v[44:47], a[208:211], v[220:223]
    s_waitcnt vmcnt(39) lgkmcnt(8)
    ds_read_b64_tr_b16 v[40:41], v9 offset:20480
    v_mfma_f32_16x16x32_bf16 v[96:99], v[16:19], a[0:3], v[96:99]
    s_add_u32 m0, s45, 61440
    ds_read_b64_tr_b16 v[42:43], v9 offset:22528
    v_mfma_f32_16x16x32_bf16 v[96:99], v[20:23], a[16:19], v[96:99]
    ds_read_b64_tr_b16 v[44:45], v9 offset:28672
    v_mfma_f32_16x16x32_bf16 v[100:103], v[16:19], a[4:7], v[100:103]
    ds_read_b64_tr_b16 v[46:47], v9 offset:30720
    v_mfma_f32_16x16x32_bf16 v[100:103], v[20:23], a[20:23], v[100:103]
    buffer_load_dwordx4 v2, s[24:27], s49 offen lds
    v_mfma_f32_16x16x32_bf16 v[104:107], v[16:19], a[8:11], v[104:107]
    s_mov_b32 s49, 4719104
    s_add_u32 m0, s45, 65536
    v_mfma_f32_16x16x32_bf16 v[104:107], v[20:23], a[24:27], v[104:107]
    s_xor_b32 s97, s96, 256
    s_mul_i32 s46, s40, 9216
    s_xor_b32 s3, s6, 1
    v_mfma_f32_16x16x32_bf16 v[108:111], v[16:19], a[12:15], v[108:111]
    buffer_load_dwordx4 v2, s[20:23], s49 offen lds
    v_mfma_f32_16x16x32_bf16 v[108:111], v[20:23], a[28:31], v[108:111]
    s_waitcnt lgkmcnt(8)
    ds_read_b64_tr_b16 v[16:17], v10 offset:16384
    v_mfma_f32_16x16x32_bf16 v[112:115], v[24:27], a[0:3], v[112:115]
    s_add_u32 m0, s45, 69632
    ds_read_b64_tr_b16 v[18:19], v10 offset:18432
    v_mfma_f32_16x16x32_bf16 v[112:115], v[28:31], a[16:19], v[112:115]
    ds_read_b64_tr_b16 v[20:21], v10 offset:24576
    v_mfma_f32_16x16x32_bf16 v[116:119], v[24:27], a[4:7], v[116:119]
    ds_read_b64_tr_b16 v[22:23], v10 offset:26624
    v_mfma_f32_16x16x32_bf16 v[116:119], v[28:31], a[20:23], v[116:119]
    buffer_load_dwordx4 v2, s[24:27], s49 offen lds
    v_mfma_f32_16x16x32_bf16 v[120:123], v[24:27], a[8:11], v[120:123]
    s_mov_b32 s49, 5014016
    s_add_u32 m0, s45, 73728
    v_mfma_f32_16x16x32_bf16 v[120:123], v[28:31], a[24:27], v[120:123]
    s_bitcmp1_b32 s0, 2
    s_cselect_b32 s4, 18, 16
    s_mul_i32 s1, s40, 36864
    v_mfma_f32_16x16x32_bf16 v[124:127], v[24:27], a[12:15], v[124:127]
    buffer_load_dwordx4 v2, s[20:23], s49 offen lds
    v_mfma_f32_16x16x32_bf16 v[124:127], v[28:31], a[28:31], v[124:127]
    s_waitcnt lgkmcnt(8)
    ds_read_b64_tr_b16 v[24:25], v10 offset:20480
    v_mfma_f32_16x16x32_bf16 v[128:131], v[32:35], a[0:3], v[128:131]
    s_add_u32 m0, s45, 77824
    ds_read_b64_tr_b16 v[26:27], v10 offset:22528
    v_mfma_f32_16x16x32_bf16 v[128:131], v[36:39], a[16:19], v[128:131]
    ds_read_b64_tr_b16 v[28:29], v10 offset:28672
    v_mfma_f32_16x16x32_bf16 v[132:135], v[32:35], a[4:7], v[132:135]
    ds_read_b64_tr_b16 v[30:31], v10 offset:30720
    v_mfma_f32_16x16x32_bf16 v[132:135], v[36:39], a[20:23], v[132:135]
    buffer_load_dwordx4 v2, s[24:27], s49 offen lds
    v_mfma_f32_16x16x32_bf16 v[136:139], v[32:35], a[8:11], v[136:139]
    s_mov_b32 s49, 512
    s_add_u32 m0, s45, 81920
    v_mfma_f32_16x16x32_bf16 v[136:139], v[36:39], a[24:27], v[136:139]
    s_mul_i32 s5, s6, s4
    s_mul_i32 s4, s3, s4
    v_mfma_f32_16x16x32_bf16 v[140:143], v[32:35], a[12:15], v[140:143]
    buffer_load_dwordx4 v2, s[20:23], s49 offen lds
    v_mfma_f32_16x16x32_bf16 v[140:143], v[36:39], a[28:31], v[140:143]
    s_waitcnt lgkmcnt(8)
    ds_read_b64_tr_b16 v[32:33], v11 offset:16384
    v_mfma_f32_16x16x32_bf16 v[144:147], v[40:43], a[0:3], v[144:147]
    s_add_u32 m0, s45, 86016
    ds_read_b64_tr_b16 v[34:35], v11 offset:18432
    v_mfma_f32_16x16x32_bf16 v[144:147], v[44:47], a[16:19], v[144:147]
    ds_read_b64_tr_b16 v[36:37], v11 offset:24576
    v_mfma_f32_16x16x32_bf16 v[148:151], v[40:43], a[4:7], v[148:151]
    ds_read_b64_tr_b16 v[38:39], v11 offset:26624
    v_mfma_f32_16x16x32_bf16 v[148:151], v[44:47], a[20:23], v[148:151]
    buffer_load_dwordx4 v2, s[24:27], s49 offen lds
    v_mfma_f32_16x16x32_bf16 v[152:155], v[40:43], a[8:11], v[152:155]
    s_mov_b32 s49, 295424
    s_add_u32 m0, s45, 90112
    v_mfma_f32_16x16x32_bf16 v[152:155], v[44:47], a[24:27], v[152:155]
    s_bitcmp1_b32 s0, 2
    s_cselect_b32 s58, 0, 0x40000000
    s_cselect_b32 s48, 4, 0
    v_mfma_f32_16x16x32_bf16 v[156:159], v[40:43], a[12:15], v[156:159]
    buffer_load_dwordx4 v2, s[20:23], s49 offen lds
    v_mfma_f32_16x16x32_bf16 v[156:159], v[44:47], a[28:31], v[156:159]
    s_waitcnt lgkmcnt(8)
    ds_read_b64_tr_b16 v[40:41], v11 offset:20480
    v_mfma_f32_16x16x32_bf16 v[160:163], v[16:19], a[0:3], v[160:163]
    ds_read_b64_tr_b16 v[42:43], v11 offset:22528
    v_add_u32 v8, 0xfffe0000, v8
    v_mfma_f32_16x16x32_bf16 v[160:163], v[20:23], a[16:19], v[160:163]
    s_add_u32 m0, s45, 94208
    ds_read_b64_tr_b16 v[44:45], v11 offset:28672
    v_mfma_f32_16x16x32_bf16 v[164:167], v[16:19], a[4:7], v[164:167]
    ds_read_b64_tr_b16 v[46:47], v11 offset:30720
    v_mfma_f32_16x16x32_bf16 v[164:167], v[20:23], a[20:23], v[164:167]
    buffer_load_dwordx4 v2, s[24:27], s49 offen lds
    v_mfma_f32_16x16x32_bf16 v[168:171], v[16:19], a[8:11], v[168:171]
    s_mov_b32 s49, 590336
    s_add_u32 m0, s45, 98304
    v_mfma_f32_16x16x32_bf16 v[168:171], v[20:23], a[24:27], v[168:171]
    s_bitcmp1_b32 s0, 2
    s_cselect_b32 s44, s96, s51
    s_cselect_b32 s41, 4, 8
    v_mfma_f32_16x16x32_bf16 v[172:175], v[16:19], a[12:15], v[172:175]
    s_waitcnt vmcnt(16)
    s_barrier
    v_mfma_f32_16x16x32_bf16 v[172:175], v[20:23], a[28:31], v[172:175]
    s_waitcnt lgkmcnt(8)
    ds_read_b64_tr_b16 v[16:17], v8 offset:0
    v_mfma_f32_16x16x32_bf16 v[176:179], v[24:27], a[0:3], v[176:179]
    ds_read_b64_tr_b16 v[18:19], v8 offset:2048
    v_mfma_f32_16x16x32_bf16 v[176:179], v[28:31], a[16:19], v[176:179]
    ds_read_b64_tr_b16 v[20:21], v8 offset:8192
    v_mfma_f32_16x16x32_bf16 v[180:183], v[24:27], a[4:7], v[180:183]
    ds_read_b64_tr_b16 v[22:23], v8 offset:10240
    v_mfma_f32_16x16x32_bf16 v[180:183], v[28:31], a[20:23], v[180:183]
    buffer_load_dwordx4 v2, s[20:23], s49 offen lds
    v_mfma_f32_16x16x32_bf16 v[184:187], v[24:27], a[8:11], v[184:187]
    s_add_u32 m0, s45, 102400
    v_mfma_f32_16x16x32_bf16 v[184:187], v[28:31], a[24:27], v[184:187]
    s_mul_i32 s14, s5, 36864
    s_mul_i32 s55, s4, 36864
    s_lshl_b32 s3, s48, 5
    v_mfma_f32_16x16x32_bf16 v[188:191], v[24:27], a[12:15], v[188:191]
    ds_read_b64_tr_b16 v[24:25], v8 offset:16384
    v_mfma_f32_16x16x32_bf16 v[188:191], v[28:31], a[28:31], v[188:191]
    s_waitcnt lgkmcnt(9)
    ds_read_b64_tr_b16 v[26:27], v8 offset:18432
    v_mfma_f32_16x16x32_bf16 v[192:195], v[32:35], a[0:3], v[192:195]
    buffer_load_dwordx4 v2, s[24:27], s49 offen lds
    v_mfma_f32_16x16x32_bf16 v[192:195], v[36:39], a[16:19], v[192:195]
    s_mov_b32 s49, 885248
    s_add_u32 m0, s45, 106496
    v_mfma_f32_16x16x32_bf16 v[196:199], v[32:35], a[4:7], v[196:199]
    s_add_u32 s5, s5, s3
    s_add_u32 s4, s4, s3
    s_lshl_b32 s12, s5, 12
    v_mfma_f32_16x16x32_bf16 v[196:199], v[36:39], a[20:23], v[196:199]
    ds_read_b64_tr_b16 v[28:29], v8 offset:4096
    v_mfma_f32_16x16x32_bf16 v[200:203], v[32:35], a[8:11], v[200:203]
    ds_read_b64_tr_b16 v[30:31], v8 offset:6144
    v_mfma_f32_16x16x32_bf16 v[200:203], v[36:39], a[24:27], v[200:203]
    buffer_load_dwordx4 v2, s[20:23], s49 offen lds
    v_mfma_f32_16x16x32_bf16 v[204:207], v[32:35], a[12:15], v[204:207]
    s_add_u32 m0, s45, 110592
    ds_read_b64_tr_b16 v[32:33], v8 offset:12288
    v_mfma_f32_16x16x32_bf16 v[204:207], v[36:39], a[28:31], v[204:207]
    s_waitcnt lgkmcnt(9)
    ds_read_b64_tr_b16 v[34:35], v8 offset:14336
    v_mfma_f32_16x16x32_bf16 v[208:211], v[40:43], a[0:3], v[208:211]
    ds_read_b64_tr_b16 v[36:37], v8 offset:20480
    v_mfma_f32_16x16x32_bf16 v[208:211], v[44:47], a[16:19], v[208:211]
    ds_read_b64_tr_b16 v[38:39], v8 offset:22528
    v_mfma_f32_16x16x32_bf16 v[212:215], v[40:43], a[4:7], v[212:215]
    buffer_load_dwordx4 v2, s[24:27], s49 offen lds
    v_mfma_f32_16x16x32_bf16 v[212:215], v[44:47], a[20:23], v[212:215]
    s_mov_b32 s49, 1180160
    s_add_u32 m0, s45, 114688
    v_mfma_f32_16x16x32_bf16 v[216:219], v[40:43], a[8:11], v[216:219]
    s_lshl_b32 s13, s4, 12
    s_add_u32 s3, s14, 589824
    s_add_u32 s4, s55, 516096
    v_mfma_f32_16x16x32_bf16 v[216:219], v[44:47], a[24:27], v[216:219]
    buffer_load_dwordx4 v2, s[20:23], s49 offen lds
    v_mfma_f32_16x16x32_bf16 v[220:223], v[40:43], a[12:15], v[220:223]
    s_add_u32 m0, s45, 118784
    v_mfma_f32_16x16x32_bf16 v[220:223], v[44:47], a[28:31], v[220:223]
    s_waitcnt vmcnt(17) lgkmcnt(6)
    ds_read_b64_tr_b16 v[40:41], v8 offset:24576
    v_mfma_f32_16x16x32_bf16 v[96:99], v[16:19], a[32:35], v[96:99]
    ds_read_b64_tr_b16 v[42:43], v8 offset:26624
    v_mfma_f32_16x16x32_bf16 v[96:99], v[20:23], a[48:51], v[96:99]
    ds_read_b64_tr_b16 v[44:45], v8 offset:32768
    v_mfma_f32_16x16x32_bf16 v[96:99], v[24:27], a[64:67], v[96:99]
    ds_read_b64_tr_b16 v[46:47], v8 offset:34816
    v_mfma_f32_16x16x32_bf16 v[100:103], v[16:19], a[36:39], v[100:103]
    buffer_load_dwordx4 v2, s[24:27], s49 offen lds
    v_mfma_f32_16x16x32_bf16 v[100:103], v[20:23], a[52:55], v[100:103]
    s_cmp_lt_u32 s40, 2
    s_cselect_b32 s7, s3, s4
    s_or_b32 s7, s7, s58
    v_mfma_f32_16x16x32_bf16 v[100:103], v[24:27], a[68:71], v[100:103]
    s_lshr_b32 s3, s2, 3
    s_mul_i32 s3, s3, 655360
    s_mul_i32 s5, s40, 5120
    v_mfma_f32_16x16x32_bf16 v[104:107], v[16:19], a[40:43], v[104:107]
    s_add_u32 s3, s3, s5
    s_add_u32 s3, s3, 0x3000000
    s_mov_b32 s10, 655360
    v_mfma_f32_16x16x32_bf16 v[104:107], v[20:23], a[56:59], v[104:107]
    s_add_u32 s8, s56, s3
    s_addc_u32 s9, s57, 0
    v_mfma_f32_16x16x32_bf16 v[104:107], v[24:27], a[72:75], v[104:107]
    global_load_dword v15, v[4:5], off
    v_mfma_f32_16x16x32_bf16 v[108:111], v[16:19], a[44:47], v[108:111]
    ds_read_b64_tr_b16 v[16:17], v8 offset:40960
    v_mfma_f32_16x16x32_bf16 v[108:111], v[20:23], a[60:63], v[108:111]
    ds_read_b64_tr_b16 v[18:19], v8 offset:43008
    v_mfma_f32_16x16x32_bf16 v[108:111], v[24:27], a[76:79], v[108:111]
    s_waitcnt lgkmcnt(6)
    ds_read_b64_tr_b16 v[20:21], v8 offset:28672
    v_mfma_f32_16x16x32_bf16 v[112:115], v[28:31], a[32:35], v[112:115]
    ds_read_b64_tr_b16 v[22:23], v8 offset:30720
    v_mfma_f32_16x16x32_bf16 v[112:115], v[32:35], a[48:51], v[112:115]
    ds_read_b64_tr_b16 v[24:25], v8 offset:36864
    v_mfma_f32_16x16x32_bf16 v[112:115], v[36:39], a[64:67], v[112:115]
    ds_read_b64_tr_b16 v[26:27], v8 offset:38912
    v_mfma_f32_16x16x32_bf16 v[116:119], v[28:31], a[36:39], v[116:119]
    v_add_u32 v9, 0xfffe0000, v9
    v_mfma_f32_16x16x32_bf16 v[116:119], v[32:35], a[52:55], v[116:119]
    buffer_store_dwordx4 v[48:51], v1, s[36:39], s59 offen offset:1024 sc1
    v_mfma_f32_16x16x32_bf16 v[116:119], v[36:39], a[68:71], v[116:119]
    v_mfma_f32_16x16x32_bf16 v[120:123], v[28:31], a[40:43], v[120:123]
    v_mfma_f32_16x16x32_bf16 v[120:123], v[32:35], a[56:59], v[120:123]
    v_mfma_f32_16x16x32_bf16 v[120:123], v[36:39], a[72:75], v[120:123]
    v_mfma_f32_16x16x32_bf16 v[124:127], v[28:31], a[44:47], v[124:127]
    ds_read_b64_tr_b16 v[28:29], v8 offset:45056
    v_mfma_f32_16x16x32_bf16 v[124:127], v[32:35], a[60:63], v[124:127]
    ds_read_b64_tr_b16 v[30:31], v8 offset:47104
    v_mfma_f32_16x16x32_bf16 v[124:127], v[36:39], a[76:79], v[124:127]
    s_waitcnt lgkmcnt(6)
    ds_read_b64_tr_b16 v[32:33], v9 offset:0
    v_mfma_f32_16x16x32_bf16 v[96:99], v[40:43], a[80:83], v[96:99]
    ds_read_b64_tr_b16 v[34:35], v9 offset:2048
    v_mfma_f32_16x16x32_bf16 v[96:99], v[44:47], a[96:99], v[96:99]
    ds_read_b64_tr_b16 v[36:37], v9 offset:8192
    v_mfma_f32_16x16x32_bf16 v[96:99], v[16:19], a[112:115], v[96:99]
    ds_read_b64_tr_b16 v[38:39], v9 offset:10240
    v_mfma_f32_16x16x32_bf16 v[100:103], v[40:43], a[84:87], v[100:103]
    buffer_store_dwordx4 v[52:55], v1, s[36:39], s59 offen offset:2048 sc1
    v_mfma_f32_16x16x32_bf16 v[100:103], v[44:47], a[100:103], v[100:103]
    v_mfma_f32_16x16x32_bf16 v[100:103], v[16:19], a[116:119], v[100:103]
    v_mfma_f32_16x16x32_bf16 v[104:107], v[40:43], a[88:91], v[104:107]
    v_mfma_f32_16x16x32_bf16 v[104:107], v[44:47], a[104:107], v[104:107]
    v_mfma_f32_16x16x32_bf16 v[104:107], v[16:19], a[120:123], v[104:107]
    v_mfma_f32_16x16x32_bf16 v[108:111], v[40:43], a[92:95], v[108:111]
    ds_read_b64_tr_b16 v[40:41], v9 offset:16384
    v_mfma_f32_16x16x32_bf16 v[108:111], v[44:47], a[108:111], v[108:111]
    ds_read_b64_tr_b16 v[42:43], v9 offset:18432
    v_mfma_f32_16x16x32_bf16 v[108:111], v[16:19], a[124:127], v[108:111]
    s_waitcnt lgkmcnt(6)
    ds_read_b64_tr_b16 v[44:45], v9 offset:4096
    v_mfma_f32_16x16x32_bf16 v[112:115], v[20:23], a[80:83], v[112:115]
    ds_read_b64_tr_b16 v[46:47], v9 offset:6144
    v_mfma_f32_16x16x32_bf16 v[112:115], v[24:27], a[96:99], v[112:115]
    ds_read_b64_tr_b16 v[16:17], v9 offset:12288
    v_mfma_f32_16x16x32_bf16 v[112:115], v[28:31], a[112:115], v[112:115]
    ds_read_b64_tr_b16 v[18:19], v9 offset:14336
    v_mfma_f32_16x16x32_bf16 v[116:119], v[20:23], a[84:87], v[116:119]
    buffer_store_dwordx4 v[56:59], v1, s[36:39], s59 offen offset:3072 sc1
    v_mfma_f32_16x16x32_bf16 v[116:119], v[24:27], a[100:103], v[116:119]
    v_mfma_f32_16x16x32_bf16 v[116:119], v[28:31], a[116:119], v[116:119]
    v_mfma_f32_16x16x32_bf16 v[120:123], v[20:23], a[88:91], v[120:123]
    v_mfma_f32_16x16x32_bf16 v[120:123], v[24:27], a[104:107], v[120:123]
    v_mfma_f32_16x16x32_bf16 v[120:123], v[28:31], a[120:123], v[120:123]
    v_mfma_f32_16x16x32_bf16 v[124:127], v[20:23], a[92:95], v[124:127]
    ds_read_b64_tr_b16 v[20:21], v9 offset:20480
    v_mfma_f32_16x16x32_bf16 v[124:127], v[24:27], a[108:111], v[124:127]
    ds_read_b64_tr_b16 v[22:23], v9 offset:22528
    v_mfma_f32_16x16x32_bf16 v[124:127], v[28:31], a[124:127], v[124:127]
    s_waitcnt lgkmcnt(6)
    ds_read_b64_tr_b16 v[24:25], v9 offset:24576
    v_mfma_f32_16x16x32_bf16 v[128:131], v[32:35], a[32:35], v[128:131]
    s_add_u32 s59, s59, 4096
    ds_read_b64_tr_b16 v[26:27], v9 offset:26624
    v_mfma_f32_16x16x32_bf16 v[128:131], v[36:39], a[48:51], v[128:131]
    ds_read_b64_tr_b16 v[28:29], v9 offset:32768
    v_mfma_f32_16x16x32_bf16 v[128:131], v[40:43], a[64:67], v[128:131]
    ds_read_b64_tr_b16 v[30:31], v9 offset:34816
    v_mfma_f32_16x16x32_bf16 v[132:135], v[32:35], a[36:39], v[132:135]
    buffer_store_dwordx4 v[60:63], v1, s[36:39], s59 offen offset:0 sc1
    v_mfma_f32_16x16x32_bf16 v[132:135], v[36:39], a[52:55], v[132:135]
    v_mfma_f32_16x16x32_bf16 v[132:135], v[40:43], a[68:71], v[132:135]
    v_mfma_f32_16x16x32_bf16 v[136:139], v[32:35], a[40:43], v[136:139]
    v_mfma_f32_16x16x32_bf16 v[136:139], v[36:39], a[56:59], v[136:139]
    v_mfma_f32_16x16x32_bf16 v[136:139], v[40:43], a[72:75], v[136:139]
    v_mul_f32 v112, v96, v112
    v_mul_f32 v113, v97, v113
    v_mfma_f32_16x16x32_bf16 v[140:143], v[32:35], a[44:47], v[140:143]
    ds_read_b64_tr_b16 v[32:33], v9 offset:40960
    v_mul_f32 v114, v98, v114
    v_mfma_f32_16x16x32_bf16 v[140:143], v[36:39], a[60:63], v[140:143]
    ds_read_b64_tr_b16 v[34:35], v9 offset:43008
    v_mul_f32 v115, v99, v115
    v_mfma_f32_16x16x32_bf16 v[140:143], v[40:43], a[76:79], v[140:143]
    s_waitcnt lgkmcnt(6)
    v_mul_f32 v96, s54, v96
    v_mul_f32 v97, s54, v97
    v_mfma_f32_16x16x32_bf16 v[144:147], v[44:47], a[32:35], v[144:147]
    ds_read_b64_tr_b16 v[36:37], v9 offset:28672
    v_mul_f32 v98, s54, v98
    v_mfma_f32_16x16x32_bf16 v[144:147], v[16:19], a[48:51], v[144:147]
    ds_read_b64_tr_b16 v[38:39], v9 offset:30720
    v_mul_f32 v99, s54, v99
    v_mfma_f32_16x16x32_bf16 v[144:147], v[20:23], a[64:67], v[144:147]
    ds_read_b64_tr_b16 v[40:41], v9 offset:36864
    v_mul_f32 v116, v100, v116
    v_mfma_f32_16x16x32_bf16 v[148:151], v[44:47], a[36:39], v[148:151]
    ds_read_b64_tr_b16 v[42:43], v9 offset:38912
    v_mul_f32 v117, v101, v117
    v_mfma_f32_16x16x32_bf16 v[148:151], v[16:19], a[52:55], v[148:151]
    v_add_u32 v10, 0xfffe0000, v10
    v_mul_f32 v118, v102, v118
    v_mfma_f32_16x16x32_bf16 v[148:151], v[20:23], a[68:71], v[148:151]
    buffer_store_dwordx4 v[244:247], v1, s[36:39], s59 offen offset:1024 sc1
    v_mfma_f32_16x16x32_bf16 v[152:155], v[44:47], a[40:43], v[152:155]
    v_exp_f32 v96, v96
    v_mfma_f32_16x16x32_bf16 v[152:155], v[16:19], a[56:59], v[152:155]
    v_exp_f32 v97, v97
    v_mfma_f32_16x16x32_bf16 v[152:155], v[20:23], a[72:75], v[152:155]
    v_exp_f32 v98, v98
    v_mfma_f32_16x16x32_bf16 v[156:159], v[44:47], a[44:47], v[156:159]
    ds_read_b64_tr_b16 v[44:45], v9 offset:45056
    v_add_f32 v96, 1.0, v96
    v_mfma_f32_16x16x32_bf16 v[156:159], v[16:19], a[60:63], v[156:159]
    ds_read_b64_tr_b16 v[46:47], v9 offset:47104
    v_add_f32 v97, 1.0, v97
    v_mfma_f32_16x16x32_bf16 v[156:159], v[20:23], a[76:79], v[156:159]
    s_waitcnt lgkmcnt(6)
    v_exp_f32 v99, v99
    v_mfma_f32_16x16x32_bf16 v[128:131], v[24:27], a[80:83], v[128:131]
    ds_read_b64_tr_b16 v[16:17], v10 offset:0
    v_add_f32 v98, 1.0, v98
    v_mfma_f32_16x16x32_bf16 v[128:131], v[28:31], a[96:99], v[128:131]
    ds_read_b64_tr_b16 v[18:19], v10 offset:2048
    v_add_f32 v99, 1.0, v99
    v_mfma_f32_16x16x32_bf16 v[128:131], v[32:35], a[112:115], v[128:131]
    ds_read_b64_tr_b16 v[20:21], v10 offset:8192
    v_mul_f32 v119, v103, v119
    v_mfma_f32_16x16x32_bf16 v[132:135], v[24:27], a[84:87], v[132:135]
    ds_read_b64_tr_b16 v[22:23], v10 offset:10240
    v_mul_f32 v100, s54, v100
    v_mfma_f32_16x16x32_bf16 v[132:135], v[28:31], a[100:103], v[132:135]
    buffer_store_dwordx4 v[248:251], v1, s[36:39], s59 offen offset:2048 sc1
    v_mfma_f32_16x16x32_bf16 v[132:135], v[32:35], a[116:119], v[132:135]
    v_rcp_f32 v96, v96
    v_mfma_f32_16x16x32_bf16 v[136:139], v[24:27], a[88:91], v[136:139]
    v_rcp_f32 v97, v97
    v_mfma_f32_16x16x32_bf16 v[136:139], v[28:31], a[104:107], v[136:139]
    v_rcp_f32 v98, v98
    v_mfma_f32_16x16x32_bf16 v[136:139], v[32:35], a[120:123], v[136:139]
    v_rcp_f32 v99, v99
    v_mfma_f32_16x16x32_bf16 v[140:143], v[24:27], a[92:95], v[140:143]
    ds_read_b64_tr_b16 v[24:25], v10 offset:16384
    v_mul_f32 v112, v112, v96
    v_mfma_f32_16x16x32_bf16 v[140:143], v[28:31], a[108:111], v[140:143]
    ds_read_b64_tr_b16 v[26:27], v10 offset:18432
    v_mul_f32 v113, v113, v97
    v_mfma_f32_16x16x32_bf16 v[140:143], v[32:35], a[124:127], v[140:143]
    s_waitcnt lgkmcnt(6)
    v_exp_f32 v100, v100
    v_mfma_f32_16x16x32_bf16 v[144:147], v[36:39], a[80:83], v[144:147]
    ds_read_b64_tr_b16 v[28:29], v10 offset:4096
    v_mul_f32 v114, v114, v98
    v_mfma_f32_16x16x32_bf16 v[144:147], v[40:43], a[96:99], v[144:147]
    ds_read_b64_tr_b16 v[30:31], v10 offset:6144
    v_mul_f32 v115, v115, v99
    v_mfma_f32_16x16x32_bf16 v[144:147], v[44:47], a[112:115], v[144:147]
    ds_read_b64_tr_b16 v[32:33], v10 offset:12288
    v_cvt_pk_bf16_f32 v48, v112, v113
    v_mfma_f32_16x16x32_bf16 v[148:151], v[36:39], a[84:87], v[148:151]
    ds_read_b64_tr_b16 v[34:35], v10 offset:14336
    v_cvt_pk_bf16_f32 v49, v114, v115
    v_mfma_f32_16x16x32_bf16 v[148:151], v[40:43], a[100:103], v[148:151]
    buffer_store_dwordx4 v[224:227], v1, s[36:39], s59 offen offset:3072 sc1
    v_mfma_f32_16x16x32_bf16 v[148:151], v[44:47], a[116:119], v[148:151]
    v_mul_f32 v101, s54, v101
    v_mul_f32 v102, s54, v102
    v_mfma_f32_16x16x32_bf16 v[152:155], v[36:39], a[88:91], v[152:155]
    v_exp_f32 v101, v101
    v_mfma_f32_16x16x32_bf16 v[152:155], v[40:43], a[104:107], v[152:155]
    v_exp_f32 v102, v102
    v_mfma_f32_16x16x32_bf16 v[152:155], v[44:47], a[120:123], v[152:155]
    v_mul_f32 v103, s54, v103
    v_add_f32 v100, 1.0, v100
    v_mfma_f32_16x16x32_bf16 v[156:159], v[36:39], a[92:95], v[156:159]
    ds_read_b64_tr_b16 v[36:37], v10 offset:20480
    v_add_f32 v101, 1.0, v101
    v_mfma_f32_16x16x32_bf16 v[156:159], v[40:43], a[108:111], v[156:159]
    ds_read_b64_tr_b16 v[38:39], v10 offset:22528
    v_add_f32 v102, 1.0, v102
    v_mfma_f32_16x16x32_bf16 v[156:159], v[44:47], a[124:127], v[156:159]
    s_waitcnt lgkmcnt(6)
    s_add_u32 s59, s59, 4096
    v_mul_f32 v120, v104, v120
    v_mfma_f32_16x16x32_bf16 v[160:163], v[16:19], a[32:35], v[160:163]
    ds_read_b64_tr_b16 v[40:41], v10 offset:24576
    v_mul_f32 v121, v105, v121
    v_mfma_f32_16x16x32_bf16 v[160:163], v[20:23], a[48:51], v[160:163]
    ds_read_b64_tr_b16 v[42:43], v10 offset:26624
    v_mul_f32 v122, v106, v122
    v_mfma_f32_16x16x32_bf16 v[160:163], v[24:27], a[64:67], v[160:163]
    ds_read_b64_tr_b16 v[44:45], v10 offset:32768
    v_mul_f32 v123, v107, v123
    v_mfma_f32_16x16x32_bf16 v[164:167], v[16:19], a[36:39], v[164:167]
    ds_read_b64_tr_b16 v[46:47], v10 offset:34816
    v_mul_f32 v104, s54, v104
    v_mfma_f32_16x16x32_bf16 v[164:167], v[20:23], a[52:55], v[164:167]
    buffer_store_dwordx4 v[228:231], v1, s[36:39], s59 offen offset:0 sc1
    v_mfma_f32_16x16x32_bf16 v[164:167], v[24:27], a[68:71], v[164:167]
    v_exp_f32 v103, v103
    v_mfma_f32_16x16x32_bf16 v[168:171], v[16:19], a[40:43], v[168:171]
    v_rcp_f32 v100, v100
    v_mfma_f32_16x16x32_bf16 v[168:171], v[20:23], a[56:59], v[168:171]
    v_rcp_f32 v101, v101
    v_mfma_f32_16x16x32_bf16 v[168:171], v[24:27], a[72:75], v[168:171]
    v_rcp_f32 v102, v102
    v_mfma_f32_16x16x32_bf16 v[172:175], v[16:19], a[44:47], v[172:175]
    ds_read_b64_tr_b16 v[16:17], v10 offset:40960
    v_add_f32 v103, 1.0, v103
    v_mfma_f32_16x16x32_bf16 v[172:175], v[20:23], a[60:63], v[172:175]
    ds_read_b64_tr_b16 v[18:19], v10 offset:43008
    v_mul_f32 v116, v116, v100
    v_mfma_f32_16x16x32_bf16 v[172:175], v[24:27], a[76:79], v[172:175]
    s_waitcnt lgkmcnt(6)
    v_rcp_f32 v103, v103
    v_mfma_f32_16x16x32_bf16 v[176:179], v[28:31], a[32:35], v[176:179]
    ds_read_b64_tr_b16 v[20:21], v10 offset:28672
    v_mul_f32 v117, v117, v101
    v_mfma_f32_16x16x32_bf16 v[176:179], v[32:35], a[48:51], v[176:179]
    ds_read_b64_tr_b16 v[22:23], v10 offset:30720
    v_mul_f32 v118, v118, v102
    v_mfma_f32_16x16x32_bf16 v[176:179], v[36:39], a[64:67], v[176:179]
    ds_read_b64_tr_b16 v[24:25], v10 offset:36864
    v_mul_f32 v119, v119, v103
    v_mfma_f32_16x16x32_bf16 v[180:183], v[28:31], a[36:39], v[180:183]
    ds_read_b64_tr_b16 v[26:27], v10 offset:38912
    v_cvt_pk_bf16_f32 v52, v116, v117
    v_mfma_f32_16x16x32_bf16 v[180:183], v[32:35], a[52:55], v[180:183]
    v_add_u32 v11, 0xfffe0000, v11
    v_cvt_pk_bf16_f32 v53, v118, v119
    v_mfma_f32_16x16x32_bf16 v[180:183], v[36:39], a[68:71], v[180:183]
    buffer_store_dwordx4 v[232:235], v1, s[36:39], s59 offen offset:1024 sc1
    v_mfma_f32_16x16x32_bf16 v[184:187], v[28:31], a[40:43], v[184:187]
    v_exp_f32 v104, v104
    v_mfma_f32_16x16x32_bf16 v[184:187], v[32:35], a[56:59], v[184:187]
    v_mul_f32 v105, s54, v105
    v_mul_f32 v106, s54, v106
    v_mfma_f32_16x16x32_bf16 v[184:187], v[36:39], a[72:75], v[184:187]
    v_exp_f32 v105, v105
    v_mfma_f32_16x16x32_bf16 v[188:191], v[28:31], a[44:47], v[188:191]
    ds_read_b64_tr_b16 v[28:29], v10 offset:45056
    v_mul_f32 v107, s54, v107
    v_mfma_f32_16x16x32_bf16 v[188:191], v[32:35], a[60:63], v[188:191]
    ds_read_b64_tr_b16 v[30:31], v10 offset:47104
    v_add_f32 v104, 1.0, v104
    v_mfma_f32_16x16x32_bf16 v[188:191], v[36:39], a[76:79], v[188:191]
    s_waitcnt lgkmcnt(6)
    v_exp_f32 v106, v106
    v_mfma_f32_16x16x32_bf16 v[160:163], v[40:43], a[80:83], v[160:163]
    ds_read_b64_tr_b16 v[32:33], v11 offset:0
    v_add_f32 v105, 1.0, v105
    v_mfma_f32_16x16x32_bf16 v[160:163], v[44:47], a[96:99], v[160:163]
    ds_read_b64_tr_b16 v[34:35], v11 offset:2048
    v_add_f32 v106, 1.0, v106
    v_mfma_f32_16x16x32_bf16 v[160:163], v[16:19], a[112:115], v[160:163]
    ds_read_b64_tr_b16 v[36:37], v11 offset:8192
    v_mul_f32 v124, v108, v124
    v_mfma_f32_16x16x32_bf16 v[164:167], v[40:43], a[84:87], v[164:167]
    ds_read_b64_tr_b16 v[38:39], v11 offset:10240
    v_mul_f32 v125, v109, v125
    v_mfma_f32_16x16x32_bf16 v[164:167], v[44:47], a[100:103], v[164:167]
    buffer_store_dwordx4 v[236:239], v1, s[36:39], s59 offen offset:2048 sc1
    v_mfma_f32_16x16x32_bf16 v[164:167], v[16:19], a[116:119], v[164:167]
    v_exp_f32 v107, v107
    v_mfma_f32_16x16x32_bf16 v[168:171], v[40:43], a[88:91], v[168:171]
    v_rcp_f32 v104, v104
    v_mfma_f32_16x16x32_bf16 v[168:171], v[44:47], a[104:107], v[168:171]
    v_rcp_f32 v105, v105
    v_mfma_f32_16x16x32_bf16 v[168:171], v[16:19], a[120:123], v[168:171]
    v_rcp_f32 v106, v106
    v_mfma_f32_16x16x32_bf16 v[172:175], v[40:43], a[92:95], v[172:175]
    ds_read_b64_tr_b16 v[40:41], v11 offset:16384
    v_add_f32 v107, 1.0, v107
    v_mfma_f32_16x16x32_bf16 v[172:175], v[44:47], a[108:111], v[172:175]
    ds_read_b64_tr_b16 v[42:43], v11 offset:18432
    v_mul_f32 v120, v120, v104
    v_mfma_f32_16x16x32_bf16 v[172:175], v[16:19], a[124:127], v[172:175]
    s_waitcnt lgkmcnt(6)
    v_rcp_f32 v107, v107
    v_mfma_f32_16x16x32_bf16 v[176:179], v[20:23], a[80:83], v[176:179]
    ds_read_b64_tr_b16 v[44:45], v11 offset:4096
    v_mul_f32 v121, v121, v105
    v_mfma_f32_16x16x32_bf16 v[176:179], v[24:27], a[96:99], v[176:179]
    ds_read_b64_tr_b16 v[46:47], v11 offset:6144
    v_mul_f32 v122, v122, v106
    v_mfma_f32_16x16x32_bf16 v[176:179], v[28:31], a[112:115], v[176:179]
    ds_read_b64_tr_b16 v[16:17], v11 offset:12288
    v_mul_f32 v123, v123, v107
    v_mfma_f32_16x16x32_bf16 v[180:183], v[20:23], a[84:87], v[180:183]
    ds_read_b64_tr_b16 v[18:19], v11 offset:14336
    v_cvt_pk_bf16_f32 v56, v120, v121
    v_mfma_f32_16x16x32_bf16 v[180:183], v[24:27], a[100:103], v[180:183]
    buffer_store_dwordx4 v[240:243], v1, s[36:39], s59 offen offset:3072 sc1
    v_mfma_f32_16x16x32_bf16 v[180:183], v[28:31], a[116:119], v[180:183]
    v_cvt_pk_bf16_f32 v57, v122, v123
    v_mul_f32 v126, v110, v126
    v_mfma_f32_16x16x32_bf16 v[184:187], v[20:23], a[88:91], v[184:187]
    v_mul_f32 v127, v111, v127
    v_mul_f32 v108, s54, v108
    v_mfma_f32_16x16x32_bf16 v[184:187], v[24:27], a[104:107], v[184:187]
    v_exp_f32 v108, v108
    v_mfma_f32_16x16x32_bf16 v[184:187], v[28:31], a[120:123], v[184:187]
    v_mul_f32 v109, s54, v109
    v_mul_f32 v110, s54, v110
    v_mfma_f32_16x16x32_bf16 v[188:191], v[20:23], a[92:95], v[188:191]
    ds_read_b64_tr_b16 v[20:21], v11 offset:20480
    v_mul_f32 v111, s54, v111
    v_mfma_f32_16x16x32_bf16 v[188:191], v[24:27], a[108:111], v[188:191]
    ds_read_b64_tr_b16 v[22:23], v11 offset:22528
    v_add_f32 v108, 1.0, v108
    v_mfma_f32_16x16x32_bf16 v[188:191], v[28:31], a[124:127], v[188:191]
    s_waitcnt lgkmcnt(6)
    v_exp_f32 v109, v109
    v_mfma_f32_16x16x32_bf16 v[192:195], v[32:35], a[32:35], v[192:195]
    ds_read_b64_tr_b16 v[24:25], v11 offset:24576
    v_add_f32 v109, 1.0, v109
    v_mfma_f32_16x16x32_bf16 v[192:195], v[36:39], a[48:51], v[192:195]
    ds_read_b64_tr_b16 v[26:27], v11 offset:26624
    v_mul_f32 v144, v128, v144
    v_mfma_f32_16x16x32_bf16 v[192:195], v[40:43], a[64:67], v[192:195]
    ds_read_b64_tr_b16 v[28:29], v11 offset:32768
    v_mul_f32 v145, v129, v145
    v_mfma_f32_16x16x32_bf16 v[196:199], v[32:35], a[36:39], v[196:199]
    ds_read_b64_tr_b16 v[30:31], v11 offset:34816
    v_mul_f32 v146, v130, v146
    v_mfma_f32_16x16x32_bf16 v[196:199], v[36:39], a[52:55], v[196:199]
    v_exp_f32 v110, v110
    v_mfma_f32_16x16x32_bf16 v[196:199], v[40:43], a[68:71], v[196:199]
    v_exp_f32 v111, v111
    v_mfma_f32_16x16x32_bf16 v[200:203], v[32:35], a[40:43], v[200:203]
    v_rcp_f32 v108, v108
    v_mfma_f32_16x16x32_bf16 v[200:203], v[36:39], a[56:59], v[200:203]
    v_rcp_f32 v109, v109
    v_mfma_f32_16x16x32_bf16 v[200:203], v[40:43], a[72:75], v[200:203]
    v_add_f32 v110, 1.0, v110
    v_add_f32 v111, 1.0, v111
    v_mfma_f32_16x16x32_bf16 v[204:207], v[32:35], a[44:47], v[204:207]
    ds_read_b64_tr_b16 v[32:33], v11 offset:40960
    v_mul_f32 v124, v124, v108
    v_mfma_f32_16x16x32_bf16 v[204:207], v[36:39], a[60:63], v[204:207]
    ds_read_b64_tr_b16 v[34:35], v11 offset:43008
    v_mul_f32 v125, v125, v109
    v_mfma_f32_16x16x32_bf16 v[204:207], v[40:43], a[76:79], v[204:207]
    s_waitcnt lgkmcnt(6)
    v_rcp_f32 v110, v110
    v_mfma_f32_16x16x32_bf16 v[208:211], v[44:47], a[32:35], v[208:211]
    ds_read_b64_tr_b16 v[36:37], v11 offset:28672
    v_mul_f32 v126, v126, v110
    v_mfma_f32_16x16x32_bf16 v[208:211], v[16:19], a[48:51], v[208:211]
    ds_read_b64_tr_b16 v[38:39], v11 offset:30720
    v_cvt_pk_bf16_f32 v60, v124, v125
    v_mfma_f32_16x16x32_bf16 v[208:211], v[20:23], a[64:67], v[208:211]
    ds_read_b64_tr_b16 v[40:41], v11 offset:36864
    v_mul_f32 v147, v131, v147
    v_mfma_f32_16x16x32_bf16 v[212:215], v[44:47], a[36:39], v[212:215]
    ds_read_b64_tr_b16 v[42:43], v11 offset:38912
    v_mul_f32 v128, s54, v128
    v_mfma_f32_16x16x32_bf16 v[212:215], v[16:19], a[52:55], v[212:215]
    v_rcp_f32 v111, v111
    v_mfma_f32_16x16x32_bf16 v[212:215], v[20:23], a[68:71], v[212:215]
    v_exp_f32 v128, v128
    v_mfma_f32_16x16x32_bf16 v[216:219], v[44:47], a[40:43], v[216:219]
    v_mul_f32 v127, v127, v111
    v_cvt_pk_bf16_f32 v61, v126, v127
    v_mfma_f32_16x16x32_bf16 v[216:219], v[16:19], a[56:59], v[216:219]
    v_mul_f32 v129, s54, v129
    v_mul_f32 v130, s54, v130
    v_mfma_f32_16x16x32_bf16 v[216:219], v[20:23], a[72:75], v[216:219]
    v_exp_f32 v129, v129
    v_mfma_f32_16x16x32_bf16 v[220:223], v[44:47], a[44:47], v[220:223]
    ds_read_b64_tr_b16 v[44:45], v11 offset:45056
    v_mul_f32 v131, s54, v131
    v_mfma_f32_16x16x32_bf16 v[220:223], v[16:19], a[60:63], v[220:223]
    ds_read_b64_tr_b16 v[46:47], v11 offset:47104
    v_add_f32 v128, 1.0, v128
    v_mfma_f32_16x16x32_bf16 v[220:223], v[20:23], a[76:79], v[220:223]
    s_waitcnt lgkmcnt(6)
    v_exp_f32 v130, v130
    v_mfma_f32_16x16x32_bf16 v[192:195], v[24:27], a[80:83], v[192:195]
    v_exp_f32 v131, v131
    v_mfma_f32_16x16x32_bf16 v[192:195], v[28:31], a[96:99], v[192:195]
    v_rcp_f32 v128, v128
    v_mfma_f32_16x16x32_bf16 v[192:195], v[32:35], a[112:115], v[192:195]
    v_add_f32 v129, 1.0, v129
    v_add_f32 v130, 1.0, v130
    v_mfma_f32_16x16x32_bf16 v[196:199], v[24:27], a[84:87], v[196:199]
    v_rcp_f32 v129, v129
    v_mfma_f32_16x16x32_bf16 v[196:199], v[28:31], a[100:103], v[196:199]
    s_mov_b32 s49, 4128768
    v_rcp_f32 v130, v130
    v_mfma_f32_16x16x32_bf16 v[196:199], v[32:35], a[116:119], v[196:199]
    s_add_u32 m0, s89, 122880
    v_add_f32 v131, 1.0, v131
    v_mul_f32 v144, v144, v128
    v_mfma_f32_16x16x32_bf16 v[200:203], v[24:27], a[88:91], v[200:203]
    s_waitcnt vmcnt(11)
    s_barrier
    v_mul_f32 v145, v145, v129
    v_mfma_f32_16x16x32_bf16 v[200:203], v[28:31], a[104:107], v[200:203]
    ds_read_b64_tr_b16 v[16:17], v8 offset:49152
    v_mul_f32 v146, v146, v130
    v_mfma_f32_16x16x32_bf16 v[200:203], v[32:35], a[120:123], v[200:203]
    ds_read_b64_tr_b16 v[18:19], v8 offset:51200
    v_cvt_pk_bf16_f32 v50, v144, v145
    v_mfma_f32_16x16x32_bf16 v[204:207], v[24:27], a[92:95], v[204:207]
    ds_read_b64_tr_b16 v[20:21], v8 offset:57344
    v_mul_f32 v148, v132, v148
    v_mfma_f32_16x16x32_bf16 v[204:207], v[28:31], a[108:111], v[204:207]
    ds_read_b64_tr_b16 v[22:23], v8 offset:59392
    v_add_u32 v8, 0x10000, v8
    v_mfma_f32_16x16x32_bf16 v[204:207], v[32:35], a[124:127], v[204:207]
    s_waitcnt lgkmcnt(4)
    ds_read_b64_tr_b16 v[24:25], v8 offset:0
    v_mfma_f32_16x16x32_bf16 v[208:211], v[36:39], a[80:83], v[208:211]
    ds_read_b64_tr_b16 v[26:27], v8 offset:2048
    v_add_u32 v8, 0xffffc000, v8
    v_mfma_f32_16x16x32_bf16 v[208:211], v[40:43], a[96:99], v[208:211]
    ds_read_b64_tr_b16 v[28:29], v8 offset:4096
    v_mul_f32 v149, v133, v149
    v_mfma_f32_16x16x32_bf16 v[208:211], v[44:47], a[112:115], v[208:211]
    ds_read_b64_tr_b16 v[30:31], v8 offset:6144
    v_mul_f32 v150, v134, v150
    v_mfma_f32_16x16x32_bf16 v[212:215], v[36:39], a[84:87], v[212:215]
    ds_read_b64_tr_b16 v[32:33], v8 offset:12288
    v_mul_f32 v151, v135, v151
    v_mfma_f32_16x16x32_bf16 v[212:215], v[40:43], a[100:103], v[212:215]
    ds_read_b64_tr_b16 v[34:35], v8 offset:14336
    v_mul_f32 v132, s54, v132
    v_mfma_f32_16x16x32_bf16 v[212:215], v[44:47], a[116:119], v[212:215]
    buffer_load_dwordx4 v3, s[28:31], s49 offen lds
    v_mfma_f32_16x16x32_bf16 v[216:219], v[36:39], a[88:91], v[216:219]
    v_rcp_f32 v131, v131
    v_mfma_f32_16x16x32_bf16 v[216:219], v[40:43], a[104:107], v[216:219]
    v_exp_f32 v132, v132
    v_mfma_f32_16x16x32_bf16 v[216:219], v[44:47], a[120:123], v[216:219]
    v_mul_f32 v147, v147, v131
    v_cvt_pk_bf16_f32 v51, v146, v147
    v_mfma_f32_16x16x32_bf16 v[220:223], v[36:39], a[92:95], v[220:223]
    ds_read_b64_tr_b16 v[36:37], v8 offset:20480
    v_mul_f32 v133, s54, v133
    v_mfma_f32_16x16x32_bf16 v[220:223], v[40:43], a[108:111], v[220:223]
    ds_read_b64_tr_b16 v[38:39], v8 offset:22528
    v_mul_f32 v134, s54, v134
    v_mfma_f32_16x16x32_bf16 v[220:223], v[44:47], a[124:127], v[220:223]
    s_waitcnt lgkmcnt(6)
    v_exp_f32 v133, v133
    v_mfma_f32_16x16x32_bf16 v[224:227], v[16:19], a[224:227], 0
    ds_read_b64_tr_b16 v[40:41], v8 offset:24576
    v_mul_f32 v135, s54, v135
    v_mfma_f32_16x16x32_bf16 v[224:227], v[20:23], a[240:243], v[224:227]
    ds_read_b64_tr_b16 v[42:43], v8 offset:26624
    v_add_f32 v132, 1.0, v132
    v_mfma_f32_16x16x32_bf16 v[224:227], v[24:27], v[64:67], v[224:227]
    ds_read_b64_tr_b16 v[44:45], v8 offset:32768
    v_add_f32 v133, 1.0, v133
    v_mfma_f32_16x16x32_bf16 v[228:231], v[16:19], a[228:231], 0
    ds_read_b64_tr_b16 v[46:47], v8 offset:34816
    v_mul_f32 v152, v136, v152
    v_mfma_f32_16x16x32_bf16 v[228:231], v[20:23], a[244:247], v[228:231]
    s_barrier
    v_exp_f32 v134, v134
    v_mfma_f32_16x16x32_bf16 v[228:231], v[24:27], v[68:71], v[228:231]
    buffer_store_dwordx4 v[48:51], v1, s[36:39], s52 offen offset:0 sc1
    v_mfma_f32_16x16x32_bf16 v[232:235], v[16:19], a[232:235], 0
    v_exp_f32 v135, v135
    v_mfma_f32_16x16x32_bf16 v[232:235], v[20:23], a[248:251], v[232:235]
    s_mov_b32 s49, 4718592
    v_rcp_f32 v132, v132
    v_mfma_f32_16x16x32_bf16 v[232:235], v[24:27], v[72:75], v[232:235]
    s_add_u32 m0, s89, 126976
    v_rcp_f32 v133, v133
    v_mfma_f32_16x16x32_bf16 v[236:239], v[16:19], a[236:239], 0
    ds_read_b64_tr_b16 v[16:17], v8 offset:40960
    v_add_f32 v134, 1.0, v134
    v_mfma_f32_16x16x32_bf16 v[236:239], v[20:23], a[252:255], v[236:239]
    ds_read_b64_tr_b16 v[18:19], v8 offset:43008
    v_add_f32 v135, 1.0, v135
    v_mfma_f32_16x16x32_bf16 v[236:239], v[24:27], v[76:79], v[236:239]
    s_waitcnt lgkmcnt(6)
    v_rcp_f32 v134, v134
    v_mfma_f32_16x16x32_bf16 v[240:243], v[28:31], a[224:227], 0
    ds_read_b64_tr_b16 v[20:21], v8 offset:28672
    v_mul_f32 v148, v148, v132
    v_mfma_f32_16x16x32_bf16 v[240:243], v[32:35], a[240:243], v[240:243]
    ds_read_b64_tr_b16 v[22:23], v8 offset:30720
    v_mul_f32 v149, v149, v133
    v_mfma_f32_16x16x32_bf16 v[240:243], v[36:39], v[64:67], v[240:243]
    ds_read_b64_tr_b16 v[24:25], v8 offset:36864
    v_mul_f32 v150, v150, v134
    v_mfma_f32_16x16x32_bf16 v[244:247], v[28:31], a[228:231], 0
    ds_read_b64_tr_b16 v[26:27], v8 offset:38912
    v_cvt_pk_bf16_f32 v54, v148, v149
    v_mfma_f32_16x16x32_bf16 v[244:247], v[32:35], a[244:247], v[244:247]
    buffer_load_dwordx4 v3, s[28:31], s49 offen lds
    v_mfma_f32_16x16x32_bf16 v[244:247], v[36:39], v[68:71], v[244:247]
    v_rcp_f32 v135, v135
    v_mfma_f32_16x16x32_bf16 v[248:251], v[28:31], a[232:235], 0
    v_mul_f32 v151, v151, v135
    v_cvt_pk_bf16_f32 v55, v150, v151
    v_mfma_f32_16x16x32_bf16 v[248:251], v[32:35], a[248:251], v[248:251]
    buffer_store_dwordx4 v[52:55], v1, s[36:39], s52 offen offset:1024 sc1
    v_mfma_f32_16x16x32_bf16 v[248:251], v[36:39], v[72:75], v[248:251]
    v_mul_f32 v153, v137, v153
    v_mul_f32 v154, v138, v154
    v_mfma_f32_16x16x32_bf16 v[252:255], v[28:31], a[236:239], 0
    ds_read_b64_tr_b16 v[28:29], v8 offset:45056
    v_mul_f32 v155, v139, v155
    v_mfma_f32_16x16x32_bf16 v[252:255], v[32:35], a[252:255], v[252:255]
    ds_read_b64_tr_b16 v[30:31], v8 offset:47104
    v_mul_f32 v136, s54, v136
    v_mfma_f32_16x16x32_bf16 v[252:255], v[36:39], v[76:79], v[252:255]
    s_waitcnt lgkmcnt(6)
    v_exp_f32 v136, v136
    v_mfma_f32_16x16x32_bf16 v[224:227], v[40:43], v[80:83], v[224:227]
    ds_read_b64_tr_b16 v[32:33], v8 offset:49152
    v_mul_f32 v137, s54, v137
    v_mfma_f32_16x16x32_bf16 v[224:227], v[44:47], a[148:151], v[224:227]
    ds_read_b64_tr_b16 v[34:35], v8 offset:51200
    v_mul_f32 v138, s54, v138
    v_mfma_f32_16x16x32_bf16 v[224:227], v[16:19], a[164:167], v[224:227]
    ds_read_b64_tr_b16 v[36:37], v8 offset:57344
    v_mul_f32 v139, s54, v139
    v_mfma_f32_16x16x32_bf16 v[228:231], v[40:43], v[84:87], v[228:231]
    ds_read_b64_tr_b16 v[38:39], v8 offset:59392
    v_add_u32 v8, 0x10000, v8
    v_mfma_f32_16x16x32_bf16 v[228:231], v[44:47], a[152:155], v[228:231]
    v_exp_f32 v137, v137
    v_mfma_f32_16x16x32_bf16 v[228:231], v[16:19], a[168:171], v[228:231]
    v_exp_f32 v138, v138
    v_mfma_f32_16x16x32_bf16 v[232:235], v[40:43], v[88:91], v[232:235]
    v_exp_f32 v139, v139
    v_mfma_f32_16x16x32_bf16 v[232:235], v[44:47], a[156:159], v[232:235]
    s_mov_b32 s49, 0
    v_add_f32 v136, 1.0, v136
    v_add_f32 v137, 1.0, v137
    v_mfma_f32_16x16x32_bf16 v[232:235], v[16:19], a[172:175], v[232:235]
    s_add_u32 m0, s89, 131072
    v_rcp_f32 v136, v136
    v_mfma_f32_16x16x32_bf16 v[236:239], v[40:43], v[92:95], v[236:239]
    ds_read_b64_tr_b16 v[40:41], v8 offset:0
    v_add_f32 v138, 1.0, v138
    v_mfma_f32_16x16x32_bf16 v[236:239], v[44:47], a[160:163], v[236:239]
    ds_read_b64_tr_b16 v[42:43], v8 offset:2048
    v_add_u32 v8, 0xffffc000, v8
    v_mfma_f32_16x16x32_bf16 v[236:239], v[16:19], a[176:179], v[236:239]
    s_waitcnt lgkmcnt(6)
    v_rcp_f32 v137, v137
    v_mfma_f32_16x16x32_bf16 v[240:243], v[20:23], v[80:83], v[240:243]
    ds_read_b64_tr_b16 v[44:45], v8 offset:4096
    v_add_f32 v139, 1.0, v139
    v_mfma_f32_16x16x32_bf16 v[240:243], v[24:27], a[148:151], v[240:243]
    ds_read_b64_tr_b16 v[46:47], v8 offset:6144
    v_mul_f32 v152, v152, v136
    v_mfma_f32_16x16x32_bf16 v[240:243], v[28:31], a[164:167], v[240:243]
    ds_read_b64_tr_b16 v[16:17], v8 offset:12288
    v_mul_f32 v153, v153, v137
    v_mfma_f32_16x16x32_bf16 v[244:247], v[20:23], v[84:87], v[244:247]
    ds_read_b64_tr_b16 v[18:19], v8 offset:14336
    v_cvt_pk_bf16_f32 v58, v152, v153
    v_mfma_f32_16x16x32_bf16 v[244:247], v[24:27], a[152:155], v[244:247]
    buffer_load_dwordx4 v3, s[28:31], s49 offen lds
    v_mfma_f32_16x16x32_bf16 v[244:247], v[28:31], a[168:171], v[244:247]
    v_rcp_f32 v138, v138
    v_mfma_f32_16x16x32_bf16 v[248:251], v[20:23], v[88:91], v[248:251]
    v_rcp_f32 v139, v139
    v_mfma_f32_16x16x32_bf16 v[248:251], v[24:27], a[156:159], v[248:251]
    v_mul_f32 v154, v154, v138
    v_mul_f32 v155, v155, v139
    v_mfma_f32_16x16x32_bf16 v[248:251], v[28:31], a[172:175], v[248:251]
    global_load_dword v15, v[4:5], off
    v_mfma_f32_16x16x32_bf16 v[252:255], v[20:23], v[92:95], v[252:255]
    ds_read_b64_tr_b16 v[20:21], v8 offset:20480
    v_cvt_pk_bf16_f32 v59, v154, v155
    v_mfma_f32_16x16x32_bf16 v[252:255], v[24:27], a[160:163], v[252:255]
    ds_read_b64_tr_b16 v[22:23], v8 offset:22528
    v_mul_f32 v156, v140, v156
    v_mfma_f32_16x16x32_bf16 v[252:255], v[28:31], a[176:179], v[252:255]
    s_waitcnt lgkmcnt(6)
    v_mul_f32 v157, v141, v157
    v_mul_f32 v158, v142, v158
    v_mfma_f32_16x16x32_bf16 v[224:227], v[32:35], a[212:215], v[224:227]
    ds_read_b64_tr_b16 v[24:25], v9 offset:49152
    v_mul_f32 v159, v143, v159
    v_mfma_f32_16x16x32_bf16 v[224:227], v[36:39], a[132:135], v[224:227]
    ds_read_b64_tr_b16 v[26:27], v9 offset:51200
    v_mul_f32 v140, s54, v140
    v_mfma_f32_16x16x32_bf16 v[224:227], v[40:43], a[180:183], v[224:227]
    ds_read_b64_tr_b16 v[28:29], v9 offset:57344
    v_mul_f32 v141, s54, v141
    v_mfma_f32_16x16x32_bf16 v[228:231], v[32:35], a[216:219], v[228:231]
    ds_read_b64_tr_b16 v[30:31], v9 offset:59392
    v_add_u32 v9, 0x10000, v9
    v_mfma_f32_16x16x32_bf16 v[228:231], v[36:39], a[136:139], v[228:231]
    buffer_store_dwordx4 v[56:59], v1, s[36:39], s52 offen offset:2048 sc1
    v_mfma_f32_16x16x32_bf16 v[228:231], v[40:43], a[184:187], v[228:231]
    v_exp_f32 v140, v140
    v_mfma_f32_16x16x32_bf16 v[232:235], v[32:35], a[220:223], v[232:235]
    v_exp_f32 v141, v141
    v_mfma_f32_16x16x32_bf16 v[232:235], v[36:39], a[140:143], v[232:235]
    s_mov_b32 s49, 589824
    v_mul_f32 v142, s54, v142
    v_mul_f32 v143, s54, v143
    v_mfma_f32_16x16x32_bf16 v[232:235], v[40:43], a[188:191], v[232:235]
    s_add_u32 m0, s89, 135168
    v_exp_f32 v142, v142
    v_mfma_f32_16x16x32_bf16 v[236:239], v[32:35], a[128:131], v[236:239]
    ds_read_b64_tr_b16 v[32:33], v9 offset:0
    v_add_f32 v140, 1.0, v140
    v_mfma_f32_16x16x32_bf16 v[236:239], v[36:39], a[144:147], v[236:239]
    ds_read_b64_tr_b16 v[34:35], v9 offset:2048
    v_add_u32 v9, 0xffffc000, v9
    v_mfma_f32_16x16x32_bf16 v[236:239], v[40:43], a[192:195], v[236:239]
    s_waitcnt lgkmcnt(6)
    v_exp_f32 v143, v143
    v_mfma_f32_16x16x32_bf16 v[240:243], v[44:47], a[212:215], v[240:243]
    ds_read_b64_tr_b16 v[36:37], v9 offset:4096
    v_add_f32 v141, 1.0, v141
    v_mfma_f32_16x16x32_bf16 v[240:243], v[16:19], a[132:135], v[240:243]
    ds_read_b64_tr_b16 v[38:39], v9 offset:6144
    v_add_f32 v142, 1.0, v142
    v_mfma_f32_16x16x32_bf16 v[240:243], v[20:23], a[180:183], v[240:243]
    ds_read_b64_tr_b16 v[40:41], v9 offset:12288
    v_add_f32 v143, 1.0, v143
    v_mfma_f32_16x16x32_bf16 v[244:247], v[44:47], a[216:219], v[244:247]
    ds_read_b64_tr_b16 v[42:43], v9 offset:14336
    v_mul_f32 v176, v160, v176
    v_mfma_f32_16x16x32_bf16 v[244:247], v[16:19], a[136:139], v[244:247]
    buffer_load_dwordx4 v3, s[28:31], s49 offen lds
    v_mfma_f32_16x16x32_bf16 v[244:247], v[20:23], a[184:187], v[244:247]
    v_rcp_f32 v140, v140
    v_mfma_f32_16x16x32_bf16 v[248:251], v[44:47], a[220:223], v[248:251]
    v_rcp_f32 v141, v141
    v_mfma_f32_16x16x32_bf16 v[248:251], v[16:19], a[140:143], v[248:251]
    v_rcp_f32 v142, v142
    v_mfma_f32_16x16x32_bf16 v[248:251], v[20:23], a[188:191], v[248:251]
    v_rcp_f32 v143, v143
    v_mfma_f32_16x16x32_bf16 v[252:255], v[44:47], a[128:131], v[252:255]
    ds_read_b64_tr_b16 v[44:45], v9 offset:20480
    v_mul_f32 v156, v156, v140
    v_mfma_f32_16x16x32_bf16 v[252:255], v[16:19], a[144:147], v[252:255]
    ds_read_b64_tr_b16 v[46:47], v9 offset:22528
    v_mul_f32 v157, v157, v141
    v_mfma_f32_16x16x32_bf16 v[252:255], v[20:23], a[192:195], v[252:255]
    s_waitcnt lgkmcnt(6)
    v_mul_f32 v158, v158, v142
    v_mul_f32 v159, v159, v143
    v_mfma_f32_16x16x32_bf16 v[96:99], v[24:27], a[224:227], 0
    ds_read_b64_tr_b16 v[16:17], v9 offset:24576
    v_cvt_pk_bf16_f32 v62, v156, v157
    v_mfma_f32_16x16x32_bf16 v[96:99], v[28:31], a[240:243], v[96:99]
    ds_read_b64_tr_b16 v[18:19], v9 offset:26624
    v_cvt_pk_bf16_f32 v63, v158, v159
    v_mfma_f32_16x16x32_bf16 v[96:99], v[32:35], v[64:67], v[96:99]
    ds_read_b64_tr_b16 v[20:21], v9 offset:32768
    v_mul_f32 v177, v161, v177
    v_mfma_f32_16x16x32_bf16 v[100:103], v[24:27], a[228:231], 0
    ds_read_b64_tr_b16 v[22:23], v9 offset:34816
    v_mul_f32 v178, v162, v178
    v_mfma_f32_16x16x32_bf16 v[100:103], v[28:31], a[244:247], v[100:103]
    buffer_store_dwordx4 v[60:63], v1, s[36:39], s52 offen offset:3072 sc1
    v_mfma_f32_16x16x32_bf16 v[100:103], v[32:35], v[68:71], v[100:103]
    v_mul_f32 v179, v163, v179
    v_mul_f32 v160, s54, v160
    v_mfma_f32_16x16x32_bf16 v[104:107], v[24:27], a[232:235], 0
    v_exp_f32 v160, v160
    v_mfma_f32_16x16x32_bf16 v[104:107], v[28:31], a[248:251], v[104:107]
    s_mov_b32 s49, 1475072
    v_mul_f32 v161, s54, v161
    v_mul_f32 v162, s54, v162
    v_mfma_f32_16x16x32_bf16 v[104:107], v[32:35], v[72:75], v[104:107]
    s_add_u32 m0, s45, 139264
    v_exp_f32 v161, v161
    v_mfma_f32_16x16x32_bf16 v[108:111], v[24:27], a[236:239], 0
    ds_read_b64_tr_b16 v[24:25], v9 offset:40960
    v_mul_f32 v163, s54, v163
    v_mfma_f32_16x16x32_bf16 v[108:111], v[28:31], a[252:255], v[108:111]
    ds_read_b64_tr_b16 v[26:27], v9 offset:43008
    v_add_f32 v160, 1.0, v160
    v_mfma_f32_16x16x32_bf16 v[108:111], v[32:35], v[76:79], v[108:111]
    s_waitcnt lgkmcnt(6)
    v_exp_f32 v162, v162
    v_mfma_f32_16x16x32_bf16 v[112:115], v[36:39], a[224:227], 0
    ds_read_b64_tr_b16 v[28:29], v9 offset:28672
    v_add_f32 v161, 1.0, v161
    v_mfma_f32_16x16x32_bf16 v[112:115], v[40:43], a[240:243], v[112:115]
    ds_read_b64_tr_b16 v[30:31], v9 offset:30720
    v_add_f32 v162, 1.0, v162
    v_mfma_f32_16x16x32_bf16 v[112:115], v[44:47], v[64:67], v[112:115]
    ds_read_b64_tr_b16 v[32:33], v9 offset:36864
    v_mul_f32 v180, v164, v180
    v_mfma_f32_16x16x32_bf16 v[116:119], v[36:39], a[228:231], 0
    ds_read_b64_tr_b16 v[34:35], v9 offset:38912
    v_mul_f32 v181, v165, v181
    v_mfma_f32_16x16x32_bf16 v[116:119], v[40:43], a[244:247], v[116:119]
    buffer_load_dwordx4 v2, s[20:23], s49 offen lds
    v_mfma_f32_16x16x32_bf16 v[116:119], v[44:47], v[68:71], v[116:119]
    v_exp_f32 v163, v163
    v_mfma_f32_16x16x32_bf16 v[120:123], v[36:39], a[232:235], 0
    v_rcp_f32 v160, v160
    v_mfma_f32_16x16x32_bf16 v[120:123], v[40:43], a[248:251], v[120:123]
    v_rcp_f32 v161, v161
    v_mfma_f32_16x16x32_bf16 v[120:123], v[44:47], v[72:75], v[120:123]
    s_add_u32 m0, s45, 143360
    v_rcp_f32 v162, v162
    v_mfma_f32_16x16x32_bf16 v[124:127], v[36:39], a[236:239], 0
    ds_read_b64_tr_b16 v[36:37], v9 offset:45056
    v_add_f32 v163, 1.0, v163
    v_mfma_f32_16x16x32_bf16 v[124:127], v[40:43], a[252:255], v[124:127]
    ds_read_b64_tr_b16 v[38:39], v9 offset:47104
    v_mul_f32 v176, v176, v160
    v_mfma_f32_16x16x32_bf16 v[124:127], v[44:47], v[76:79], v[124:127]
    s_waitcnt lgkmcnt(6)
    v_rcp_f32 v163, v163
    v_mfma_f32_16x16x32_bf16 v[96:99], v[16:19], v[80:83], v[96:99]
    ds_read_b64_tr_b16 v[40:41], v9 offset:49152
    v_mul_f32 v177, v177, v161
    v_mfma_f32_16x16x32_bf16 v[96:99], v[20:23], a[148:151], v[96:99]
    ds_read_b64_tr_b16 v[42:43], v9 offset:51200
    v_mul_f32 v178, v178, v162
    v_mfma_f32_16x16x32_bf16 v[96:99], v[24:27], a[164:167], v[96:99]
    ds_read_b64_tr_b16 v[44:45], v9 offset:57344
    v_mul_f32 v179, v179, v163
    v_mfma_f32_16x16x32_bf16 v[100:103], v[16:19], v[84:87], v[100:103]
    ds_read_b64_tr_b16 v[46:47], v9 offset:59392
    v_add_u32 v9, 0x10000, v9
    v_mfma_f32_16x16x32_bf16 v[100:103], v[20:23], a[152:155], v[100:103]
    buffer_load_dwordx4 v2, s[24:27], s49 offen lds
    v_mfma_f32_16x16x32_bf16 v[100:103], v[24:27], a[168:171], v[100:103]
    v_cvt_pk_bf16_f32 v48, v176, v177
    v_cvt_pk_bf16_f32 v49, v178, v179
    v_mfma_f32_16x16x32_bf16 v[104:107], v[16:19], v[88:91], v[104:107]
    v_mul_f32 v182, v166, v182
    v_mul_f32 v183, v167, v183
    v_mfma_f32_16x16x32_bf16 v[104:107], v[20:23], a[156:159], v[104:107]
    s_mov_b32 s49, 1769984
    v_mul_f32 v164, s54, v164
    v_mul_f32 v165, s54, v165
    v_mfma_f32_16x16x32_bf16 v[104:107], v[24:27], a[172:175], v[104:107]
    s_add_u32 m0, s45, 147456
    v_exp_f32 v164, v164
    v_mfma_f32_16x16x32_bf16 v[108:111], v[16:19], v[92:95], v[108:111]
    ds_read_b64_tr_b16 v[16:17], v9 offset:0
    v_mul_f32 v166, s54, v166
    v_mfma_f32_16x16x32_bf16 v[108:111], v[20:23], a[160:163], v[108:111]
    ds_read_b64_tr_b16 v[18:19], v9 offset:2048
    v_add_u32 v9, 0xffffc000, v9
    v_mfma_f32_16x16x32_bf16 v[108:111], v[24:27], a[176:179], v[108:111]
    s_waitcnt lgkmcnt(6)
    v_exp_f32 v165, v165
    v_mfma_f32_16x16x32_bf16 v[112:115], v[28:31], v[80:83], v[112:115]
    ds_read_b64_tr_b16 v[20:21], v9 offset:4096
    v_mul_f32 v167, s54, v167
    v_mfma_f32_16x16x32_bf16 v[112:115], v[32:35], a[148:151], v[112:115]
    ds_read_b64_tr_b16 v[22:23], v9 offset:6144
    v_add_f32 v164, 1.0, v164
    v_mfma_f32_16x16x32_bf16 v[112:115], v[36:39], a[164:167], v[112:115]
    ds_read_b64_tr_b16 v[24:25], v9 offset:12288
    v_add_f32 v165, 1.0, v165
    v_mfma_f32_16x16x32_bf16 v[116:119], v[28:31], v[84:87], v[116:119]
    ds_read_b64_tr_b16 v[26:27], v9 offset:14336
    v_mul_f32 v184, v168, v184
    v_mfma_f32_16x16x32_bf16 v[116:119], v[32:35], a[152:155], v[116:119]
    buffer_load_dwordx4 v2, s[20:23], s49 offen lds
    v_mfma_f32_16x16x32_bf16 v[116:119], v[36:39], a[168:171], v[116:119]
    v_exp_f32 v166, v166
    v_mfma_f32_16x16x32_bf16 v[120:123], v[28:31], v[88:91], v[120:123]
    v_exp_f32 v167, v167
    v_mfma_f32_16x16x32_bf16 v[120:123], v[32:35], a[156:159], v[120:123]
    v_rcp_f32 v164, v164
    v_mfma_f32_16x16x32_bf16 v[120:123], v[36:39], a[172:175], v[120:123]
    s_add_u32 m0, s45, 151552
    v_rcp_f32 v165, v165
    v_mfma_f32_16x16x32_bf16 v[124:127], v[28:31], v[92:95], v[124:127]
    ds_read_b64_tr_b16 v[28:29], v9 offset:20480
    v_add_f32 v166, 1.0, v166
    v_mfma_f32_16x16x32_bf16 v[124:127], v[32:35], a[160:163], v[124:127]
    ds_read_b64_tr_b16 v[30:31], v9 offset:22528
    v_add_f32 v167, 1.0, v167
    v_mfma_f32_16x16x32_bf16 v[124:127], v[36:39], a[176:179], v[124:127]
    s_waitcnt lgkmcnt(6)
    v_rcp_f32 v166, v166
    v_mfma_f32_16x16x32_bf16 v[96:99], v[40:43], a[212:215], v[96:99]
    ds_read_b64_tr_b16 v[32:33], v10 offset:49152
    v_mul_f32 v180, v180, v164
    v_mfma_f32_16x16x32_bf16 v[96:99], v[44:47], a[132:135], v[96:99]
    ds_read_b64_tr_b16 v[34:35], v10 offset:51200
    v_mul_f32 v181, v181, v165
    v_mfma_f32_16x16x32_bf16 v[96:99], v[16:19], a[180:183], v[96:99]
    ds_read_b64_tr_b16 v[36:37], v10 offset:57344
    v_mul_f32 v182, v182, v166
    v_mfma_f32_16x16x32_bf16 v[100:103], v[40:43], a[216:219], v[100:103]
    ds_read_b64_tr_b16 v[38:39], v10 offset:59392
    v_add_u32 v10, 0x10000, v10
    v_mfma_f32_16x16x32_bf16 v[100:103], v[44:47], a[136:139], v[100:103]
    buffer_load_dwordx4 v2, s[24:27], s49 offen lds
    v_mfma_f32_16x16x32_bf16 v[100:103], v[16:19], a[184:187], v[100:103]
    v_rcp_f32 v167, v167
    v_mfma_f32_16x16x32_bf16 v[104:107], v[40:43], a[220:223], v[104:107]
    s_mov_b32 s49, 2064896
    v_mul_f32 v183, v183, v167
    v_cvt_pk_bf16_f32 v52, v180, v181
    v_mfma_f32_16x16x32_bf16 v[104:107], v[44:47], a[140:143], v[104:107]
    s_add_u32 m0, s45, 155648
    v_cvt_pk_bf16_f32 v53, v182, v183
    v_mul_f32 v185, v169, v185
    v_mfma_f32_16x16x32_bf16 v[104:107], v[16:19], a[188:191], v[104:107]
    buffer_load_dwordx4 v2, s[20:23], s49 offen lds
    v_mfma_f32_16x16x32_bf16 v[108:111], v[40:43], a[128:131], v[108:111]
    ds_read_b64_tr_b16 v[40:41], v10 offset:0
    v_mul_f32 v186, v170, v186
    v_mfma_f32_16x16x32_bf16 v[108:111], v[44:47], a[144:147], v[108:111]
    ds_read_b64_tr_b16 v[42:43], v10 offset:2048
    v_add_u32 v10, 0xffffc000, v10
    v_mfma_f32_16x16x32_bf16 v[108:111], v[16:19], a[192:195], v[108:111]
    s_waitcnt lgkmcnt(6)
    v_mul_f32 v187, v171, v187
    v_mul_f32 v168, s54, v168
    v_mfma_f32_16x16x32_bf16 v[112:115], v[20:23], a[212:215], v[112:115]
    ds_read_b64_tr_b16 v[44:45], v10 offset:4096
    v_mul_f32 v169, s54, v169
    v_mfma_f32_16x16x32_bf16 v[112:115], v[24:27], a[132:135], v[112:115]
    ds_read_b64_tr_b16 v[46:47], v10 offset:6144
    v_mul_f32 v170, s54, v170
    v_mfma_f32_16x16x32_bf16 v[112:115], v[28:31], a[180:183], v[112:115]
    ds_read_b64_tr_b16 v[16:17], v10 offset:12288
    v_mul_f32 v171, s54, v171
    v_mfma_f32_16x16x32_bf16 v[116:119], v[20:23], a[216:219], v[116:119]
    ds_read_b64_tr_b16 v[18:19], v10 offset:14336
    v_mul_f32 v188, v172, v188
    v_mfma_f32_16x16x32_bf16 v[116:119], v[24:27], a[136:139], v[116:119]
    s_add_u32 m0, s45, 159744
    v_exp_f32 v168, v168
    v_mfma_f32_16x16x32_bf16 v[116:119], v[28:31], a[184:187], v[116:119]
    buffer_load_dwordx4 v2, s[24:27], s49 offen lds
    v_mfma_f32_16x16x32_bf16 v[120:123], v[20:23], a[220:223], v[120:123]
    v_exp_f32 v169, v169
    v_mfma_f32_16x16x32_bf16 v[120:123], v[24:27], a[140:143], v[120:123]
    s_mov_b32 s49, 2359808
    v_exp_f32 v170, v170
    v_mfma_f32_16x16x32_bf16 v[120:123], v[28:31], a[188:191], v[120:123]
    s_add_u32 m0, s45, 0
    v_exp_f32 v171, v171
    v_mfma_f32_16x16x32_bf16 v[124:127], v[20:23], a[128:131], v[124:127]
    ds_read_b64_tr_b16 v[20:21], v10 offset:20480
    v_add_f32 v168, 1.0, v168
    v_mfma_f32_16x16x32_bf16 v[124:127], v[24:27], a[144:147], v[124:127]
    ds_read_b64_tr_b16 v[22:23], v10 offset:22528
    v_add_f32 v169, 1.0, v169
    v_mfma_f32_16x16x32_bf16 v[124:127], v[28:31], a[192:195], v[124:127]
    s_waitcnt lgkmcnt(6)
    v_rcp_f32 v168, v168
    v_mfma_f32_16x16x32_bf16 v[128:131], v[32:35], a[224:227], 0
    ds_read_b64_tr_b16 v[24:25], v10 offset:24576
    v_add_f32 v170, 1.0, v170
    v_mfma_f32_16x16x32_bf16 v[128:131], v[36:39], a[240:243], v[128:131]
    ds_read_b64_tr_b16 v[26:27], v10 offset:26624
    v_add_f32 v171, 1.0, v171
    v_mfma_f32_16x16x32_bf16 v[128:131], v[40:43], v[64:67], v[128:131]
    ds_read_b64_tr_b16 v[28:29], v10 offset:32768
    v_mul_f32 v184, v184, v168
    v_mfma_f32_16x16x32_bf16 v[132:135], v[32:35], a[228:231], 0
    s_add_u32 s52, s52, 4096
    ds_read_b64_tr_b16 v[30:31], v10 offset:34816
    v_mfma_f32_16x16x32_bf16 v[132:135], v[36:39], a[244:247], v[132:135]
    buffer_load_dwordx4 v2, s[20:23], s49 offen lds
    v_mfma_f32_16x16x32_bf16 v[132:135], v[40:43], v[68:71], v[132:135]
    v_rcp_f32 v169, v169
    v_mfma_f32_16x16x32_bf16 v[136:139], v[32:35], a[232:235], 0
    v_rcp_f32 v170, v170
    v_mfma_f32_16x16x32_bf16 v[136:139], v[36:39], a[248:251], v[136:139]
    v_rcp_f32 v171, v171
    v_mfma_f32_16x16x32_bf16 v[136:139], v[40:43], v[72:75], v[136:139]
    s_add_u32 m0, s45, 4096
    v_mul_f32 v185, v185, v169
    v_mul_f32 v186, v186, v170
    v_mfma_f32_16x16x32_bf16 v[140:143], v[32:35], a[236:239], 0
    ds_read_b64_tr_b16 v[32:33], v10 offset:40960
    v_mul_f32 v187, v187, v171
    v_mfma_f32_16x16x32_bf16 v[140:143], v[36:39], a[252:255], v[140:143]
    ds_read_b64_tr_b16 v[34:35], v10 offset:43008
    v_cvt_pk_bf16_f32 v56, v184, v185
    v_mfma_f32_16x16x32_bf16 v[140:143], v[40:43], v[76:79], v[140:143]
    s_waitcnt lgkmcnt(6)
    v_cvt_pk_bf16_f32 v57, v186, v187
    v_mul_f32 v189, v173, v189
    v_mfma_f32_16x16x32_bf16 v[144:147], v[44:47], a[224:227], 0
    ds_read_b64_tr_b16 v[36:37], v10 offset:28672
    v_mul_f32 v190, v174, v190
    v_mfma_f32_16x16x32_bf16 v[144:147], v[16:19], a[240:243], v[144:147]
    ds_read_b64_tr_b16 v[38:39], v10 offset:30720
    v_mul_f32 v191, v175, v191
    v_mfma_f32_16x16x32_bf16 v[144:147], v[20:23], v[64:67], v[144:147]
    ds_read_b64_tr_b16 v[40:41], v10 offset:36864
    v_mul_f32 v172, s54, v172
    v_mfma_f32_16x16x32_bf16 v[148:151], v[44:47], a[228:231], 0
    ds_read_b64_tr_b16 v[42:43], v10 offset:38912
    v_mul_f32 v173, s54, v173
    v_mfma_f32_16x16x32_bf16 v[148:151], v[16:19], a[244:247], v[148:151]
    buffer_load_dwordx4 v2, s[24:27], s49 offen lds
    v_mfma_f32_16x16x32_bf16 v[148:151], v[20:23], v[68:71], v[148:151]
    v_exp_f32 v172, v172
    v_mfma_f32_16x16x32_bf16 v[152:155], v[44:47], a[232:235], 0
    s_mov_b32 s49, 2654720
    v_exp_f32 v173, v173
    v_mfma_f32_16x16x32_bf16 v[152:155], v[16:19], a[248:251], v[152:155]
    s_add_u32 m0, s45, 8192
    v_mul_f32 v174, s54, v174
    v_mul_f32 v175, s54, v175
    v_mfma_f32_16x16x32_bf16 v[152:155], v[20:23], v[72:75], v[152:155]
    buffer_load_dwordx4 v2, s[20:23], s49 offen lds
    v_mfma_f32_16x16x32_bf16 v[156:159], v[44:47], a[236:239], 0
    ds_read_b64_tr_b16 v[44:45], v10 offset:45056
    v_add_f32 v172, 1.0, v172
    v_mfma_f32_16x16x32_bf16 v[156:159], v[16:19], a[252:255], v[156:159]
    ds_read_b64_tr_b16 v[46:47], v10 offset:47104
    v_add_f32 v173, 1.0, v173
    v_mfma_f32_16x16x32_bf16 v[156:159], v[20:23], v[76:79], v[156:159]
    s_waitcnt lgkmcnt(6)
    v_exp_f32 v174, v174
    v_mfma_f32_16x16x32_bf16 v[128:131], v[24:27], v[80:83], v[128:131]
    ds_read_b64_tr_b16 v[16:17], v10 offset:49152
    v_add_f32 v174, 1.0, v174
    v_mfma_f32_16x16x32_bf16 v[128:131], v[28:31], a[148:151], v[128:131]
    ds_read_b64_tr_b16 v[18:19], v10 offset:51200
    v_mul_f32 v208, v192, v208
    v_mfma_f32_16x16x32_bf16 v[128:131], v[32:35], a[164:167], v[128:131]
    ds_read_b64_tr_b16 v[20:21], v10 offset:57344
    v_mul_f32 v209, v193, v209
    v_mfma_f32_16x16x32_bf16 v[132:135], v[24:27], v[84:87], v[132:135]
    ds_read_b64_tr_b16 v[22:23], v10 offset:59392
    v_add_u32 v10, 0x10000, v10
    v_mfma_f32_16x16x32_bf16 v[132:135], v[28:31], a[152:155], v[132:135]
    s_add_u32 m0, s45, 12288
    v_exp_f32 v175, v175
    v_mfma_f32_16x16x32_bf16 v[132:135], v[32:35], a[168:171], v[132:135]
    buffer_load_dwordx4 v2, s[24:27], s49 offen lds
    v_mfma_f32_16x16x32_bf16 v[136:139], v[24:27], v[88:91], v[136:139]
    v_rcp_f32 v172, v172
    v_mfma_f32_16x16x32_bf16 v[136:139], v[28:31], a[156:159], v[136:139]
    s_mov_b32 s49, 2949632
    v_rcp_f32 v173, v173
    v_mfma_f32_16x16x32_bf16 v[136:139], v[32:35], a[172:175], v[136:139]
    s_add_u32 m0, s45, 16384
    v_rcp_f32 v174, v174
    v_mfma_f32_16x16x32_bf16 v[140:143], v[24:27], v[92:95], v[140:143]
    ds_read_b64_tr_b16 v[24:25], v10 offset:0
    v_add_f32 v175, 1.0, v175
    v_mfma_f32_16x16x32_bf16 v[140:143], v[28:31], a[160:163], v[140:143]
    ds_read_b64_tr_b16 v[26:27], v10 offset:2048
    v_add_u32 v10, 0xffffc000, v10
    v_mfma_f32_16x16x32_bf16 v[140:143], v[32:35], a[176:179], v[140:143]
    s_waitcnt lgkmcnt(6)
    v_rcp_f32 v175, v175
    v_mfma_f32_16x16x32_bf16 v[144:147], v[36:39], v[80:83], v[144:147]
    ds_read_b64_tr_b16 v[28:29], v10 offset:4096
    v_mul_f32 v188, v188, v172
    v_mfma_f32_16x16x32_bf16 v[144:147], v[40:43], a[148:151], v[144:147]
    ds_read_b64_tr_b16 v[30:31], v10 offset:6144
    v_mul_f32 v189, v189, v173
    v_mfma_f32_16x16x32_bf16 v[144:147], v[44:47], a[164:167], v[144:147]
    ds_read_b64_tr_b16 v[32:33], v10 offset:12288
    v_mul_f32 v190, v190, v174
    v_mfma_f32_16x16x32_bf16 v[148:151], v[36:39], v[84:87], v[148:151]
    ds_read_b64_tr_b16 v[34:35], v10 offset:14336
    v_mul_f32 v191, v191, v175
    v_mfma_f32_16x16x32_bf16 v[148:151], v[40:43], a[152:155], v[148:151]
    buffer_load_dwordx4 v2, s[20:23], s49 offen lds
    v_mfma_f32_16x16x32_bf16 v[148:151], v[44:47], a[168:171], v[148:151]
    v_cvt_pk_bf16_f32 v60, v188, v189
    v_cvt_pk_bf16_f32 v61, v190, v191
    v_mfma_f32_16x16x32_bf16 v[152:155], v[36:39], v[88:91], v[152:155]
    v_mul_f32 v210, v194, v210
    v_mul_f32 v211, v195, v211
    v_mfma_f32_16x16x32_bf16 v[152:155], v[40:43], a[156:159], v[152:155]
    s_add_u32 m0, s45, 20480
    v_mul_f32 v192, s54, v192
    v_mul_f32 v193, s54, v193
    v_mfma_f32_16x16x32_bf16 v[152:155], v[44:47], a[172:175], v[152:155]
    buffer_load_dwordx4 v2, s[24:27], s49 offen lds
    v_mfma_f32_16x16x32_bf16 v[156:159], v[36:39], v[92:95], v[156:159]
    ds_read_b64_tr_b16 v[36:37], v10 offset:20480
    v_mul_f32 v194, s54, v194
    v_mfma_f32_16x16x32_bf16 v[156:159], v[40:43], a[160:163], v[156:159]
    ds_read_b64_tr_b16 v[38:39], v10 offset:22528
    v_mul_f32 v195, s54, v195
    v_mfma_f32_16x16x32_bf16 v[156:159], v[44:47], a[176:179], v[156:159]
    s_waitcnt lgkmcnt(6)
    v_exp_f32 v192, v192
    v_mfma_f32_16x16x32_bf16 v[128:131], v[16:19], a[212:215], v[128:131]
    ds_read_b64_tr_b16 v[40:41], v11 offset:49152
    v_add_f32 v192, 1.0, v192
    v_mfma_f32_16x16x32_bf16 v[128:131], v[20:23], a[132:135], v[128:131]
    ds_read_b64_tr_b16 v[42:43], v11 offset:51200
    v_mul_f32 v212, v196, v212
    v_mfma_f32_16x16x32_bf16 v[128:131], v[24:27], a[180:183], v[128:131]
    ds_read_b64_tr_b16 v[44:45], v11 offset:57344
    v_mul_f32 v213, v197, v213
    v_mfma_f32_16x16x32_bf16 v[132:135], v[16:19], a[216:219], v[132:135]
    ds_read_b64_tr_b16 v[46:47], v11 offset:59392
    v_add_u32 v11, 0x10000, v11
    v_mfma_f32_16x16x32_bf16 v[132:135], v[20:23], a[136:139], v[132:135]
    s_mov_b32 s49, 3244544
    v_exp_f32 v193, v193
    v_mfma_f32_16x16x32_bf16 v[132:135], v[24:27], a[184:187], v[132:135]
    s_add_u32 m0, s45, 24576
    v_exp_f32 v194, v194
    v_mfma_f32_16x16x32_bf16 v[136:139], v[16:19], a[220:223], v[136:139]
    buffer_load_dwordx4 v2, s[20:23], s49 offen lds
    v_mfma_f32_16x16x32_bf16 v[136:139], v[20:23], a[140:143], v[136:139]
    v_exp_f32 v195, v195
    v_mfma_f32_16x16x32_bf16 v[136:139], v[24:27], a[188:191], v[136:139]
    s_add_u32 m0, s45, 28672
    v_rcp_f32 v192, v192
    v_mfma_f32_16x16x32_bf16 v[140:143], v[16:19], a[128:131], v[140:143]
    ds_read_b64_tr_b16 v[16:17], v11 offset:0
    v_add_f32 v193, 1.0, v193
    v_mfma_f32_16x16x32_bf16 v[140:143], v[20:23], a[144:147], v[140:143]
    ds_read_b64_tr_b16 v[18:19], v11 offset:2048
    v_add_u32 v11, 0xffffc000, v11
    v_mfma_f32_16x16x32_bf16 v[140:143], v[24:27], a[192:195], v[140:143]
    s_waitcnt lgkmcnt(6)
    v_rcp_f32 v193, v193
    v_mfma_f32_16x16x32_bf16 v[144:147], v[28:31], a[212:215], v[144:147]
    ds_read_b64_tr_b16 v[20:21], v11 offset:4096
    v_add_f32 v194, 1.0, v194
    v_mfma_f32_16x16x32_bf16 v[144:147], v[32:35], a[132:135], v[144:147]
    ds_read_b64_tr_b16 v[22:23], v11 offset:6144
    v_add_f32 v195, 1.0, v195
    v_mfma_f32_16x16x32_bf16 v[144:147], v[36:39], a[180:183], v[144:147]
    ds_read_b64_tr_b16 v[24:25], v11 offset:12288
    v_mul_f32 v208, v208, v192
    v_mfma_f32_16x16x32_bf16 v[148:151], v[28:31], a[216:219], v[148:151]
    ds_read_b64_tr_b16 v[26:27], v11 offset:14336
    v_mul_f32 v209, v209, v193
    v_mfma_f32_16x16x32_bf16 v[148:151], v[32:35], a[136:139], v[148:151]
    buffer_load_dwordx4 v2, s[24:27], s49 offen lds
    v_mfma_f32_16x16x32_bf16 v[148:151], v[36:39], a[184:187], v[148:151]
    s_mov_b32 s49, 3539456
    v_rcp_f32 v194, v194
    v_mfma_f32_16x16x32_bf16 v[152:155], v[28:31], a[220:223], v[152:155]
    s_add_u32 m0, s45, 32768
    v_rcp_f32 v195, v195
    v_mfma_f32_16x16x32_bf16 v[152:155], v[32:35], a[140:143], v[152:155]
    buffer_load_dwordx4 v2, s[20:23], s49 offen lds
    v_mfma_f32_16x16x32_bf16 v[152:155], v[36:39], a[188:191], v[152:155]
    s_add_u32 m0, s45, 36864
    v_mul_f32 v210, v210, v194
    v_mul_f32 v211, v211, v195
    v_mfma_f32_16x16x32_bf16 v[156:159], v[28:31], a[128:131], v[156:159]
    ds_read_b64_tr_b16 v[28:29], v11 offset:20480
    v_cvt_pk_bf16_f32 v50, v208, v209
    v_mfma_f32_16x16x32_bf16 v[156:159], v[32:35], a[144:147], v[156:159]
    ds_read_b64_tr_b16 v[30:31], v11 offset:22528
    v_cvt_pk_bf16_f32 v51, v210, v211
    v_mfma_f32_16x16x32_bf16 v[156:159], v[36:39], a[192:195], v[156:159]
    s_waitcnt lgkmcnt(6)
    v_mul_f32 v214, v198, v214
    v_mul_f32 v215, v199, v215
    v_mfma_f32_16x16x32_bf16 v[160:163], v[40:43], a[224:227], 0
    ds_read_b64_tr_b16 v[32:33], v11 offset:24576
    v_mul_f32 v196, s54, v196
    v_mfma_f32_16x16x32_bf16 v[160:163], v[44:47], a[240:243], v[160:163]
    ds_read_b64_tr_b16 v[34:35], v11 offset:26624
    v_mul_f32 v197, s54, v197
    v_mfma_f32_16x16x32_bf16 v[160:163], v[16:19], v[64:67], v[160:163]
    ds_read_b64_tr_b16 v[36:37], v11 offset:32768
    v_mul_f32 v198, s54, v198
    v_mfma_f32_16x16x32_bf16 v[164:167], v[40:43], a[228:231], 0
    ds_read_b64_tr_b16 v[38:39], v11 offset:34816
    v_mul_f32 v199, s54, v199
    v_mfma_f32_16x16x32_bf16 v[164:167], v[44:47], a[244:247], v[164:167]
    buffer_load_dwordx4 v2, s[24:27], s49 offen lds
    v_mfma_f32_16x16x32_bf16 v[164:167], v[16:19], v[68:71], v[164:167]
    s_mov_b32 s49, 3834368
    v_exp_f32 v196, v196
    v_mfma_f32_16x16x32_bf16 v[168:171], v[40:43], a[232:235], 0
    s_add_u32 m0, s45, 40960
    v_exp_f32 v197, v197
    v_mfma_f32_16x16x32_bf16 v[168:171], v[44:47], a[248:251], v[168:171]
    buffer_load_dwordx4 v2, s[20:23], s49 offen lds
    v_mfma_f32_16x16x32_bf16 v[168:171], v[16:19], v[72:75], v[168:171]
    s_add_u32 m0, s45, 45056
    v_exp_f32 v198, v198
    v_mfma_f32_16x16x32_bf16 v[172:175], v[40:43], a[236:239], 0
    ds_read_b64_tr_b16 v[40:41], v11 offset:40960
    v_add_f32 v196, 1.0, v196
    v_mfma_f32_16x16x32_bf16 v[172:175], v[44:47], a[252:255], v[172:175]
    ds_read_b64_tr_b16 v[42:43], v11 offset:43008
    v_add_f32 v197, 1.0, v197
    v_mfma_f32_16x16x32_bf16 v[172:175], v[16:19], v[76:79], v[172:175]
    s_waitcnt lgkmcnt(6)
    v_exp_f32 v199, v199
    v_mfma_f32_16x16x32_bf16 v[176:179], v[20:23], a[224:227], 0
    ds_read_b64_tr_b16 v[44:45], v11 offset:28672
    v_add_f32 v198, 1.0, v198
    v_mfma_f32_16x16x32_bf16 v[176:179], v[24:27], a[240:243], v[176:179]
    ds_read_b64_tr_b16 v[46:47], v11 offset:30720
    v_add_f32 v199, 1.0, v199
    v_mfma_f32_16x16x32_bf16 v[176:179], v[28:31], v[64:67], v[176:179]
    ds_read_b64_tr_b16 v[16:17], v11 offset:36864
    v_mul_f32 v216, v200, v216
    v_mfma_f32_16x16x32_bf16 v[180:183], v[20:23], a[228:231], 0
    ds_read_b64_tr_b16 v[18:19], v11 offset:38912
    v_mul_f32 v217, v201, v217
    v_mfma_f32_16x16x32_bf16 v[180:183], v[24:27], a[244:247], v[180:183]
    buffer_load_dwordx4 v2, s[24:27], s49 offen lds
    v_mfma_f32_16x16x32_bf16 v[180:183], v[28:31], v[68:71], v[180:183]
    buffer_store_dwordx4 v[48:51], v1, s[36:39], s52 offen offset:0 sc1
    v_mfma_f32_16x16x32_bf16 v[184:187], v[20:23], a[232:235], 0
    v_rcp_f32 v196, v196
    v_mfma_f32_16x16x32_bf16 v[184:187], v[24:27], a[248:251], v[184:187]
    v_rcp_f32 v197, v197
    v_mfma_f32_16x16x32_bf16 v[184:187], v[28:31], v[72:75], v[184:187]
    v_rcp_f32 v198, v198
    v_mfma_f32_16x16x32_bf16 v[188:191], v[20:23], a[236:239], 0
    ds_read_b64_tr_b16 v[20:21], v11 offset:45056
    v_mul_f32 v212, v212, v196
    v_mfma_f32_16x16x32_bf16 v[188:191], v[24:27], a[252:255], v[188:191]
    ds_read_b64_tr_b16 v[22:23], v11 offset:47104
    v_mul_f32 v213, v213, v197
    v_mfma_f32_16x16x32_bf16 v[188:191], v[28:31], v[76:79], v[188:191]
    s_waitcnt lgkmcnt(6)
    v_rcp_f32 v199, v199
    v_mfma_f32_16x16x32_bf16 v[160:163], v[32:35], v[80:83], v[160:163]
    ds_read_b64_tr_b16 v[24:25], v11 offset:49152
    v_mul_f32 v214, v214, v198
    v_mfma_f32_16x16x32_bf16 v[160:163], v[36:39], a[148:151], v[160:163]
    ds_read_b64_tr_b16 v[26:27], v11 offset:51200
    v_mul_f32 v215, v215, v199
    v_mfma_f32_16x16x32_bf16 v[160:163], v[40:43], a[164:167], v[160:163]
    ds_read_b64_tr_b16 v[28:29], v11 offset:57344
    v_cvt_pk_bf16_f32 v54, v212, v213
    v_mfma_f32_16x16x32_bf16 v[164:167], v[32:35], v[84:87], v[164:167]
    ds_read_b64_tr_b16 v[30:31], v11 offset:59392
    v_add_u32 v11, 0x10000, v11
    v_mfma_f32_16x16x32_bf16 v[164:167], v[36:39], a[152:155], v[164:167]
    v_cvt_pk_bf16_f32 v55, v214, v215
    v_mul_f32 v218, v202, v218
    v_mfma_f32_16x16x32_bf16 v[164:167], v[40:43], a[168:171], v[164:167]
    buffer_store_dwordx4 v[52:55], v1, s[36:39], s52 offen offset:1024 sc1
    v_mfma_f32_16x16x32_bf16 v[168:171], v[32:35], v[88:91], v[168:171]
    v_mul_f32 v219, v203, v219
    v_mul_f32 v200, s54, v200
    v_mfma_f32_16x16x32_bf16 v[168:171], v[36:39], a[156:159], v[168:171]
    v_exp_f32 v200, v200
    v_mfma_f32_16x16x32_bf16 v[168:171], v[40:43], a[172:175], v[168:171]
    v_mul_f32 v201, s54, v201
    v_mul_f32 v202, s54, v202
    v_mfma_f32_16x16x32_bf16 v[172:175], v[32:35], v[92:95], v[172:175]
    ds_read_b64_tr_b16 v[32:33], v11 offset:0
    v_mul_f32 v203, s54, v203
    v_mfma_f32_16x16x32_bf16 v[172:175], v[36:39], a[160:163], v[172:175]
    ds_read_b64_tr_b16 v[34:35], v11 offset:2048
    v_add_u32 v11, 0xffffc000, v11
    v_mfma_f32_16x16x32_bf16 v[172:175], v[40:43], a[176:179], v[172:175]
    s_waitcnt lgkmcnt(6)
    v_exp_f32 v201, v201
    v_mfma_f32_16x16x32_bf16 v[176:179], v[44:47], v[80:83], v[176:179]
    ds_read_b64_tr_b16 v[36:37], v11 offset:4096
    v_add_f32 v200, 1.0, v200
    v_mfma_f32_16x16x32_bf16 v[176:179], v[16:19], a[148:151], v[176:179]
    ds_read_b64_tr_b16 v[38:39], v11 offset:6144
    v_add_f32 v201, 1.0, v201
    v_mfma_f32_16x16x32_bf16 v[176:179], v[20:23], a[164:167], v[176:179]
    ds_read_b64_tr_b16 v[40:41], v11 offset:12288
    v_mul_f32 v220, v204, v220
    v_mfma_f32_16x16x32_bf16 v[180:183], v[44:47], v[84:87], v[180:183]
    ds_read_b64_tr_b16 v[42:43], v11 offset:14336
    v_mul_f32 v221, v205, v221
    v_mfma_f32_16x16x32_bf16 v[180:183], v[16:19], a[152:155], v[180:183]
    v_exp_f32 v202, v202
    v_mfma_f32_16x16x32_bf16 v[180:183], v[20:23], a[168:171], v[180:183]
    v_exp_f32 v203, v203
    v_mfma_f32_16x16x32_bf16 v[184:187], v[44:47], v[88:91], v[184:187]
    v_rcp_f32 v200, v200
    v_mfma_f32_16x16x32_bf16 v[184:187], v[16:19], a[156:159], v[184:187]
    v_rcp_f32 v201, v201
    v_mfma_f32_16x16x32_bf16 v[184:187], v[20:23], a[172:175], v[184:187]
    v_add_f32 v202, 1.0, v202
    v_add_f32 v203, 1.0, v203
    v_mfma_f32_16x16x32_bf16 v[188:191], v[44:47], v[92:95], v[188:191]
    ds_read_b64_tr_b16 v[44:45], v11 offset:20480
    v_mul_f32 v216, v216, v200
    v_mfma_f32_16x16x32_bf16 v[188:191], v[16:19], a[160:163], v[188:191]
    s_add_u32 s87, s51, s86
    ds_read_b64_tr_b16 v[46:47], v11 offset:22528
    v_mfma_f32_16x16x32_bf16 v[188:191], v[20:23], a[176:179], v[188:191]
    s_waitcnt lgkmcnt(6)
    v_add_u32 v7, 0x1e000, v7
    v_mov_b32 v14, 0x1
    v_mfma_f32_16x16x32_bf16 v[160:163], v[24:27], a[212:215], v[160:163]
    v_rcp_f32 v202, v202
    v_mfma_f32_16x16x32_bf16 v[160:163], v[28:31], a[132:135], v[160:163]
    v_rcp_f32 v203, v203
    v_mfma_f32_16x16x32_bf16 v[160:163], v[32:35], a[180:183], v[160:163]
    v_mul_f32 v217, v217, v201
    v_mul_f32 v218, v218, v202
    v_mfma_f32_16x16x32_bf16 v[164:167], v[24:27], a[216:219], v[164:167]
    v_mul_f32 v219, v219, v203
    v_cvt_pk_bf16_f32 v58, v216, v217
    v_mfma_f32_16x16x32_bf16 v[164:167], v[28:31], a[136:139], v[164:167]
    s_mov_b32 s49, 1179648
    v_cvt_pk_bf16_f32 v59, v218, v219
    v_mul_f32 v222, v206, v222
    v_mfma_f32_16x16x32_bf16 v[164:167], v[32:35], a[184:187], v[164:167]
    s_add_u32 m0, s89, 49152
    v_mul_f32 v223, v207, v223
    v_mul_f32 v204, s54, v204
    v_mfma_f32_16x16x32_bf16 v[168:171], v[24:27], a[220:223], v[168:171]
    s_waitcnt vmcnt(21)
    s_barrier
    v_mul_f32 v205, s54, v205
    v_mfma_f32_16x16x32_bf16 v[168:171], v[28:31], a[140:143], v[168:171]
    ds_read_b64_tr_b16 v[16:17], v7 offset:0
    v_mul_f32 v206, s54, v206
    v_mfma_f32_16x16x32_bf16 v[168:171], v[32:35], a[188:191], v[168:171]
    ds_read_b64_tr_b16 v[18:19], v7 offset:512
    v_mul_f32 v207, s54, v207
    v_mfma_f32_16x16x32_bf16 v[172:175], v[24:27], a[128:131], v[172:175]
    ds_read_b64_tr_b16 v[20:21], v7 offset:2048
    v_mfma_f32_16x16x32_bf16 v[172:175], v[28:31], a[144:147], v[172:175]
    ds_read_b64_tr_b16 v[22:23], v7 offset:2560
    v_mfma_f32_16x16x32_bf16 v[172:175], v[32:35], a[192:195], v[172:175]
    s_waitcnt lgkmcnt(4)
    ds_read_b64_tr_b16 v[24:25], v7 offset:4096
    v_mfma_f32_16x16x32_bf16 v[176:179], v[36:39], a[212:215], v[176:179]
    ds_read_b64_tr_b16 v[26:27], v7 offset:4608
    v_mfma_f32_16x16x32_bf16 v[176:179], v[40:43], a[132:135], v[176:179]
    ds_read_b64_tr_b16 v[28:29], v7 offset:6144
    v_mfma_f32_16x16x32_bf16 v[176:179], v[44:47], a[180:183], v[176:179]
    ds_read_b64_tr_b16 v[30:31], v7 offset:6656
    v_mfma_f32_16x16x32_bf16 v[180:183], v[36:39], a[216:219], v[180:183]
    buffer_atomic_add v14, v6, s[60:63], s87 offen
    v_mfma_f32_16x16x32_bf16 v[180:183], v[40:43], a[136:139], v[180:183]
    ds_read_b64_tr_b16 v[32:33], v7 offset:1024
    v_mfma_f32_16x16x32_bf16 v[180:183], v[44:47], a[184:187], v[180:183]
    ds_read_b64_tr_b16 v[34:35], v7 offset:1536
    v_mfma_f32_16x16x32_bf16 v[184:187], v[36:39], a[220:223], v[184:187]
    buffer_load_dwordx4 v3, s[28:31], s49 offen lds
    v_mfma_f32_16x16x32_bf16 v[184:187], v[40:43], a[140:143], v[184:187]
    buffer_store_dwordx4 v[56:59], v1, s[36:39], s52 offen offset:2048 sc1
    v_mfma_f32_16x16x32_bf16 v[184:187], v[44:47], a[188:191], v[184:187]
    v_exp_f32 v204, v204
    v_mfma_f32_16x16x32_bf16 v[188:191], v[36:39], a[128:131], v[188:191]
    ds_read_b64_tr_b16 v[36:37], v7 offset:3072
    v_exp_f32 v205, v205
    v_exp_f32 v206, v206
    v_exp_f32 v207, v207
    v_add_f32 v204, 1.0, v204
    v_add_f32 v205, 1.0, v205
    v_add_f32 v206, 1.0, v206
    v_add_f32 v207, 1.0, v207
    v_rcp_f32 v204, v204
    v_rcp_f32 v205, v205
    v_rcp_f32 v206, v206
    v_rcp_f32 v207, v207
    v_mul_f32 v220, v220, v204
    v_mul_f32 v221, v221, v205
    v_mul_f32 v222, v222, v206
    v_mul_f32 v223, v223, v207
    v_cvt_pk_bf16_f32 v62, v220, v221
    v_cvt_pk_bf16_f32 v63, v222, v223
    buffer_store_dwordx4 v[60:63], v1, s[36:39], s52 offen offset:3072 sc1
    v_mfma_f32_16x16x32_bf16 v[188:191], v[40:43], a[144:147], v[188:191]
    ds_read_b64_tr_b16 v[38:39], v7 offset:3584
    v_mfma_f32_16x16x32_bf16 v[188:191], v[44:47], a[192:195], v[188:191]
    s_waitcnt lgkmcnt(4)
    ds_read_b64_tr_b16 v[40:41], v7 offset:5120
    v_mfma_f32_16x16x32_bf16 v[192:195], v[16:19], a[224:227], 0
    ds_read_b64_tr_b16 v[42:43], v7 offset:5632
    v_mfma_f32_16x16x32_bf16 v[192:195], v[20:23], a[240:243], v[192:195]
    ds_read_b64_tr_b16 v[44:45], v7 offset:7168
    v_mfma_f32_16x16x32_bf16 v[192:195], v[24:27], v[64:67], v[192:195]
    ds_read_b64_tr_b16 v[46:47], v7 offset:7680
    v_mfma_f32_16x16x32_bf16 v[192:195], v[28:31], v[80:83], v[192:195]
    v_mfma_f32_16x16x32_bf16 v[196:199], v[16:19], a[228:231], 0
    v_mfma_f32_16x16x32_bf16 v[196:199], v[20:23], a[244:247], v[196:199]
    v_mfma_f32_16x16x32_bf16 v[196:199], v[24:27], v[68:71], v[196:199]
    v_mfma_f32_16x16x32_bf16 v[196:199], v[28:31], v[84:87], v[196:199]
    v_mfma_f32_16x16x32_bf16 v[200:203], v[16:19], a[232:235], 0
    v_mfma_f32_16x16x32_bf16 v[200:203], v[20:23], a[248:251], v[200:203]
    v_mfma_f32_16x16x32_bf16 v[200:203], v[24:27], v[72:75], v[200:203]
    s_mov_b32 s49, 1769472
    v_mfma_f32_16x16x32_bf16 v[200:203], v[28:31], v[88:91], v[200:203]
    s_add_u32 m0, s89, 53248
    v_mfma_f32_16x16x32_bf16 v[204:207], v[16:19], a[236:239], 0
    ds_read_b64_tr_b16 v[16:17], v7 offset:8192
    v_mfma_f32_16x16x32_bf16 v[204:207], v[20:23], a[252:255], v[204:207]
    ds_read_b64_tr_b16 v[18:19], v7 offset:8704
    v_mfma_f32_16x16x32_bf16 v[204:207], v[24:27], v[76:79], v[204:207]
    ds_read_b64_tr_b16 v[20:21], v7 offset:10240
    v_mfma_f32_16x16x32_bf16 v[204:207], v[28:31], v[92:95], v[204:207]
    s_waitcnt lgkmcnt(3)
    ds_read_b64_tr_b16 v[22:23], v7 offset:10752
    v_mfma_f32_16x16x32_bf16 v[208:211], v[32:35], a[224:227], 0
    ds_read_b64_tr_b16 v[24:25], v7 offset:12288
    v_mfma_f32_16x16x32_bf16 v[208:211], v[36:39], a[240:243], v[208:211]
    ds_read_b64_tr_b16 v[26:27], v7 offset:12800
    v_mfma_f32_16x16x32_bf16 v[208:211], v[40:43], v[64:67], v[208:211]
    ds_read_b64_tr_b16 v[28:29], v7 offset:14336
    v_mfma_f32_16x16x32_bf16 v[208:211], v[44:47], v[80:83], v[208:211]
    ds_read_b64_tr_b16 v[30:31], v7 offset:14848
    v_mfma_f32_16x16x32_bf16 v[212:215], v[32:35], a[228:231], 0
    buffer_load_dwordx4 v3, s[28:31], s49 offen lds
    v_mfma_f32_16x16x32_bf16 v[212:215], v[36:39], a[244:247], v[212:215]
    v_mfma_f32_16x16x32_bf16 v[212:215], v[40:43], v[68:71], v[212:215]
    v_mfma_f32_16x16x32_bf16 v[212:215], v[44:47], v[84:87], v[212:215]
    v_mfma_f32_16x16x32_bf16 v[216:219], v[32:35], a[232:235], 0
    v_mfma_f32_16x16x32_bf16 v[216:219], v[36:39], a[248:251], v[216:219]
    v_mfma_f32_16x16x32_bf16 v[216:219], v[40:43], v[72:75], v[216:219]
    v_mfma_f32_16x16x32_bf16 v[216:219], v[44:47], v[88:91], v[216:219]
    v_mfma_f32_16x16x32_bf16 v[220:223], v[32:35], a[236:239], 0
    ds_read_b64_tr_b16 v[32:33], v7 offset:9216
    v_mfma_f32_16x16x32_bf16 v[220:223], v[36:39], a[252:255], v[220:223]
    ds_read_b64_tr_b16 v[34:35], v7 offset:9728
    v_mfma_f32_16x16x32_bf16 v[220:223], v[40:43], v[76:79], v[220:223]
    ds_read_b64_tr_b16 v[36:37], v7 offset:11264
    v_mfma_f32_16x16x32_bf16 v[220:223], v[44:47], v[92:95], v[220:223]
    s_waitcnt lgkmcnt(3)
    ds_read_b64_tr_b16 v[38:39], v7 offset:11776
    v_mfma_f32_16x16x32_bf16 v[192:195], v[16:19], a[148:151], v[192:195]
    ds_read_b64_tr_b16 v[40:41], v7 offset:13312
    v_mul_u32_u24 v13, 3641, v0
    v_mfma_f32_16x16x32_bf16 v[192:195], v[20:23], a[164:167], v[192:195]
    ds_read_b64_tr_b16 v[42:43], v7 offset:13824
    v_lshrrev_b32 v13, 16, v13
    v_mfma_f32_16x16x32_bf16 v[192:195], v[24:27], a[212:215], v[192:195]
    ds_read_b64_tr_b16 v[44:45], v7 offset:15360
    v_mul_u32_u24 v12, 18, v13
    v_mfma_f32_16x16x32_bf16 v[192:195], v[28:31], a[132:135], v[192:195]
    ds_read_b64_tr_b16 v[46:47], v7 offset:15872
    v_sub_u32 v12, v0, v12
    v_mfma_f32_16x16x32_bf16 v[196:199], v[16:19], a[152:155], v[196:199]
    v_lshl_add_u32 v13, s40, 5, v13
    v_mul_u32_u24 v13, 1152, v13
    v_mfma_f32_16x16x32_bf16 v[196:199], v[20:23], a[168:171], v[196:199]
    v_lshl_add_u32 v64, v12, 4, v13
    v_mov_b32 v15, 864
    v_mfma_f32_16x16x32_bf16 v[196:199], v[24:27], a[216:219], v[196:199]
    s_add_u32 s87, s96, s86
    v_mov_b32 v14, 0x1
    v_add_u32 v13, 24, v12
    v_mfma_f32_16x16x32_bf16 v[196:199], v[28:31], a[136:139], v[196:199]
    v_lshrrev_b32 v13, 5, v13
    v_mad_u32_u24 v65, v13, v15, v64
    v_mfma_f32_16x16x32_bf16 v[200:203], v[16:19], a[156:159], v[200:203]
    v_add_u32 v65, 3616, v65
    v_add_u32 v13, 16, v12
    v_mfma_f32_16x16x32_bf16 v[200:203], v[20:23], a[172:175], v[200:203]
    s_mov_b32 s49, 2359296
    v_lshrrev_b32 v13, 5, v13
    v_mad_u32_u24 v66, v13, v15, v64
    v_mfma_f32_16x16x32_bf16 v[200:203], v[24:27], a[220:223], v[200:203]
    s_add_u32 m0, s89, 57344
    v_add_u32 v66, 8096, v66
    v_add_u32 v13, 26, v12
    v_mfma_f32_16x16x32_bf16 v[200:203], v[28:31], a[140:143], v[200:203]
    buffer_load_dwordx4 v3, s[28:31], s49 offen lds
    v_mfma_f32_16x16x32_bf16 v[204:207], v[16:19], a[160:163], v[204:207]
    v_lshrrev_b32 v13, 5, v13
    v_mad_u32_u24 v67, v13, v15, v64
    v_mfma_f32_16x16x32_bf16 v[204:207], v[20:23], a[176:179], v[204:207]
    v_add_u32 v67, 11712, v67
    v_add_u32 v13, 18, v12
    v_mfma_f32_16x16x32_bf16 v[204:207], v[24:27], a[128:131], v[204:207]
    s_waitcnt vmcnt(2)
    s_barrier
    v_lshrrev_b32 v13, 5, v13
    v_mfma_f32_16x16x32_bf16 v[204:207], v[28:31], a[144:147], v[204:207]
    s_waitcnt lgkmcnt(0)
    ds_read_b64_tr_b16 v[16:17], v8 offset:40960
    v_mfma_f32_16x16x32_bf16 v[208:211], v[32:35], a[148:151], v[208:211]
    ds_read_b64_tr_b16 v[18:19], v8 offset:43008
    v_mad_u32_u24 v68, v13, v15, v64
    v_mfma_f32_16x16x32_bf16 v[208:211], v[36:39], a[164:167], v[208:211]
    ds_read_b64_tr_b16 v[20:21], v8 offset:49152
    v_add_u32 v68, 16192, v68
    v_mfma_f32_16x16x32_bf16 v[208:211], v[40:43], a[212:215], v[208:211]
    ds_read_b64_tr_b16 v[22:23], v8 offset:51200
    v_add_u32 v13, 28, v12
    v_mfma_f32_16x16x32_bf16 v[208:211], v[44:47], a[132:135], v[208:211]
    ds_read_b64_tr_b16 v[24:25], v8 offset:57344
    v_lshrrev_b32 v13, 5, v13
    v_mfma_f32_16x16x32_bf16 v[212:215], v[32:35], a[152:155], v[212:215]
    ds_read_b64_tr_b16 v[26:27], v8 offset:59392
    v_mad_u32_u24 v69, v13, v15, v64
    v_mfma_f32_16x16x32_bf16 v[212:215], v[36:39], a[168:171], v[212:215]
    ds_read_b64_tr_b16 v[28:29], v8 offset:45056
    v_add_u32 v69, 19808, v69
    v_mfma_f32_16x16x32_bf16 v[212:215], v[40:43], a[216:219], v[212:215]
    ds_read_b64_tr_b16 v[30:31], v8 offset:47104
    v_add_u32 v13, 20, v12
    v_mfma_f32_16x16x32_bf16 v[212:215], v[44:47], a[136:139], v[212:215]
    buffer_atomic_add v14, v6, s[60:63], s87 offen
    v_mfma_f32_16x16x32_bf16 v[216:219], v[32:35], a[156:159], v[216:219]
    v_lshrrev_b32 v13, 5, v13
    v_mad_u32_u24 v70, v13, v15, v64
    v_mfma_f32_16x16x32_bf16 v[216:219], v[36:39], a[172:175], v[216:219]
    v_add_u32 v70, 24288, v70
    v_add_u32 v13, 30, v12
    v_mfma_f32_16x16x32_bf16 v[216:219], v[40:43], a[220:223], v[216:219]
    s_mov_b32 s49, 2949120
    v_lshrrev_b32 v13, 5, v13
    v_mad_u32_u24 v71, v13, v15, v64
    v_mfma_f32_16x16x32_bf16 v[216:219], v[44:47], a[140:143], v[216:219]
    s_add_u32 m0, s89, 61440
    v_add_u32 v71, 27904, v71
    v_add_u32 v13, 22, v12
    v_mfma_f32_16x16x32_bf16 v[220:223], v[32:35], a[160:163], v[220:223]
    ds_read_b64_tr_b16 v[32:33], v8 offset:53248
    v_lshrrev_b32 v13, 5, v13
    v_mfma_f32_16x16x32_bf16 v[220:223], v[36:39], a[176:179], v[220:223]
    ds_read_b64_tr_b16 v[34:35], v8 offset:55296
    v_mad_u32_u24 v72, v13, v15, v64
    v_mfma_f32_16x16x32_bf16 v[220:223], v[40:43], a[128:131], v[220:223]
    ds_read_b64_tr_b16 v[36:37], v8 offset:61440
    v_add_u32 v72, 32384, v72
    v_mfma_f32_16x16x32_bf16 v[220:223], v[44:47], a[144:147], v[220:223]
    s_waitcnt lgkmcnt(5)
    ds_read_b64_tr_b16 v[38:39], v8 offset:63488
    v_mfma_f32_16x16x32_bf16 v[224:227], v[16:19], a[196:199], v[224:227]
    v_add_u32 v8, 0xfffe8000, v8
    v_lshrrev_b32 v12, 2, v0
    v_mfma_f32_16x16x32_bf16 v[224:227], v[20:23], a[0:3], v[224:227]
    ds_read_b64_tr_b16 v[40:41], v8 offset:0
    v_mul_u32_u24 v13, 288, v12
    v_mfma_f32_16x16x32_bf16 v[224:227], v[24:27], a[16:19], v[224:227]
    ds_read_b64_tr_b16 v[42:43], v8 offset:2048
    v_and_b32 v12, 3, v0
    v_mfma_f32_16x16x32_bf16 v[228:231], v[16:19], a[200:203], v[228:231]
    ds_read_b64_tr_b16 v[44:45], v8 offset:8192
    v_lshl_add_u32 v73, v12, 3, v13
    v_mfma_f32_16x16x32_bf16 v[228:231], v[20:23], a[4:7], v[228:231]
    ds_read_b64_tr_b16 v[46:47], v8 offset:10240
    v_add_u32 v76, 73728, v73
    v_mfma_f32_16x16x32_bf16 v[228:231], v[24:27], a[20:23], v[228:231]
    buffer_load_dwordx4 v3, s[28:31], s49 offen lds
    v_mfma_f32_16x16x32_bf16 v[232:235], v[16:19], a[204:207], v[232:235]
    v_add_u32 v77, 110592, v73
    v_and_b32 v74, 15, v0
    v_mfma_f32_16x16x32_bf16 v[232:235], v[20:23], a[8:11], v[232:235]
    v_mul_u32_u24 v74, 1152, v74
    v_lshrrev_b32 v12, 4, v0
    v_mfma_f32_16x16x32_bf16 v[232:235], v[24:27], a[24:27], v[232:235]
    v_lshl_add_u32 v74, v12, 3, v74
    v_lshlrev_b32 v75, 3, v0
    v_mfma_f32_16x16x32_bf16 v[236:239], v[16:19], a[208:211], v[236:239]
    ds_read_b64_tr_b16 v[16:17], v8 offset:16384
    v_add_u32 v75, 4096, v75
    v_mfma_f32_16x16x32_bf16 v[236:239], v[20:23], a[12:15], v[236:239]
    ds_read_b64_tr_b16 v[18:19], v8 offset:18432
    v_mfma_f32_16x16x32_bf16 v[236:239], v[24:27], a[28:31], v[236:239]
    s_waitcnt lgkmcnt(6)
    v_mfma_f32_16x16x32_bf16 v[240:243], v[28:31], a[196:199], v[240:243]
    ds_read_b64_tr_b16 v[20:21], v8 offset:4096
    v_mfma_f32_16x16x32_bf16 v[240:243], v[32:35], a[0:3], v[240:243]
    ds_read_b64_tr_b16 v[22:23], v8 offset:6144
    v_mfma_f32_16x16x32_bf16 v[240:243], v[36:39], a[16:19], v[240:243]
    ds_read_b64_tr_b16 v[24:25], v8 offset:12288
    v_mfma_f32_16x16x32_bf16 v[244:247], v[28:31], a[200:203], v[244:247]
    ds_read_b64_tr_b16 v[26:27], v8 offset:14336
    v_mfma_f32_16x16x32_bf16 v[244:247], v[32:35], a[4:7], v[244:247]
    v_mfma_f32_16x16x32_bf16 v[244:247], v[36:39], a[20:23], v[244:247]
    v_mfma_f32_16x16x32_bf16 v[248:251], v[28:31], a[204:207], v[248:251]
    v_mfma_f32_16x16x32_bf16 v[248:251], v[32:35], a[8:11], v[248:251]
    s_mov_b32 s49, 3538944
    v_mfma_f32_16x16x32_bf16 v[248:251], v[36:39], a[24:27], v[248:251]
    s_add_u32 m0, s89, 65536
    v_mfma_f32_16x16x32_bf16 v[252:255], v[28:31], a[208:211], v[252:255]
    ds_read_b64_tr_b16 v[28:29], v8 offset:20480
    v_mfma_f32_16x16x32_bf16 v[252:255], v[32:35], a[12:15], v[252:255]
    ds_read_b64_tr_b16 v[30:31], v8 offset:22528
    v_mfma_f32_16x16x32_bf16 v[252:255], v[36:39], a[28:31], v[252:255]
    s_waitcnt lgkmcnt(6)
    v_mfma_f32_16x16x32_bf16 v[224:227], v[40:43], a[32:35], v[224:227]
    ds_read_b64_tr_b16 v[32:33], v8 offset:24576
    v_mfma_f32_16x16x32_bf16 v[224:227], v[44:47], a[48:51], v[224:227]
    ds_read_b64_tr_b16 v[34:35], v8 offset:26624
    v_mfma_f32_16x16x32_bf16 v[224:227], v[16:19], a[64:67], v[224:227]
    ds_read_b64_tr_b16 v[36:37], v8 offset:32768
    v_mfma_f32_16x16x32_bf16 v[228:231], v[40:43], a[36:39], v[228:231]
    ds_read_b64_tr_b16 v[38:39], v8 offset:34816
    v_mfma_f32_16x16x32_bf16 v[228:231], v[44:47], a[52:55], v[228:231]
    buffer_load_dwordx4 v3, s[28:31], s49 offen lds
    v_mfma_f32_16x16x32_bf16 v[228:231], v[16:19], a[68:71], v[228:231]
    v_mfma_f32_16x16x32_bf16 v[232:235], v[40:43], a[40:43], v[232:235]
    v_mfma_f32_16x16x32_bf16 v[232:235], v[44:47], a[56:59], v[232:235]
    v_mfma_f32_16x16x32_bf16 v[232:235], v[16:19], a[72:75], v[232:235]
    v_mfma_f32_16x16x32_bf16 v[236:239], v[40:43], a[44:47], v[236:239]
    ds_read_b64_tr_b16 v[40:41], v8 offset:40960
    v_mfma_f32_16x16x32_bf16 v[236:239], v[44:47], a[60:63], v[236:239]
    ds_read_b64_tr_b16 v[42:43], v8 offset:43008
    v_mfma_f32_16x16x32_bf16 v[236:239], v[16:19], a[76:79], v[236:239]
    s_waitcnt lgkmcnt(6)
    v_mfma_f32_16x16x32_bf16 v[240:243], v[20:23], a[32:35], v[240:243]
    ds_read_b64_tr_b16 v[44:45], v8 offset:28672
    v_mfma_f32_16x16x32_bf16 v[240:243], v[24:27], a[48:51], v[240:243]
    ds_read_b64_tr_b16 v[46:47], v8 offset:30720
    v_mfma_f32_16x16x32_bf16 v[240:243], v[28:31], a[64:67], v[240:243]
    ds_read_b64_tr_b16 v[16:17], v8 offset:36864
    v_mfma_f32_16x16x32_bf16 v[244:247], v[20:23], a[36:39], v[244:247]
    ds_read_b64_tr_b16 v[18:19], v8 offset:38912
    v_mfma_f32_16x16x32_bf16 v[244:247], v[24:27], a[52:55], v[244:247]
    v_mfma_f32_16x16x32_bf16 v[244:247], v[28:31], a[68:71], v[244:247]
    v_mfma_f32_16x16x32_bf16 v[248:251], v[20:23], a[40:43], v[248:251]
    v_mfma_f32_16x16x32_bf16 v[248:251], v[24:27], a[56:59], v[248:251]
    s_add_u32 m0, s46, 73728
    v_mfma_f32_16x16x32_bf16 v[248:251], v[28:31], a[72:75], v[248:251]
    s_add_u32 s47, s14, 0
    v_mfma_f32_16x16x32_bf16 v[252:255], v[20:23], a[44:47], v[252:255]
    ds_read_b64_tr_b16 v[20:21], v8 offset:45056
    v_mfma_f32_16x16x32_bf16 v[252:255], v[24:27], a[60:63], v[252:255]
    ds_read_b64_tr_b16 v[22:23], v8 offset:47104
    v_mfma_f32_16x16x32_bf16 v[252:255], v[28:31], a[76:79], v[252:255]
    s_waitcnt lgkmcnt(6)
    v_mfma_f32_16x16x32_bf16 v[224:227], v[32:35], a[80:83], v[224:227]
    ds_read_b64_tr_b16 v[24:25], v9 offset:40960
    v_mfma_f32_16x16x32_bf16 v[224:227], v[36:39], a[96:99], v[224:227]
    ds_read_b64_tr_b16 v[26:27], v9 offset:43008
    v_mfma_f32_16x16x32_bf16 v[224:227], v[40:43], a[112:115], v[224:227]
    ds_read_b64_tr_b16 v[28:29], v9 offset:49152
    v_mfma_f32_16x16x32_bf16 v[228:231], v[32:35], a[84:87], v[228:231]
    ds_read_b64_tr_b16 v[30:31], v9 offset:51200
    v_mfma_f32_16x16x32_bf16 v[228:231], v[36:39], a[100:103], v[228:231]
    buffer_load_dwordx4 v64, s[16:19], s47 offen lds
    v_mfma_f32_16x16x32_bf16 v[228:231], v[40:43], a[116:119], v[228:231]
    v_mfma_f32_16x16x32_bf16 v[232:235], v[32:35], a[88:91], v[232:235]
    v_mfma_f32_16x16x32_bf16 v[232:235], v[36:39], a[104:107], v[232:235]
    v_mfma_f32_16x16x32_bf16 v[232:235], v[40:43], a[120:123], v[232:235]
    s_add_u32 m0, s46, 74752
    v_mfma_f32_16x16x32_bf16 v[236:239], v[32:35], a[92:95], v[236:239]
    ds_read_b64_tr_b16 v[32:33], v9 offset:57344
    v_mfma_f32_16x16x32_bf16 v[236:239], v[36:39], a[108:111], v[236:239]
    ds_read_b64_tr_b16 v[34:35], v9 offset:59392
    v_mfma_f32_16x16x32_bf16 v[236:239], v[40:43], a[124:127], v[236:239]
    s_waitcnt lgkmcnt(6)
    v_mfma_f32_16x16x32_bf16 v[240:243], v[44:47], a[80:83], v[240:243]
    ds_read_b64_tr_b16 v[36:37], v9 offset:45056
    v_mfma_f32_16x16x32_bf16 v[240:243], v[16:19], a[96:99], v[240:243]
    ds_read_b64_tr_b16 v[38:39], v9 offset:47104
    v_mfma_f32_16x16x32_bf16 v[240:243], v[20:23], a[112:115], v[240:243]
    ds_read_b64_tr_b16 v[40:41], v9 offset:53248
    v_mfma_f32_16x16x32_bf16 v[244:247], v[44:47], a[84:87], v[244:247]
    ds_read_b64_tr_b16 v[42:43], v9 offset:55296
    v_mfma_f32_16x16x32_bf16 v[244:247], v[16:19], a[100:103], v[244:247]
    buffer_load_dwordx4 v65, s[16:19], s47 offen lds
    v_mfma_f32_16x16x32_bf16 v[244:247], v[20:23], a[116:119], v[244:247]
    s_add_u32 m0, s46, 75776
    v_mfma_f32_16x16x32_bf16 v[248:251], v[44:47], a[88:91], v[248:251]
    buffer_load_dwordx4 v66, s[16:19], s47 offen lds
    v_mfma_f32_16x16x32_bf16 v[248:251], v[16:19], a[104:107], v[248:251]
    global_load_dword v79, v[4:5], off
    v_mfma_f32_16x16x32_bf16 v[248:251], v[20:23], a[120:123], v[248:251]
    s_add_u32 m0, s46, 76800
    v_mfma_f32_16x16x32_bf16 v[252:255], v[44:47], a[92:95], v[252:255]
    ds_read_b64_tr_b16 v[44:45], v9 offset:61440
    v_mfma_f32_16x16x32_bf16 v[252:255], v[16:19], a[108:111], v[252:255]
    ds_read_b64_tr_b16 v[46:47], v9 offset:63488
    v_add_u32 v9, 0xfffe8000, v9
    v_mfma_f32_16x16x32_bf16 v[252:255], v[20:23], a[124:127], v[252:255]
    s_waitcnt lgkmcnt(6)
    v_mfma_f32_16x16x32_bf16 v[96:99], v[24:27], a[196:199], v[96:99]
    ds_read_b64_tr_b16 v[16:17], v9 offset:0
    v_mfma_f32_16x16x32_bf16 v[96:99], v[28:31], a[0:3], v[96:99]
    ds_read_b64_tr_b16 v[18:19], v9 offset:2048
    v_mfma_f32_16x16x32_bf16 v[96:99], v[32:35], a[16:19], v[96:99]
    ds_read_b64_tr_b16 v[20:21], v9 offset:8192
    v_mfma_f32_16x16x32_bf16 v[100:103], v[24:27], a[200:203], v[100:103]
    ds_read_b64_tr_b16 v[22:23], v9 offset:10240
    v_mfma_f32_16x16x32_bf16 v[100:103], v[28:31], a[4:7], v[100:103]
    buffer_load_dwordx4 v67, s[16:19], s47 offen lds
    v_mfma_f32_16x16x32_bf16 v[100:103], v[32:35], a[20:23], v[100:103]
    buffer_load_dword v78, v6, s[60:63], s44 offen sc1
    v_mfma_f32_16x16x32_bf16 v[104:107], v[24:27], a[204:207], v[104:107]
    s_add_u32 m0, s46, 77824
    v_mfma_f32_16x16x32_bf16 v[104:107], v[28:31], a[8:11], v[104:107]
    buffer_load_dwordx4 v68, s[16:19], s47 offen lds
    v_mfma_f32_16x16x32_bf16 v[104:107], v[32:35], a[24:27], v[104:107]
    s_add_u32 m0, s46, 78848
    v_mul_f32 v240, v224, v240
    v_mul_f32 v241, v225, v241
    v_mfma_f32_16x16x32_bf16 v[108:111], v[24:27], a[208:211], v[108:111]
    ds_read_b64_tr_b16 v[24:25], v9 offset:16384
    v_mul_f32 v242, v226, v242
    v_mfma_f32_16x16x32_bf16 v[108:111], v[28:31], a[12:15], v[108:111]
    ds_read_b64_tr_b16 v[26:27], v9 offset:18432
    v_mul_f32 v243, v227, v243
    v_mfma_f32_16x16x32_bf16 v[108:111], v[32:35], a[28:31], v[108:111]
    s_waitcnt lgkmcnt(6)
    v_mul_f32 v224, s54, v224
    v_mul_f32 v225, s54, v225
    v_mfma_f32_16x16x32_bf16 v[112:115], v[36:39], a[196:199], v[112:115]
    ds_read_b64_tr_b16 v[28:29], v9 offset:4096
    v_mul_f32 v226, s54, v226
    v_mfma_f32_16x16x32_bf16 v[112:115], v[40:43], a[0:3], v[112:115]
    ds_read_b64_tr_b16 v[30:31], v9 offset:6144
    v_mul_f32 v227, s54, v227
    v_mfma_f32_16x16x32_bf16 v[112:115], v[44:47], a[16:19], v[112:115]
    ds_read_b64_tr_b16 v[32:33], v9 offset:12288
    v_mul_f32 v244, v228, v244
    v_mfma_f32_16x16x32_bf16 v[116:119], v[36:39], a[200:203], v[116:119]
    ds_read_b64_tr_b16 v[34:35], v9 offset:14336
    v_mul_f32 v245, v229, v245
    v_mfma_f32_16x16x32_bf16 v[116:119], v[40:43], a[4:7], v[116:119]
    buffer_load_dwordx4 v69, s[16:19], s47 offen lds
    v_mfma_f32_16x16x32_bf16 v[116:119], v[44:47], a[20:23], v[116:119]
    v_exp_f32 v224, v224
    v_mfma_f32_16x16x32_bf16 v[120:123], v[36:39], a[204:207], v[120:123]
    v_exp_f32 v225, v225
    v_mfma_f32_16x16x32_bf16 v[120:123], v[40:43], a[8:11], v[120:123]
    v_exp_f32 v226, v226
    v_mfma_f32_16x16x32_bf16 v[120:123], v[44:47], a[24:27], v[120:123]
    s_add_u32 m0, s46, 79872
    v_exp_f32 v227, v227
    v_mfma_f32_16x16x32_bf16 v[124:127], v[36:39], a[208:211], v[124:127]
    ds_read_b64_tr_b16 v[36:37], v9 offset:20480
    v_add_f32 v224, 1.0, v224
    v_mfma_f32_16x16x32_bf16 v[124:127], v[40:43], a[12:15], v[124:127]
    ds_read_b64_tr_b16 v[38:39], v9 offset:22528
    v_add_f32 v225, 1.0, v225
    v_mfma_f32_16x16x32_bf16 v[124:127], v[44:47], a[28:31], v[124:127]
    s_waitcnt lgkmcnt(6)
    v_rcp_f32 v224, v224
    v_mfma_f32_16x16x32_bf16 v[96:99], v[16:19], a[32:35], v[96:99]
    ds_read_b64_tr_b16 v[40:41], v9 offset:24576
    v_add_f32 v226, 1.0, v226
    v_mfma_f32_16x16x32_bf16 v[96:99], v[20:23], a[48:51], v[96:99]
    ds_read_b64_tr_b16 v[42:43], v9 offset:26624
    v_add_f32 v227, 1.0, v227
    v_mfma_f32_16x16x32_bf16 v[96:99], v[24:27], a[64:67], v[96:99]
    ds_read_b64_tr_b16 v[44:45], v9 offset:32768
    v_mul_f32 v240, v240, v224
    v_mfma_f32_16x16x32_bf16 v[100:103], v[16:19], a[36:39], v[100:103]
    ds_read_b64_tr_b16 v[46:47], v9 offset:34816
    v_mul_f32 v246, v230, v246
    v_mfma_f32_16x16x32_bf16 v[100:103], v[20:23], a[52:55], v[100:103]
    buffer_load_dwordx4 v70, s[16:19], s47 offen lds
    v_mfma_f32_16x16x32_bf16 v[100:103], v[24:27], a[68:71], v[100:103]
    s_add_u32 m0, s46, 80896
    v_rcp_f32 v225, v225
    v_mfma_f32_16x16x32_bf16 v[104:107], v[16:19], a[40:43], v[104:107]
    buffer_load_dwordx4 v71, s[16:19], s47 offen lds
    v_mfma_f32_16x16x32_bf16 v[104:107], v[20:23], a[56:59], v[104:107]
    v_rcp_f32 v226, v226
    v_mfma_f32_16x16x32_bf16 v[104:107], v[24:27], a[72:75], v[104:107]
    s_add_u32 m0, s46, 81920
    v_rcp_f32 v227, v227
    v_mfma_f32_16x16x32_bf16 v[108:111], v[16:19], a[44:47], v[108:111]
    ds_read_b64_tr_b16 v[16:17], v9 offset:40960
    v_mul_f32 v241, v241, v225
    v_mfma_f32_16x16x32_bf16 v[108:111], v[20:23], a[60:63], v[108:111]
    ds_read_b64_tr_b16 v[18:19], v9 offset:43008
    v_mul_f32 v242, v242, v226
    v_mfma_f32_16x16x32_bf16 v[108:111], v[24:27], a[76:79], v[108:111]
    s_waitcnt lgkmcnt(6)
    v_mul_f32 v243, v243, v227
    v_cvt_pk_bf16_f32 v48, v240, v241
    v_mfma_f32_16x16x32_bf16 v[112:115], v[28:31], a[32:35], v[112:115]
    ds_read_b64_tr_b16 v[20:21], v9 offset:28672
    v_cvt_pk_bf16_f32 v49, v242, v243
    v_mfma_f32_16x16x32_bf16 v[112:115], v[32:35], a[48:51], v[112:115]
    ds_read_b64_tr_b16 v[22:23], v9 offset:30720
    v_mul_f32 v247, v231, v247
    v_mfma_f32_16x16x32_bf16 v[112:115], v[36:39], a[64:67], v[112:115]
    ds_read_b64_tr_b16 v[24:25], v9 offset:36864
    v_mul_f32 v228, s54, v228
    v_mfma_f32_16x16x32_bf16 v[116:119], v[28:31], a[36:39], v[116:119]
    ds_read_b64_tr_b16 v[26:27], v9 offset:38912
    v_mul_f32 v229, s54, v229
    v_mfma_f32_16x16x32_bf16 v[116:119], v[32:35], a[52:55], v[116:119]
    buffer_load_dwordx4 v72, s[16:19], s47 offen lds
    v_mfma_f32_16x16x32_bf16 v[116:119], v[36:39], a[68:71], v[116:119]
    v_exp_f32 v228, v228
    v_mfma_f32_16x16x32_bf16 v[120:123], v[28:31], a[40:43], v[120:123]
    v_exp_f32 v229, v229
    v_mfma_f32_16x16x32_bf16 v[120:123], v[32:35], a[56:59], v[120:123]
    v_mul_f32 v230, s54, v230
    v_mul_f32 v231, s54, v231
    v_mfma_f32_16x16x32_bf16 v[120:123], v[36:39], a[72:75], v[120:123]
    v_exp_f32 v230, v230
    v_mfma_f32_16x16x32_bf16 v[124:127], v[28:31], a[44:47], v[124:127]
    ds_read_b64_tr_b16 v[28:29], v9 offset:45056
    v_add_f32 v228, 1.0, v228
    v_mfma_f32_16x16x32_bf16 v[124:127], v[32:35], a[60:63], v[124:127]
    ds_read_b64_tr_b16 v[30:31], v9 offset:47104
    v_add_f32 v229, 1.0, v229
    v_mfma_f32_16x16x32_bf16 v[124:127], v[36:39], a[76:79], v[124:127]
    s_waitcnt lgkmcnt(6)
    v_exp_f32 v231, v231
    v_mfma_f32_16x16x32_bf16 v[96:99], v[40:43], a[80:83], v[96:99]
    ds_read_b64_tr_b16 v[32:33], v10 offset:40960
    v_add_f32 v230, 1.0, v230
    v_mfma_f32_16x16x32_bf16 v[96:99], v[44:47], a[96:99], v[96:99]
    ds_read_b64_tr_b16 v[34:35], v10 offset:43008
    v_add_f32 v231, 1.0, v231
    v_mfma_f32_16x16x32_bf16 v[96:99], v[16:19], a[112:115], v[96:99]
    ds_read_b64_tr_b16 v[36:37], v10 offset:49152
    v_mul_f32 v248, v232, v248
    v_mfma_f32_16x16x32_bf16 v[100:103], v[40:43], a[84:87], v[100:103]
    ds_read_b64_tr_b16 v[38:39], v10 offset:51200
    v_mul_f32 v249, v233, v249
    v_mfma_f32_16x16x32_bf16 v[100:103], v[44:47], a[100:103], v[100:103]
    v_rcp_f32 v228, v228
    v_mfma_f32_16x16x32_bf16 v[100:103], v[16:19], a[116:119], v[100:103]
    v_rcp_f32 v229, v229
    v_mfma_f32_16x16x32_bf16 v[104:107], v[40:43], a[88:91], v[104:107]
    v_rcp_f32 v230, v230
    v_mfma_f32_16x16x32_bf16 v[104:107], v[44:47], a[104:107], v[104:107]
    s_add_u32 s49, s12, 0
    v_rcp_f32 v231, v231
    v_mfma_f32_16x16x32_bf16 v[104:107], v[16:19], a[120:123], v[104:107]
    s_waitcnt vmcnt(5)
    v_mul_f32 v244, v244, v228
    v_mul_f32 v245, v245, v229
    v_mfma_f32_16x16x32_bf16 v[108:111], v[40:43], a[92:95], v[108:111]
    ds_read_b64_tr_b16 v[40:41], v10 offset:57344
    v_readfirstlane_b32 s3, v78
    v_mfma_f32_16x16x32_bf16 v[108:111], v[44:47], a[108:111], v[108:111]
    ds_read_b64_tr_b16 v[42:43], v10 offset:59392
    v_mul_f32 v246, v246, v230
    v_mfma_f32_16x16x32_bf16 v[108:111], v[16:19], a[124:127], v[108:111]
    s_waitcnt lgkmcnt(6)
    v_mul_f32 v247, v247, v231
    v_cvt_pk_bf16_f32 v52, v244, v245
    v_mfma_f32_16x16x32_bf16 v[112:115], v[20:23], a[80:83], v[112:115]
    ds_read_b64_tr_b16 v[44:45], v10 offset:45056
    v_cvt_pk_bf16_f32 v53, v246, v247
    v_mfma_f32_16x16x32_bf16 v[112:115], v[24:27], a[96:99], v[112:115]
    ds_read_b64_tr_b16 v[46:47], v10 offset:47104
    v_mul_f32 v250, v234, v250
    v_mfma_f32_16x16x32_bf16 v[112:115], v[28:31], a[112:115], v[112:115]
    ds_read_b64_tr_b16 v[16:17], v10 offset:53248
    v_mul_f32 v251, v235, v251
    v_mfma_f32_16x16x32_bf16 v[116:119], v[20:23], a[84:87], v[116:119]
    ds_read_b64_tr_b16 v[18:19], v10 offset:55296
    v_mul_f32 v232, s54, v232
    v_mfma_f32_16x16x32_bf16 v[116:119], v[24:27], a[100:103], v[116:119]
    s_bfe_u32 s3, s3, 0x80000
    s_cmp_lt_u32 s3, s41
    s_cbranch_scc1 L_dep0
L_dep0_ret:
    v_mfma_f32_16x16x32_bf16 v[116:119], v[28:31], a[116:119], v[116:119]
    buffer_load_dwordx4 a[224:227], v1, s[36:39], s49 offen offset:0 sc1
    v_mfma_f32_16x16x32_bf16 v[120:123], v[20:23], a[88:91], v[120:123]
    v_exp_f32 v232, v232
    v_mfma_f32_16x16x32_bf16 v[120:123], v[24:27], a[104:107], v[120:123]
    v_mul_f32 v233, s54, v233
    v_mul_f32 v234, s54, v234
    v_mfma_f32_16x16x32_bf16 v[120:123], v[28:31], a[120:123], v[120:123]
    v_exp_f32 v233, v233
    v_mfma_f32_16x16x32_bf16 v[124:127], v[20:23], a[92:95], v[124:127]
    ds_read_b64_tr_b16 v[20:21], v10 offset:61440
    v_mul_f32 v235, s54, v235
    v_mfma_f32_16x16x32_bf16 v[124:127], v[24:27], a[108:111], v[124:127]
    ds_read_b64_tr_b16 v[22:23], v10 offset:63488
    v_add_u32 v10, 0xfffe8000, v10
    v_mfma_f32_16x16x32_bf16 v[124:127], v[28:31], a[124:127], v[124:127]
    s_waitcnt lgkmcnt(6)
    v_exp_f32 v234, v234
    v_mfma_f32_16x16x32_bf16 v[128:131], v[32:35], a[196:199], v[128:131]
    ds_read_b64_tr_b16 v[24:25], v10 offset:0
    v_add_f32 v232, 1.0, v232
    v_mfma_f32_16x16x32_bf16 v[128:131], v[36:39], a[0:3], v[128:131]
    ds_read_b64_tr_b16 v[26:27], v10 offset:2048
    v_add_f32 v233, 1.0, v233
    v_mfma_f32_16x16x32_bf16 v[128:131], v[40:43], a[16:19], v[128:131]
    ds_read_b64_tr_b16 v[28:29], v10 offset:8192
    v_add_f32 v234, 1.0, v234
    v_mfma_f32_16x16x32_bf16 v[132:135], v[32:35], a[200:203], v[132:135]
    ds_read_b64_tr_b16 v[30:31], v10 offset:10240
    v_mul_f32 v252, v236, v252
    v_mfma_f32_16x16x32_bf16 v[132:135], v[36:39], a[4:7], v[132:135]
    buffer_load_dwordx4 a[228:231], v1, s[36:39], s49 offen offset:1024 sc1
    v_mfma_f32_16x16x32_bf16 v[132:135], v[40:43], a[20:23], v[132:135]
    buffer_load_dwordx4 a[232:235], v1, s[36:39], s49 offen offset:2048 sc1
    v_mfma_f32_16x16x32_bf16 v[136:139], v[32:35], a[204:207], v[136:139]
    v_exp_f32 v235, v235
    v_mfma_f32_16x16x32_bf16 v[136:139], v[36:39], a[8:11], v[136:139]
    v_rcp_f32 v232, v232
    v_mfma_f32_16x16x32_bf16 v[136:139], v[40:43], a[24:27], v[136:139]
    v_rcp_f32 v233, v233
    v_mfma_f32_16x16x32_bf16 v[140:143], v[32:35], a[208:211], v[140:143]
    ds_read_b64_tr_b16 v[32:33], v10 offset:16384
    v_add_f32 v235, 1.0, v235
    v_mfma_f32_16x16x32_bf16 v[140:143], v[36:39], a[12:15], v[140:143]
    s_add_u32 s52, s52, 28672
    ds_read_b64_tr_b16 v[34:35], v10 offset:18432
    v_mfma_f32_16x16x32_bf16 v[140:143], v[40:43], a[28:31], v[140:143]
    s_waitcnt lgkmcnt(6)
    v_rcp_f32 v234, v234
    v_mfma_f32_16x16x32_bf16 v[144:147], v[44:47], a[196:199], v[144:147]
    ds_read_b64_tr_b16 v[36:37], v10 offset:4096
    v_mul_f32 v248, v248, v232
    v_mfma_f32_16x16x32_bf16 v[144:147], v[16:19], a[0:3], v[144:147]
    ds_read_b64_tr_b16 v[38:39], v10 offset:6144
    v_mul_f32 v249, v249, v233
    v_mfma_f32_16x16x32_bf16 v[144:147], v[20:23], a[16:19], v[144:147]
    ds_read_b64_tr_b16 v[40:41], v10 offset:12288
    v_mul_f32 v250, v250, v234
    v_mfma_f32_16x16x32_bf16 v[148:151], v[44:47], a[200:203], v[148:151]
    ds_read_b64_tr_b16 v[42:43], v10 offset:14336
    v_cvt_pk_bf16_f32 v56, v248, v249
    v_mfma_f32_16x16x32_bf16 v[148:151], v[16:19], a[4:7], v[148:151]
    buffer_load_dwordx4 a[236:239], v1, s[36:39], s49 offen offset:3072 sc1
    v_mfma_f32_16x16x32_bf16 v[148:151], v[20:23], a[20:23], v[148:151]
    s_add_u32 s49, s12, 4096
    v_rcp_f32 v235, v235
    v_mfma_f32_16x16x32_bf16 v[152:155], v[44:47], a[204:207], v[152:155]
    buffer_load_dwordx4 a[240:243], v1, s[36:39], s49 offen offset:0 sc1
    v_mfma_f32_16x16x32_bf16 v[152:155], v[16:19], a[8:11], v[152:155]
    v_mul_f32 v251, v251, v235
    v_cvt_pk_bf16_f32 v57, v250, v251
    v_mfma_f32_16x16x32_bf16 v[152:155], v[20:23], a[24:27], v[152:155]
    buffer_load_dwordx4 a[244:247], v1, s[36:39], s49 offen offset:1024 sc1
    v_mfma_f32_16x16x32_bf16 v[156:159], v[44:47], a[208:211], v[156:159]
    ds_read_b64_tr_b16 v[44:45], v10 offset:20480
    v_mul_f32 v253, v237, v253
    v_mfma_f32_16x16x32_bf16 v[156:159], v[16:19], a[12:15], v[156:159]
    ds_read_b64_tr_b16 v[46:47], v10 offset:22528
    v_mul_f32 v254, v238, v254
    v_mfma_f32_16x16x32_bf16 v[156:159], v[20:23], a[28:31], v[156:159]
    s_waitcnt lgkmcnt(6)
    v_mul_f32 v255, v239, v255
    v_mul_f32 v236, s54, v236
    v_mfma_f32_16x16x32_bf16 v[128:131], v[24:27], a[32:35], v[128:131]
    ds_read_b64_tr_b16 v[16:17], v10 offset:24576
    v_mul_f32 v237, s54, v237
    v_mfma_f32_16x16x32_bf16 v[128:131], v[28:31], a[48:51], v[128:131]
    ds_read_b64_tr_b16 v[18:19], v10 offset:26624
    v_mul_f32 v238, s54, v238
    v_mfma_f32_16x16x32_bf16 v[128:131], v[32:35], a[64:67], v[128:131]
    ds_read_b64_tr_b16 v[20:21], v10 offset:32768
    v_mul_f32 v239, s54, v239
    v_mfma_f32_16x16x32_bf16 v[132:135], v[24:27], a[36:39], v[132:135]
    ds_read_b64_tr_b16 v[22:23], v10 offset:34816
    v_mul_f32 v112, v96, v112
    v_mfma_f32_16x16x32_bf16 v[132:135], v[28:31], a[52:55], v[132:135]
    buffer_load_dwordx4 a[248:251], v1, s[36:39], s49 offen offset:2048 sc1
    v_mfma_f32_16x16x32_bf16 v[132:135], v[32:35], a[68:71], v[132:135]
    v_exp_f32 v236, v236
    v_mfma_f32_16x16x32_bf16 v[136:139], v[24:27], a[40:43], v[136:139]
    v_exp_f32 v237, v237
    v_mfma_f32_16x16x32_bf16 v[136:139], v[28:31], a[56:59], v[136:139]
    buffer_load_dwordx4 a[252:255], v1, s[36:39], s49 offen offset:3072 sc1
    v_mfma_f32_16x16x32_bf16 v[136:139], v[32:35], a[72:75], v[136:139]
    s_add_u32 s49, s12, 8192
    v_exp_f32 v238, v238
    v_mfma_f32_16x16x32_bf16 v[140:143], v[24:27], a[44:47], v[140:143]
    ds_read_b64_tr_b16 v[24:25], v10 offset:40960
    v_add_f32 v236, 1.0, v236
    v_mfma_f32_16x16x32_bf16 v[140:143], v[28:31], a[60:63], v[140:143]
    ds_read_b64_tr_b16 v[26:27], v10 offset:43008
    v_add_f32 v237, 1.0, v237
    v_mfma_f32_16x16x32_bf16 v[140:143], v[32:35], a[76:79], v[140:143]
    s_waitcnt lgkmcnt(6)
    v_exp_f32 v239, v239
    v_mfma_f32_16x16x32_bf16 v[144:147], v[36:39], a[32:35], v[144:147]
    ds_read_b64_tr_b16 v[28:29], v10 offset:28672
    v_add_f32 v238, 1.0, v238
    v_mfma_f32_16x16x32_bf16 v[144:147], v[40:43], a[48:51], v[144:147]
    ds_read_b64_tr_b16 v[30:31], v10 offset:30720
    v_add_f32 v239, 1.0, v239
    v_mfma_f32_16x16x32_bf16 v[144:147], v[44:47], a[64:67], v[144:147]
    ds_read_b64_tr_b16 v[32:33], v10 offset:36864
    v_mul_f32 v113, v97, v113
    v_mfma_f32_16x16x32_bf16 v[148:151], v[36:39], a[36:39], v[148:151]
    ds_read_b64_tr_b16 v[34:35], v10 offset:38912
    v_mul_f32 v114, v98, v114
    v_mfma_f32_16x16x32_bf16 v[148:151], v[40:43], a[52:55], v[148:151]
    buffer_load_dwordx4 a[148:151], v1, s[36:39], s49 offen offset:0 sc1
    v_mfma_f32_16x16x32_bf16 v[148:151], v[44:47], a[68:71], v[148:151]
    v_rcp_f32 v236, v236
    v_mfma_f32_16x16x32_bf16 v[152:155], v[36:39], a[40:43], v[152:155]
    buffer_load_dwordx4 a[152:155], v1, s[36:39], s49 offen offset:1024 sc1
    v_mfma_f32_16x16x32_bf16 v[152:155], v[40:43], a[56:59], v[152:155]
    v_rcp_f32 v237, v237
    v_mfma_f32_16x16x32_bf16 v[152:155], v[44:47], a[72:75], v[152:155]
    v_rcp_f32 v238, v238
    v_mfma_f32_16x16x32_bf16 v[156:159], v[36:39], a[44:47], v[156:159]
    ds_read_b64_tr_b16 v[36:37], v10 offset:45056
    v_mul_f32 v252, v252, v236
    v_mfma_f32_16x16x32_bf16 v[156:159], v[40:43], a[60:63], v[156:159]
    ds_read_b64_tr_b16 v[38:39], v10 offset:47104
    v_mul_f32 v253, v253, v237
    v_mfma_f32_16x16x32_bf16 v[156:159], v[44:47], a[76:79], v[156:159]
    s_waitcnt lgkmcnt(6)
    v_rcp_f32 v239, v239
    v_mfma_f32_16x16x32_bf16 v[128:131], v[16:19], a[80:83], v[128:131]
    ds_read_b64_tr_b16 v[40:41], v11 offset:40960
    v_mul_f32 v254, v254, v238
    v_mfma_f32_16x16x32_bf16 v[128:131], v[20:23], a[96:99], v[128:131]
    ds_read_b64_tr_b16 v[42:43], v11 offset:43008
    v_mul_f32 v255, v255, v239
    v_mfma_f32_16x16x32_bf16 v[128:131], v[24:27], a[112:115], v[128:131]
    ds_read_b64_tr_b16 v[44:45], v11 offset:49152
    v_cvt_pk_bf16_f32 v60, v252, v253
    v_mfma_f32_16x16x32_bf16 v[132:135], v[16:19], a[84:87], v[132:135]
    ds_read_b64_tr_b16 v[46:47], v11 offset:51200
    v_cvt_pk_bf16_f32 v61, v254, v255
    v_mfma_f32_16x16x32_bf16 v[132:135], v[20:23], a[100:103], v[132:135]
    buffer_load_dwordx4 a[156:159], v1, s[36:39], s49 offen offset:2048 sc1
    v_mfma_f32_16x16x32_bf16 v[132:135], v[24:27], a[116:119], v[132:135]
    buffer_load_dwordx4 a[160:163], v1, s[36:39], s49 offen offset:3072 sc1
    v_mfma_f32_16x16x32_bf16 v[136:139], v[16:19], a[88:91], v[136:139]
    v_mul_f32 v115, v99, v115
    v_mul_f32 v96, s54, v96
    v_mfma_f32_16x16x32_bf16 v[136:139], v[20:23], a[104:107], v[136:139]
    v_exp_f32 v96, v96
    v_mfma_f32_16x16x32_bf16 v[136:139], v[24:27], a[120:123], v[136:139]
    s_add_u32 s49, s12, 12288
    v_mul_f32 v97, s54, v97
    v_mul_f32 v98, s54, v98
    v_mfma_f32_16x16x32_bf16 v[140:143], v[16:19], a[92:95], v[140:143]
    ds_read_b64_tr_b16 v[16:17], v11 offset:57344
    v_mul_f32 v99, s54, v99
    v_mfma_f32_16x16x32_bf16 v[140:143], v[20:23], a[108:111], v[140:143]
    ds_read_b64_tr_b16 v[18:19], v11 offset:59392
    v_add_f32 v96, 1.0, v96
    v_mfma_f32_16x16x32_bf16 v[140:143], v[24:27], a[124:127], v[140:143]
    s_waitcnt lgkmcnt(6)
    v_exp_f32 v97, v97
    v_mfma_f32_16x16x32_bf16 v[144:147], v[28:31], a[80:83], v[144:147]
    ds_read_b64_tr_b16 v[20:21], v11 offset:45056
    v_add_f32 v97, 1.0, v97
    v_mfma_f32_16x16x32_bf16 v[144:147], v[32:35], a[96:99], v[144:147]
    ds_read_b64_tr_b16 v[22:23], v11 offset:47104
    v_mul_f32 v116, v100, v116
    v_mfma_f32_16x16x32_bf16 v[144:147], v[36:39], a[112:115], v[144:147]
    ds_read_b64_tr_b16 v[24:25], v11 offset:53248
    v_mul_f32 v117, v101, v117
    v_mfma_f32_16x16x32_bf16 v[148:151], v[28:31], a[84:87], v[148:151]
    ds_read_b64_tr_b16 v[26:27], v11 offset:55296
    v_mul_f32 v118, v102, v118
    v_mfma_f32_16x16x32_bf16 v[148:151], v[32:35], a[100:103], v[148:151]
    buffer_load_dwordx4 a[164:167], v1, s[36:39], s49 offen offset:0 sc1
    v_mfma_f32_16x16x32_bf16 v[148:151], v[36:39], a[116:119], v[148:151]
    buffer_load_dwordx4 a[168:171], v1, s[36:39], s49 offen offset:1024 sc1
    v_mfma_f32_16x16x32_bf16 v[152:155], v[28:31], a[88:91], v[152:155]
    v_exp_f32 v98, v98
    v_mfma_f32_16x16x32_bf16 v[152:155], v[32:35], a[104:107], v[152:155]
    v_exp_f32 v99, v99
    v_mfma_f32_16x16x32_bf16 v[152:155], v[36:39], a[120:123], v[152:155]
    v_rcp_f32 v96, v96
    v_mfma_f32_16x16x32_bf16 v[156:159], v[28:31], a[92:95], v[156:159]
    ds_read_b64_tr_b16 v[28:29], v11 offset:61440
    v_add_f32 v98, 1.0, v98
    v_mfma_f32_16x16x32_bf16 v[156:159], v[32:35], a[108:111], v[156:159]
    ds_read_b64_tr_b16 v[30:31], v11 offset:63488
    v_add_u32 v11, 0xfffe8000, v11
    v_mfma_f32_16x16x32_bf16 v[156:159], v[36:39], a[124:127], v[156:159]
    s_waitcnt lgkmcnt(6)
    v_rcp_f32 v97, v97
    v_mfma_f32_16x16x32_bf16 v[160:163], v[40:43], a[196:199], v[160:163]
    ds_read_b64_tr_b16 v[32:33], v11 offset:0
    v_add_f32 v99, 1.0, v99
    v_mfma_f32_16x16x32_bf16 v[160:163], v[44:47], a[0:3], v[160:163]
    ds_read_b64_tr_b16 v[34:35], v11 offset:2048
    v_mul_f32 v112, v112, v96
    v_mfma_f32_16x16x32_bf16 v[160:163], v[16:19], a[16:19], v[160:163]
    ds_read_b64_tr_b16 v[36:37], v11 offset:8192
    v_mul_f32 v113, v113, v97
    v_mfma_f32_16x16x32_bf16 v[164:167], v[40:43], a[200:203], v[164:167]
    ds_read_b64_tr_b16 v[38:39], v11 offset:10240
    v_cvt_pk_bf16_f32 v50, v112, v113
    v_mfma_f32_16x16x32_bf16 v[164:167], v[44:47], a[4:7], v[164:167]
    buffer_load_dwordx4 a[172:175], v1, s[36:39], s49 offen offset:2048 sc1
    v_mfma_f32_16x16x32_bf16 v[164:167], v[16:19], a[20:23], v[164:167]
    buffer_load_dwordx4 a[176:179], v1, s[36:39], s49 offen offset:3072 sc1
    v_mfma_f32_16x16x32_bf16 v[168:171], v[40:43], a[204:207], v[168:171]
    v_rcp_f32 v98, v98
    v_mfma_f32_16x16x32_bf16 v[168:171], v[44:47], a[8:11], v[168:171]
    v_rcp_f32 v99, v99
    v_mfma_f32_16x16x32_bf16 v[168:171], v[16:19], a[24:27], v[168:171]
    s_add_u32 s49, s12, 16384
    v_mul_f32 v114, v114, v98
    v_mul_f32 v115, v115, v99
    v_mfma_f32_16x16x32_bf16 v[172:175], v[40:43], a[208:211], v[172:175]
    ds_read_b64_tr_b16 v[40:41], v11 offset:16384
    v_cvt_pk_bf16_f32 v51, v114, v115
    v_mfma_f32_16x16x32_bf16 v[172:175], v[44:47], a[12:15], v[172:175]
    ds_read_b64_tr_b16 v[42:43], v11 offset:18432
    v_mul_f32 v119, v103, v119
    v_mfma_f32_16x16x32_bf16 v[172:175], v[16:19], a[28:31], v[172:175]
    s_waitcnt lgkmcnt(6)
    v_mul_f32 v100, s54, v100
    v_mul_f32 v101, s54, v101
    v_mfma_f32_16x16x32_bf16 v[176:179], v[20:23], a[196:199], v[176:179]
    ds_read_b64_tr_b16 v[44:45], v11 offset:4096
    v_mul_f32 v102, s54, v102
    v_mfma_f32_16x16x32_bf16 v[176:179], v[24:27], a[0:3], v[176:179]
    ds_read_b64_tr_b16 v[46:47], v11 offset:6144
    v_mul_f32 v103, s54, v103
    v_mfma_f32_16x16x32_bf16 v[176:179], v[28:31], a[16:19], v[176:179]
    ds_read_b64_tr_b16 v[16:17], v11 offset:12288
    v_mul_f32 v120, v104, v120
    v_mfma_f32_16x16x32_bf16 v[180:183], v[20:23], a[200:203], v[180:183]
    ds_read_b64_tr_b16 v[18:19], v11 offset:14336
    v_mul_f32 v121, v105, v121
    v_mfma_f32_16x16x32_bf16 v[180:183], v[24:27], a[4:7], v[180:183]
    buffer_load_dwordx4 a[212:215], v1, s[36:39], s49 offen offset:0 sc1
    v_mfma_f32_16x16x32_bf16 v[180:183], v[28:31], a[20:23], v[180:183]
    buffer_load_dwordx4 a[216:219], v1, s[36:39], s49 offen offset:1024 sc1
    v_mfma_f32_16x16x32_bf16 v[184:187], v[20:23], a[204:207], v[184:187]
    buffer_store_dwordx4 v[48:51], v1, s[36:39], s52 offen offset:0 sc1
    v_mfma_f32_16x16x32_bf16 v[184:187], v[24:27], a[8:11], v[184:187]
    v_exp_f32 v100, v100
    v_mfma_f32_16x16x32_bf16 v[184:187], v[28:31], a[24:27], v[184:187]
    buffer_load_dwordx4 a[220:223], v1, s[36:39], s49 offen offset:2048 sc1
    v_mfma_f32_16x16x32_bf16 v[188:191], v[20:23], a[208:211], v[188:191]
    ds_read_b64_tr_b16 v[20:21], v11 offset:20480
    v_add_f32 v100, 1.0, v100
    v_mfma_f32_16x16x32_bf16 v[188:191], v[24:27], a[12:15], v[188:191]
    ds_read_b64_tr_b16 v[22:23], v11 offset:22528
    v_mul_f32 v122, v106, v122
    v_mfma_f32_16x16x32_bf16 v[188:191], v[28:31], a[28:31], v[188:191]
    s_waitcnt lgkmcnt(6)
    v_exp_f32 v101, v101
    v_mfma_f32_16x16x32_bf16 v[160:163], v[32:35], a[32:35], v[160:163]
    ds_read_b64_tr_b16 v[24:25], v11 offset:24576
    v_add_f32 v101, 1.0, v101
    v_mfma_f32_16x16x32_bf16 v[160:163], v[36:39], a[48:51], v[160:163]
    ds_read_b64_tr_b16 v[26:27], v11 offset:26624
    v_mul_f32 v123, v107, v123
    v_mfma_f32_16x16x32_bf16 v[160:163], v[40:43], a[64:67], v[160:163]
    ds_read_b64_tr_b16 v[28:29], v11 offset:32768
    v_mul_f32 v104, s54, v104
    v_mfma_f32_16x16x32_bf16 v[164:167], v[32:35], a[36:39], v[164:167]
    ds_read_b64_tr_b16 v[30:31], v11 offset:34816
    v_mul_f32 v105, s54, v105
    v_mfma_f32_16x16x32_bf16 v[164:167], v[36:39], a[52:55], v[164:167]
    buffer_load_dwordx4 a[128:131], v1, s[36:39], s49 offen offset:3072 sc1
    v_mfma_f32_16x16x32_bf16 v[164:167], v[40:43], a[68:71], v[164:167]
    v_exp_f32 v102, v102
    v_mfma_f32_16x16x32_bf16 v[168:171], v[32:35], a[40:43], v[168:171]
    s_add_u32 s49, s12, 20480
    v_exp_f32 v103, v103
    v_mfma_f32_16x16x32_bf16 v[168:171], v[36:39], a[56:59], v[168:171]
    buffer_load_dwordx4 a[132:135], v1, s[36:39], s49 offen offset:0 sc1
    v_mfma_f32_16x16x32_bf16 v[168:171], v[40:43], a[72:75], v[168:171]
    v_rcp_f32 v100, v100
    v_mfma_f32_16x16x32_bf16 v[172:175], v[32:35], a[44:47], v[172:175]
    ds_read_b64_tr_b16 v[32:33], v11 offset:40960
    v_add_f32 v102, 1.0, v102
    v_mfma_f32_16x16x32_bf16 v[172:175], v[36:39], a[60:63], v[172:175]
    ds_read_b64_tr_b16 v[34:35], v11 offset:43008
    v_add_f32 v103, 1.0, v103
    v_mfma_f32_16x16x32_bf16 v[172:175], v[40:43], a[76:79], v[172:175]
    s_waitcnt lgkmcnt(6)
    v_rcp_f32 v101, v101
    v_mfma_f32_16x16x32_bf16 v[176:179], v[44:47], a[32:35], v[176:179]
    ds_read_b64_tr_b16 v[36:37], v11 offset:28672
    v_mul_f32 v116, v116, v100
    v_mfma_f32_16x16x32_bf16 v[176:179], v[16:19], a[48:51], v[176:179]
    ds_read_b64_tr_b16 v[38:39], v11 offset:30720
    v_mul_f32 v117, v117, v101
    v_mfma_f32_16x16x32_bf16 v[176:179], v[20:23], a[64:67], v[176:179]
    ds_read_b64_tr_b16 v[40:41], v11 offset:36864
    v_cvt_pk_bf16_f32 v54, v116, v117
    v_mfma_f32_16x16x32_bf16 v[180:183], v[44:47], a[36:39], v[180:183]
    ds_read_b64_tr_b16 v[42:43], v11 offset:38912
    v_mul_f32 v106, s54, v106
    v_mfma_f32_16x16x32_bf16 v[180:183], v[16:19], a[52:55], v[180:183]
    buffer_load_dwordx4 a[136:139], v1, s[36:39], s49 offen offset:1024 sc1
    v_mfma_f32_16x16x32_bf16 v[180:183], v[20:23], a[68:71], v[180:183]
    v_rcp_f32 v102, v102
    v_mfma_f32_16x16x32_bf16 v[184:187], v[44:47], a[40:43], v[184:187]
    buffer_load_dwordx4 a[140:143], v1, s[36:39], s49 offen offset:2048 sc1
    v_mfma_f32_16x16x32_bf16 v[184:187], v[16:19], a[56:59], v[184:187]
    v_rcp_f32 v103, v103
    v_mfma_f32_16x16x32_bf16 v[184:187], v[20:23], a[72:75], v[184:187]
    v_exp_f32 v104, v104
    v_mfma_f32_16x16x32_bf16 v[188:191], v[44:47], a[44:47], v[188:191]
    ds_read_b64_tr_b16 v[44:45], v11 offset:45056
    v_mul_f32 v118, v118, v102
    v_mfma_f32_16x16x32_bf16 v[188:191], v[16:19], a[60:63], v[188:191]
    ds_read_b64_tr_b16 v[46:47], v11 offset:47104
    v_mul_f32 v119, v119, v103
    v_mfma_f32_16x16x32_bf16 v[188:191], v[20:23], a[76:79], v[188:191]
    s_waitcnt lgkmcnt(6)
    v_add_u32 v7, 0xfffee000, v7
    v_cvt_pk_bf16_f32 v55, v118, v119
    v_mfma_f32_16x16x32_bf16 v[160:163], v[24:27], a[80:83], v[160:163]
    buffer_load_dwordx4 a[144:147], v1, s[36:39], s49 offen offset:3072 sc1
    v_mfma_f32_16x16x32_bf16 v[160:163], v[28:31], a[96:99], v[160:163]
    buffer_store_dwordx4 v[52:55], v1, s[36:39], s52 offen offset:1024 sc1
    v_mfma_f32_16x16x32_bf16 v[160:163], v[32:35], a[112:115], v[160:163]
    v_exp_f32 v105, v105
    v_mfma_f32_16x16x32_bf16 v[164:167], v[24:27], a[84:87], v[164:167]
    v_exp_f32 v106, v106
    v_mfma_f32_16x16x32_bf16 v[164:167], v[28:31], a[100:103], v[164:167]
    s_add_u32 m0, s46, 110592
    v_mul_f32 v107, s54, v107
    v_add_f32 v104, 1.0, v104
    v_mfma_f32_16x16x32_bf16 v[164:167], v[32:35], a[116:119], v[164:167]
    s_add_u32 s47, s14, 147456
    v_exp_f32 v107, v107
    v_mfma_f32_16x16x32_bf16 v[168:171], v[24:27], a[88:91], v[168:171]
    s_waitcnt vmcnt(36)
    s_barrier
    v_add_f32 v105, 1.0, v105
    v_mfma_f32_16x16x32_bf16 v[168:171], v[28:31], a[104:107], v[168:171]
    ds_read_b64_tr_b16 v[16:17], v7 offset:0
    v_add_f32 v106, 1.0, v106
    v_mfma_f32_16x16x32_bf16 v[168:171], v[32:35], a[120:123], v[168:171]
    ds_read_b64_tr_b16 v[18:19], v7 offset:512
    v_add_f32 v107, 1.0, v107
    v_mfma_f32_16x16x32_bf16 v[172:175], v[24:27], a[92:95], v[172:175]
    ds_read_b64_tr_b16 v[20:21], v7 offset:2048
    v_mul_f32 v124, v108, v124
    v_mfma_f32_16x16x32_bf16 v[172:175], v[28:31], a[108:111], v[172:175]
    ds_read_b64_tr_b16 v[22:23], v7 offset:2560
    v_mul_f32 v125, v109, v125
    v_mfma_f32_16x16x32_bf16 v[172:175], v[32:35], a[124:127], v[172:175]
    s_waitcnt lgkmcnt(4)
    ds_read_b64_tr_b16 v[24:25], v7 offset:4096
    v_mfma_f32_16x16x32_bf16 v[176:179], v[36:39], a[80:83], v[176:179]
    ds_read_b64_tr_b16 v[26:27], v7 offset:4608
    v_mul_f32 v126, v110, v126
    v_mfma_f32_16x16x32_bf16 v[176:179], v[40:43], a[96:99], v[176:179]
    ds_read_b64_tr_b16 v[28:29], v7 offset:6144
    v_mul_f32 v127, v111, v127
    v_mfma_f32_16x16x32_bf16 v[176:179], v[44:47], a[112:115], v[176:179]
    ds_read_b64_tr_b16 v[30:31], v7 offset:6656
    v_mul_f32 v108, s54, v108
    v_mfma_f32_16x16x32_bf16 v[180:183], v[36:39], a[84:87], v[180:183]
    buffer_load_dwordx4 v64, s[16:19], s47 offen lds
    v_mfma_f32_16x16x32_bf16 v[180:183], v[40:43], a[100:103], v[180:183]
    ds_read_b64_tr_b16 v[32:33], v7 offset:1024
    v_mul_f32 v109, s54, v109
    v_mfma_f32_16x16x32_bf16 v[180:183], v[44:47], a[116:119], v[180:183]
    ds_read_b64_tr_b16 v[34:35], v7 offset:1536
    v_mul_f32 v110, s54, v110
    v_mfma_f32_16x16x32_bf16 v[184:187], v[36:39], a[88:91], v[184:187]
    s_add_u32 m0, s46, 111616
    v_rcp_f32 v104, v104
    v_mfma_f32_16x16x32_bf16 v[184:187], v[40:43], a[104:107], v[184:187]
    buffer_load_dwordx4 v65, s[16:19], s47 offen lds
    v_mfma_f32_16x16x32_bf16 v[184:187], v[44:47], a[120:123], v[184:187]
    s_add_u32 m0, s46, 112640
    v_rcp_f32 v105, v105
    v_mfma_f32_16x16x32_bf16 v[188:191], v[36:39], a[92:95], v[188:191]
    ds_read_b64_tr_b16 v[36:37], v7 offset:3072
    v_mul_f32 v120, v120, v104
    v_mfma_f32_16x16x32_bf16 v[188:191], v[40:43], a[108:111], v[188:191]
    ds_read_b64_tr_b16 v[38:39], v7 offset:3584
    v_mul_f32 v121, v121, v105
    v_mfma_f32_16x16x32_bf16 v[188:191], v[44:47], a[124:127], v[188:191]
    s_waitcnt lgkmcnt(4)
    ds_read_b64_tr_b16 v[40:41], v7 offset:5120
    v_mfma_f32_16x16x32_bf16 v[192:195], v[16:19], a[180:183], v[192:195]
    ds_read_b64_tr_b16 v[42:43], v7 offset:5632
    v_cvt_pk_bf16_f32 v58, v120, v121
    v_mfma_f32_16x16x32_bf16 v[192:195], v[20:23], a[196:199], v[192:195]
    ds_read_b64_tr_b16 v[44:45], v7 offset:7168
    v_mul_f32 v111, s54, v111
    v_mfma_f32_16x16x32_bf16 v[192:195], v[24:27], a[0:3], v[192:195]
    ds_read_b64_tr_b16 v[46:47], v7 offset:7680
    v_mul_f32 v144, v128, v144
    v_mfma_f32_16x16x32_bf16 v[192:195], v[28:31], a[16:19], v[192:195]
    buffer_load_dwordx4 v66, s[16:19], s47 offen lds
    v_mfma_f32_16x16x32_bf16 v[196:199], v[16:19], a[184:187], v[196:199]
    s_add_u32 m0, s46, 113664
    v_rcp_f32 v106, v106
    v_mfma_f32_16x16x32_bf16 v[196:199], v[20:23], a[200:203], v[196:199]
    buffer_load_dwordx4 v67, s[16:19], s47 offen lds
    v_mfma_f32_16x16x32_bf16 v[196:199], v[24:27], a[4:7], v[196:199]
    s_add_u32 m0, s46, 114688
    v_rcp_f32 v107, v107
    v_mfma_f32_16x16x32_bf16 v[196:199], v[28:31], a[20:23], v[196:199]
    buffer_load_dwordx4 v68, s[16:19], s47 offen lds
    v_mfma_f32_16x16x32_bf16 v[200:203], v[16:19], a[188:191], v[200:203]
    s_add_u32 m0, s46, 115712
    v_exp_f32 v108, v108
    v_mfma_f32_16x16x32_bf16 v[200:203], v[20:23], a[204:207], v[200:203]
    buffer_load_dwordx4 v69, s[16:19], s47 offen lds
    v_mfma_f32_16x16x32_bf16 v[200:203], v[24:27], a[8:11], v[200:203]
    v_exp_f32 v109, v109
    v_mfma_f32_16x16x32_bf16 v[200:203], v[28:31], a[24:27], v[200:203]
    s_add_u32 m0, s46, 116736
    v_exp_f32 v110, v110
    v_mfma_f32_16x16x32_bf16 v[204:207], v[16:19], a[192:195], v[204:207]
    ds_read_b64_tr_b16 v[16:17], v7 offset:8192
    v_mul_f32 v122, v122, v106
    v_mfma_f32_16x16x32_bf16 v[204:207], v[20:23], a[208:211], v[204:207]
    ds_read_b64_tr_b16 v[18:19], v7 offset:8704
    v_mul_f32 v123, v123, v107
    v_mfma_f32_16x16x32_bf16 v[204:207], v[24:27], a[12:15], v[204:207]
    ds_read_b64_tr_b16 v[20:21], v7 offset:10240
    v_cvt_pk_bf16_f32 v59, v122, v123
    v_mfma_f32_16x16x32_bf16 v[204:207], v[28:31], a[28:31], v[204:207]
    s_waitcnt lgkmcnt(3)
    ds_read_b64_tr_b16 v[22:23], v7 offset:10752
    v_mfma_f32_16x16x32_bf16 v[208:211], v[32:35], a[180:183], v[208:211]
    ds_read_b64_tr_b16 v[24:25], v7 offset:12288
    v_add_f32 v108, 1.0, v108
    v_mfma_f32_16x16x32_bf16 v[208:211], v[36:39], a[196:199], v[208:211]
    ds_read_b64_tr_b16 v[26:27], v7 offset:12800
    v_add_f32 v109, 1.0, v109
    v_mfma_f32_16x16x32_bf16 v[208:211], v[40:43], a[0:3], v[208:211]
    buffer_load_dwordx4 v70, s[16:19], s47 offen lds
    v_mfma_f32_16x16x32_bf16 v[208:211], v[44:47], a[16:19], v[208:211]
    s_add_u32 m0, s46, 117760
    v_exp_f32 v111, v111
    v_mfma_f32_16x16x32_bf16 v[212:215], v[32:35], a[184:187], v[212:215]
    ds_read_b64_tr_b16 v[28:29], v7 offset:9216
    v_add_f32 v110, 1.0, v110
    v_mfma_f32_16x16x32_bf16 v[212:215], v[36:39], a[200:203], v[212:215]
    ds_read_b64_tr_b16 v[30:31], v7 offset:9728
    v_add_f32 v111, 1.0, v111
    v_mfma_f32_16x16x32_bf16 v[212:215], v[40:43], a[4:7], v[212:215]
    buffer_load_dwordx4 v71, s[16:19], s47 offen lds
    v_mfma_f32_16x16x32_bf16 v[212:215], v[44:47], a[20:23], v[212:215]
    buffer_load_dword v78, v6, s[60:63], s97 offen sc1
    v_mfma_f32_16x16x32_bf16 v[216:219], v[32:35], a[188:191], v[216:219]
    s_add_u32 m0, s46, 118784
    v_rcp_f32 v108, v108
    v_mfma_f32_16x16x32_bf16 v[216:219], v[36:39], a[204:207], v[216:219]
    buffer_load_dwordx4 v72, s[16:19], s47 offen lds
    v_mfma_f32_16x16x32_bf16 v[216:219], v[40:43], a[8:11], v[216:219]
    buffer_store_dwordx4 v[56:59], v1, s[36:39], s52 offen offset:2048 sc1
    v_mfma_f32_16x16x32_bf16 v[216:219], v[44:47], a[24:27], v[216:219]
    s_add_u32 s49, s12, 24576
    v_rcp_f32 v109, v109
    v_mfma_f32_16x16x32_bf16 v[220:223], v[32:35], a[192:195], v[220:223]
    ds_read_b64_tr_b16 v[32:33], v7 offset:11264
    v_mul_f32 v124, v124, v108
    v_mfma_f32_16x16x32_bf16 v[220:223], v[36:39], a[208:211], v[220:223]
    ds_read_b64_tr_b16 v[34:35], v7 offset:11776
    v_mul_f32 v125, v125, v109
    v_mfma_f32_16x16x32_bf16 v[220:223], v[40:43], a[12:15], v[220:223]
    ds_read_b64_tr_b16 v[36:37], v7 offset:13312
    v_cvt_pk_bf16_f32 v62, v124, v125
    v_mfma_f32_16x16x32_bf16 v[220:223], v[44:47], a[28:31], v[220:223]
    s_waitcnt lgkmcnt(5)
    ds_read_b64_tr_b16 v[38:39], v7 offset:13824
    v_mfma_f32_16x16x32_bf16 v[192:195], v[16:19], a[32:35], v[192:195]
    ds_read_b64_tr_b16 v[40:41], v7 offset:14336
    v_mul_f32 v145, v129, v145
    v_mfma_f32_16x16x32_bf16 v[192:195], v[20:23], a[48:51], v[192:195]
    ds_read_b64_tr_b16 v[42:43], v7 offset:14848
    v_mul_f32 v146, v130, v146
    v_mfma_f32_16x16x32_bf16 v[192:195], v[24:27], a[64:67], v[192:195]
    ds_read_b64_tr_b16 v[44:45], v7 offset:16384
    v_mul_f32 v147, v131, v147
    v_mfma_f32_16x16x32_bf16 v[196:199], v[16:19], a[36:39], v[196:199]
    ds_read_b64_tr_b16 v[46:47], v7 offset:16896
    v_mul_f32 v128, s54, v128
    v_mfma_f32_16x16x32_bf16 v[196:199], v[20:23], a[52:55], v[196:199]
    buffer_load_dwordx4 a[180:183], v1, s[36:39], s49 offen offset:0 sc1
    v_mfma_f32_16x16x32_bf16 v[196:199], v[24:27], a[68:71], v[196:199]
    buffer_load_dwordx4 a[184:187], v1, s[36:39], s49 offen offset:1024 sc1
    v_mfma_f32_16x16x32_bf16 v[200:203], v[16:19], a[40:43], v[200:203]
    v_rcp_f32 v110, v110
    v_mfma_f32_16x16x32_bf16 v[200:203], v[20:23], a[56:59], v[200:203]
    v_rcp_f32 v111, v111
    v_mfma_f32_16x16x32_bf16 v[200:203], v[24:27], a[72:75], v[200:203]
    v_exp_f32 v128, v128
    v_mfma_f32_16x16x32_bf16 v[204:207], v[16:19], a[44:47], v[204:207]
    ds_read_b64_tr_b16 v[16:17], v7 offset:18432
    v_mul_f32 v126, v126, v110
    v_mfma_f32_16x16x32_bf16 v[204:207], v[20:23], a[60:63], v[204:207]
    ds_read_b64_tr_b16 v[18:19], v7 offset:18944
    v_mul_f32 v127, v127, v111
    v_mfma_f32_16x16x32_bf16 v[204:207], v[24:27], a[76:79], v[204:207]
    s_waitcnt lgkmcnt(6)
    v_cvt_pk_bf16_f32 v63, v126, v127
    v_mul_f32 v129, s54, v129
    v_mfma_f32_16x16x32_bf16 v[208:211], v[28:31], a[32:35], v[208:211]
    ds_read_b64_tr_b16 v[20:21], v7 offset:15360
    v_mul_f32 v130, s54, v130
    v_mfma_f32_16x16x32_bf16 v[208:211], v[32:35], a[48:51], v[208:211]
    ds_read_b64_tr_b16 v[22:23], v7 offset:15872
    v_mul_f32 v131, s54, v131
    v_mfma_f32_16x16x32_bf16 v[208:211], v[36:39], a[64:67], v[208:211]
    ds_read_b64_tr_b16 v[24:25], v7 offset:17408
    v_add_f32 v128, 1.0, v128
    v_mfma_f32_16x16x32_bf16 v[212:215], v[28:31], a[36:39], v[212:215]
    ds_read_b64_tr_b16 v[26:27], v7 offset:17920
    v_mul_f32 v148, v132, v148
    v_mfma_f32_16x16x32_bf16 v[212:215], v[32:35], a[52:55], v[212:215]
    buffer_load_dwordx4 a[188:191], v1, s[36:39], s49 offen offset:2048 sc1
    v_mfma_f32_16x16x32_bf16 v[212:215], v[36:39], a[68:71], v[212:215]
    buffer_load_dwordx4 a[192:195], v1, s[36:39], s49 offen offset:3072 sc1
    v_mfma_f32_16x16x32_bf16 v[216:219], v[28:31], a[40:43], v[216:219]
    buffer_store_dwordx4 v[60:63], v1, s[36:39], s52 offen offset:3072 sc1
    v_mfma_f32_16x16x32_bf16 v[216:219], v[32:35], a[56:59], v[216:219]
    v_exp_f32 v129, v129
    v_mfma_f32_16x16x32_bf16 v[216:219], v[36:39], a[72:75], v[216:219]
    s_add_u32 s49, s12, 28672
    v_exp_f32 v130, v130
    v_mfma_f32_16x16x32_bf16 v[220:223], v[28:31], a[44:47], v[220:223]
    ds_read_b64_tr_b16 v[28:29], v7 offset:19456
    v_add_f32 v129, 1.0, v129
    v_mfma_f32_16x16x32_bf16 v[220:223], v[32:35], a[60:63], v[220:223]
    ds_read_b64_tr_b16 v[30:31], v7 offset:19968
    v_add_f32 v130, 1.0, v130
    v_mfma_f32_16x16x32_bf16 v[220:223], v[36:39], a[76:79], v[220:223]
    s_waitcnt lgkmcnt(6)
    v_exp_f32 v131, v131
    v_mfma_f32_16x16x32_bf16 v[192:195], v[40:43], a[80:83], v[192:195]
    buffer_load_dwordx4 a[196:199], v1, s[36:39], s49 offen offset:0 sc1
    v_mfma_f32_16x16x32_bf16 v[192:195], v[44:47], a[96:99], v[192:195]
    v_rcp_f32 v128, v128
    v_mfma_f32_16x16x32_bf16 v[192:195], v[16:19], a[112:115], v[192:195]
    v_rcp_f32 v129, v129
    v_mfma_f32_16x16x32_bf16 v[196:199], v[40:43], a[84:87], v[196:199]
    buffer_load_dwordx4 a[200:203], v1, s[36:39], s49 offen offset:1024 sc1
    v_mfma_f32_16x16x32_bf16 v[196:199], v[44:47], a[100:103], v[196:199]
    v_rcp_f32 v130, v130
    v_mfma_f32_16x16x32_bf16 v[196:199], v[16:19], a[116:119], v[196:199]
    v_add_f32 v131, 1.0, v131
    v_mul_f32 v144, v144, v128
    v_mfma_f32_16x16x32_bf16 v[200:203], v[40:43], a[88:91], v[200:203]
    v_rcp_f32 v131, v131
    v_mfma_f32_16x16x32_bf16 v[200:203], v[44:47], a[104:107], v[200:203]
    v_mul_f32 v145, v145, v129
    v_mul_f32 v146, v146, v130
    v_mfma_f32_16x16x32_bf16 v[200:203], v[16:19], a[120:123], v[200:203]
    s_waitcnt vmcnt(44)
    s_barrier
    v_mul_f32 v147, v147, v131
    v_mfma_f32_16x16x32_bf16 v[204:207], v[40:43], a[92:95], v[204:207]
    ds_read_b64_tr_b16 v[32:33], v76 offset:0
    v_cvt_pk_bf16_f32 v48, v144, v145
    v_mfma_f32_16x16x32_bf16 v[204:207], v[44:47], a[108:111], v[204:207]
    ds_read_b64_tr_b16 v[34:35], v76 offset:4608
    v_cvt_pk_bf16_f32 v49, v146, v147
    v_mfma_f32_16x16x32_bf16 v[204:207], v[16:19], a[124:127], v[204:207]
    s_waitcnt lgkmcnt(2)
    ds_read_b64_tr_b16 v[36:37], v76 offset:9216
    v_mfma_f32_16x16x32_bf16 v[208:211], v[20:23], a[80:83], v[208:211]
    ds_read_b64_tr_b16 v[38:39], v76 offset:13824
    v_mul_f32 v149, v133, v149
    v_mfma_f32_16x16x32_bf16 v[208:211], v[24:27], a[96:99], v[208:211]
    ds_read_b64_tr_b16 v[40:41], v76 offset:18432
    v_mul_f32 v150, v134, v150
    v_mfma_f32_16x16x32_bf16 v[208:211], v[28:31], a[112:115], v[208:211]
    ds_read_b64_tr_b16 v[42:43], v76 offset:23040
    v_mul_f32 v151, v135, v151
    v_mfma_f32_16x16x32_bf16 v[212:215], v[20:23], a[84:87], v[212:215]
    ds_read_b64_tr_b16 v[44:45], v76 offset:27648
    v_mul_f32 v132, s54, v132
    v_mfma_f32_16x16x32_bf16 v[212:215], v[24:27], a[100:103], v[212:215]
    ds_read_b64_tr_b16 v[46:47], v76 offset:32256
    v_mul_f32 v133, s54, v133
    v_mfma_f32_16x16x32_bf16 v[212:215], v[28:31], a[116:119], v[212:215]
    ds_read_b64_tr_b16 v[16:17], v76 offset:32
    v_mul_f32 v134, s54, v134
    v_mfma_f32_16x16x32_bf16 v[216:219], v[20:23], a[88:91], v[216:219]
    ds_read_b64_tr_b16 v[18:19], v76 offset:4640
    v_mul_f32 v135, s54, v135
    v_mfma_f32_16x16x32_bf16 v[216:219], v[24:27], a[104:107], v[216:219]
    buffer_load_dwordx4 a[204:207], v1, s[36:39], s49 offen offset:2048 sc1
    v_mfma_f32_16x16x32_bf16 v[216:219], v[28:31], a[120:123], v[216:219]
    buffer_load_dwordx4 a[208:211], v1, s[36:39], s49 offen offset:3072 sc1
    v_mfma_f32_16x16x32_bf16 v[220:223], v[20:23], a[92:95], v[220:223]
    s_waitcnt vmcnt(11)
    ds_read_b64_tr_b16 v[20:21], v76 offset:9248
    v_mfma_f32_16x16x32_bf16 v[220:223], v[24:27], a[108:111], v[220:223]
    ds_read_b64_tr_b16 v[22:23], v76 offset:13856
    v_readfirstlane_b32 s3, v78
    v_mfma_f32_16x16x32_bf16 v[220:223], v[28:31], a[124:127], v[220:223]
    s_waitcnt vmcnt(30) lgkmcnt(4)
    ds_read_b64_tr_b16 v[24:25], v76 offset:18464
    v_mfma_f32_16x16x32_bf16 v[224:227], v[32:35], a[224:227], 0
    ds_read_b64_tr_b16 v[26:27], v76 offset:23072
    v_mul_f32 v152, v136, v152
    v_mfma_f32_16x16x32_bf16 v[224:227], v[36:39], a[240:243], v[224:227]
    ds_read_b64_tr_b16 v[28:29], v76 offset:27680
    v_mul_f32 v153, v137, v153
    v_mfma_f32_16x16x32_bf16 v[224:227], v[40:43], a[148:151], v[224:227]
    ds_read_b64_tr_b16 v[30:31], v76 offset:32288
    v_mul_f32 v154, v138, v154
    v_mfma_f32_16x16x32_bf16 v[224:227], v[44:47], a[164:167], v[224:227]
    s_bfe_u32 s3, s3, 0x80000
    s_cmp_lt_u32 s3, s48
    s_cbranch_scc1 L_dep2
L_dep2_ret:
    v_mfma_f32_16x16x32_bf16 v[228:231], v[32:35], a[228:231], 0
    s_add_u32 m0, s46, 0
    v_exp_f32 v132, v132
    v_mfma_f32_16x16x32_bf16 v[228:231], v[36:39], a[244:247], v[228:231]
    s_add_u32 s47, s55, 0
    v_exp_f32 v133, v133
    v_mfma_f32_16x16x32_bf16 v[228:231], v[40:43], a[152:155], v[228:231]
    buffer_load_dwordx4 v64, s[16:19], s47 offen lds
    v_mfma_f32_16x16x32_bf16 v[228:231], v[44:47], a[168:171], v[228:231]
    v_exp_f32 v134, v134
    v_mfma_f32_16x16x32_bf16 v[232:235], v[32:35], a[232:235], 0
    s_add_u32 s49, s13, 0
    v_exp_f32 v135, v135
    v_mfma_f32_16x16x32_bf16 v[232:235], v[36:39], a[248:251], v[232:235]
    buffer_load_dwordx4 a[0:3], v1, s[36:39], s49 offen offset:0 sc1
    v_mfma_f32_16x16x32_bf16 v[232:235], v[40:43], a[156:159], v[232:235]
    v_add_f32 v132, 1.0, v132
    v_add_f32 v133, 1.0, v133
    v_mfma_f32_16x16x32_bf16 v[232:235], v[44:47], a[172:175], v[232:235]
    s_add_u32 m0, s46, 1024
    v_rcp_f32 v132, v132
    v_mfma_f32_16x16x32_bf16 v[236:239], v[32:35], a[236:239], 0
    ds_read_b64_tr_b16 v[32:33], v76 offset:64
    v_add_f32 v134, 1.0, v134
    v_mfma_f32_16x16x32_bf16 v[236:239], v[36:39], a[252:255], v[236:239]
    ds_read_b64_tr_b16 v[34:35], v76 offset:4672
    v_add_f32 v135, 1.0, v135
    v_mfma_f32_16x16x32_bf16 v[236:239], v[40:43], a[160:163], v[236:239]
    ds_read_b64_tr_b16 v[36:37], v76 offset:9280
    v_mul_f32 v148, v148, v132
    v_mfma_f32_16x16x32_bf16 v[236:239], v[44:47], a[176:179], v[236:239]
    s_waitcnt lgkmcnt(3)
    ds_read_b64_tr_b16 v[38:39], v76 offset:13888
    v_mfma_f32_16x16x32_bf16 v[80:83], v[16:19], a[224:227], 0
    ds_read_b64_tr_b16 v[40:41], v76 offset:18496
    v_mul_f32 v155, v139, v155
    v_mfma_f32_16x16x32_bf16 v[80:83], v[20:23], a[240:243], v[80:83]
    ds_read_b64_tr_b16 v[42:43], v76 offset:23104
    v_mul_f32 v136, s54, v136
    v_mfma_f32_16x16x32_bf16 v[80:83], v[24:27], a[148:151], v[80:83]
    ds_read_b64_tr_b16 v[44:45], v76 offset:27712
    v_mul_f32 v137, s54, v137
    v_mfma_f32_16x16x32_bf16 v[80:83], v[28:31], a[164:167], v[80:83]
    ds_read_b64_tr_b16 v[46:47], v76 offset:32320
    v_mul_f32 v138, s54, v138
    v_mfma_f32_16x16x32_bf16 v[84:87], v[16:19], a[228:231], 0
    buffer_load_dwordx4 v65, s[16:19], s47 offen lds
    v_mfma_f32_16x16x32_bf16 v[84:87], v[20:23], a[244:247], v[84:87]
    buffer_load_dwordx4 a[4:7], v1, s[36:39], s49 offen offset:1024 sc1
    v_mfma_f32_16x16x32_bf16 v[84:87], v[24:27], a[152:155], v[84:87]
    v_rcp_f32 v133, v133
    v_mfma_f32_16x16x32_bf16 v[84:87], v[28:31], a[168:171], v[84:87]
    v_rcp_f32 v134, v134
    v_mfma_f32_16x16x32_bf16 v[88:91], v[16:19], a[232:235], 0
    s_add_u32 m0, s46, 2048
    v_rcp_f32 v135, v135
    v_mfma_f32_16x16x32_bf16 v[88:91], v[20:23], a[248:251], v[88:91]
    buffer_load_dwordx4 v66, s[16:19], s47 offen lds
    v_mfma_f32_16x16x32_bf16 v[88:91], v[24:27], a[156:159], v[88:91]
    v_exp_f32 v136, v136
    v_mfma_f32_16x16x32_bf16 v[88:91], v[28:31], a[172:175], v[88:91]
    v_exp_f32 v137, v137
    v_mfma_f32_16x16x32_bf16 v[92:95], v[16:19], a[236:239], 0
    ds_read_b64_tr_b16 v[16:17], v76 offset:96
    v_mul_f32 v149, v149, v133
    v_mfma_f32_16x16x32_bf16 v[92:95], v[20:23], a[252:255], v[92:95]
    ds_read_b64_tr_b16 v[18:19], v76 offset:4704
    v_mul_f32 v150, v150, v134
    v_mfma_f32_16x16x32_bf16 v[92:95], v[24:27], a[160:163], v[92:95]
    ds_read_b64_tr_b16 v[20:21], v76 offset:9312
    v_mul_f32 v151, v151, v135
    v_mfma_f32_16x16x32_bf16 v[92:95], v[28:31], a[176:179], v[92:95]
    s_waitcnt lgkmcnt(3)
    ds_read_b64_tr_b16 v[22:23], v76 offset:13920
    v_mfma_f32_16x16x32_bf16 a[64:67], v[32:35], a[224:227], 0
    ds_read_b64_tr_b16 v[24:25], v76 offset:18528
    v_cvt_pk_bf16_f32 v52, v148, v149
    v_mfma_f32_16x16x32_bf16 a[64:67], v[36:39], a[240:243], a[64:67]
    ds_read_b64_tr_b16 v[26:27], v76 offset:23136
    v_cvt_pk_bf16_f32 v53, v150, v151
    v_mfma_f32_16x16x32_bf16 a[64:67], v[40:43], a[148:151], a[64:67]
    ds_read_b64_tr_b16 v[28:29], v76 offset:27744
    v_mul_f32 v139, s54, v139
    v_mfma_f32_16x16x32_bf16 a[64:67], v[44:47], a[164:167], a[64:67]
    ds_read_b64_tr_b16 v[30:31], v76 offset:32352
    v_add_f32 v136, 1.0, v136
    v_mfma_f32_16x16x32_bf16 a[68:71], v[32:35], a[228:231], 0
    buffer_load_dwordx4 a[8:11], v1, s[36:39], s49 offen offset:2048 sc1
    v_mfma_f32_16x16x32_bf16 a[68:71], v[36:39], a[244:247], a[68:71]
    s_add_u32 m0, s46, 3072
    v_exp_f32 v138, v138
    v_mfma_f32_16x16x32_bf16 a[68:71], v[40:43], a[152:155], a[68:71]
    buffer_load_dwordx4 v67, s[16:19], s47 offen lds
    v_mfma_f32_16x16x32_bf16 a[68:71], v[44:47], a[168:171], a[68:71]
    v_exp_f32 v139, v139
    v_mfma_f32_16x16x32_bf16 a[72:75], v[32:35], a[232:235], 0
    v_rcp_f32 v136, v136
    v_mfma_f32_16x16x32_bf16 a[72:75], v[36:39], a[248:251], a[72:75]
    buffer_load_dwordx4 a[12:15], v1, s[36:39], s49 offen offset:3072 sc1
    v_mfma_f32_16x16x32_bf16 a[72:75], v[40:43], a[156:159], a[72:75]
    v_add_f32 v137, 1.0, v137
    v_add_f32 v138, 1.0, v138
    v_mfma_f32_16x16x32_bf16 a[72:75], v[44:47], a[172:175], a[72:75]
    s_add_u32 m0, s46, 4096
    v_rcp_f32 v137, v137
    v_mfma_f32_16x16x32_bf16 a[76:79], v[32:35], a[236:239], 0
    ds_read_b64_tr_b16 v[32:33], v76 offset:128
    v_add_f32 v139, 1.0, v139
    v_mfma_f32_16x16x32_bf16 a[76:79], v[36:39], a[252:255], a[76:79]
    ds_read_b64_tr_b16 v[34:35], v76 offset:4736
    v_mul_f32 v152, v152, v136
    v_mfma_f32_16x16x32_bf16 a[76:79], v[40:43], a[160:163], a[76:79]
    s_add_u32 s52, s52, 4096
    ds_read_b64_tr_b16 v[36:37], v76 offset:9344
    v_mfma_f32_16x16x32_bf16 a[76:79], v[44:47], a[176:179], a[76:79]
    s_waitcnt lgkmcnt(3)
    ds_read_b64_tr_b16 v[38:39], v76 offset:13952
    v_mfma_f32_16x16x32_bf16 a[80:83], v[16:19], a[224:227], 0
    ds_read_b64_tr_b16 v[40:41], v76 offset:18560
    v_mul_f32 v153, v153, v137
    v_mfma_f32_16x16x32_bf16 a[80:83], v[20:23], a[240:243], a[80:83]
    ds_read_b64_tr_b16 v[42:43], v76 offset:23168
    v_cvt_pk_bf16_f32 v56, v152, v153
    v_mfma_f32_16x16x32_bf16 a[80:83], v[24:27], a[148:151], a[80:83]
    ds_read_b64_tr_b16 v[44:45], v76 offset:27776
    v_mul_f32 v156, v140, v156
    v_mfma_f32_16x16x32_bf16 a[80:83], v[28:31], a[164:167], a[80:83]
    ds_read_b64_tr_b16 v[46:47], v76 offset:32384
    v_mul_f32 v157, v141, v157
    v_mfma_f32_16x16x32_bf16 a[84:87], v[16:19], a[228:231], 0
    buffer_load_dwordx4 v68, s[16:19], s47 offen lds
    v_mfma_f32_16x16x32_bf16 a[84:87], v[20:23], a[244:247], a[84:87]
    s_add_u32 s49, s13, 4096
    v_rcp_f32 v138, v138
    v_mfma_f32_16x16x32_bf16 a[84:87], v[24:27], a[152:155], a[84:87]
    buffer_load_dwordx4 a[16:19], v1, s[36:39], s49 offen offset:0 sc1
    v_mfma_f32_16x16x32_bf16 a[84:87], v[28:31], a[168:171], a[84:87]
    v_rcp_f32 v139, v139
    v_mfma_f32_16x16x32_bf16 a[88:91], v[16:19], a[232:235], 0
    v_mul_f32 v154, v154, v138
    v_mul_f32 v155, v155, v139
    v_mfma_f32_16x16x32_bf16 a[88:91], v[20:23], a[248:251], a[88:91]
    s_add_u32 m0, s46, 5120
    v_cvt_pk_bf16_f32 v57, v154, v155
    v_mul_f32 v158, v142, v158
    v_mfma_f32_16x16x32_bf16 a[88:91], v[24:27], a[156:159], a[88:91]
    buffer_load_dwordx4 v69, s[16:19], s47 offen lds
    v_mfma_f32_16x16x32_bf16 a[88:91], v[28:31], a[172:175], a[88:91]
    v_mul_f32 v159, v143, v159
    v_mul_f32 v140, s54, v140
    v_mfma_f32_16x16x32_bf16 a[92:95], v[16:19], a[236:239], 0
    ds_read_b64_tr_b16 v[16:17], v76 offset:160
    v_mul_f32 v141, s54, v141
    v_mfma_f32_16x16x32_bf16 a[92:95], v[20:23], a[252:255], a[92:95]
    ds_read_b64_tr_b16 v[18:19], v76 offset:4768
    v_mul_f32 v142, s54, v142
    v_mfma_f32_16x16x32_bf16 a[92:95], v[24:27], a[160:163], a[92:95]
    ds_read_b64_tr_b16 v[20:21], v76 offset:9376
    v_mul_f32 v143, s54, v143
    v_mfma_f32_16x16x32_bf16 a[92:95], v[28:31], a[176:179], a[92:95]
    s_waitcnt lgkmcnt(3)
    ds_read_b64_tr_b16 v[22:23], v76 offset:13984
    v_mfma_f32_16x16x32_bf16 a[96:99], v[32:35], a[224:227], 0
    ds_read_b64_tr_b16 v[24:25], v76 offset:18592
    v_mul_f32 v176, v160, v176
    v_mfma_f32_16x16x32_bf16 a[96:99], v[36:39], a[240:243], a[96:99]
    ds_read_b64_tr_b16 v[26:27], v76 offset:23200
    v_mul_f32 v177, v161, v177
    v_mfma_f32_16x16x32_bf16 a[96:99], v[40:43], a[148:151], a[96:99]
    ds_read_b64_tr_b16 v[28:29], v76 offset:27808
    v_mul_f32 v178, v162, v178
    v_mfma_f32_16x16x32_bf16 a[96:99], v[44:47], a[164:167], a[96:99]
    ds_read_b64_tr_b16 v[30:31], v76 offset:32416
    v_mul_f32 v179, v163, v179
    v_mfma_f32_16x16x32_bf16 a[100:103], v[32:35], a[228:231], 0
    buffer_load_dwordx4 a[20:23], v1, s[36:39], s49 offen offset:1024 sc1
    v_mfma_f32_16x16x32_bf16 a[100:103], v[36:39], a[244:247], a[100:103]
    s_add_u32 m0, s46, 6144
    v_exp_f32 v140, v140
    v_mfma_f32_16x16x32_bf16 a[100:103], v[40:43], a[152:155], a[100:103]
    buffer_load_dwordx4 v70, s[16:19], s47 offen lds
    v_mfma_f32_16x16x32_bf16 a[100:103], v[44:47], a[168:171], a[100:103]
    v_exp_f32 v141, v141
    v_mfma_f32_16x16x32_bf16 a[104:107], v[32:35], a[232:235], 0
    v_exp_f32 v142, v142
    v_mfma_f32_16x16x32_bf16 a[104:107], v[36:39], a[248:251], a[104:107]
    v_exp_f32 v143, v143
    v_mfma_f32_16x16x32_bf16 a[104:107], v[40:43], a[156:159], a[104:107]
    buffer_load_dwordx4 a[24:27], v1, s[36:39], s49 offen offset:2048 sc1
    v_mfma_f32_16x16x32_bf16 a[104:107], v[44:47], a[172:175], a[104:107]
    s_add_u32 m0, s46, 7168
    v_add_f32 v140, 1.0, v140
    v_add_f32 v141, 1.0, v141
    v_mfma_f32_16x16x32_bf16 a[108:111], v[32:35], a[236:239], 0
    ds_read_b64_tr_b16 v[32:33], v76 offset:192
    v_add_f32 v142, 1.0, v142
    v_mfma_f32_16x16x32_bf16 a[108:111], v[36:39], a[252:255], a[108:111]
    ds_read_b64_tr_b16 v[34:35], v76 offset:4800
    v_add_f32 v143, 1.0, v143
    v_mfma_f32_16x16x32_bf16 a[108:111], v[40:43], a[160:163], a[108:111]
    ds_read_b64_tr_b16 v[36:37], v76 offset:9408
    v_mul_f32 v160, s54, v160
    v_mfma_f32_16x16x32_bf16 a[108:111], v[44:47], a[176:179], a[108:111]
    s_waitcnt lgkmcnt(3)
    ds_read_b64_tr_b16 v[38:39], v76 offset:14016
    v_mfma_f32_16x16x32_bf16 a[112:115], v[16:19], a[224:227], 0
    ds_read_b64_tr_b16 v[40:41], v76 offset:18624
    v_mul_f32 v161, s54, v161
    v_mfma_f32_16x16x32_bf16 a[112:115], v[20:23], a[240:243], a[112:115]
    ds_read_b64_tr_b16 v[42:43], v76 offset:23232
    v_mul_f32 v162, s54, v162
    v_mfma_f32_16x16x32_bf16 a[112:115], v[24:27], a[148:151], a[112:115]
    ds_read_b64_tr_b16 v[44:45], v76 offset:27840
    v_mul_f32 v163, s54, v163
    v_mfma_f32_16x16x32_bf16 a[112:115], v[28:31], a[164:167], a[112:115]
    ds_read_b64_tr_b16 v[46:47], v76 offset:32448
    v_mul_f32 v180, v164, v180
    v_mfma_f32_16x16x32_bf16 a[116:119], v[16:19], a[228:231], 0
    buffer_load_dwordx4 v71, s[16:19], s47 offen lds
    v_mfma_f32_16x16x32_bf16 a[116:119], v[20:23], a[244:247], a[116:119]
    buffer_load_dwordx4 a[28:31], v1, s[36:39], s49 offen offset:3072 sc1
    v_mfma_f32_16x16x32_bf16 a[116:119], v[24:27], a[152:155], a[116:119]
    v_rcp_f32 v140, v140
    v_mfma_f32_16x16x32_bf16 a[116:119], v[28:31], a[168:171], a[116:119]
    v_rcp_f32 v141, v141
    v_mfma_f32_16x16x32_bf16 a[120:123], v[16:19], a[232:235], 0
    v_rcp_f32 v142, v142
    v_mfma_f32_16x16x32_bf16 a[120:123], v[20:23], a[248:251], a[120:123]
    s_add_u32 m0, s46, 8192
    v_rcp_f32 v143, v143
    v_mfma_f32_16x16x32_bf16 a[120:123], v[24:27], a[156:159], a[120:123]
    buffer_load_dwordx4 v72, s[16:19], s47 offen lds
    v_mfma_f32_16x16x32_bf16 a[120:123], v[28:31], a[172:175], a[120:123]
    s_add_u32 s49, s13, 8192
    v_exp_f32 v160, v160
    v_mfma_f32_16x16x32_bf16 a[124:127], v[16:19], a[236:239], 0
    ds_read_b64_tr_b16 v[16:17], v76 offset:224
    v_mul_f32 v156, v156, v140
    v_mfma_f32_16x16x32_bf16 a[124:127], v[20:23], a[252:255], a[124:127]
    ds_read_b64_tr_b16 v[18:19], v76 offset:4832
    v_mul_f32 v157, v157, v141
    v_mfma_f32_16x16x32_bf16 a[124:127], v[24:27], a[160:163], a[124:127]
    ds_read_b64_tr_b16 v[20:21], v76 offset:9440
    v_mul_f32 v158, v158, v142
    v_mfma_f32_16x16x32_bf16 a[124:127], v[28:31], a[176:179], a[124:127]
    s_waitcnt lgkmcnt(3)
    ds_read_b64_tr_b16 v[22:23], v76 offset:14048
    v_mfma_f32_16x16x32_bf16 v[240:243], v[32:35], a[224:227], 0
    ds_read_b64_tr_b16 v[24:25], v76 offset:18656
    v_mul_f32 v159, v159, v143
    v_mfma_f32_16x16x32_bf16 v[240:243], v[36:39], a[240:243], v[240:243]
    ds_read_b64_tr_b16 v[26:27], v76 offset:23264
    v_cvt_pk_bf16_f32 v60, v156, v157
    v_mfma_f32_16x16x32_bf16 v[240:243], v[40:43], a[148:151], v[240:243]
    ds_read_b64_tr_b16 v[28:29], v76 offset:27872
    v_cvt_pk_bf16_f32 v61, v158, v159
    v_mfma_f32_16x16x32_bf16 v[240:243], v[44:47], a[164:167], v[240:243]
    ds_read_b64_tr_b16 v[30:31], v76 offset:32480
    v_add_f32 v160, 1.0, v160
    v_mfma_f32_16x16x32_bf16 v[244:247], v[32:35], a[228:231], 0
    buffer_load_dwordx4 a[32:35], v1, s[36:39], s49 offen offset:0 sc1
    v_mfma_f32_16x16x32_bf16 v[244:247], v[36:39], a[244:247], v[244:247]
    buffer_load_dwordx4 a[36:39], v1, s[36:39], s49 offen offset:1024 sc1
    v_mfma_f32_16x16x32_bf16 v[244:247], v[40:43], a[152:155], v[244:247]
    v_exp_f32 v161, v161
    v_mfma_f32_16x16x32_bf16 v[244:247], v[44:47], a[168:171], v[244:247]
    v_exp_f32 v162, v162
    v_mfma_f32_16x16x32_bf16 v[248:251], v[32:35], a[232:235], 0
    v_exp_f32 v163, v163
    v_mfma_f32_16x16x32_bf16 v[248:251], v[36:39], a[248:251], v[248:251]
    v_rcp_f32 v160, v160
    v_mfma_f32_16x16x32_bf16 v[248:251], v[40:43], a[156:159], v[248:251]
    buffer_load_dwordx4 a[40:43], v1, s[36:39], s49 offen offset:2048 sc1
    v_mfma_f32_16x16x32_bf16 v[248:251], v[44:47], a[172:175], v[248:251]
    v_add_f32 v161, 1.0, v161
    v_add_f32 v162, 1.0, v162
    v_mfma_f32_16x16x32_bf16 v[252:255], v[32:35], a[236:239], 0
    ds_read_b64_tr_b16 v[32:33], v76 offset:256
    v_add_f32 v163, 1.0, v163
    v_mfma_f32_16x16x32_bf16 v[252:255], v[36:39], a[252:255], v[252:255]
    ds_read_b64_tr_b16 v[34:35], v76 offset:4864
    v_mul_f32 v176, v176, v160
    v_mfma_f32_16x16x32_bf16 v[252:255], v[40:43], a[160:163], v[252:255]
    ds_read_b64_tr_b16 v[36:37], v76 offset:9472
    v_mul_f32 v181, v165, v181
    v_mfma_f32_16x16x32_bf16 v[252:255], v[44:47], a[176:179], v[252:255]
    s_waitcnt lgkmcnt(3)
    ds_read_b64_tr_b16 v[38:39], v76 offset:14080
    v_mfma_f32_16x16x32_bf16 v[96:99], v[16:19], a[224:227], 0
    ds_read_b64_tr_b16 v[40:41], v76 offset:18688
    v_mul_f32 v182, v166, v182
    v_mfma_f32_16x16x32_bf16 v[96:99], v[20:23], a[240:243], v[96:99]
    ds_read_b64_tr_b16 v[42:43], v76 offset:23296
    v_mul_f32 v183, v167, v183
    v_mfma_f32_16x16x32_bf16 v[96:99], v[24:27], a[148:151], v[96:99]
    ds_read_b64_tr_b16 v[44:45], v76 offset:27904
    v_mul_f32 v164, s54, v164
    v_mfma_f32_16x16x32_bf16 v[96:99], v[28:31], a[164:167], v[96:99]
    ds_read_b64_tr_b16 v[46:47], v76 offset:32512
    v_mul_f32 v165, s54, v165
    v_mfma_f32_16x16x32_bf16 v[100:103], v[16:19], a[228:231], 0
    buffer_load_dwordx4 a[44:47], v1, s[36:39], s49 offen offset:3072 sc1
    v_mfma_f32_16x16x32_bf16 v[100:103], v[20:23], a[244:247], v[100:103]
    s_add_u32 s49, s13, 12288
    v_rcp_f32 v161, v161
    v_mfma_f32_16x16x32_bf16 v[100:103], v[24:27], a[152:155], v[100:103]
    buffer_load_dwordx4 a[48:51], v1, s[36:39], s49 offen offset:0 sc1
    v_mfma_f32_16x16x32_bf16 v[100:103], v[28:31], a[168:171], v[100:103]
    v_rcp_f32 v162, v162
    v_mfma_f32_16x16x32_bf16 v[104:107], v[16:19], a[232:235], 0
    s_add_u32 s87, s96, s86
    v_mov_b32 v14, 0x100
    v_mul_f32 v177, v177, v161
    v_mfma_f32_16x16x32_bf16 v[104:107], v[20:23], a[248:251], v[104:107]
    v_rcp_f32 v163, v163
    v_mfma_f32_16x16x32_bf16 v[104:107], v[24:27], a[156:159], v[104:107]
    buffer_load_dwordx4 a[52:55], v1, s[36:39], s49 offen offset:1024 sc1
    v_mfma_f32_16x16x32_bf16 v[104:107], v[28:31], a[172:175], v[104:107]
    v_exp_f32 v164, v164
    v_mfma_f32_16x16x32_bf16 v[108:111], v[16:19], a[236:239], 0
    v_exp_f32 v165, v165
    v_mfma_f32_16x16x32_bf16 v[108:111], v[20:23], a[252:255], v[108:111]
    v_mul_f32 v178, v178, v162
    v_mul_f32 v179, v179, v163
    v_mfma_f32_16x16x32_bf16 v[108:111], v[24:27], a[160:163], v[108:111]
    v_cvt_pk_bf16_f32 v50, v176, v177
    v_cvt_pk_bf16_f32 v51, v178, v179
    v_mfma_f32_16x16x32_bf16 v[108:111], v[28:31], a[176:179], v[108:111]
    s_waitcnt lgkmcnt(0)
    v_mul_f32 v166, s54, v166
    v_mul_f32 v167, s54, v167
    v_mfma_f32_16x16x32_bf16 v[112:115], v[32:35], a[224:227], 0
    s_waitcnt vmcnt(27)
    s_barrier
    v_add_f32 v164, 1.0, v164
    v_mfma_f32_16x16x32_bf16 v[112:115], v[36:39], a[240:243], v[112:115]
    ds_read_b64_tr_b16 v[16:17], v77 offset:0
    v_add_f32 v165, 1.0, v165
    v_mfma_f32_16x16x32_bf16 v[112:115], v[40:43], a[148:151], v[112:115]
    ds_read_b64_tr_b16 v[18:19], v77 offset:4608
    v_mul_f32 v184, v168, v184
    v_mfma_f32_16x16x32_bf16 v[112:115], v[44:47], a[164:167], v[112:115]
    ds_read_b64_tr_b16 v[20:21], v77 offset:9216
    v_mul_f32 v185, v169, v185
    v_mfma_f32_16x16x32_bf16 v[116:119], v[32:35], a[228:231], 0
    ds_read_b64_tr_b16 v[22:23], v77 offset:13824
    v_mul_f32 v186, v170, v186
    v_mfma_f32_16x16x32_bf16 v[116:119], v[36:39], a[244:247], v[116:119]
    ds_read_b64_tr_b16 v[24:25], v77 offset:18432
    v_mul_f32 v187, v171, v187
    v_mfma_f32_16x16x32_bf16 v[116:119], v[40:43], a[152:155], v[116:119]
    ds_read_b64_tr_b16 v[26:27], v77 offset:23040
    v_mul_f32 v168, s54, v168
    v_mfma_f32_16x16x32_bf16 v[116:119], v[44:47], a[168:171], v[116:119]
    ds_read_b64_tr_b16 v[28:29], v77 offset:27648
    v_mul_f32 v169, s54, v169
    v_mfma_f32_16x16x32_bf16 v[120:123], v[32:35], a[232:235], 0
    ds_read_b64_tr_b16 v[30:31], v77 offset:32256
    v_mul_f32 v170, s54, v170
    v_mfma_f32_16x16x32_bf16 v[120:123], v[36:39], a[248:251], v[120:123]
    buffer_atomic_add v14, v6, s[60:63], s87 offen
    v_mfma_f32_16x16x32_bf16 v[120:123], v[40:43], a[156:159], v[120:123]
    buffer_load_dwordx4 a[56:59], v1, s[36:39], s49 offen offset:2048 sc1
    v_mfma_f32_16x16x32_bf16 v[120:123], v[44:47], a[172:175], v[120:123]
    buffer_load_dwordx4 a[60:63], v1, s[36:39], s49 offen offset:3072 sc1
    v_mfma_f32_16x16x32_bf16 v[124:127], v[32:35], a[236:239], 0
    ds_read_b64_tr_b16 v[32:33], v77 offset:32
    v_mul_f32 v171, s54, v171
    v_mfma_f32_16x16x32_bf16 v[124:127], v[36:39], a[252:255], v[124:127]
    ds_read_b64_tr_b16 v[34:35], v77 offset:4640
    v_mul_f32 v188, v172, v188
    v_mfma_f32_16x16x32_bf16 v[124:127], v[40:43], a[160:163], v[124:127]
    ds_read_b64_tr_b16 v[36:37], v77 offset:9248
    v_mul_f32 v189, v173, v189
    v_mfma_f32_16x16x32_bf16 v[124:127], v[44:47], a[176:179], v[124:127]
    s_waitcnt vmcnt(25) lgkmcnt(3)
    ds_read_b64_tr_b16 v[38:39], v77 offset:13856
    v_mfma_f32_16x16x32_bf16 v[224:227], v[16:19], a[212:215], v[224:227]
    ds_read_b64_tr_b16 v[40:41], v77 offset:18464
    v_mul_f32 v190, v174, v190
    v_mfma_f32_16x16x32_bf16 v[224:227], v[20:23], a[132:135], v[224:227]
    ds_read_b64_tr_b16 v[42:43], v77 offset:23072
    v_mul_f32 v191, v175, v191
    v_mfma_f32_16x16x32_bf16 v[224:227], v[24:27], a[180:183], v[224:227]
    ds_read_b64_tr_b16 v[44:45], v77 offset:27680
    v_mul_f32 v172, s54, v172
    v_mfma_f32_16x16x32_bf16 v[224:227], v[28:31], a[196:199], v[224:227]
    ds_read_b64_tr_b16 v[46:47], v77 offset:32288
    v_mul_f32 v173, s54, v173
    v_mfma_f32_16x16x32_bf16 v[228:231], v[16:19], a[216:219], v[228:231]
    s_add_u32 m0, s46, 73728
    v_exp_f32 v166, v166
    v_mfma_f32_16x16x32_bf16 v[228:231], v[20:23], a[136:139], v[228:231]
    s_add_u32 s47, s55, 147456
    v_exp_f32 v167, v167
    v_mfma_f32_16x16x32_bf16 v[228:231], v[24:27], a[184:187], v[228:231]
    buffer_load_dwordx4 v64, s[16:19], s47 offen lds
    v_mfma_f32_16x16x32_bf16 v[228:231], v[28:31], a[200:203], v[228:231]
    s_add_u32 s49, s13, 16384
    v_rcp_f32 v164, v164
    v_mfma_f32_16x16x32_bf16 v[232:235], v[16:19], a[220:223], v[232:235]
    buffer_load_dwordx4 a[224:227], v1, s[36:39], s49 offen offset:0 sc1
    v_mfma_f32_16x16x32_bf16 v[232:235], v[20:23], a[140:143], v[232:235]
    s_add_u32 m0, s46, 74752
    v_rcp_f32 v165, v165
    v_mfma_f32_16x16x32_bf16 v[232:235], v[24:27], a[188:191], v[232:235]
    buffer_load_dwordx4 v65, s[16:19], s47 offen lds
    v_mfma_f32_16x16x32_bf16 v[232:235], v[28:31], a[204:207], v[232:235]
    global_load_dword v79, v[4:5], off
    v_mfma_f32_16x16x32_bf16 v[236:239], v[16:19], a[128:131], v[236:239]
    ds_read_b64_tr_b16 v[16:17], v77 offset:64
    v_add_f32 v166, 1.0, v166
    v_mfma_f32_16x16x32_bf16 v[236:239], v[20:23], a[144:147], v[236:239]
    ds_read_b64_tr_b16 v[18:19], v77 offset:4672
    v_add_f32 v167, 1.0, v167
    v_mfma_f32_16x16x32_bf16 v[236:239], v[24:27], a[192:195], v[236:239]
    ds_read_b64_tr_b16 v[20:21], v77 offset:9280
    v_mul_f32 v180, v180, v164
    v_mfma_f32_16x16x32_bf16 v[236:239], v[28:31], a[208:211], v[236:239]
    s_waitcnt lgkmcnt(3)
    ds_read_b64_tr_b16 v[22:23], v77 offset:13888
    v_mfma_f32_16x16x32_bf16 v[80:83], v[32:35], a[212:215], v[80:83]
    ds_read_b64_tr_b16 v[24:25], v77 offset:18496
    v_mul_f32 v181, v181, v165
    v_mfma_f32_16x16x32_bf16 v[80:83], v[36:39], a[132:135], v[80:83]
    ds_read_b64_tr_b16 v[26:27], v77 offset:23104
    v_cvt_pk_bf16_f32 v54, v180, v181
    v_mfma_f32_16x16x32_bf16 v[80:83], v[40:43], a[180:183], v[80:83]
    ds_read_b64_tr_b16 v[28:29], v77 offset:27712
    v_mul_f32 v174, s54, v174
    v_mfma_f32_16x16x32_bf16 v[80:83], v[44:47], a[196:199], v[80:83]
    ds_read_b64_tr_b16 v[30:31], v77 offset:32320
    v_mul_f32 v175, s54, v175
    v_mfma_f32_16x16x32_bf16 v[84:87], v[32:35], a[216:219], v[84:87]
    buffer_load_dwordx4 a[228:231], v1, s[36:39], s49 offen offset:1024 sc1
    v_mfma_f32_16x16x32_bf16 v[84:87], v[36:39], a[136:139], v[84:87]
    s_add_u32 m0, s46, 75776
    v_rcp_f32 v166, v166
    v_mfma_f32_16x16x32_bf16 v[84:87], v[40:43], a[184:187], v[84:87]
    buffer_load_dwordx4 v66, s[16:19], s47 offen lds
    v_mfma_f32_16x16x32_bf16 v[84:87], v[44:47], a[200:203], v[84:87]
    buffer_store_dwordx4 v[48:51], v1, s[36:39], s52 offen offset:0 sc1
    v_mfma_f32_16x16x32_bf16 v[88:91], v[32:35], a[220:223], v[88:91]
    v_rcp_f32 v167, v167
    v_mfma_f32_16x16x32_bf16 v[88:91], v[36:39], a[140:143], v[88:91]
    v_exp_f32 v168, v168
    v_mfma_f32_16x16x32_bf16 v[88:91], v[40:43], a[188:191], v[88:91]
    v_exp_f32 v169, v169
    v_mfma_f32_16x16x32_bf16 v[88:91], v[44:47], a[204:207], v[88:91]
    buffer_load_dwordx4 a[232:235], v1, s[36:39], s49 offen offset:2048 sc1
    v_mfma_f32_16x16x32_bf16 v[92:95], v[32:35], a[128:131], v[92:95]
    ds_read_b64_tr_b16 v[32:33], v77 offset:96
    v_mul_f32 v182, v182, v166
    v_mfma_f32_16x16x32_bf16 v[92:95], v[36:39], a[144:147], v[92:95]
    ds_read_b64_tr_b16 v[34:35], v77 offset:4704
    v_mul_f32 v183, v183, v167
    v_mfma_f32_16x16x32_bf16 v[92:95], v[40:43], a[192:195], v[92:95]
    ds_read_b64_tr_b16 v[36:37], v77 offset:9312
    v_cvt_pk_bf16_f32 v55, v182, v183
    v_mfma_f32_16x16x32_bf16 v[92:95], v[44:47], a[208:211], v[92:95]
    s_waitcnt lgkmcnt(3)
    ds_read_b64_tr_b16 v[38:39], v77 offset:13920
    v_mfma_f32_16x16x32_bf16 a[64:67], v[16:19], a[212:215], a[64:67]
    ds_read_b64_tr_b16 v[40:41], v77 offset:18528
    v_add_f32 v168, 1.0, v168
    v_mfma_f32_16x16x32_bf16 a[64:67], v[20:23], a[132:135], a[64:67]
    ds_read_b64_tr_b16 v[42:43], v77 offset:23136
    v_add_f32 v169, 1.0, v169
    v_mfma_f32_16x16x32_bf16 a[64:67], v[24:27], a[180:183], a[64:67]
    ds_read_b64_tr_b16 v[44:45], v77 offset:27744
    v_mul_f32 v208, v192, v208
    v_mfma_f32_16x16x32_bf16 a[64:67], v[28:31], a[196:199], a[64:67]
    ds_read_b64_tr_b16 v[46:47], v77 offset:32352
    v_mul_f32 v209, v193, v209
    v_mfma_f32_16x16x32_bf16 a[68:71], v[16:19], a[216:219], a[68:71]
    s_add_u32 m0, s46, 76800
    v_exp_f32 v170, v170
    v_mfma_f32_16x16x32_bf16 a[68:71], v[20:23], a[136:139], a[68:71]
    buffer_load_dwordx4 v67, s[16:19], s47 offen lds
    v_mfma_f32_16x16x32_bf16 a[68:71], v[24:27], a[184:187], a[68:71]
    buffer_load_dwordx4 a[236:239], v1, s[36:39], s49 offen offset:3072 sc1
    v_mfma_f32_16x16x32_bf16 a[68:71], v[28:31], a[200:203], a[68:71]
    buffer_store_dwordx4 v[52:55], v1, s[36:39], s52 offen offset:1024 sc1
    v_mfma_f32_16x16x32_bf16 a[72:75], v[16:19], a[220:223], a[72:75]
    v_exp_f32 v171, v171
    v_mfma_f32_16x16x32_bf16 a[72:75], v[20:23], a[140:143], a[72:75]
    v_rcp_f32 v168, v168
    v_mfma_f32_16x16x32_bf16 a[72:75], v[24:27], a[188:191], a[72:75]
    s_add_u32 m0, s46, 77824
    v_rcp_f32 v169, v169
    v_mfma_f32_16x16x32_bf16 a[72:75], v[28:31], a[204:207], a[72:75]
    buffer_load_dwordx4 v68, s[16:19], s47 offen lds
    v_mfma_f32_16x16x32_bf16 a[76:79], v[16:19], a[128:131], a[76:79]
    ds_read_b64_tr_b16 v[16:17], v77 offset:128
    v_add_f32 v170, 1.0, v170
    v_mfma_f32_16x16x32_bf16 a[76:79], v[20:23], a[144:147], a[76:79]
    ds_read_b64_tr_b16 v[18:19], v77 offset:4736
    v_add_f32 v171, 1.0, v171
    v_mfma_f32_16x16x32_bf16 a[76:79], v[24:27], a[192:195], a[76:79]
    ds_read_b64_tr_b16 v[20:21], v77 offset:9344
    v_mul_f32 v184, v184, v168
    v_mfma_f32_16x16x32_bf16 a[76:79], v[28:31], a[208:211], a[76:79]
    s_waitcnt lgkmcnt(3)
    ds_read_b64_tr_b16 v[22:23], v77 offset:13952
    v_mfma_f32_16x16x32_bf16 a[80:83], v[32:35], a[212:215], a[80:83]
    ds_read_b64_tr_b16 v[24:25], v77 offset:18560
    v_mul_f32 v185, v185, v169
    v_mfma_f32_16x16x32_bf16 a[80:83], v[36:39], a[132:135], a[80:83]
    ds_read_b64_tr_b16 v[26:27], v77 offset:23168
    v_cvt_pk_bf16_f32 v58, v184, v185
    v_mfma_f32_16x16x32_bf16 a[80:83], v[40:43], a[180:183], a[80:83]
    ds_read_b64_tr_b16 v[28:29], v77 offset:27776
    v_mul_f32 v210, v194, v210
    v_mfma_f32_16x16x32_bf16 a[80:83], v[44:47], a[196:199], a[80:83]
    ds_read_b64_tr_b16 v[30:31], v77 offset:32384
    v_mul_f32 v211, v195, v211
    v_mfma_f32_16x16x32_bf16 a[84:87], v[32:35], a[216:219], a[84:87]
    s_add_u32 s49, s13, 20480
    v_rcp_f32 v170, v170
    v_mfma_f32_16x16x32_bf16 a[84:87], v[36:39], a[136:139], a[84:87]
    buffer_load_dwordx4 a[240:243], v1, s[36:39], s49 offen offset:0 sc1
    v_mfma_f32_16x16x32_bf16 a[84:87], v[40:43], a[184:187], a[84:87]
    s_add_u32 m0, s46, 78848
    v_rcp_f32 v171, v171
    v_mfma_f32_16x16x32_bf16 a[84:87], v[44:47], a[200:203], a[84:87]
    buffer_load_dwordx4 v69, s[16:19], s47 offen lds
    v_mfma_f32_16x16x32_bf16 a[88:91], v[32:35], a[220:223], a[88:91]
    v_exp_f32 v172, v172
    v_mfma_f32_16x16x32_bf16 a[88:91], v[36:39], a[140:143], a[88:91]
    v_exp_f32 v173, v173
    v_mfma_f32_16x16x32_bf16 a[88:91], v[40:43], a[188:191], a[88:91]
    v_exp_f32 v174, v174
    v_mfma_f32_16x16x32_bf16 a[88:91], v[44:47], a[204:207], a[88:91]
    buffer_load_dwordx4 a[244:247], v1, s[36:39], s49 offen offset:1024 sc1
    v_mfma_f32_16x16x32_bf16 a[92:95], v[32:35], a[128:131], a[92:95]
    ds_read_b64_tr_b16 v[32:33], v77 offset:160
    v_mul_f32 v186, v186, v170
    v_mfma_f32_16x16x32_bf16 a[92:95], v[36:39], a[144:147], a[92:95]
    ds_read_b64_tr_b16 v[34:35], v77 offset:4768
    v_mul_f32 v187, v187, v171
    v_mfma_f32_16x16x32_bf16 a[92:95], v[40:43], a[192:195], a[92:95]
    ds_read_b64_tr_b16 v[36:37], v77 offset:9376
    v_cvt_pk_bf16_f32 v59, v186, v187
    v_mfma_f32_16x16x32_bf16 a[92:95], v[44:47], a[208:211], a[92:95]
    s_waitcnt lgkmcnt(3)
    ds_read_b64_tr_b16 v[38:39], v77 offset:13984
    v_mfma_f32_16x16x32_bf16 a[96:99], v[16:19], a[212:215], a[96:99]
    ds_read_b64_tr_b16 v[40:41], v77 offset:18592
    v_add_f32 v172, 1.0, v172
    v_mfma_f32_16x16x32_bf16 a[96:99], v[20:23], a[132:135], a[96:99]
    ds_read_b64_tr_b16 v[42:43], v77 offset:23200
    v_add_f32 v173, 1.0, v173
    v_mfma_f32_16x16x32_bf16 a[96:99], v[24:27], a[180:183], a[96:99]
    ds_read_b64_tr_b16 v[44:45], v77 offset:27808
    v_add_f32 v174, 1.0, v174
    v_mfma_f32_16x16x32_bf16 a[96:99], v[28:31], a[196:199], a[96:99]
    ds_read_b64_tr_b16 v[46:47], v77 offset:32416
    v_mul_f32 v192, s54, v192
    v_mfma_f32_16x16x32_bf16 a[100:103], v[16:19], a[216:219], a[100:103]
    s_add_u32 m0, s46, 79872
    v_exp_f32 v175, v175
    v_mfma_f32_16x16x32_bf16 a[100:103], v[20:23], a[136:139], a[100:103]
    buffer_load_dwordx4 v70, s[16:19], s47 offen lds
    v_mfma_f32_16x16x32_bf16 a[100:103], v[24:27], a[184:187], a[100:103]
    buffer_load_dwordx4 a[248:251], v1, s[36:39], s49 offen offset:2048 sc1
    v_mfma_f32_16x16x32_bf16 a[100:103], v[28:31], a[200:203], a[100:103]
    buffer_store_dwordx4 v[56:59], v1, s[36:39], s52 offen offset:2048 sc1
    v_mfma_f32_16x16x32_bf16 a[104:107], v[16:19], a[220:223], a[104:107]
    v_rcp_f32 v172, v172
    v_mfma_f32_16x16x32_bf16 a[104:107], v[20:23], a[140:143], a[104:107]
    v_rcp_f32 v173, v173
    v_mfma_f32_16x16x32_bf16 a[104:107], v[24:27], a[188:191], a[104:107]
    s_add_u32 m0, s46, 80896
    v_rcp_f32 v174, v174
    v_mfma_f32_16x16x32_bf16 a[104:107], v[28:31], a[204:207], a[104:107]
    buffer_load_dwordx4 v71, s[16:19], s47 offen lds
    v_mfma_f32_16x16x32_bf16 a[108:111], v[16:19], a[128:131], a[108:111]
    ds_read_b64_tr_b16 v[16:17], v77 offset:192
    v_add_f32 v175, 1.0, v175
    v_mfma_f32_16x16x32_bf16 a[108:111], v[20:23], a[144:147], a[108:111]
    ds_read_b64_tr_b16 v[18:19], v77 offset:4800
    v_mul_f32 v188, v188, v172
    v_mfma_f32_16x16x32_bf16 a[108:111], v[24:27], a[192:195], a[108:111]
    ds_read_b64_tr_b16 v[20:21], v77 offset:9408
    v_mul_f32 v189, v189, v173
    v_mfma_f32_16x16x32_bf16 a[108:111], v[28:31], a[208:211], a[108:111]
    s_waitcnt lgkmcnt(3)
    ds_read_b64_tr_b16 v[22:23], v77 offset:14016
    v_mfma_f32_16x16x32_bf16 a[112:115], v[32:35], a[212:215], a[112:115]
    ds_read_b64_tr_b16 v[24:25], v77 offset:18624
    v_mul_f32 v190, v190, v174
    v_mfma_f32_16x16x32_bf16 a[112:115], v[36:39], a[132:135], a[112:115]
    ds_read_b64_tr_b16 v[26:27], v77 offset:23232
    v_cvt_pk_bf16_f32 v62, v188, v189
    v_mfma_f32_16x16x32_bf16 a[112:115], v[40:43], a[180:183], a[112:115]
    ds_read_b64_tr_b16 v[28:29], v77 offset:27840
    v_mul_f32 v193, s54, v193
    v_mfma_f32_16x16x32_bf16 a[112:115], v[44:47], a[196:199], a[112:115]
    ds_read_b64_tr_b16 v[30:31], v77 offset:32448
    v_mul_f32 v194, s54, v194
    v_mfma_f32_16x16x32_bf16 a[116:119], v[32:35], a[216:219], a[116:119]
    buffer_load_dwordx4 a[252:255], v1, s[36:39], s49 offen offset:3072 sc1
    v_mfma_f32_16x16x32_bf16 a[116:119], v[36:39], a[136:139], a[116:119]
    s_add_u32 m0, s46, 81920
    v_rcp_f32 v175, v175
    v_mfma_f32_16x16x32_bf16 a[116:119], v[40:43], a[184:187], a[116:119]
    buffer_load_dwordx4 v72, s[16:19], s47 offen lds
    v_mfma_f32_16x16x32_bf16 a[116:119], v[44:47], a[200:203], a[116:119]
    buffer_load_dword v78, v6, s[60:63], s96 offen sc1
    v_mfma_f32_16x16x32_bf16 a[120:123], v[32:35], a[220:223], a[120:123]
    v_exp_f32 v192, v192
    v_mfma_f32_16x16x32_bf16 a[120:123], v[36:39], a[140:143], a[120:123]
    v_exp_f32 v193, v193
    v_mfma_f32_16x16x32_bf16 a[120:123], v[40:43], a[188:191], a[120:123]
    s_add_u32 s49, s13, 24576
    v_exp_f32 v194, v194
    v_mfma_f32_16x16x32_bf16 a[120:123], v[44:47], a[204:207], a[120:123]
    buffer_load_dwordx4 a[148:151], v1, s[36:39], s49 offen offset:0 sc1
    v_mfma_f32_16x16x32_bf16 a[124:127], v[32:35], a[128:131], a[124:127]
    ds_read_b64_tr_b16 v[32:33], v77 offset:224
    v_mul_f32 v191, v191, v175
    v_mfma_f32_16x16x32_bf16 a[124:127], v[36:39], a[144:147], a[124:127]
    ds_read_b64_tr_b16 v[34:35], v77 offset:4832
    v_cvt_pk_bf16_f32 v63, v190, v191
    v_mfma_f32_16x16x32_bf16 a[124:127], v[40:43], a[192:195], a[124:127]
    ds_read_b64_tr_b16 v[36:37], v77 offset:9440
    v_mul_f32 v195, s54, v195
    v_mfma_f32_16x16x32_bf16 a[124:127], v[44:47], a[208:211], a[124:127]
    s_waitcnt lgkmcnt(3)
    ds_read_b64_tr_b16 v[38:39], v77 offset:14048
    v_mfma_f32_16x16x32_bf16 v[240:243], v[16:19], a[212:215], v[240:243]
    ds_read_b64_tr_b16 v[40:41], v77 offset:18656
    v_add_f32 v192, 1.0, v192
    v_mfma_f32_16x16x32_bf16 v[240:243], v[20:23], a[132:135], v[240:243]
    ds_read_b64_tr_b16 v[42:43], v77 offset:23264
    v_add_f32 v193, 1.0, v193
    v_mfma_f32_16x16x32_bf16 v[240:243], v[24:27], a[180:183], v[240:243]
    ds_read_b64_tr_b16 v[44:45], v77 offset:27872
    v_add_f32 v194, 1.0, v194
    v_mfma_f32_16x16x32_bf16 v[240:243], v[28:31], a[196:199], v[240:243]
    ds_read_b64_tr_b16 v[46:47], v77 offset:32480
    v_mul_f32 v212, v196, v212
    v_mfma_f32_16x16x32_bf16 v[244:247], v[16:19], a[216:219], v[244:247]
    buffer_load_dwordx4 a[152:155], v1, s[36:39], s49 offen offset:1024 sc1
    v_mfma_f32_16x16x32_bf16 v[244:247], v[20:23], a[136:139], v[244:247]
    buffer_store_dwordx4 v[60:63], v1, s[36:39], s52 offen offset:3072 sc1
    v_mfma_f32_16x16x32_bf16 v[244:247], v[24:27], a[184:187], v[244:247]
    buffer_load_dwordx4 a[156:159], v1, s[36:39], s49 offen offset:2048 sc1
    v_mfma_f32_16x16x32_bf16 v[244:247], v[28:31], a[200:203], v[244:247]
    v_exp_f32 v195, v195
    v_mfma_f32_16x16x32_bf16 v[248:251], v[16:19], a[220:223], v[248:251]
    v_rcp_f32 v192, v192
    v_mfma_f32_16x16x32_bf16 v[248:251], v[20:23], a[140:143], v[248:251]
    v_rcp_f32 v193, v193
    v_mfma_f32_16x16x32_bf16 v[248:251], v[24:27], a[188:191], v[248:251]
    v_rcp_f32 v194, v194
    v_mfma_f32_16x16x32_bf16 v[248:251], v[28:31], a[204:207], v[248:251]
    v_add_f32 v195, 1.0, v195
    v_mul_f32 v208, v208, v192
    v_mfma_f32_16x16x32_bf16 v[252:255], v[16:19], a[128:131], v[252:255]
    ds_read_b64_tr_b16 v[16:17], v77 offset:256
    v_mul_f32 v209, v209, v193
    v_mfma_f32_16x16x32_bf16 v[252:255], v[20:23], a[144:147], v[252:255]
    ds_read_b64_tr_b16 v[18:19], v77 offset:4864
    v_mul_f32 v210, v210, v194
    v_mfma_f32_16x16x32_bf16 v[252:255], v[24:27], a[192:195], v[252:255]
    ds_read_b64_tr_b16 v[20:21], v77 offset:9472
    v_cvt_pk_bf16_f32 v48, v208, v209
    v_mfma_f32_16x16x32_bf16 v[252:255], v[28:31], a[208:211], v[252:255]
    s_waitcnt lgkmcnt(3)
    ds_read_b64_tr_b16 v[22:23], v77 offset:14080
    v_mfma_f32_16x16x32_bf16 v[96:99], v[32:35], a[212:215], v[96:99]
    ds_read_b64_tr_b16 v[24:25], v77 offset:18688
    v_mul_f32 v213, v197, v213
    v_mfma_f32_16x16x32_bf16 v[96:99], v[36:39], a[132:135], v[96:99]
    ds_read_b64_tr_b16 v[26:27], v77 offset:23296
    v_mul_f32 v214, v198, v214
    v_mfma_f32_16x16x32_bf16 v[96:99], v[40:43], a[180:183], v[96:99]
    ds_read_b64_tr_b16 v[28:29], v77 offset:27904
    v_mul_f32 v215, v199, v215
    v_mfma_f32_16x16x32_bf16 v[96:99], v[44:47], a[196:199], v[96:99]
    ds_read_b64_tr_b16 v[30:31], v77 offset:32512
    v_mul_f32 v196, s54, v196
    v_mfma_f32_16x16x32_bf16 v[100:103], v[32:35], a[216:219], v[100:103]
    buffer_load_dwordx4 a[160:163], v1, s[36:39], s49 offen offset:3072 sc1
    v_mfma_f32_16x16x32_bf16 v[100:103], v[36:39], a[136:139], v[100:103]
    s_add_u32 s49, s13, 28672
    v_rcp_f32 v195, v195
    v_mfma_f32_16x16x32_bf16 v[100:103], v[40:43], a[184:187], v[100:103]
    buffer_load_dwordx4 a[164:167], v1, s[36:39], s49 offen offset:0 sc1
    v_mfma_f32_16x16x32_bf16 v[100:103], v[44:47], a[200:203], v[100:103]
    buffer_load_dwordx4 a[168:171], v1, s[36:39], s49 offen offset:1024 sc1
    v_mfma_f32_16x16x32_bf16 v[104:107], v[32:35], a[220:223], v[104:107]
    v_exp_f32 v196, v196
    v_mfma_f32_16x16x32_bf16 v[104:107], v[36:39], a[140:143], v[104:107]
    v_mul_f32 v211, v211, v195
    v_cvt_pk_bf16_f32 v49, v210, v211
    v_mfma_f32_16x16x32_bf16 v[104:107], v[40:43], a[188:191], v[104:107]
    buffer_store_dwordx2 v[48:49], v75, s[36:39], s53 offen offset:0 sc1
    v_mfma_f32_16x16x32_bf16 v[104:107], v[44:47], a[204:207], v[104:107]
    v_mul_f32 v197, s54, v197
    v_mul_f32 v198, s54, v198
    v_mfma_f32_16x16x32_bf16 v[108:111], v[32:35], a[128:131], v[108:111]
    buffer_load_dwordx4 a[172:175], v1, s[36:39], s49 offen offset:2048 sc1
    v_mfma_f32_16x16x32_bf16 v[108:111], v[36:39], a[144:147], v[108:111]
    v_exp_f32 v197, v197
    v_mfma_f32_16x16x32_bf16 v[108:111], v[40:43], a[192:195], v[108:111]
    v_exp_f32 v198, v198
    v_mfma_f32_16x16x32_bf16 v[108:111], v[44:47], a[208:211], v[108:111]
    s_waitcnt lgkmcnt(0)
    v_mul_f32 v199, s54, v199
    v_add_f32 v196, 1.0, v196
    v_mfma_f32_16x16x32_bf16 v[112:115], v[16:19], a[212:215], v[112:115]
    s_waitcnt vmcnt(38)
    s_barrier
    v_add_f32 v197, 1.0, v197
    v_mfma_f32_16x16x32_bf16 v[112:115], v[20:23], a[132:135], v[112:115]
    ds_read_b64_tr_b16 v[32:33], v73 offset:0
    v_add_f32 v198, 1.0, v198
    v_mfma_f32_16x16x32_bf16 v[112:115], v[24:27], a[180:183], v[112:115]
    ds_read_b64_tr_b16 v[34:35], v73 offset:4608
    v_mul_f32 v216, v200, v216
    v_mfma_f32_16x16x32_bf16 v[112:115], v[28:31], a[196:199], v[112:115]
    ds_read_b64_tr_b16 v[36:37], v73 offset:9216
    v_mul_f32 v217, v201, v217
    v_mfma_f32_16x16x32_bf16 v[116:119], v[16:19], a[216:219], v[116:119]
    ds_read_b64_tr_b16 v[38:39], v73 offset:13824
    v_mul_f32 v218, v202, v218
    v_mfma_f32_16x16x32_bf16 v[116:119], v[20:23], a[136:139], v[116:119]
    ds_read_b64_tr_b16 v[40:41], v73 offset:18432
    v_mul_f32 v219, v203, v219
    v_mfma_f32_16x16x32_bf16 v[116:119], v[24:27], a[184:187], v[116:119]
    ds_read_b64_tr_b16 v[42:43], v73 offset:23040
    v_mul_f32 v200, s54, v200
    v_mfma_f32_16x16x32_bf16 v[116:119], v[28:31], a[200:203], v[116:119]
    ds_read_b64_tr_b16 v[44:45], v73 offset:27648
    v_mul_f32 v201, s54, v201
    v_mfma_f32_16x16x32_bf16 v[120:123], v[16:19], a[220:223], v[120:123]
    ds_read_b64_tr_b16 v[46:47], v73 offset:32256
    v_mul_f32 v202, s54, v202
    v_mfma_f32_16x16x32_bf16 v[120:123], v[20:23], a[140:143], v[120:123]
    buffer_load_dwordx4 a[176:179], v1, s[36:39], s49 offen offset:3072 sc1
    v_mfma_f32_16x16x32_bf16 v[120:123], v[24:27], a[188:191], v[120:123]
    s_add_u32 m0, s46, 110592
    v_exp_f32 v199, v199
    v_mfma_f32_16x16x32_bf16 v[120:123], v[28:31], a[204:207], v[120:123]
    s_add_u32 s47, s14, 294912
    v_rcp_f32 v196, v196
    v_mfma_f32_16x16x32_bf16 v[124:127], v[16:19], a[128:131], v[124:127]
    s_waitcnt vmcnt(10)
    ds_read_b64_tr_b16 v[16:17], v73 offset:32
    v_mfma_f32_16x16x32_bf16 v[124:127], v[20:23], a[144:147], v[124:127]
    ds_read_b64_tr_b16 v[18:19], v73 offset:4640
    v_readfirstlane_b32 s3, v78
    v_mfma_f32_16x16x32_bf16 v[124:127], v[24:27], a[192:195], v[124:127]
    ds_read_b64_tr_b16 v[20:21], v73 offset:9248
    v_add_f32 v199, 1.0, v199
    v_mfma_f32_16x16x32_bf16 v[124:127], v[28:31], a[208:211], v[124:127]
    s_waitcnt vmcnt(31) lgkmcnt(3)
    ds_read_b64_tr_b16 v[22:23], v73 offset:13856
    v_mfma_f32_16x16x32_bf16 v[224:227], v[32:35], a[0:3], v[224:227]
    ds_read_b64_tr_b16 v[24:25], v73 offset:18464
    v_mul_f32 v212, v212, v196
    v_mfma_f32_16x16x32_bf16 v[224:227], v[36:39], a[16:19], v[224:227]
    ds_read_b64_tr_b16 v[26:27], v73 offset:23072
    v_mul_f32 v203, s54, v203
    v_mfma_f32_16x16x32_bf16 v[224:227], v[40:43], a[32:35], v[224:227]
    ds_read_b64_tr_b16 v[28:29], v73 offset:27680
    v_mul_f32 v220, v204, v220
    v_mfma_f32_16x16x32_bf16 v[224:227], v[44:47], a[48:51], v[224:227]
    ds_read_b64_tr_b16 v[30:31], v73 offset:32288
    v_mul_f32 v221, v205, v221
    v_mfma_f32_16x16x32_bf16 v[228:231], v[32:35], a[4:7], v[228:231]
    s_bfe_u32 s3, s3, 0x80008
    s_cmp_lt_u32 s3, s48
    s_cbranch_scc1 L_dep4
L_dep4_ret:
    v_mfma_f32_16x16x32_bf16 v[228:231], v[36:39], a[20:23], v[228:231]
    s_add_u32 s47, s47, s1
    v_rcp_f32 v197, v197
    v_mfma_f32_16x16x32_bf16 v[228:231], v[40:43], a[36:39], v[228:231]
    buffer_load_dwordx4 v64, s[16:19], s47 offen lds
    v_mfma_f32_16x16x32_bf16 v[228:231], v[44:47], a[52:55], v[228:231]
    v_rcp_f32 v198, v198
    v_mfma_f32_16x16x32_bf16 v[232:235], v[32:35], a[8:11], v[232:235]
    v_rcp_f32 v199, v199
    v_mfma_f32_16x16x32_bf16 v[232:235], v[36:39], a[24:27], v[232:235]
    s_add_u32 s49, s12, 32768
    v_exp_f32 v200, v200
    v_mfma_f32_16x16x32_bf16 v[232:235], v[40:43], a[40:43], v[232:235]
    buffer_load_dwordx4 a[212:215], v1, s[36:39], s49 offen offset:0 sc1
    v_mfma_f32_16x16x32_bf16 v[232:235], v[44:47], a[56:59], v[232:235]
    s_add_u32 m0, s46, 111616
    v_exp_f32 v201, v201
    v_mfma_f32_16x16x32_bf16 v[236:239], v[32:35], a[12:15], v[236:239]
    ds_read_b64_tr_b16 v[32:33], v73 offset:64
    v_mul_f32 v213, v213, v197
    v_mfma_f32_16x16x32_bf16 v[236:239], v[36:39], a[28:31], v[236:239]
    ds_read_b64_tr_b16 v[34:35], v73 offset:4672
    v_mul_f32 v214, v214, v198
    v_mfma_f32_16x16x32_bf16 v[236:239], v[40:43], a[44:47], v[236:239]
    ds_read_b64_tr_b16 v[36:37], v73 offset:9280
    v_mul_f32 v215, v215, v199
    v_mfma_f32_16x16x32_bf16 v[236:239], v[44:47], a[60:63], v[236:239]
    s_waitcnt lgkmcnt(3)
    ds_read_b64_tr_b16 v[38:39], v73 offset:13888
    v_mfma_f32_16x16x32_bf16 v[80:83], v[16:19], a[0:3], v[80:83]
    ds_read_b64_tr_b16 v[40:41], v73 offset:18496
    v_cvt_pk_bf16_f32 v52, v212, v213
    v_mfma_f32_16x16x32_bf16 v[80:83], v[20:23], a[16:19], v[80:83]
    ds_read_b64_tr_b16 v[42:43], v73 offset:23104
    v_cvt_pk_bf16_f32 v53, v214, v215
    v_mfma_f32_16x16x32_bf16 v[80:83], v[24:27], a[32:35], v[80:83]
    ds_read_b64_tr_b16 v[44:45], v73 offset:27712
    v_add_f32 v200, 1.0, v200
    v_mfma_f32_16x16x32_bf16 v[80:83], v[28:31], a[48:51], v[80:83]
    ds_read_b64_tr_b16 v[46:47], v73 offset:32320
    v_add_f32 v201, 1.0, v201
    v_mfma_f32_16x16x32_bf16 v[84:87], v[16:19], a[4:7], v[84:87]
    buffer_load_dwordx4 v65, s[16:19], s47 offen lds
    v_mfma_f32_16x16x32_bf16 v[84:87], v[20:23], a[20:23], v[84:87]
    buffer_load_dwordx4 a[216:219], v1, s[36:39], s49 offen offset:1024 sc1
    v_mfma_f32_16x16x32_bf16 v[84:87], v[24:27], a[36:39], v[84:87]
    buffer_store_dwordx2 v[52:53], v75, s[36:39], s53 offen offset:1024 sc1
    v_mfma_f32_16x16x32_bf16 v[84:87], v[28:31], a[52:55], v[84:87]
    v_exp_f32 v202, v202
    v_mfma_f32_16x16x32_bf16 v[88:91], v[16:19], a[8:11], v[88:91]
    v_exp_f32 v203, v203
    v_mfma_f32_16x16x32_bf16 v[88:91], v[20:23], a[24:27], v[88:91]
    s_add_u32 m0, s46, 112640
    v_rcp_f32 v200, v200
    v_mfma_f32_16x16x32_bf16 v[88:91], v[24:27], a[40:43], v[88:91]
    buffer_load_dwordx4 v66, s[16:19], s47 offen lds
    v_mfma_f32_16x16x32_bf16 v[88:91], v[28:31], a[56:59], v[88:91]
    v_rcp_f32 v201, v201
    v_mfma_f32_16x16x32_bf16 v[92:95], v[16:19], a[12:15], v[92:95]
    ds_read_b64_tr_b16 v[16:17], v73 offset:96
    v_add_f32 v202, 1.0, v202
    v_mfma_f32_16x16x32_bf16 v[92:95], v[20:23], a[28:31], v[92:95]
    ds_read_b64_tr_b16 v[18:19], v73 offset:4704
    v_add_f32 v203, 1.0, v203
    v_mfma_f32_16x16x32_bf16 v[92:95], v[24:27], a[44:47], v[92:95]
    ds_read_b64_tr_b16 v[20:21], v73 offset:9312
    v_mul_f32 v216, v216, v200
    v_mfma_f32_16x16x32_bf16 v[92:95], v[28:31], a[60:63], v[92:95]
    s_waitcnt lgkmcnt(3)
    ds_read_b64_tr_b16 v[22:23], v73 offset:13920
    v_mfma_f32_16x16x32_bf16 a[64:67], v[32:35], a[0:3], a[64:67]
    ds_read_b64_tr_b16 v[24:25], v73 offset:18528
    v_mul_f32 v217, v217, v201
    v_mfma_f32_16x16x32_bf16 a[64:67], v[36:39], a[16:19], a[64:67]
    ds_read_b64_tr_b16 v[26:27], v73 offset:23136
    v_cvt_pk_bf16_f32 v56, v216, v217
    v_mfma_f32_16x16x32_bf16 a[64:67], v[40:43], a[32:35], a[64:67]
    ds_read_b64_tr_b16 v[28:29], v73 offset:27744
    v_mul_f32 v222, v206, v222
    v_mfma_f32_16x16x32_bf16 a[64:67], v[44:47], a[48:51], a[64:67]
    ds_read_b64_tr_b16 v[30:31], v73 offset:32352
    v_mul_f32 v223, v207, v223
    v_mfma_f32_16x16x32_bf16 a[68:71], v[32:35], a[4:7], a[68:71]
    buffer_load_dwordx4 a[220:223], v1, s[36:39], s49 offen offset:2048 sc1
    v_mfma_f32_16x16x32_bf16 a[68:71], v[36:39], a[20:23], a[68:71]
    s_add_u32 m0, s46, 113664
    v_rcp_f32 v202, v202
    v_mfma_f32_16x16x32_bf16 a[68:71], v[40:43], a[36:39], a[68:71]
    buffer_load_dwordx4 v67, s[16:19], s47 offen lds
    v_mfma_f32_16x16x32_bf16 a[68:71], v[44:47], a[52:55], a[68:71]
    v_rcp_f32 v203, v203
    v_mfma_f32_16x16x32_bf16 a[72:75], v[32:35], a[8:11], a[72:75]
    v_mul_f32 v218, v218, v202
    v_mul_f32 v219, v219, v203
    v_mfma_f32_16x16x32_bf16 a[72:75], v[36:39], a[24:27], a[72:75]
    v_cvt_pk_bf16_f32 v57, v218, v219
    v_mul_f32 v204, s54, v204
    v_mfma_f32_16x16x32_bf16 a[72:75], v[40:43], a[40:43], a[72:75]
    buffer_load_dwordx4 a[128:131], v1, s[36:39], s49 offen offset:3072 sc1
    v_mfma_f32_16x16x32_bf16 a[72:75], v[44:47], a[56:59], a[72:75]
    s_add_u32 m0, s46, 114688
    v_exp_f32 v204, v204
    v_mfma_f32_16x16x32_bf16 a[76:79], v[32:35], a[12:15], a[76:79]
    ds_read_b64_tr_b16 v[32:33], v73 offset:128
    v_mul_f32 v205, s54, v205
    v_mfma_f32_16x16x32_bf16 a[76:79], v[36:39], a[28:31], a[76:79]
    ds_read_b64_tr_b16 v[34:35], v73 offset:4736
    v_mul_f32 v206, s54, v206
    v_mfma_f32_16x16x32_bf16 a[76:79], v[40:43], a[44:47], a[76:79]
    ds_read_b64_tr_b16 v[36:37], v73 offset:9344
    v_mul_f32 v207, s54, v207
    v_mfma_f32_16x16x32_bf16 a[76:79], v[44:47], a[60:63], a[76:79]
    s_waitcnt lgkmcnt(3)
    ds_read_b64_tr_b16 v[38:39], v73 offset:13952
    v_mfma_f32_16x16x32_bf16 a[80:83], v[16:19], a[0:3], a[80:83]
    ds_read_b64_tr_b16 v[40:41], v73 offset:18560
    v_add_f32 v204, 1.0, v204
    v_mfma_f32_16x16x32_bf16 a[80:83], v[20:23], a[16:19], a[80:83]
    ds_read_b64_tr_b16 v[42:43], v73 offset:23168
    v_mfma_f32_16x16x32_bf16 a[80:83], v[24:27], a[32:35], a[80:83]
    ds_read_b64_tr_b16 v[44:45], v73 offset:27776
    v_mfma_f32_16x16x32_bf16 a[80:83], v[28:31], a[48:51], a[80:83]
    ds_read_b64_tr_b16 v[46:47], v73 offset:32384
    v_mfma_f32_16x16x32_bf16 a[84:87], v[16:19], a[4:7], a[84:87]
    buffer_load_dwordx4 v68, s[16:19], s47 offen lds
    v_mfma_f32_16x16x32_bf16 a[84:87], v[20:23], a[20:23], a[84:87]
    s_add_u32 s49, s12, 40960
    v_exp_f32 v205, v205
    v_mfma_f32_16x16x32_bf16 a[84:87], v[24:27], a[36:39], a[84:87]
    buffer_load_dwordx4 a[132:135], v1, s[36:39], s49 offen offset:0 sc1
    v_mfma_f32_16x16x32_bf16 a[84:87], v[28:31], a[52:55], a[84:87]
    buffer_store_dwordx2 v[56:57], v75, s[36:39], s53 offen offset:2048 sc1
    v_mfma_f32_16x16x32_bf16 a[88:91], v[16:19], a[8:11], a[88:91]
    v_exp_f32 v206, v206
    v_mfma_f32_16x16x32_bf16 a[88:91], v[20:23], a[24:27], a[88:91]
    v_exp_f32 v207, v207
    v_mfma_f32_16x16x32_bf16 a[88:91], v[24:27], a[40:43], a[88:91]
    s_add_u32 m0, s46, 115712
    v_rcp_f32 v204, v204
    v_mfma_f32_16x16x32_bf16 a[88:91], v[28:31], a[56:59], a[88:91]
    buffer_load_dwordx4 v69, s[16:19], s47 offen lds
    v_mfma_f32_16x16x32_bf16 a[92:95], v[16:19], a[12:15], a[92:95]
    ds_read_b64_tr_b16 v[16:17], v73 offset:160
    v_add_f32 v205, 1.0, v205
    v_mfma_f32_16x16x32_bf16 a[92:95], v[20:23], a[28:31], a[92:95]
    ds_read_b64_tr_b16 v[18:19], v73 offset:4768
    v_add_f32 v206, 1.0, v206
    v_mfma_f32_16x16x32_bf16 a[92:95], v[24:27], a[44:47], a[92:95]
    ds_read_b64_tr_b16 v[20:21], v73 offset:9376
    v_add_f32 v207, 1.0, v207
    v_mfma_f32_16x16x32_bf16 a[92:95], v[28:31], a[60:63], a[92:95]
    s_waitcnt lgkmcnt(3)
    ds_read_b64_tr_b16 v[22:23], v73 offset:13984
    v_mfma_f32_16x16x32_bf16 a[96:99], v[32:35], a[0:3], a[96:99]
    ds_read_b64_tr_b16 v[24:25], v73 offset:18592
    v_mul_f32 v220, v220, v204
    v_mfma_f32_16x16x32_bf16 a[96:99], v[36:39], a[16:19], a[96:99]
    ds_read_b64_tr_b16 v[26:27], v73 offset:23200
    v_mfma_f32_16x16x32_bf16 a[96:99], v[40:43], a[32:35], a[96:99]
    ds_read_b64_tr_b16 v[28:29], v73 offset:27808
    v_mfma_f32_16x16x32_bf16 a[96:99], v[44:47], a[48:51], a[96:99]
    ds_read_b64_tr_b16 v[30:31], v73 offset:32416
    v_mfma_f32_16x16x32_bf16 a[100:103], v[32:35], a[4:7], a[100:103]
    buffer_load_dwordx4 a[136:139], v1, s[36:39], s49 offen offset:1024 sc1
    v_mfma_f32_16x16x32_bf16 a[100:103], v[36:39], a[20:23], a[100:103]
    s_add_u32 m0, s46, 116736
    v_rcp_f32 v205, v205
    v_mfma_f32_16x16x32_bf16 a[100:103], v[40:43], a[36:39], a[100:103]
    buffer_load_dwordx4 v70, s[16:19], s47 offen lds
    v_mfma_f32_16x16x32_bf16 a[100:103], v[44:47], a[52:55], a[100:103]
    v_rcp_f32 v206, v206
    v_mfma_f32_16x16x32_bf16 a[104:107], v[32:35], a[8:11], a[104:107]
    v_rcp_f32 v207, v207
    v_mfma_f32_16x16x32_bf16 a[104:107], v[36:39], a[24:27], a[104:107]
    v_mul_f32 v221, v221, v205
    v_mul_f32 v222, v222, v206
    v_mfma_f32_16x16x32_bf16 a[104:107], v[40:43], a[40:43], a[104:107]
    v_mul_f32 v223, v223, v207
    v_cvt_pk_bf16_f32 v60, v220, v221
    v_mfma_f32_16x16x32_bf16 a[104:107], v[44:47], a[56:59], a[104:107]
    buffer_load_dwordx4 a[140:143], v1, s[36:39], s49 offen offset:2048 sc1
    v_mfma_f32_16x16x32_bf16 a[108:111], v[32:35], a[12:15], a[108:111]
    ds_read_b64_tr_b16 v[32:33], v73 offset:192
    v_cvt_pk_bf16_f32 v61, v222, v223
    v_mfma_f32_16x16x32_bf16 a[108:111], v[36:39], a[28:31], a[108:111]
    ds_read_b64_tr_b16 v[34:35], v73 offset:4800
    v_mfma_f32_16x16x32_bf16 a[108:111], v[40:43], a[44:47], a[108:111]
    ds_read_b64_tr_b16 v[36:37], v73 offset:9408
    v_mfma_f32_16x16x32_bf16 a[108:111], v[44:47], a[60:63], a[108:111]
    s_waitcnt lgkmcnt(3)
    ds_read_b64_tr_b16 v[38:39], v73 offset:14016
    v_mfma_f32_16x16x32_bf16 a[112:115], v[16:19], a[0:3], a[112:115]
    ds_read_b64_tr_b16 v[40:41], v73 offset:18624
    v_mfma_f32_16x16x32_bf16 a[112:115], v[20:23], a[16:19], a[112:115]
    ds_read_b64_tr_b16 v[42:43], v73 offset:23232
    v_mfma_f32_16x16x32_bf16 a[112:115], v[24:27], a[32:35], a[112:115]
    ds_read_b64_tr_b16 v[44:45], v73 offset:27840
    v_mfma_f32_16x16x32_bf16 a[112:115], v[28:31], a[48:51], a[112:115]
    ds_read_b64_tr_b16 v[46:47], v73 offset:32448
    v_mfma_f32_16x16x32_bf16 a[116:119], v[16:19], a[4:7], a[116:119]
    s_add_u32 m0, s46, 117760
    v_mfma_f32_16x16x32_bf16 a[116:119], v[20:23], a[20:23], a[116:119]
    buffer_load_dwordx4 v71, s[16:19], s47 offen lds
    v_mfma_f32_16x16x32_bf16 a[116:119], v[24:27], a[36:39], a[116:119]
    buffer_load_dwordx4 a[144:147], v1, s[36:39], s49 offen offset:3072 sc1
    v_mfma_f32_16x16x32_bf16 a[116:119], v[28:31], a[52:55], a[116:119]
    buffer_load_dword v78, v6, s[60:63], s97 offen sc1
    v_mfma_f32_16x16x32_bf16 a[120:123], v[16:19], a[8:11], a[120:123]
    buffer_store_dwordx2 v[60:61], v75, s[36:39], s53 offen offset:3072 sc1
    v_mfma_f32_16x16x32_bf16 a[120:123], v[20:23], a[24:27], a[120:123]
    v_mfma_f32_16x16x32_bf16 a[120:123], v[24:27], a[40:43], a[120:123]
    s_add_u32 m0, s46, 118784
    v_mfma_f32_16x16x32_bf16 a[120:123], v[28:31], a[56:59], a[120:123]
    buffer_load_dwordx4 v72, s[16:19], s47 offen lds
    v_mfma_f32_16x16x32_bf16 a[124:127], v[16:19], a[12:15], a[124:127]
    ds_read_b64_tr_b16 v[16:17], v73 offset:224
    v_mfma_f32_16x16x32_bf16 a[124:127], v[20:23], a[28:31], a[124:127]
    ds_read_b64_tr_b16 v[18:19], v73 offset:4832
    v_mfma_f32_16x16x32_bf16 a[124:127], v[24:27], a[44:47], a[124:127]
    ds_read_b64_tr_b16 v[20:21], v73 offset:9440
    v_mfma_f32_16x16x32_bf16 a[124:127], v[28:31], a[60:63], a[124:127]
    s_waitcnt lgkmcnt(3)
    ds_read_b64_tr_b16 v[22:23], v73 offset:14048
    v_mfma_f32_16x16x32_bf16 v[240:243], v[32:35], a[0:3], v[240:243]
    ds_read_b64_tr_b16 v[24:25], v73 offset:18656
    v_mfma_f32_16x16x32_bf16 v[240:243], v[36:39], a[16:19], v[240:243]
    ds_read_b64_tr_b16 v[26:27], v73 offset:23264
    v_mfma_f32_16x16x32_bf16 v[240:243], v[40:43], a[32:35], v[240:243]
    ds_read_b64_tr_b16 v[28:29], v73 offset:27872
    v_mfma_f32_16x16x32_bf16 v[240:243], v[44:47], a[48:51], v[240:243]
    ds_read_b64_tr_b16 v[30:31], v73 offset:32480
    v_mfma_f32_16x16x32_bf16 v[244:247], v[32:35], a[4:7], v[244:247]
    s_add_u32 s49, s12, 49152
    v_mfma_f32_16x16x32_bf16 v[244:247], v[36:39], a[20:23], v[244:247]
    buffer_load_dwordx4 a[180:183], v1, s[36:39], s49 offen offset:0 sc1
    v_mfma_f32_16x16x32_bf16 v[244:247], v[40:43], a[36:39], v[244:247]
    buffer_load_dwordx4 a[184:187], v1, s[36:39], s49 offen offset:1024 sc1
    v_mfma_f32_16x16x32_bf16 v[244:247], v[44:47], a[52:55], v[244:247]
    v_mfma_f32_16x16x32_bf16 v[248:251], v[32:35], a[8:11], v[248:251]
    v_mfma_f32_16x16x32_bf16 v[248:251], v[36:39], a[24:27], v[248:251]
    v_mfma_f32_16x16x32_bf16 v[248:251], v[40:43], a[40:43], v[248:251]
    v_mfma_f32_16x16x32_bf16 v[248:251], v[44:47], a[56:59], v[248:251]
    buffer_load_dwordx4 a[188:191], v1, s[36:39], s49 offen offset:2048 sc1
    v_mfma_f32_16x16x32_bf16 v[252:255], v[32:35], a[12:15], v[252:255]
    ds_read_b64_tr_b16 v[32:33], v73 offset:256
    v_mfma_f32_16x16x32_bf16 v[252:255], v[36:39], a[28:31], v[252:255]
    ds_read_b64_tr_b16 v[34:35], v73 offset:4864
    v_mfma_f32_16x16x32_bf16 v[252:255], v[40:43], a[44:47], v[252:255]
    ds_read_b64_tr_b16 v[36:37], v73 offset:9472
    v_mfma_f32_16x16x32_bf16 v[252:255], v[44:47], a[60:63], v[252:255]
    s_waitcnt lgkmcnt(3)
    ds_read_b64_tr_b16 v[38:39], v73 offset:14080
    v_mfma_f32_16x16x32_bf16 v[96:99], v[16:19], a[0:3], v[96:99]
    ds_read_b64_tr_b16 v[40:41], v73 offset:18688
    v_mfma_f32_16x16x32_bf16 v[96:99], v[20:23], a[16:19], v[96:99]
    ds_read_b64_tr_b16 v[42:43], v73 offset:23296
    v_mfma_f32_16x16x32_bf16 v[96:99], v[24:27], a[32:35], v[96:99]
    ds_read_b64_tr_b16 v[44:45], v73 offset:27904
    v_mfma_f32_16x16x32_bf16 v[96:99], v[28:31], a[48:51], v[96:99]
    ds_read_b64_tr_b16 v[46:47], v73 offset:32512
    v_mfma_f32_16x16x32_bf16 v[100:103], v[16:19], a[4:7], v[100:103]
    buffer_load_dwordx4 a[192:195], v1, s[36:39], s49 offen offset:3072 sc1
    v_mfma_f32_16x16x32_bf16 v[100:103], v[20:23], a[20:23], v[100:103]
    s_add_u32 s49, s12, 57344
    v_mfma_f32_16x16x32_bf16 v[100:103], v[24:27], a[36:39], v[100:103]
    buffer_load_dwordx4 a[196:199], v1, s[36:39], s49 offen offset:0 sc1
    v_mfma_f32_16x16x32_bf16 v[100:103], v[28:31], a[52:55], v[100:103]
    v_mfma_f32_16x16x32_bf16 v[104:107], v[16:19], a[8:11], v[104:107]
    s_add_u32 s87, s96, s86
    v_mov_b32 v14, 0x10000
    v_mfma_f32_16x16x32_bf16 v[104:107], v[20:23], a[24:27], v[104:107]
    v_mfma_f32_16x16x32_bf16 v[104:107], v[24:27], a[40:43], v[104:107]
    v_mfma_f32_16x16x32_bf16 v[104:107], v[28:31], a[56:59], v[104:107]
    buffer_load_dwordx4 a[200:203], v1, s[36:39], s49 offen offset:1024 sc1
    v_mfma_f32_16x16x32_bf16 v[108:111], v[16:19], a[12:15], v[108:111]
    v_mfma_f32_16x16x32_bf16 v[108:111], v[20:23], a[28:31], v[108:111]
    v_mfma_f32_16x16x32_bf16 v[108:111], v[24:27], a[44:47], v[108:111]
    v_mfma_f32_16x16x32_bf16 v[108:111], v[28:31], a[60:63], v[108:111]
    s_waitcnt lgkmcnt(0)
    v_mfma_f32_16x16x32_bf16 v[112:115], v[32:35], a[0:3], v[112:115]
    s_waitcnt vmcnt(34)
    s_barrier
    v_mfma_f32_16x16x32_bf16 v[112:115], v[36:39], a[16:19], v[112:115]
    ds_read_b64_tr_b16 v[16:17], v76 offset:0
    v_mfma_f32_16x16x32_bf16 v[112:115], v[40:43], a[32:35], v[112:115]
    ds_read_b64_tr_b16 v[18:19], v76 offset:4608
    v_mfma_f32_16x16x32_bf16 v[112:115], v[44:47], a[48:51], v[112:115]
    ds_read_b64_tr_b16 v[20:21], v76 offset:9216
    v_mfma_f32_16x16x32_bf16 v[116:119], v[32:35], a[4:7], v[116:119]
    ds_read_b64_tr_b16 v[22:23], v76 offset:13824
    v_mfma_f32_16x16x32_bf16 v[116:119], v[36:39], a[20:23], v[116:119]
    ds_read_b64_tr_b16 v[24:25], v76 offset:18432
    v_mfma_f32_16x16x32_bf16 v[116:119], v[40:43], a[36:39], v[116:119]
    ds_read_b64_tr_b16 v[26:27], v76 offset:23040
    v_mfma_f32_16x16x32_bf16 v[116:119], v[44:47], a[52:55], v[116:119]
    ds_read_b64_tr_b16 v[28:29], v76 offset:27648
    v_mfma_f32_16x16x32_bf16 v[120:123], v[32:35], a[8:11], v[120:123]
    ds_read_b64_tr_b16 v[30:31], v76 offset:32256
    v_mfma_f32_16x16x32_bf16 v[120:123], v[36:39], a[24:27], v[120:123]
    buffer_atomic_add v14, v6, s[60:63], s87 offen
    v_mfma_f32_16x16x32_bf16 v[120:123], v[40:43], a[40:43], v[120:123]
    buffer_load_dwordx4 a[204:207], v1, s[36:39], s49 offen offset:2048 sc1
    v_mfma_f32_16x16x32_bf16 v[120:123], v[44:47], a[56:59], v[120:123]
    buffer_load_dwordx4 a[208:211], v1, s[36:39], s49 offen offset:3072 sc1
    v_mfma_f32_16x16x32_bf16 v[124:127], v[32:35], a[12:15], v[124:127]
    s_waitcnt vmcnt(10)
    ds_read_b64_tr_b16 v[32:33], v76 offset:32
    v_mfma_f32_16x16x32_bf16 v[124:127], v[36:39], a[28:31], v[124:127]
    ds_read_b64_tr_b16 v[34:35], v76 offset:4640
    v_readfirstlane_b32 s3, v78
    v_mfma_f32_16x16x32_bf16 v[124:127], v[40:43], a[44:47], v[124:127]
    ds_read_b64_tr_b16 v[36:37], v76 offset:9248
    v_mfma_f32_16x16x32_bf16 v[124:127], v[44:47], a[60:63], v[124:127]
    s_waitcnt vmcnt(29) lgkmcnt(3)
    ds_read_b64_tr_b16 v[38:39], v76 offset:13856
    v_mfma_f32_16x16x32_bf16 v[224:227], v[16:19], a[224:227], v[224:227]
    ds_read_b64_tr_b16 v[40:41], v76 offset:18464
    v_mfma_f32_16x16x32_bf16 v[224:227], v[20:23], a[240:243], v[224:227]
    ds_read_b64_tr_b16 v[42:43], v76 offset:23072
    v_mfma_f32_16x16x32_bf16 v[224:227], v[24:27], a[148:151], v[224:227]
    s_add_u32 m0, s46, 0
    ds_read_b64_tr_b16 v[44:45], v76 offset:27680
    v_mfma_f32_16x16x32_bf16 v[224:227], v[28:31], a[164:167], v[224:227]
    s_add_u32 s47, s55, 294912
    ds_read_b64_tr_b16 v[46:47], v76 offset:32288
    v_mfma_f32_16x16x32_bf16 v[228:231], v[16:19], a[228:231], v[228:231]
    s_bfe_u32 s3, s3, 0x80008
    s_cmp_lt_u32 s3, s48
    s_cbranch_scc1 L_dep5
L_dep5_ret:
    v_mfma_f32_16x16x32_bf16 v[228:231], v[20:23], a[244:247], v[228:231]
    s_add_u32 s47, s47, s1
    v_mfma_f32_16x16x32_bf16 v[228:231], v[24:27], a[152:155], v[228:231]
    buffer_load_dwordx4 v64, s[16:19], s47 offen lds
    v_mfma_f32_16x16x32_bf16 v[228:231], v[28:31], a[168:171], v[228:231]
    s_add_u32 s49, s13, 32768
    v_mfma_f32_16x16x32_bf16 v[232:235], v[16:19], a[232:235], v[232:235]
    global_load_dword v79, v[4:5], off
    v_mfma_f32_16x16x32_bf16 v[232:235], v[20:23], a[248:251], v[232:235]
    v_mfma_f32_16x16x32_bf16 v[232:235], v[24:27], a[156:159], v[232:235]
    buffer_load_dwordx4 a[0:3], v1, s[36:39], s49 offen offset:0 sc1
    v_mfma_f32_16x16x32_bf16 v[232:235], v[28:31], a[172:175], v[232:235]
    v_mfma_f32_16x16x32_bf16 v[236:239], v[16:19], a[236:239], v[236:239]
    s_add_u32 m0, s46, 1024
    ds_read_b64_tr_b16 v[16:17], v76 offset:64
    v_mfma_f32_16x16x32_bf16 v[236:239], v[20:23], a[252:255], v[236:239]
    ds_read_b64_tr_b16 v[18:19], v76 offset:4672
    v_mfma_f32_16x16x32_bf16 v[236:239], v[24:27], a[160:163], v[236:239]
    ds_read_b64_tr_b16 v[20:21], v76 offset:9280
    v_mfma_f32_16x16x32_bf16 v[236:239], v[28:31], a[176:179], v[236:239]
    s_waitcnt lgkmcnt(3)
    ds_read_b64_tr_b16 v[22:23], v76 offset:13888
    v_mfma_f32_16x16x32_bf16 v[80:83], v[32:35], a[224:227], v[80:83]
    ds_read_b64_tr_b16 v[24:25], v76 offset:18496
    v_mfma_f32_16x16x32_bf16 v[80:83], v[36:39], a[240:243], v[80:83]
    ds_read_b64_tr_b16 v[26:27], v76 offset:23104
    v_mfma_f32_16x16x32_bf16 v[80:83], v[40:43], a[148:151], v[80:83]
    ds_read_b64_tr_b16 v[28:29], v76 offset:27712
    v_mfma_f32_16x16x32_bf16 v[80:83], v[44:47], a[164:167], v[80:83]
    ds_read_b64_tr_b16 v[30:31], v76 offset:32320
    v_mfma_f32_16x16x32_bf16 v[84:87], v[32:35], a[228:231], v[84:87]
    buffer_load_dwordx4 v65, s[16:19], s47 offen lds
    v_mfma_f32_16x16x32_bf16 v[84:87], v[36:39], a[244:247], v[84:87]
    buffer_load_dwordx4 a[4:7], v1, s[36:39], s49 offen offset:1024 sc1
    v_mfma_f32_16x16x32_bf16 v[84:87], v[40:43], a[152:155], v[84:87]
    v_mfma_f32_16x16x32_bf16 v[84:87], v[44:47], a[168:171], v[84:87]
    s_add_u32 m0, s46, 2048
    v_mfma_f32_16x16x32_bf16 v[88:91], v[32:35], a[232:235], v[88:91]
    v_mfma_f32_16x16x32_bf16 v[88:91], v[36:39], a[248:251], v[88:91]
    v_mfma_f32_16x16x32_bf16 v[88:91], v[40:43], a[156:159], v[88:91]
    buffer_load_dwordx4 v66, s[16:19], s47 offen lds
    v_mfma_f32_16x16x32_bf16 v[88:91], v[44:47], a[172:175], v[88:91]
    v_mfma_f32_16x16x32_bf16 v[92:95], v[32:35], a[236:239], v[92:95]
    ds_read_b64_tr_b16 v[32:33], v76 offset:96
    v_mfma_f32_16x16x32_bf16 v[92:95], v[36:39], a[252:255], v[92:95]
    ds_read_b64_tr_b16 v[34:35], v76 offset:4704
    v_mfma_f32_16x16x32_bf16 v[92:95], v[40:43], a[160:163], v[92:95]
    ds_read_b64_tr_b16 v[36:37], v76 offset:9312
    v_mfma_f32_16x16x32_bf16 v[92:95], v[44:47], a[176:179], v[92:95]
    s_waitcnt lgkmcnt(3)
    ds_read_b64_tr_b16 v[38:39], v76 offset:13920
    v_mfma_f32_16x16x32_bf16 a[64:67], v[16:19], a[224:227], a[64:67]
    ds_read_b64_tr_b16 v[40:41], v76 offset:18528
    v_mfma_f32_16x16x32_bf16 a[64:67], v[20:23], a[240:243], a[64:67]
    ds_read_b64_tr_b16 v[42:43], v76 offset:23136
    v_mfma_f32_16x16x32_bf16 a[64:67], v[24:27], a[148:151], a[64:67]
    ds_read_b64_tr_b16 v[44:45], v76 offset:27744
    v_mfma_f32_16x16x32_bf16 a[64:67], v[28:31], a[164:167], a[64:67]
    ds_read_b64_tr_b16 v[46:47], v76 offset:32352
    v_mfma_f32_16x16x32_bf16 a[68:71], v[16:19], a[228:231], a[68:71]
    buffer_load_dwordx4 a[8:11], v1, s[36:39], s49 offen offset:2048 sc1
    v_mfma_f32_16x16x32_bf16 a[68:71], v[20:23], a[244:247], a[68:71]
    s_add_u32 m0, s46, 3072
    v_mfma_f32_16x16x32_bf16 a[68:71], v[24:27], a[152:155], a[68:71]
    buffer_load_dwordx4 v67, s[16:19], s47 offen lds
    v_mfma_f32_16x16x32_bf16 a[68:71], v[28:31], a[168:171], a[68:71]
    v_mfma_f32_16x16x32_bf16 a[72:75], v[16:19], a[232:235], a[72:75]
    v_mfma_f32_16x16x32_bf16 a[72:75], v[20:23], a[248:251], a[72:75]
    v_mfma_f32_16x16x32_bf16 a[72:75], v[24:27], a[156:159], a[72:75]
    buffer_load_dwordx4 a[12:15], v1, s[36:39], s49 offen offset:3072 sc1
    v_mfma_f32_16x16x32_bf16 a[72:75], v[28:31], a[172:175], a[72:75]
    v_mfma_f32_16x16x32_bf16 a[76:79], v[16:19], a[236:239], a[76:79]
    ds_read_b64_tr_b16 v[16:17], v76 offset:128
    v_mfma_f32_16x16x32_bf16 a[76:79], v[20:23], a[252:255], a[76:79]
    s_add_u32 m0, s46, 4096
    ds_read_b64_tr_b16 v[18:19], v76 offset:4736
    v_mfma_f32_16x16x32_bf16 a[76:79], v[24:27], a[160:163], a[76:79]
    ds_read_b64_tr_b16 v[20:21], v76 offset:9344
    v_mfma_f32_16x16x32_bf16 a[76:79], v[28:31], a[176:179], a[76:79]
    s_waitcnt lgkmcnt(3)
    ds_read_b64_tr_b16 v[22:23], v76 offset:13952
    v_mfma_f32_16x16x32_bf16 a[80:83], v[32:35], a[224:227], a[80:83]
    ds_read_b64_tr_b16 v[24:25], v76 offset:18560
    v_mfma_f32_16x16x32_bf16 a[80:83], v[36:39], a[240:243], a[80:83]
    ds_read_b64_tr_b16 v[26:27], v76 offset:23168
    v_mfma_f32_16x16x32_bf16 a[80:83], v[40:43], a[148:151], a[80:83]
    ds_read_b64_tr_b16 v[28:29], v76 offset:27776
    v_mfma_f32_16x16x32_bf16 a[80:83], v[44:47], a[164:167], a[80:83]
    ds_read_b64_tr_b16 v[30:31], v76 offset:32384
    v_mfma_f32_16x16x32_bf16 a[84:87], v[32:35], a[228:231], a[84:87]
    buffer_load_dwordx4 v68, s[16:19], s47 offen lds
    v_mfma_f32_16x16x32_bf16 a[84:87], v[36:39], a[244:247], a[84:87]
    s_add_u32 s49, s13, 40960
    v_mfma_f32_16x16x32_bf16 a[84:87], v[40:43], a[152:155], a[84:87]
    buffer_load_dwordx4 a[16:19], v1, s[36:39], s49 offen offset:0 sc1
    v_mfma_f32_16x16x32_bf16 a[84:87], v[44:47], a[168:171], a[84:87]
    v_mfma_f32_16x16x32_bf16 a[88:91], v[32:35], a[232:235], a[88:91]
    s_add_u32 m0, s46, 5120
    v_mfma_f32_16x16x32_bf16 a[88:91], v[36:39], a[248:251], a[88:91]
    v_mfma_f32_16x16x32_bf16 a[88:91], v[40:43], a[156:159], a[88:91]
    v_mfma_f32_16x16x32_bf16 a[88:91], v[44:47], a[172:175], a[88:91]
    buffer_load_dwordx4 v69, s[16:19], s47 offen lds
    v_mfma_f32_16x16x32_bf16 a[92:95], v[32:35], a[236:239], a[92:95]
    ds_read_b64_tr_b16 v[32:33], v76 offset:160
    v_mfma_f32_16x16x32_bf16 a[92:95], v[36:39], a[252:255], a[92:95]
    ds_read_b64_tr_b16 v[34:35], v76 offset:4768
    v_mfma_f32_16x16x32_bf16 a[92:95], v[40:43], a[160:163], a[92:95]
    ds_read_b64_tr_b16 v[36:37], v76 offset:9376
    v_mfma_f32_16x16x32_bf16 a[92:95], v[44:47], a[176:179], a[92:95]
    s_waitcnt lgkmcnt(3)
    ds_read_b64_tr_b16 v[38:39], v76 offset:13984
    v_mfma_f32_16x16x32_bf16 a[96:99], v[16:19], a[224:227], a[96:99]
    ds_read_b64_tr_b16 v[40:41], v76 offset:18592
    v_mfma_f32_16x16x32_bf16 a[96:99], v[20:23], a[240:243], a[96:99]
    ds_read_b64_tr_b16 v[42:43], v76 offset:23200
    v_mfma_f32_16x16x32_bf16 a[96:99], v[24:27], a[148:151], a[96:99]
    ds_read_b64_tr_b16 v[44:45], v76 offset:27808
    v_mfma_f32_16x16x32_bf16 a[96:99], v[28:31], a[164:167], a[96:99]
    ds_read_b64_tr_b16 v[46:47], v76 offset:32416
    v_mfma_f32_16x16x32_bf16 a[100:103], v[16:19], a[228:231], a[100:103]
    buffer_load_dwordx4 a[20:23], v1, s[36:39], s49 offen offset:1024 sc1
    v_mfma_f32_16x16x32_bf16 a[100:103], v[20:23], a[244:247], a[100:103]
    s_add_u32 m0, s46, 6144
    v_mfma_f32_16x16x32_bf16 a[100:103], v[24:27], a[152:155], a[100:103]
    buffer_load_dwordx4 v70, s[16:19], s47 offen lds
    v_mfma_f32_16x16x32_bf16 a[100:103], v[28:31], a[168:171], a[100:103]
    v_mfma_f32_16x16x32_bf16 a[104:107], v[16:19], a[232:235], a[104:107]
    v_mfma_f32_16x16x32_bf16 a[104:107], v[20:23], a[248:251], a[104:107]
    v_mfma_f32_16x16x32_bf16 a[104:107], v[24:27], a[156:159], a[104:107]
    v_mfma_f32_16x16x32_bf16 a[104:107], v[28:31], a[172:175], a[104:107]
    buffer_load_dwordx4 a[24:27], v1, s[36:39], s49 offen offset:2048 sc1
    v_mfma_f32_16x16x32_bf16 a[108:111], v[16:19], a[236:239], a[108:111]
    ds_read_b64_tr_b16 v[16:17], v76 offset:192
    v_mfma_f32_16x16x32_bf16 a[108:111], v[20:23], a[252:255], a[108:111]
    s_add_u32 m0, s46, 7168
    ds_read_b64_tr_b16 v[18:19], v76 offset:4800
    v_mfma_f32_16x16x32_bf16 a[108:111], v[24:27], a[160:163], a[108:111]
    ds_read_b64_tr_b16 v[20:21], v76 offset:9408
    v_mfma_f32_16x16x32_bf16 a[108:111], v[28:31], a[176:179], a[108:111]
    s_waitcnt lgkmcnt(3)
    ds_read_b64_tr_b16 v[22:23], v76 offset:14016
    v_mfma_f32_16x16x32_bf16 a[112:115], v[32:35], a[224:227], a[112:115]
    ds_read_b64_tr_b16 v[24:25], v76 offset:18624
    v_mfma_f32_16x16x32_bf16 a[112:115], v[36:39], a[240:243], a[112:115]
    ds_read_b64_tr_b16 v[26:27], v76 offset:23232
    v_mfma_f32_16x16x32_bf16 a[112:115], v[40:43], a[148:151], a[112:115]
    ds_read_b64_tr_b16 v[28:29], v76 offset:27840
    v_mfma_f32_16x16x32_bf16 a[112:115], v[44:47], a[164:167], a[112:115]
    ds_read_b64_tr_b16 v[30:31], v76 offset:32448
    v_mfma_f32_16x16x32_bf16 a[116:119], v[32:35], a[228:231], a[116:119]
    buffer_load_dwordx4 v71, s[16:19], s47 offen lds
    v_mfma_f32_16x16x32_bf16 a[116:119], v[36:39], a[244:247], a[116:119]
    buffer_load_dword v78, v6, s[60:63], s96 offen sc1
    v_mfma_f32_16x16x32_bf16 a[116:119], v[40:43], a[152:155], a[116:119]
    buffer_load_dwordx4 a[28:31], v1, s[36:39], s49 offen offset:3072 sc1
    v_mfma_f32_16x16x32_bf16 a[116:119], v[44:47], a[168:171], a[116:119]
    v_mfma_f32_16x16x32_bf16 a[120:123], v[32:35], a[232:235], a[120:123]
    s_add_u32 m0, s46, 8192
    v_mfma_f32_16x16x32_bf16 a[120:123], v[36:39], a[248:251], a[120:123]
    v_mfma_f32_16x16x32_bf16 a[120:123], v[40:43], a[156:159], a[120:123]
    v_mfma_f32_16x16x32_bf16 a[120:123], v[44:47], a[172:175], a[120:123]
    buffer_load_dwordx4 v72, s[16:19], s47 offen lds
    v_mfma_f32_16x16x32_bf16 a[124:127], v[32:35], a[236:239], a[124:127]
    ds_read_b64_tr_b16 v[32:33], v76 offset:224
    v_mfma_f32_16x16x32_bf16 a[124:127], v[36:39], a[252:255], a[124:127]
    s_add_u32 s49, s13, 49152
    ds_read_b64_tr_b16 v[34:35], v76 offset:4832
    v_mfma_f32_16x16x32_bf16 a[124:127], v[40:43], a[160:163], a[124:127]
    ds_read_b64_tr_b16 v[36:37], v76 offset:9440
    v_mfma_f32_16x16x32_bf16 a[124:127], v[44:47], a[176:179], a[124:127]
    s_waitcnt lgkmcnt(3)
    ds_read_b64_tr_b16 v[38:39], v76 offset:14048
    v_mfma_f32_16x16x32_bf16 v[240:243], v[16:19], a[224:227], v[240:243]
    ds_read_b64_tr_b16 v[40:41], v76 offset:18656
    v_mfma_f32_16x16x32_bf16 v[240:243], v[20:23], a[240:243], v[240:243]
    ds_read_b64_tr_b16 v[42:43], v76 offset:23264
    v_mfma_f32_16x16x32_bf16 v[240:243], v[24:27], a[148:151], v[240:243]
    ds_read_b64_tr_b16 v[44:45], v76 offset:27872
    v_mfma_f32_16x16x32_bf16 v[240:243], v[28:31], a[164:167], v[240:243]
    ds_read_b64_tr_b16 v[46:47], v76 offset:32480
    v_mfma_f32_16x16x32_bf16 v[244:247], v[16:19], a[228:231], v[244:247]
    buffer_load_dwordx4 a[32:35], v1, s[36:39], s49 offen offset:0 sc1
    v_mfma_f32_16x16x32_bf16 v[244:247], v[20:23], a[244:247], v[244:247]
    v_mfma_f32_16x16x32_bf16 v[244:247], v[24:27], a[152:155], v[244:247]
    buffer_load_dwordx4 a[36:39], v1, s[36:39], s49 offen offset:1024 sc1
    v_mfma_f32_16x16x32_bf16 v[244:247], v[28:31], a[168:171], v[244:247]
    v_mfma_f32_16x16x32_bf16 v[248:251], v[16:19], a[232:235], v[248:251]
    v_mfma_f32_16x16x32_bf16 v[248:251], v[20:23], a[248:251], v[248:251]
    v_mfma_f32_16x16x32_bf16 v[248:251], v[24:27], a[156:159], v[248:251]
    v_mfma_f32_16x16x32_bf16 v[248:251], v[28:31], a[172:175], v[248:251]
    buffer_load_dwordx4 a[40:43], v1, s[36:39], s49 offen offset:2048 sc1
    v_mfma_f32_16x16x32_bf16 v[252:255], v[16:19], a[236:239], v[252:255]
    ds_read_b64_tr_b16 v[16:17], v76 offset:256
    v_mfma_f32_16x16x32_bf16 v[252:255], v[20:23], a[252:255], v[252:255]
    ds_read_b64_tr_b16 v[18:19], v76 offset:4864
    v_mfma_f32_16x16x32_bf16 v[252:255], v[24:27], a[160:163], v[252:255]
    ds_read_b64_tr_b16 v[20:21], v76 offset:9472
    v_mfma_f32_16x16x32_bf16 v[252:255], v[28:31], a[176:179], v[252:255]
    s_waitcnt lgkmcnt(3)
    ds_read_b64_tr_b16 v[22:23], v76 offset:14080
    v_mfma_f32_16x16x32_bf16 v[96:99], v[32:35], a[224:227], v[96:99]
    ds_read_b64_tr_b16 v[24:25], v76 offset:18688
    v_mfma_f32_16x16x32_bf16 v[96:99], v[36:39], a[240:243], v[96:99]
    ds_read_b64_tr_b16 v[26:27], v76 offset:23296
    v_mfma_f32_16x16x32_bf16 v[96:99], v[40:43], a[148:151], v[96:99]
    ds_read_b64_tr_b16 v[28:29], v76 offset:27904
    v_mfma_f32_16x16x32_bf16 v[96:99], v[44:47], a[164:167], v[96:99]
    ds_read_b64_tr_b16 v[30:31], v76 offset:32512
    v_mfma_f32_16x16x32_bf16 v[100:103], v[32:35], a[228:231], v[100:103]
    buffer_load_dwordx4 a[44:47], v1, s[36:39], s49 offen offset:3072 sc1
    v_mfma_f32_16x16x32_bf16 v[100:103], v[36:39], a[244:247], v[100:103]
    s_add_u32 s49, s13, 57344
    v_mfma_f32_16x16x32_bf16 v[100:103], v[40:43], a[152:155], v[100:103]
    buffer_load_dwordx4 a[48:51], v1, s[36:39], s49 offen offset:0 sc1
    v_mfma_f32_16x16x32_bf16 v[100:103], v[44:47], a[168:171], v[100:103]
    v_mfma_f32_16x16x32_bf16 v[104:107], v[32:35], a[232:235], v[104:107]
    s_add_u32 s87, s51, s86
    v_mov_b32 v14, 0x100
    v_mfma_f32_16x16x32_bf16 v[104:107], v[36:39], a[248:251], v[104:107]
    v_mfma_f32_16x16x32_bf16 v[104:107], v[40:43], a[156:159], v[104:107]
    v_mfma_f32_16x16x32_bf16 v[104:107], v[44:47], a[172:175], v[104:107]
    buffer_load_dwordx4 a[52:55], v1, s[36:39], s49 offen offset:1024 sc1
    v_mfma_f32_16x16x32_bf16 v[108:111], v[32:35], a[236:239], v[108:111]
    v_mfma_f32_16x16x32_bf16 v[108:111], v[36:39], a[252:255], v[108:111]
    v_mfma_f32_16x16x32_bf16 v[108:111], v[40:43], a[160:163], v[108:111]
    v_mfma_f32_16x16x32_bf16 v[108:111], v[44:47], a[176:179], v[108:111]
    s_waitcnt lgkmcnt(0)
    v_mfma_f32_16x16x32_bf16 v[112:115], v[16:19], a[224:227], v[112:115]
    s_waitcnt vmcnt(32)
    s_barrier
    v_mfma_f32_16x16x32_bf16 v[112:115], v[20:23], a[240:243], v[112:115]
    ds_read_b64_tr_b16 v[32:33], v77 offset:0
    v_mfma_f32_16x16x32_bf16 v[112:115], v[24:27], a[148:151], v[112:115]
    ds_read_b64_tr_b16 v[34:35], v77 offset:4608
    v_mfma_f32_16x16x32_bf16 v[112:115], v[28:31], a[164:167], v[112:115]
    ds_read_b64_tr_b16 v[36:37], v77 offset:9216
    v_mfma_f32_16x16x32_bf16 v[116:119], v[16:19], a[228:231], v[116:119]
    ds_read_b64_tr_b16 v[38:39], v77 offset:13824
    v_mfma_f32_16x16x32_bf16 v[116:119], v[20:23], a[244:247], v[116:119]
    ds_read_b64_tr_b16 v[40:41], v77 offset:18432
    v_mfma_f32_16x16x32_bf16 v[116:119], v[24:27], a[152:155], v[116:119]
    ds_read_b64_tr_b16 v[42:43], v77 offset:23040
    v_mfma_f32_16x16x32_bf16 v[116:119], v[28:31], a[168:171], v[116:119]
    ds_read_b64_tr_b16 v[44:45], v77 offset:27648
    v_mfma_f32_16x16x32_bf16 v[120:123], v[16:19], a[232:235], v[120:123]
    ds_read_b64_tr_b16 v[46:47], v77 offset:32256
    v_mfma_f32_16x16x32_bf16 v[120:123], v[20:23], a[248:251], v[120:123]
    buffer_atomic_add v14, v6, s[60:63], s87 offen
    v_mfma_f32_16x16x32_bf16 v[120:123], v[24:27], a[156:159], v[120:123]
    buffer_load_dwordx4 a[56:59], v1, s[36:39], s49 offen offset:2048 sc1
    v_mfma_f32_16x16x32_bf16 v[120:123], v[28:31], a[172:175], v[120:123]
    buffer_load_dwordx4 a[60:63], v1, s[36:39], s49 offen offset:3072 sc1
    v_mfma_f32_16x16x32_bf16 v[124:127], v[16:19], a[236:239], v[124:127]
    s_waitcnt vmcnt(10)
    ds_read_b64_tr_b16 v[16:17], v77 offset:32
    v_mfma_f32_16x16x32_bf16 v[124:127], v[20:23], a[252:255], v[124:127]
    ds_read_b64_tr_b16 v[18:19], v77 offset:4640
    v_readfirstlane_b32 s3, v78
    v_mfma_f32_16x16x32_bf16 v[124:127], v[24:27], a[160:163], v[124:127]
    ds_read_b64_tr_b16 v[20:21], v77 offset:9248
    v_mfma_f32_16x16x32_bf16 v[124:127], v[28:31], a[176:179], v[124:127]
    s_waitcnt vmcnt(26) lgkmcnt(3)
    ds_read_b64_tr_b16 v[22:23], v77 offset:13856
    v_mfma_f32_16x16x32_bf16 v[224:227], v[32:35], a[212:215], v[224:227]
    ds_read_b64_tr_b16 v[24:25], v77 offset:18464
    v_mfma_f32_16x16x32_bf16 v[224:227], v[36:39], a[132:135], v[224:227]
    ds_read_b64_tr_b16 v[26:27], v77 offset:23072
    v_mfma_f32_16x16x32_bf16 v[224:227], v[40:43], a[180:183], v[224:227]
    s_add_u32 m0, s46, 73728
    ds_read_b64_tr_b16 v[28:29], v77 offset:27680
    v_mfma_f32_16x16x32_bf16 v[224:227], v[44:47], a[196:199], v[224:227]
    s_add_u32 s47, s14, 331776
    ds_read_b64_tr_b16 v[30:31], v77 offset:32288
    v_mfma_f32_16x16x32_bf16 v[228:231], v[32:35], a[216:219], v[228:231]
    s_bfe_u32 s3, s3, 0x80010
    s_cmp_lt_u32 s3, s48
    s_cbranch_scc1 L_dep6
L_dep6_ret:
    v_mfma_f32_16x16x32_bf16 v[228:231], v[36:39], a[136:139], v[228:231]
    s_add_u32 s47, s47, s1
    v_mfma_f32_16x16x32_bf16 v[228:231], v[40:43], a[184:187], v[228:231]
    buffer_load_dwordx4 v64, s[16:19], s47 offen lds
    v_mfma_f32_16x16x32_bf16 v[228:231], v[44:47], a[200:203], v[228:231]
    s_add_u32 s49, s12, 36864
    v_mfma_f32_16x16x32_bf16 v[232:235], v[32:35], a[220:223], v[232:235]
    v_mfma_f32_16x16x32_bf16 v[232:235], v[36:39], a[140:143], v[232:235]
    v_mfma_f32_16x16x32_bf16 v[232:235], v[40:43], a[188:191], v[232:235]
    buffer_load_dwordx4 a[224:227], v1, s[36:39], s49 offen offset:0 sc1
    v_mfma_f32_16x16x32_bf16 v[232:235], v[44:47], a[204:207], v[232:235]
    v_mfma_f32_16x16x32_bf16 v[236:239], v[32:35], a[128:131], v[236:239]
    s_add_u32 m0, s46, 74752
    ds_read_b64_tr_b16 v[32:33], v77 offset:64
    v_mfma_f32_16x16x32_bf16 v[236:239], v[36:39], a[144:147], v[236:239]
    ds_read_b64_tr_b16 v[34:35], v77 offset:4672
    v_mfma_f32_16x16x32_bf16 v[236:239], v[40:43], a[192:195], v[236:239]
    ds_read_b64_tr_b16 v[36:37], v77 offset:9280
    v_mfma_f32_16x16x32_bf16 v[236:239], v[44:47], a[208:211], v[236:239]
    s_waitcnt lgkmcnt(3)
    ds_read_b64_tr_b16 v[38:39], v77 offset:13888
    v_mfma_f32_16x16x32_bf16 v[80:83], v[16:19], a[212:215], v[80:83]
    ds_read_b64_tr_b16 v[40:41], v77 offset:18496
    v_mfma_f32_16x16x32_bf16 v[80:83], v[20:23], a[132:135], v[80:83]
    ds_read_b64_tr_b16 v[42:43], v77 offset:23104
    v_mfma_f32_16x16x32_bf16 v[80:83], v[24:27], a[180:183], v[80:83]
    ds_read_b64_tr_b16 v[44:45], v77 offset:27712
    v_mfma_f32_16x16x32_bf16 v[80:83], v[28:31], a[196:199], v[80:83]
    ds_read_b64_tr_b16 v[46:47], v77 offset:32320
    v_mfma_f32_16x16x32_bf16 v[84:87], v[16:19], a[216:219], v[84:87]
    buffer_load_dwordx4 v65, s[16:19], s47 offen lds
    v_mfma_f32_16x16x32_bf16 v[84:87], v[20:23], a[136:139], v[84:87]
    buffer_load_dwordx4 a[228:231], v1, s[36:39], s49 offen offset:1024 sc1
    v_mfma_f32_16x16x32_bf16 v[84:87], v[24:27], a[184:187], v[84:87]
    v_mfma_f32_16x16x32_bf16 v[84:87], v[28:31], a[200:203], v[84:87]
    s_add_u32 m0, s46, 75776
    v_mfma_f32_16x16x32_bf16 v[88:91], v[16:19], a[220:223], v[88:91]
    v_mfma_f32_16x16x32_bf16 v[88:91], v[20:23], a[140:143], v[88:91]
    v_mfma_f32_16x16x32_bf16 v[88:91], v[24:27], a[188:191], v[88:91]
    buffer_load_dwordx4 v66, s[16:19], s47 offen lds
    v_mfma_f32_16x16x32_bf16 v[88:91], v[28:31], a[204:207], v[88:91]
    v_mfma_f32_16x16x32_bf16 v[92:95], v[16:19], a[128:131], v[92:95]
    ds_read_b64_tr_b16 v[16:17], v77 offset:96
    v_mfma_f32_16x16x32_bf16 v[92:95], v[20:23], a[144:147], v[92:95]
    ds_read_b64_tr_b16 v[18:19], v77 offset:4704
    v_mfma_f32_16x16x32_bf16 v[92:95], v[24:27], a[192:195], v[92:95]
    ds_read_b64_tr_b16 v[20:21], v77 offset:9312
    v_mfma_f32_16x16x32_bf16 v[92:95], v[28:31], a[208:211], v[92:95]
    s_waitcnt lgkmcnt(3)
    ds_read_b64_tr_b16 v[22:23], v77 offset:13920
    v_mfma_f32_16x16x32_bf16 a[64:67], v[32:35], a[212:215], a[64:67]
    ds_read_b64_tr_b16 v[24:25], v77 offset:18528
    v_mfma_f32_16x16x32_bf16 a[64:67], v[36:39], a[132:135], a[64:67]
    ds_read_b64_tr_b16 v[26:27], v77 offset:23136
    v_mfma_f32_16x16x32_bf16 a[64:67], v[40:43], a[180:183], a[64:67]
    ds_read_b64_tr_b16 v[28:29], v77 offset:27744
    v_mfma_f32_16x16x32_bf16 a[64:67], v[44:47], a[196:199], a[64:67]
    ds_read_b64_tr_b16 v[30:31], v77 offset:32352
    v_mfma_f32_16x16x32_bf16 a[68:71], v[32:35], a[216:219], a[68:71]
    buffer_load_dwordx4 a[232:235], v1, s[36:39], s49 offen offset:2048 sc1
    v_mfma_f32_16x16x32_bf16 a[68:71], v[36:39], a[136:139], a[68:71]
    s_add_u32 m0, s46, 76800
    v_mfma_f32_16x16x32_bf16 a[68:71], v[40:43], a[184:187], a[68:71]
    buffer_load_dwordx4 v67, s[16:19], s47 offen lds
    v_mfma_f32_16x16x32_bf16 a[68:71], v[44:47], a[200:203], a[68:71]
    v_mfma_f32_16x16x32_bf16 a[72:75], v[32:35], a[220:223], a[72:75]
    v_mfma_f32_16x16x32_bf16 a[72:75], v[36:39], a[140:143], a[72:75]
    v_mfma_f32_16x16x32_bf16 a[72:75], v[40:43], a[188:191], a[72:75]
    buffer_load_dwordx4 a[236:239], v1, s[36:39], s49 offen offset:3072 sc1
    v_mfma_f32_16x16x32_bf16 a[72:75], v[44:47], a[204:207], a[72:75]
    v_mfma_f32_16x16x32_bf16 a[76:79], v[32:35], a[128:131], a[76:79]
    ds_read_b64_tr_b16 v[32:33], v77 offset:128
    v_mfma_f32_16x16x32_bf16 a[76:79], v[36:39], a[144:147], a[76:79]
    s_add_u32 m0, s46, 77824
    ds_read_b64_tr_b16 v[34:35], v77 offset:4736
    v_mfma_f32_16x16x32_bf16 a[76:79], v[40:43], a[192:195], a[76:79]
    ds_read_b64_tr_b16 v[36:37], v77 offset:9344
    v_mfma_f32_16x16x32_bf16 a[76:79], v[44:47], a[208:211], a[76:79]
    s_waitcnt lgkmcnt(3)
    ds_read_b64_tr_b16 v[38:39], v77 offset:13952
    v_mfma_f32_16x16x32_bf16 a[80:83], v[16:19], a[212:215], a[80:83]
    ds_read_b64_tr_b16 v[40:41], v77 offset:18560
    v_mfma_f32_16x16x32_bf16 a[80:83], v[20:23], a[132:135], a[80:83]
    ds_read_b64_tr_b16 v[42:43], v77 offset:23168
    v_mfma_f32_16x16x32_bf16 a[80:83], v[24:27], a[180:183], a[80:83]
    ds_read_b64_tr_b16 v[44:45], v77 offset:27776
    v_mfma_f32_16x16x32_bf16 a[80:83], v[28:31], a[196:199], a[80:83]
    ds_read_b64_tr_b16 v[46:47], v77 offset:32384
    v_mfma_f32_16x16x32_bf16 a[84:87], v[16:19], a[216:219], a[84:87]
    buffer_load_dwordx4 v68, s[16:19], s47 offen lds
    v_mfma_f32_16x16x32_bf16 a[84:87], v[20:23], a[136:139], a[84:87]
    s_add_u32 s49, s12, 45056
    v_mfma_f32_16x16x32_bf16 a[84:87], v[24:27], a[184:187], a[84:87]
    buffer_load_dwordx4 a[240:243], v1, s[36:39], s49 offen offset:0 sc1
    v_mfma_f32_16x16x32_bf16 a[84:87], v[28:31], a[200:203], a[84:87]
    v_mfma_f32_16x16x32_bf16 a[88:91], v[16:19], a[220:223], a[88:91]
    s_add_u32 m0, s46, 78848
    v_accvgpr_read_b32 v128, a64
    v_accvgpr_read_b32 v129, a65
    v_mfma_f32_16x16x32_bf16 a[88:91], v[20:23], a[140:143], a[88:91]
    v_accvgpr_read_b32 v130, a66
    v_accvgpr_read_b32 v131, a67
    v_mfma_f32_16x16x32_bf16 a[88:91], v[24:27], a[188:191], a[88:91]
    v_accvgpr_read_b32 v132, a68
    v_accvgpr_read_b32 v133, a69
    v_mfma_f32_16x16x32_bf16 a[88:91], v[28:31], a[204:207], a[88:91]
    buffer_load_dwordx4 v69, s[16:19], s47 offen lds
    v_mfma_f32_16x16x32_bf16 a[92:95], v[16:19], a[128:131], a[92:95]
    ds_read_b64_tr_b16 v[16:17], v77 offset:160
    v_accvgpr_read_b32 v134, a70
    v_mfma_f32_16x16x32_bf16 a[92:95], v[20:23], a[144:147], a[92:95]
    ds_read_b64_tr_b16 v[18:19], v77 offset:4768
    v_accvgpr_read_b32 v135, a71
    v_mfma_f32_16x16x32_bf16 a[92:95], v[24:27], a[192:195], a[92:95]
    ds_read_b64_tr_b16 v[20:21], v77 offset:9376
    v_accvgpr_read_b32 v136, a72
    v_mfma_f32_16x16x32_bf16 a[92:95], v[28:31], a[208:211], a[92:95]
    s_waitcnt lgkmcnt(3)
    ds_read_b64_tr_b16 v[22:23], v77 offset:13984
    v_mfma_f32_16x16x32_bf16 a[96:99], v[32:35], a[212:215], a[96:99]
    ds_read_b64_tr_b16 v[24:25], v77 offset:18592
    v_accvgpr_read_b32 v137, a73
    v_mfma_f32_16x16x32_bf16 a[96:99], v[36:39], a[132:135], a[96:99]
    ds_read_b64_tr_b16 v[26:27], v77 offset:23200
    v_accvgpr_read_b32 v138, a74
    v_mfma_f32_16x16x32_bf16 a[96:99], v[40:43], a[180:183], a[96:99]
    ds_read_b64_tr_b16 v[28:29], v77 offset:27808
    v_accvgpr_read_b32 v139, a75
    v_mfma_f32_16x16x32_bf16 a[96:99], v[44:47], a[196:199], a[96:99]
    ds_read_b64_tr_b16 v[30:31], v77 offset:32416
    v_accvgpr_read_b32 v140, a76
    v_mfma_f32_16x16x32_bf16 a[100:103], v[32:35], a[216:219], a[100:103]
    buffer_load_dwordx4 a[244:247], v1, s[36:39], s49 offen offset:1024 sc1
    v_mfma_f32_16x16x32_bf16 a[100:103], v[36:39], a[136:139], a[100:103]
    s_add_u32 m0, s46, 79872
    v_accvgpr_read_b32 v141, a77
    v_accvgpr_read_b32 v142, a78
    v_mfma_f32_16x16x32_bf16 a[100:103], v[40:43], a[184:187], a[100:103]
    buffer_load_dwordx4 v70, s[16:19], s47 offen lds
    v_mfma_f32_16x16x32_bf16 a[100:103], v[44:47], a[200:203], a[100:103]
    v_accvgpr_read_b32 v143, a79
    v_mfma_f32_16x16x32_bf16 a[104:107], v[32:35], a[220:223], a[104:107]
    v_accvgpr_read_b32 v144, a80
    v_accvgpr_read_b32 v145, a81
    v_mfma_f32_16x16x32_bf16 a[104:107], v[36:39], a[140:143], a[104:107]
    v_accvgpr_read_b32 v146, a82
    v_accvgpr_read_b32 v147, a83
    v_mfma_f32_16x16x32_bf16 a[104:107], v[40:43], a[188:191], a[104:107]
    v_accvgpr_read_b32 v148, a84
    v_accvgpr_read_b32 v149, a85
    v_mfma_f32_16x16x32_bf16 a[104:107], v[44:47], a[204:207], a[104:107]
    buffer_load_dwordx4 a[248:251], v1, s[36:39], s49 offen offset:2048 sc1
    v_mfma_f32_16x16x32_bf16 a[108:111], v[32:35], a[128:131], a[108:111]
    ds_read_b64_tr_b16 v[32:33], v77 offset:192
    v_accvgpr_read_b32 v150, a86
    v_mfma_f32_16x16x32_bf16 a[108:111], v[36:39], a[144:147], a[108:111]
    s_add_u32 m0, s46, 80896
    ds_read_b64_tr_b16 v[34:35], v77 offset:4800
    v_mfma_f32_16x16x32_bf16 a[108:111], v[40:43], a[192:195], a[108:111]
    ds_read_b64_tr_b16 v[36:37], v77 offset:9408
    v_accvgpr_read_b32 v151, a87
    v_mfma_f32_16x16x32_bf16 a[108:111], v[44:47], a[208:211], a[108:111]
    s_waitcnt lgkmcnt(3)
    ds_read_b64_tr_b16 v[38:39], v77 offset:14016
    v_mfma_f32_16x16x32_bf16 a[112:115], v[16:19], a[212:215], a[112:115]
    ds_read_b64_tr_b16 v[40:41], v77 offset:18624
    v_accvgpr_read_b32 v152, a88
    v_mfma_f32_16x16x32_bf16 a[112:115], v[20:23], a[132:135], a[112:115]
    ds_read_b64_tr_b16 v[42:43], v77 offset:23232
    v_accvgpr_read_b32 v153, a89
    v_mfma_f32_16x16x32_bf16 a[112:115], v[24:27], a[180:183], a[112:115]
    ds_read_b64_tr_b16 v[44:45], v77 offset:27840
    v_accvgpr_read_b32 v154, a90
    v_mfma_f32_16x16x32_bf16 a[112:115], v[28:31], a[196:199], a[112:115]
    ds_read_b64_tr_b16 v[46:47], v77 offset:32448
    v_accvgpr_read_b32 v155, a91
    v_mfma_f32_16x16x32_bf16 a[116:119], v[16:19], a[216:219], a[116:119]
    buffer_load_dwordx4 v71, s[16:19], s47 offen lds
    v_mfma_f32_16x16x32_bf16 a[116:119], v[20:23], a[136:139], a[116:119]
    buffer_load_dword v78, v6, s[60:63], s97 offen sc1
    v_mfma_f32_16x16x32_bf16 a[116:119], v[24:27], a[184:187], a[116:119]
    buffer_load_dwordx4 a[252:255], v1, s[36:39], s49 offen offset:3072 sc1
    v_mfma_f32_16x16x32_bf16 a[116:119], v[28:31], a[200:203], a[116:119]
    v_accvgpr_read_b32 v156, a92
    v_accvgpr_read_b32 v157, a93
    v_mfma_f32_16x16x32_bf16 a[120:123], v[16:19], a[220:223], a[120:123]
    s_add_u32 m0, s46, 81920
    v_accvgpr_read_b32 v158, a94
    v_accvgpr_read_b32 v159, a95
    v_mfma_f32_16x16x32_bf16 a[120:123], v[20:23], a[140:143], a[120:123]
    v_accvgpr_read_b32 v160, a96
    v_accvgpr_read_b32 v161, a97
    v_mfma_f32_16x16x32_bf16 a[120:123], v[24:27], a[188:191], a[120:123]
    v_accvgpr_read_b32 v162, a98
    v_accvgpr_read_b32 v163, a99
    v_mfma_f32_16x16x32_bf16 a[120:123], v[28:31], a[204:207], a[120:123]
    buffer_load_dwordx4 v72, s[16:19], s47 offen lds
    v_mfma_f32_16x16x32_bf16 a[124:127], v[16:19], a[128:131], a[124:127]
    ds_read_b64_tr_b16 v[16:17], v77 offset:224
    v_accvgpr_read_b32 v164, a100
    v_mfma_f32_16x16x32_bf16 a[124:127], v[20:23], a[144:147], a[124:127]
    s_add_u32 s49, s12, 53248
    ds_read_b64_tr_b16 v[18:19], v77 offset:4832
    v_mfma_f32_16x16x32_bf16 a[124:127], v[24:27], a[192:195], a[124:127]
    ds_read_b64_tr_b16 v[20:21], v77 offset:9440
    v_accvgpr_read_b32 v165, a101
    v_mfma_f32_16x16x32_bf16 a[124:127], v[28:31], a[208:211], a[124:127]
    s_waitcnt lgkmcnt(3)
    ds_read_b64_tr_b16 v[22:23], v77 offset:14048
    v_mfma_f32_16x16x32_bf16 v[240:243], v[32:35], a[212:215], v[240:243]
    ds_read_b64_tr_b16 v[24:25], v77 offset:18656
    v_accvgpr_read_b32 v166, a102
    v_mfma_f32_16x16x32_bf16 v[240:243], v[36:39], a[132:135], v[240:243]
    ds_read_b64_tr_b16 v[26:27], v77 offset:23264
    v_accvgpr_read_b32 v167, a103
    v_mfma_f32_16x16x32_bf16 v[240:243], v[40:43], a[180:183], v[240:243]
    ds_read_b64_tr_b16 v[28:29], v77 offset:27872
    v_accvgpr_read_b32 v168, a104
    v_mfma_f32_16x16x32_bf16 v[240:243], v[44:47], a[196:199], v[240:243]
    ds_read_b64_tr_b16 v[30:31], v77 offset:32480
    v_accvgpr_read_b32 v169, a105
    v_mfma_f32_16x16x32_bf16 v[244:247], v[32:35], a[216:219], v[244:247]
    buffer_load_dwordx4 a[148:151], v1, s[36:39], s49 offen offset:0 sc1
    v_mfma_f32_16x16x32_bf16 v[244:247], v[36:39], a[136:139], v[244:247]
    v_accvgpr_read_b32 v170, a106
    v_accvgpr_read_b32 v171, a107
    v_mfma_f32_16x16x32_bf16 v[244:247], v[40:43], a[184:187], v[244:247]
    buffer_load_dwordx4 a[152:155], v1, s[36:39], s49 offen offset:1024 sc1
    v_mfma_f32_16x16x32_bf16 v[244:247], v[44:47], a[200:203], v[244:247]
    v_accvgpr_read_b32 v172, a108
    v_accvgpr_read_b32 v173, a109
    v_mfma_f32_16x16x32_bf16 v[248:251], v[32:35], a[220:223], v[248:251]
    v_accvgpr_read_b32 v174, a110
    v_accvgpr_read_b32 v175, a111
    v_mfma_f32_16x16x32_bf16 v[248:251], v[36:39], a[140:143], v[248:251]
    v_accvgpr_read_b32 v176, a112
    v_accvgpr_read_b32 v177, a113
    v_mfma_f32_16x16x32_bf16 v[248:251], v[40:43], a[188:191], v[248:251]
    v_accvgpr_read_b32 v178, a114
    v_accvgpr_read_b32 v179, a115
    v_mfma_f32_16x16x32_bf16 v[248:251], v[44:47], a[204:207], v[248:251]
    buffer_load_dwordx4 a[156:159], v1, s[36:39], s49 offen offset:2048 sc1
    v_mfma_f32_16x16x32_bf16 v[252:255], v[32:35], a[128:131], v[252:255]
    ds_read_b64_tr_b16 v[32:33], v77 offset:256
    v_accvgpr_read_b32 v180, a116
    v_mfma_f32_16x16x32_bf16 v[252:255], v[36:39], a[144:147], v[252:255]
    ds_read_b64_tr_b16 v[34:35], v77 offset:4864
    v_accvgpr_read_b32 v181, a117
    v_mfma_f32_16x16x32_bf16 v[252:255], v[40:43], a[192:195], v[252:255]
    ds_read_b64_tr_b16 v[36:37], v77 offset:9472
    v_accvgpr_read_b32 v182, a118
    v_mfma_f32_16x16x32_bf16 v[252:255], v[44:47], a[208:211], v[252:255]
    s_waitcnt lgkmcnt(3)
    ds_read_b64_tr_b16 v[38:39], v77 offset:14080
    v_mfma_f32_16x16x32_bf16 v[96:99], v[16:19], a[212:215], v[96:99]
    ds_read_b64_tr_b16 v[40:41], v77 offset:18688
    v_accvgpr_read_b32 v183, a119
    v_mfma_f32_16x16x32_bf16 v[96:99], v[20:23], a[132:135], v[96:99]
    ds_read_b64_tr_b16 v[42:43], v77 offset:23296
    v_accvgpr_read_b32 v184, a120
    v_mfma_f32_16x16x32_bf16 v[96:99], v[24:27], a[180:183], v[96:99]
    ds_read_b64_tr_b16 v[44:45], v77 offset:27904
    v_accvgpr_read_b32 v185, a121
    v_mfma_f32_16x16x32_bf16 v[96:99], v[28:31], a[196:199], v[96:99]
    ds_read_b64_tr_b16 v[46:47], v77 offset:32512
    v_accvgpr_read_b32 v186, a122
    v_mfma_f32_16x16x32_bf16 v[100:103], v[16:19], a[216:219], v[100:103]
    buffer_load_dwordx4 a[160:163], v1, s[36:39], s49 offen offset:3072 sc1
    v_mfma_f32_16x16x32_bf16 v[100:103], v[20:23], a[136:139], v[100:103]
    s_add_u32 s49, s12, 61440
    v_accvgpr_read_b32 v187, a123
    v_accvgpr_read_b32 v188, a124
    v_mfma_f32_16x16x32_bf16 v[100:103], v[24:27], a[184:187], v[100:103]
    buffer_load_dwordx4 a[164:167], v1, s[36:39], s49 offen offset:0 sc1
    v_mfma_f32_16x16x32_bf16 v[100:103], v[28:31], a[200:203], v[100:103]
    v_accvgpr_read_b32 v189, a125
    v_accvgpr_read_b32 v190, a126
    v_mfma_f32_16x16x32_bf16 v[104:107], v[16:19], a[220:223], v[104:107]
    v_accvgpr_read_b32 v191, a127
    v_mfma_f32_16x16x32_bf16 v[104:107], v[20:23], a[140:143], v[104:107]
    v_mfma_f32_16x16x32_bf16 v[104:107], v[24:27], a[188:191], v[104:107]
    v_mfma_f32_16x16x32_bf16 v[104:107], v[28:31], a[204:207], v[104:107]
    buffer_load_dwordx4 a[168:171], v1, s[36:39], s49 offen offset:1024 sc1
    v_mfma_f32_16x16x32_bf16 v[108:111], v[16:19], a[128:131], v[108:111]
    v_mfma_f32_16x16x32_bf16 v[108:111], v[20:23], a[144:147], v[108:111]
    v_mfma_f32_16x16x32_bf16 v[108:111], v[24:27], a[192:195], v[108:111]
    v_mfma_f32_16x16x32_bf16 v[108:111], v[28:31], a[208:211], v[108:111]
    s_waitcnt lgkmcnt(0)
    v_mfma_f32_16x16x32_bf16 v[112:115], v[32:35], a[212:215], v[112:115]
    s_waitcnt vmcnt(32)
    s_barrier
    v_mfma_f32_16x16x32_bf16 v[112:115], v[36:39], a[132:135], v[112:115]
    ds_read_b64_tr_b16 v[16:17], v73 offset:0
    v_mfma_f32_16x16x32_bf16 v[112:115], v[40:43], a[180:183], v[112:115]
    ds_read_b64_tr_b16 v[18:19], v73 offset:4608
    v_mfma_f32_16x16x32_bf16 v[112:115], v[44:47], a[196:199], v[112:115]
    ds_read_b64_tr_b16 v[20:21], v73 offset:9216
    v_mfma_f32_16x16x32_bf16 v[116:119], v[32:35], a[216:219], v[116:119]
    ds_read_b64_tr_b16 v[22:23], v73 offset:13824
    v_mfma_f32_16x16x32_bf16 v[116:119], v[36:39], a[136:139], v[116:119]
    ds_read_b64_tr_b16 v[24:25], v73 offset:18432
    v_mfma_f32_16x16x32_bf16 v[116:119], v[40:43], a[184:187], v[116:119]
    ds_read_b64_tr_b16 v[26:27], v73 offset:23040
    v_mfma_f32_16x16x32_bf16 v[116:119], v[44:47], a[200:203], v[116:119]
    ds_read_b64_tr_b16 v[28:29], v73 offset:27648
    v_mfma_f32_16x16x32_bf16 v[120:123], v[32:35], a[220:223], v[120:123]
    ds_read_b64_tr_b16 v[30:31], v73 offset:32256
    v_mfma_f32_16x16x32_bf16 v[120:123], v[36:39], a[140:143], v[120:123]
    buffer_load_dwordx4 a[172:175], v1, s[36:39], s49 offen offset:2048 sc1
    v_mfma_f32_16x16x32_bf16 v[120:123], v[40:43], a[188:191], v[120:123]
    buffer_load_dwordx4 a[176:179], v1, s[36:39], s49 offen offset:3072 sc1
    v_mfma_f32_16x16x32_bf16 v[120:123], v[44:47], a[204:207], v[120:123]
    global_load_dword v79, v[4:5], off
    v_mfma_f32_16x16x32_bf16 v[124:127], v[32:35], a[128:131], v[124:127]
    s_waitcnt vmcnt(10)
    ds_read_b64_tr_b16 v[32:33], v73 offset:32
    v_mfma_f32_16x16x32_bf16 v[124:127], v[36:39], a[144:147], v[124:127]
    ds_read_b64_tr_b16 v[34:35], v73 offset:4640
    v_readfirstlane_b32 s3, v78
    v_mfma_f32_16x16x32_bf16 v[124:127], v[40:43], a[192:195], v[124:127]
    ds_read_b64_tr_b16 v[36:37], v73 offset:9248
    v_mfma_f32_16x16x32_bf16 v[124:127], v[44:47], a[208:211], v[124:127]
    s_waitcnt vmcnt(26) lgkmcnt(3)
    ds_read_b64_tr_b16 v[38:39], v73 offset:13856
    v_mfma_f32_16x16x32_bf16 v[224:227], v[16:19], a[0:3], v[224:227]
    ds_read_b64_tr_b16 v[40:41], v73 offset:18464
    v_mfma_f32_16x16x32_bf16 v[224:227], v[20:23], a[16:19], v[224:227]
    ds_read_b64_tr_b16 v[42:43], v73 offset:23072
    v_mfma_f32_16x16x32_bf16 v[224:227], v[24:27], a[32:35], v[224:227]
    s_add_u32 m0, s46, 110592
    ds_read_b64_tr_b16 v[44:45], v73 offset:27680
    v_mfma_f32_16x16x32_bf16 v[224:227], v[28:31], a[48:51], v[224:227]
    s_add_u32 s47, s55, 331776
    ds_read_b64_tr_b16 v[46:47], v73 offset:32288
    v_mfma_f32_16x16x32_bf16 v[228:231], v[16:19], a[4:7], v[228:231]
    s_bfe_u32 s3, s3, 0x80010
    s_cmp_lt_u32 s3, s48
    s_cbranch_scc1 L_dep7
L_dep7_ret:
    v_mfma_f32_16x16x32_bf16 v[228:231], v[20:23], a[20:23], v[228:231]
    s_add_u32 s47, s47, s1
    v_mfma_f32_16x16x32_bf16 v[228:231], v[24:27], a[36:39], v[228:231]
    buffer_load_dwordx4 v64, s[16:19], s47 offen lds
    v_mfma_f32_16x16x32_bf16 v[228:231], v[28:31], a[52:55], v[228:231]
    s_add_u32 s49, s13, 36864
    v_mfma_f32_16x16x32_bf16 v[232:235], v[16:19], a[8:11], v[232:235]
    v_mfma_f32_16x16x32_bf16 v[232:235], v[20:23], a[24:27], v[232:235]
    v_mfma_f32_16x16x32_bf16 v[232:235], v[24:27], a[40:43], v[232:235]
    buffer_load_dwordx4 a[212:215], v1, s[36:39], s49 offen offset:0 sc1
    v_mfma_f32_16x16x32_bf16 v[232:235], v[28:31], a[56:59], v[232:235]
    v_mfma_f32_16x16x32_bf16 v[236:239], v[16:19], a[12:15], v[236:239]
    s_add_u32 m0, s46, 111616
    ds_read_b64_tr_b16 v[16:17], v73 offset:64
    v_mfma_f32_16x16x32_bf16 v[236:239], v[20:23], a[28:31], v[236:239]
    ds_read_b64_tr_b16 v[18:19], v73 offset:4672
    v_mfma_f32_16x16x32_bf16 v[236:239], v[24:27], a[44:47], v[236:239]
    ds_read_b64_tr_b16 v[20:21], v73 offset:9280
    v_mfma_f32_16x16x32_bf16 v[236:239], v[28:31], a[60:63], v[236:239]
    s_waitcnt lgkmcnt(3)
    ds_read_b64_tr_b16 v[22:23], v73 offset:13888
    v_mfma_f32_16x16x32_bf16 v[80:83], v[32:35], a[0:3], v[80:83]
    ds_read_b64_tr_b16 v[24:25], v73 offset:18496
    v_mfma_f32_16x16x32_bf16 v[80:83], v[36:39], a[16:19], v[80:83]
    ds_read_b64_tr_b16 v[26:27], v73 offset:23104
    v_mfma_f32_16x16x32_bf16 v[80:83], v[40:43], a[32:35], v[80:83]
    ds_read_b64_tr_b16 v[28:29], v73 offset:27712
    v_mfma_f32_16x16x32_bf16 v[80:83], v[44:47], a[48:51], v[80:83]
    ds_read_b64_tr_b16 v[30:31], v73 offset:32320
    v_mfma_f32_16x16x32_bf16 v[84:87], v[32:35], a[4:7], v[84:87]
    buffer_load_dwordx4 v65, s[16:19], s47 offen lds
    v_mfma_f32_16x16x32_bf16 v[84:87], v[36:39], a[20:23], v[84:87]
    buffer_load_dwordx4 a[216:219], v1, s[36:39], s49 offen offset:1024 sc1
    v_mfma_f32_16x16x32_bf16 v[84:87], v[40:43], a[36:39], v[84:87]
    v_mfma_f32_16x16x32_bf16 v[84:87], v[44:47], a[52:55], v[84:87]
    s_add_u32 m0, s46, 112640
    v_mfma_f32_16x16x32_bf16 v[88:91], v[32:35], a[8:11], v[88:91]
    v_mfma_f32_16x16x32_bf16 v[88:91], v[36:39], a[24:27], v[88:91]
    v_mfma_f32_16x16x32_bf16 v[88:91], v[40:43], a[40:43], v[88:91]
    buffer_load_dwordx4 v66, s[16:19], s47 offen lds
    v_mfma_f32_16x16x32_bf16 v[88:91], v[44:47], a[56:59], v[88:91]
    v_mfma_f32_16x16x32_bf16 v[92:95], v[32:35], a[12:15], v[92:95]
    ds_read_b64_tr_b16 v[32:33], v73 offset:96
    v_mfma_f32_16x16x32_bf16 v[92:95], v[36:39], a[28:31], v[92:95]
    ds_read_b64_tr_b16 v[34:35], v73 offset:4704
    v_mfma_f32_16x16x32_bf16 v[92:95], v[40:43], a[44:47], v[92:95]
    ds_read_b64_tr_b16 v[36:37], v73 offset:9312
    v_mfma_f32_16x16x32_bf16 v[92:95], v[44:47], a[60:63], v[92:95]
    s_waitcnt lgkmcnt(3)
    ds_read_b64_tr_b16 v[38:39], v73 offset:13920
    v_mfma_f32_16x16x32_bf16 v[128:131], v[16:19], a[0:3], v[128:131]
    ds_read_b64_tr_b16 v[40:41], v73 offset:18528
    v_mfma_f32_16x16x32_bf16 v[128:131], v[20:23], a[16:19], v[128:131]
    ds_read_b64_tr_b16 v[42:43], v73 offset:23136
    v_mfma_f32_16x16x32_bf16 v[128:131], v[24:27], a[32:35], v[128:131]
    ds_read_b64_tr_b16 v[44:45], v73 offset:27744
    v_mfma_f32_16x16x32_bf16 v[128:131], v[28:31], a[48:51], v[128:131]
    ds_read_b64_tr_b16 v[46:47], v73 offset:32352
    v_mfma_f32_16x16x32_bf16 v[132:135], v[16:19], a[4:7], v[132:135]
    buffer_load_dwordx4 a[220:223], v1, s[36:39], s49 offen offset:2048 sc1
    v_mfma_f32_16x16x32_bf16 v[132:135], v[20:23], a[20:23], v[132:135]
    s_add_u32 m0, s46, 113664
    v_mfma_f32_16x16x32_bf16 v[132:135], v[24:27], a[36:39], v[132:135]
    buffer_load_dwordx4 v67, s[16:19], s47 offen lds
    v_mfma_f32_16x16x32_bf16 v[132:135], v[28:31], a[52:55], v[132:135]
    v_mfma_f32_16x16x32_bf16 v[136:139], v[16:19], a[8:11], v[136:139]
    v_mfma_f32_16x16x32_bf16 v[136:139], v[20:23], a[24:27], v[136:139]
    v_mfma_f32_16x16x32_bf16 v[136:139], v[24:27], a[40:43], v[136:139]
    buffer_load_dwordx4 a[128:131], v1, s[36:39], s49 offen offset:3072 sc1
    v_mfma_f32_16x16x32_bf16 v[136:139], v[28:31], a[56:59], v[136:139]
    v_mfma_f32_16x16x32_bf16 v[140:143], v[16:19], a[12:15], v[140:143]
    ds_read_b64_tr_b16 v[16:17], v73 offset:128
    v_mfma_f32_16x16x32_bf16 v[140:143], v[20:23], a[28:31], v[140:143]
    s_add_u32 m0, s46, 114688
    ds_read_b64_tr_b16 v[18:19], v73 offset:4736
    v_mfma_f32_16x16x32_bf16 v[140:143], v[24:27], a[44:47], v[140:143]
    ds_read_b64_tr_b16 v[20:21], v73 offset:9344
    v_mfma_f32_16x16x32_bf16 v[140:143], v[28:31], a[60:63], v[140:143]
    s_waitcnt lgkmcnt(3)
    ds_read_b64_tr_b16 v[22:23], v73 offset:13952
    v_mfma_f32_16x16x32_bf16 v[144:147], v[32:35], a[0:3], v[144:147]
    ds_read_b64_tr_b16 v[24:25], v73 offset:18560
    v_mfma_f32_16x16x32_bf16 v[144:147], v[36:39], a[16:19], v[144:147]
    ds_read_b64_tr_b16 v[26:27], v73 offset:23168
    v_mfma_f32_16x16x32_bf16 v[144:147], v[40:43], a[32:35], v[144:147]
    ds_read_b64_tr_b16 v[28:29], v73 offset:27776
    v_mfma_f32_16x16x32_bf16 v[144:147], v[44:47], a[48:51], v[144:147]
    ds_read_b64_tr_b16 v[30:31], v73 offset:32384
    v_mfma_f32_16x16x32_bf16 v[148:151], v[32:35], a[4:7], v[148:151]
    buffer_load_dwordx4 v68, s[16:19], s47 offen lds
    v_mfma_f32_16x16x32_bf16 v[148:151], v[36:39], a[20:23], v[148:151]
    s_add_u32 s49, s13, 45056
    v_mfma_f32_16x16x32_bf16 v[148:151], v[40:43], a[36:39], v[148:151]
    buffer_load_dwordx4 a[132:135], v1, s[36:39], s49 offen offset:0 sc1
    v_mfma_f32_16x16x32_bf16 v[148:151], v[44:47], a[52:55], v[148:151]
    v_mfma_f32_16x16x32_bf16 v[152:155], v[32:35], a[8:11], v[152:155]
    s_add_u32 m0, s46, 115712
    v_mfma_f32_16x16x32_bf16 v[152:155], v[36:39], a[24:27], v[152:155]
    v_mfma_f32_16x16x32_bf16 v[152:155], v[40:43], a[40:43], v[152:155]
    v_mfma_f32_16x16x32_bf16 v[152:155], v[44:47], a[56:59], v[152:155]
    buffer_load_dwordx4 v69, s[16:19], s47 offen lds
    v_mfma_f32_16x16x32_bf16 v[156:159], v[32:35], a[12:15], v[156:159]
    ds_read_b64_tr_b16 v[32:33], v73 offset:160
    v_mfma_f32_16x16x32_bf16 v[156:159], v[36:39], a[28:31], v[156:159]
    ds_read_b64_tr_b16 v[34:35], v73 offset:4768
    v_mfma_f32_16x16x32_bf16 v[156:159], v[40:43], a[44:47], v[156:159]
    ds_read_b64_tr_b16 v[36:37], v73 offset:9376
    v_mfma_f32_16x16x32_bf16 v[156:159], v[44:47], a[60:63], v[156:159]
    s_waitcnt lgkmcnt(3)
    ds_read_b64_tr_b16 v[38:39], v73 offset:13984
    v_mfma_f32_16x16x32_bf16 v[160:163], v[16:19], a[0:3], v[160:163]
    ds_read_b64_tr_b16 v[40:41], v73 offset:18592
    v_mfma_f32_16x16x32_bf16 v[160:163], v[20:23], a[16:19], v[160:163]
    ds_read_b64_tr_b16 v[42:43], v73 offset:23200
    v_mfma_f32_16x16x32_bf16 v[160:163], v[24:27], a[32:35], v[160:163]
    ds_read_b64_tr_b16 v[44:45], v73 offset:27808
    v_mfma_f32_16x16x32_bf16 v[160:163], v[28:31], a[48:51], v[160:163]
    ds_read_b64_tr_b16 v[46:47], v73 offset:32416
    v_mfma_f32_16x16x32_bf16 v[164:167], v[16:19], a[4:7], v[164:167]
    buffer_load_dwordx4 a[136:139], v1, s[36:39], s49 offen offset:1024 sc1
    v_mfma_f32_16x16x32_bf16 v[164:167], v[20:23], a[20:23], v[164:167]
    s_add_u32 m0, s46, 116736
    v_mfma_f32_16x16x32_bf16 v[164:167], v[24:27], a[36:39], v[164:167]
    buffer_load_dwordx4 v70, s[16:19], s47 offen lds
    v_mfma_f32_16x16x32_bf16 v[164:167], v[28:31], a[52:55], v[164:167]
    v_mfma_f32_16x16x32_bf16 v[168:171], v[16:19], a[8:11], v[168:171]
    v_mfma_f32_16x16x32_bf16 v[168:171], v[20:23], a[24:27], v[168:171]
    v_mfma_f32_16x16x32_bf16 v[168:171], v[24:27], a[40:43], v[168:171]
    v_mfma_f32_16x16x32_bf16 v[168:171], v[28:31], a[56:59], v[168:171]
    buffer_load_dwordx4 a[140:143], v1, s[36:39], s49 offen offset:2048 sc1
    v_mfma_f32_16x16x32_bf16 v[172:175], v[16:19], a[12:15], v[172:175]
    ds_read_b64_tr_b16 v[16:17], v73 offset:192
    v_mfma_f32_16x16x32_bf16 v[172:175], v[20:23], a[28:31], v[172:175]
    s_add_u32 m0, s46, 117760
    ds_read_b64_tr_b16 v[18:19], v73 offset:4800
    v_mfma_f32_16x16x32_bf16 v[172:175], v[24:27], a[44:47], v[172:175]
    ds_read_b64_tr_b16 v[20:21], v73 offset:9408
    v_mfma_f32_16x16x32_bf16 v[172:175], v[28:31], a[60:63], v[172:175]
    s_waitcnt lgkmcnt(3)
    ds_read_b64_tr_b16 v[22:23], v73 offset:14016
    v_mfma_f32_16x16x32_bf16 v[176:179], v[32:35], a[0:3], v[176:179]
    ds_read_b64_tr_b16 v[24:25], v73 offset:18624
    v_mfma_f32_16x16x32_bf16 v[176:179], v[36:39], a[16:19], v[176:179]
    ds_read_b64_tr_b16 v[26:27], v73 offset:23232
    v_mfma_f32_16x16x32_bf16 v[176:179], v[40:43], a[32:35], v[176:179]
    ds_read_b64_tr_b16 v[28:29], v73 offset:27840
    v_mfma_f32_16x16x32_bf16 v[176:179], v[44:47], a[48:51], v[176:179]
    ds_read_b64_tr_b16 v[30:31], v73 offset:32448
    v_mfma_f32_16x16x32_bf16 v[180:183], v[32:35], a[4:7], v[180:183]
    buffer_load_dwordx4 v71, s[16:19], s47 offen lds
    v_mfma_f32_16x16x32_bf16 v[180:183], v[36:39], a[20:23], v[180:183]
    v_mfma_f32_16x16x32_bf16 v[180:183], v[40:43], a[36:39], v[180:183]
    buffer_load_dwordx4 a[144:147], v1, s[36:39], s49 offen offset:3072 sc1
    v_mfma_f32_16x16x32_bf16 v[180:183], v[44:47], a[52:55], v[180:183]
    v_mfma_f32_16x16x32_bf16 v[184:187], v[32:35], a[8:11], v[184:187]
    s_add_u32 m0, s46, 118784
    v_mfma_f32_16x16x32_bf16 v[184:187], v[36:39], a[24:27], v[184:187]
    v_mfma_f32_16x16x32_bf16 v[184:187], v[40:43], a[40:43], v[184:187]
    v_mfma_f32_16x16x32_bf16 v[184:187], v[44:47], a[56:59], v[184:187]
    buffer_load_dwordx4 v72, s[16:19], s47 offen lds
    v_mfma_f32_16x16x32_bf16 v[188:191], v[32:35], a[12:15], v[188:191]
    ds_read_b64_tr_b16 v[32:33], v73 offset:224
    v_mfma_f32_16x16x32_bf16 v[188:191], v[36:39], a[28:31], v[188:191]
    s_add_u32 s49, s13, 53248
    ds_read_b64_tr_b16 v[34:35], v73 offset:4832
    v_mfma_f32_16x16x32_bf16 v[188:191], v[40:43], a[44:47], v[188:191]
    ds_read_b64_tr_b16 v[36:37], v73 offset:9440
    v_mfma_f32_16x16x32_bf16 v[188:191], v[44:47], a[60:63], v[188:191]
    s_waitcnt lgkmcnt(3)
    ds_read_b64_tr_b16 v[38:39], v73 offset:14048
    v_mfma_f32_16x16x32_bf16 v[240:243], v[16:19], a[0:3], v[240:243]
    ds_read_b64_tr_b16 v[40:41], v73 offset:18656
    v_mfma_f32_16x16x32_bf16 v[240:243], v[20:23], a[16:19], v[240:243]
    ds_read_b64_tr_b16 v[42:43], v73 offset:23264
    v_mfma_f32_16x16x32_bf16 v[240:243], v[24:27], a[32:35], v[240:243]
    ds_read_b64_tr_b16 v[44:45], v73 offset:27872
    v_mfma_f32_16x16x32_bf16 v[240:243], v[28:31], a[48:51], v[240:243]
    ds_read_b64_tr_b16 v[46:47], v73 offset:32480
    v_mfma_f32_16x16x32_bf16 v[244:247], v[16:19], a[4:7], v[244:247]
    buffer_load_dwordx4 a[180:183], v1, s[36:39], s49 offen offset:0 sc1
    v_mfma_f32_16x16x32_bf16 v[244:247], v[20:23], a[20:23], v[244:247]
    global_load_dword v79, v[4:5], off
    v_mfma_f32_16x16x32_bf16 v[244:247], v[24:27], a[36:39], v[244:247]
    buffer_load_dwordx4 a[184:187], v1, s[36:39], s49 offen offset:1024 sc1
    v_mfma_f32_16x16x32_bf16 v[244:247], v[28:31], a[52:55], v[244:247]
    v_mfma_f32_16x16x32_bf16 v[248:251], v[16:19], a[8:11], v[248:251]
    v_mfma_f32_16x16x32_bf16 v[248:251], v[20:23], a[24:27], v[248:251]
    v_mfma_f32_16x16x32_bf16 v[248:251], v[24:27], a[40:43], v[248:251]
    v_mfma_f32_16x16x32_bf16 v[248:251], v[28:31], a[56:59], v[248:251]
    buffer_load_dwordx4 a[188:191], v1, s[36:39], s49 offen offset:2048 sc1
    v_mfma_f32_16x16x32_bf16 v[252:255], v[16:19], a[12:15], v[252:255]
    ds_read_b64_tr_b16 v[16:17], v73 offset:256
    v_mfma_f32_16x16x32_bf16 v[252:255], v[20:23], a[28:31], v[252:255]
    ds_read_b64_tr_b16 v[18:19], v73 offset:4864
    v_mfma_f32_16x16x32_bf16 v[252:255], v[24:27], a[44:47], v[252:255]
    ds_read_b64_tr_b16 v[20:21], v73 offset:9472
    v_mfma_f32_16x16x32_bf16 v[252:255], v[28:31], a[60:63], v[252:255]
    s_waitcnt lgkmcnt(3)
    ds_read_b64_tr_b16 v[22:23], v73 offset:14080
    v_mfma_f32_16x16x32_bf16 v[96:99], v[32:35], a[0:3], v[96:99]
    ds_read_b64_tr_b16 v[24:25], v73 offset:18688
    v_mfma_f32_16x16x32_bf16 v[96:99], v[36:39], a[16:19], v[96:99]
    ds_read_b64_tr_b16 v[26:27], v73 offset:23296
    v_mfma_f32_16x16x32_bf16 v[96:99], v[40:43], a[32:35], v[96:99]
    ds_read_b64_tr_b16 v[28:29], v73 offset:27904
    v_mfma_f32_16x16x32_bf16 v[96:99], v[44:47], a[48:51], v[96:99]
    ds_read_b64_tr_b16 v[30:31], v73 offset:32512
    v_mfma_f32_16x16x32_bf16 v[100:103], v[32:35], a[4:7], v[100:103]
    buffer_load_dwordx4 a[192:195], v1, s[36:39], s49 offen offset:3072 sc1
    v_mfma_f32_16x16x32_bf16 v[100:103], v[36:39], a[20:23], v[100:103]
    s_add_u32 s49, s13, 61440
    v_mfma_f32_16x16x32_bf16 v[100:103], v[40:43], a[36:39], v[100:103]
    buffer_load_dwordx4 a[196:199], v1, s[36:39], s49 offen offset:0 sc1
    v_mfma_f32_16x16x32_bf16 v[100:103], v[44:47], a[52:55], v[100:103]
    v_mfma_f32_16x16x32_bf16 v[104:107], v[32:35], a[8:11], v[104:107]
    v_mfma_f32_16x16x32_bf16 v[104:107], v[36:39], a[24:27], v[104:107]
    v_mfma_f32_16x16x32_bf16 v[104:107], v[40:43], a[40:43], v[104:107]
    v_mfma_f32_16x16x32_bf16 v[104:107], v[44:47], a[56:59], v[104:107]
    buffer_load_dwordx4 a[200:203], v1, s[36:39], s49 offen offset:1024 sc1
    v_mfma_f32_16x16x32_bf16 v[108:111], v[32:35], a[12:15], v[108:111]
    v_mfma_f32_16x16x32_bf16 v[108:111], v[36:39], a[28:31], v[108:111]
    v_mfma_f32_16x16x32_bf16 v[108:111], v[40:43], a[44:47], v[108:111]
    v_mfma_f32_16x16x32_bf16 v[108:111], v[44:47], a[60:63], v[108:111]
    s_waitcnt lgkmcnt(0)
    v_mfma_f32_16x16x32_bf16 v[112:115], v[16:19], a[0:3], v[112:115]
    s_waitcnt vmcnt(31)
    s_barrier
    v_mfma_f32_16x16x32_bf16 v[112:115], v[20:23], a[16:19], v[112:115]
    ds_read_b64_tr_b16 v[32:33], v76 offset:0
    v_mfma_f32_16x16x32_bf16 v[112:115], v[24:27], a[32:35], v[112:115]
    ds_read_b64_tr_b16 v[34:35], v76 offset:4608
    v_mfma_f32_16x16x32_bf16 v[112:115], v[28:31], a[48:51], v[112:115]
    ds_read_b64_tr_b16 v[36:37], v76 offset:9216
    v_mfma_f32_16x16x32_bf16 v[116:119], v[16:19], a[4:7], v[116:119]
    ds_read_b64_tr_b16 v[38:39], v76 offset:13824
    v_mfma_f32_16x16x32_bf16 v[116:119], v[20:23], a[20:23], v[116:119]
    ds_read_b64_tr_b16 v[40:41], v76 offset:18432
    v_mfma_f32_16x16x32_bf16 v[116:119], v[24:27], a[36:39], v[116:119]
    ds_read_b64_tr_b16 v[42:43], v76 offset:23040
    v_mfma_f32_16x16x32_bf16 v[116:119], v[28:31], a[52:55], v[116:119]
    ds_read_b64_tr_b16 v[44:45], v76 offset:27648
    v_mfma_f32_16x16x32_bf16 v[120:123], v[16:19], a[8:11], v[120:123]
    ds_read_b64_tr_b16 v[46:47], v76 offset:32256
    v_mfma_f32_16x16x32_bf16 v[120:123], v[20:23], a[24:27], v[120:123]
    buffer_load_dwordx4 a[204:207], v1, s[36:39], s49 offen offset:2048 sc1
    v_mfma_f32_16x16x32_bf16 v[120:123], v[24:27], a[40:43], v[120:123]
    buffer_load_dwordx4 a[208:211], v1, s[36:39], s49 offen offset:3072 sc1
    v_mfma_f32_16x16x32_bf16 v[120:123], v[28:31], a[56:59], v[120:123]
    v_mfma_f32_16x16x32_bf16 v[124:127], v[16:19], a[12:15], v[124:127]
    ds_read_b64_tr_b16 v[16:17], v76 offset:32
    v_mfma_f32_16x16x32_bf16 v[124:127], v[20:23], a[28:31], v[124:127]
    ds_read_b64_tr_b16 v[18:19], v76 offset:4640
    v_mfma_f32_16x16x32_bf16 v[124:127], v[24:27], a[44:47], v[124:127]
    ds_read_b64_tr_b16 v[20:21], v76 offset:9248
    v_mfma_f32_16x16x32_bf16 v[124:127], v[28:31], a[60:63], v[124:127]
    s_waitcnt vmcnt(25) lgkmcnt(3)
    ds_read_b64_tr_b16 v[22:23], v76 offset:13856
    s_bitcmp1_b32 s0, 2
    s_cbranch_scc1 L_role_f
    v_mfma_f32_16x16x32_bf16 v[224:227], v[32:35], a[224:227], v[224:227]
    ds_read_b64_tr_b16 v[24:25], v76 offset:18464
    v_mfma_f32_16x16x32_bf16 v[224:227], v[36:39], a[240:243], v[224:227]
    ds_read_b64_tr_b16 v[26:27], v76 offset:23072
    v_mfma_f32_16x16x32_bf16 v[224:227], v[40:43], a[148:151], v[224:227]
    ds_read_b64_tr_b16 v[28:29], v76 offset:27680
    v_mfma_f32_16x16x32_bf16 v[224:227], v[44:47], a[164:167], v[224:227]
    ds_read_b64_tr_b16 v[30:31], v76 offset:32288
    v_mfma_f32_16x16x32_bf16 v[228:231], v[32:35], a[228:231], v[228:231]
    v_mfma_f32_16x16x32_bf16 v[228:231], v[36:39], a[244:247], v[228:231]
    v_mfma_f32_16x16x32_bf16 v[228:231], v[40:43], a[152:155], v[228:231]
    v_mfma_f32_16x16x32_bf16 v[228:231], v[44:47], a[168:171], v[228:231]
    v_mfma_f32_16x16x32_bf16 v[232:235], v[32:35], a[232:235], v[232:235]
    v_mfma_f32_16x16x32_bf16 v[232:235], v[36:39], a[248:251], v[232:235]
    v_mfma_f32_16x16x32_bf16 v[232:235], v[40:43], a[156:159], v[232:235]
    v_mfma_f32_16x16x32_bf16 v[232:235], v[44:47], a[172:175], v[232:235]
    v_mfma_f32_16x16x32_bf16 v[236:239], v[32:35], a[236:239], v[236:239]
    ds_read_b64_tr_b16 v[32:33], v76 offset:256
    v_mfma_f32_16x16x32_bf16 v[236:239], v[36:39], a[252:255], v[236:239]
    ds_read_b64_tr_b16 v[34:35], v76 offset:4864
    v_mfma_f32_16x16x32_bf16 v[236:239], v[40:43], a[160:163], v[236:239]
    ds_read_b64_tr_b16 v[36:37], v76 offset:9472
    v_mfma_f32_16x16x32_bf16 v[236:239], v[44:47], a[176:179], v[236:239]
    s_waitcnt lgkmcnt(3)
    ds_read_b64_tr_b16 v[38:39], v76 offset:14080
    v_mfma_f32_16x16x32_bf16 v[80:83], v[16:19], a[224:227], v[80:83]
    ds_read_b64_tr_b16 v[40:41], v76 offset:18688
    v_mfma_f32_16x16x32_bf16 v[80:83], v[20:23], a[240:243], v[80:83]
    ds_read_b64_tr_b16 v[42:43], v76 offset:23296
    v_mfma_f32_16x16x32_bf16 v[80:83], v[24:27], a[148:151], v[80:83]
    ds_read_b64_tr_b16 v[44:45], v76 offset:27904
    v_mfma_f32_16x16x32_bf16 v[80:83], v[28:31], a[164:167], v[80:83]
    ds_read_b64_tr_b16 v[46:47], v76 offset:32512
    v_mfma_f32_16x16x32_bf16 v[84:87], v[16:19], a[228:231], v[84:87]
    v_mfma_f32_16x16x32_bf16 v[84:87], v[20:23], a[244:247], v[84:87]
    v_mfma_f32_16x16x32_bf16 v[84:87], v[24:27], a[152:155], v[84:87]
    v_mfma_f32_16x16x32_bf16 v[84:87], v[28:31], a[168:171], v[84:87]
    v_mfma_f32_16x16x32_bf16 v[88:91], v[16:19], a[232:235], v[88:91]
    v_mfma_f32_16x16x32_bf16 v[88:91], v[20:23], a[248:251], v[88:91]
    v_mfma_f32_16x16x32_bf16 v[88:91], v[24:27], a[156:159], v[88:91]
    v_mfma_f32_16x16x32_bf16 v[88:91], v[28:31], a[172:175], v[88:91]
    v_mfma_f32_16x16x32_bf16 v[92:95], v[16:19], a[236:239], v[92:95]
    v_mfma_f32_16x16x32_bf16 v[92:95], v[20:23], a[252:255], v[92:95]
    v_mfma_f32_16x16x32_bf16 v[92:95], v[24:27], a[160:163], v[92:95]
    s_mov_b64 s[20:21], s[92:93]
    s_mov_b64 s[24:25], s[94:95]
    v_mfma_f32_16x16x32_bf16 v[92:95], v[28:31], a[176:179], v[92:95]
    s_waitcnt lgkmcnt(0)
    v_mfma_f32_16x16x32_bf16 v[112:115], v[32:35], a[224:227], v[112:115]
    s_waitcnt vmcnt(8)
    s_barrier
    v_mfma_f32_16x16x32_bf16 v[112:115], v[36:39], a[240:243], v[112:115]
    ds_read_b64_tr_b16 v[16:17], v77 offset:256
    v_mfma_f32_16x16x32_bf16 v[112:115], v[40:43], a[148:151], v[112:115]
    ds_read_b64_tr_b16 v[18:19], v77 offset:4864
    v_mfma_f32_16x16x32_bf16 v[112:115], v[44:47], a[164:167], v[112:115]
    ds_read_b64_tr_b16 v[20:21], v77 offset:9472
    v_mfma_f32_16x16x32_bf16 v[116:119], v[32:35], a[228:231], v[116:119]
    ds_read_b64_tr_b16 v[22:23], v77 offset:14080
    v_mfma_f32_16x16x32_bf16 v[116:119], v[36:39], a[244:247], v[116:119]
    ds_read_b64_tr_b16 v[24:25], v77 offset:18688
    v_mfma_f32_16x16x32_bf16 v[116:119], v[40:43], a[152:155], v[116:119]
    ds_read_b64_tr_b16 v[26:27], v77 offset:23296
    v_mfma_f32_16x16x32_bf16 v[116:119], v[44:47], a[168:171], v[116:119]
    ds_read_b64_tr_b16 v[28:29], v77 offset:27904
    v_mfma_f32_16x16x32_bf16 v[120:123], v[32:35], a[232:235], v[120:123]
    ds_read_b64_tr_b16 v[30:31], v77 offset:32512
    v_mfma_f32_16x16x32_bf16 v[120:123], v[36:39], a[248:251], v[120:123]
    s_lshl_b32 s5, s42, 2
    s_add_u32 s5, s5, s40
    s_lshl_b32 s5, s5, 2
    v_mfma_f32_16x16x32_bf16 v[120:123], v[40:43], a[156:159], v[120:123]
    s_and_b32 s6, s0, 3
    s_add_u32 s5, s5, s6
    s_mul_i32 s5, s5, 18432
    v_mfma_f32_16x16x32_bf16 v[120:123], v[44:47], a[172:175], v[120:123]
    s_mul_i32 s47, s6, 163840
    s_mul_i32 s6, s43, 288
    s_add_u32 s5, s5, s6
    v_mfma_f32_16x16x32_bf16 v[124:127], v[32:35], a[236:239], v[124:127]
    ds_read_b64_tr_b16 v[32:33], v76 offset:64
    v_mfma_f32_16x16x32_bf16 v[124:127], v[36:39], a[252:255], v[124:127]
    ds_read_b64_tr_b16 v[34:35], v76 offset:4672
    v_mfma_f32_16x16x32_bf16 v[124:127], v[40:43], a[160:163], v[124:127]
    ds_read_b64_tr_b16 v[36:37], v76 offset:9280
    v_mfma_f32_16x16x32_bf16 v[124:127], v[44:47], a[176:179], v[124:127]
    s_waitcnt vmcnt(0) lgkmcnt(3)
    ds_read_b64_tr_b16 v[38:39], v76 offset:13888
    v_mfma_f32_16x16x32_bf16 v[112:115], v[16:19], a[212:215], v[112:115]
    ds_read_b64_tr_b16 v[40:41], v76 offset:18496
    v_mfma_f32_16x16x32_bf16 v[112:115], v[20:23], a[132:135], v[112:115]
    ds_read_b64_tr_b16 v[42:43], v76 offset:23104
    v_mfma_f32_16x16x32_bf16 v[112:115], v[24:27], a[180:183], v[112:115]
    ds_read_b64_tr_b16 v[44:45], v76 offset:27712
    v_mfma_f32_16x16x32_bf16 v[112:115], v[28:31], a[196:199], v[112:115]
    ds_read_b64_tr_b16 v[46:47], v76 offset:32320
    v_mfma_f32_16x16x32_bf16 v[116:119], v[16:19], a[216:219], v[116:119]
    s_mul_i32 s32, s0, 20480
    s_add_u32 s33, s32, 163840
    v_mfma_f32_16x16x32_bf16 v[116:119], v[20:23], a[136:139], v[116:119]
    s_add_u32 s34, s32, 327680
    s_add_u32 s35, s32, 491520
    s_lshl_b32 s3, s42, 5
    v_mfma_f32_16x16x32_bf16 v[116:119], v[24:27], a[184:187], v[116:119]
    s_add_u32 s3, s3, s43
    s_lshl_b32 s3, s3, 8
    v_mfma_f32_16x16x32_bf16 v[116:119], v[28:31], a[200:203], v[116:119]
    s_add_u32 s52, s3, 4096
    s_add_u32 s53, s3, 5120
    v_mfma_f32_16x16x32_bf16 v[120:123], v[16:19], a[220:223], v[120:123]
    s_add_u32 s12, s5, 64
    s_add_u32 s13, s5, 128
    s_add_u32 s14, s5, 256
    v_mfma_f32_16x16x32_bf16 v[120:123], v[20:23], a[140:143], v[120:123]
    s_add_u32 s55, s47, 1024
    s_add_u32 s50, s47, 2048
    s_add_u32 s47, s47, 0
    v_mfma_f32_16x16x32_bf16 v[120:123], v[24:27], a[188:191], v[120:123]
    s_mov_b32 s22, 2359296
    s_mov_b32 s26, 2359296
    v_mfma_f32_16x16x32_bf16 v[120:123], v[28:31], a[204:207], v[120:123]
    buffer_load_dwordx2 v[192:193], v74, s[20:23], s12 offen offset:0
    v_mfma_f32_16x16x32_bf16 v[124:127], v[16:19], a[128:131], v[124:127]
    ds_read_b64_tr_b16 v[16:17], v77 offset:0
    v_mfma_f32_16x16x32_bf16 v[124:127], v[20:23], a[144:147], v[124:127]
    ds_read_b64_tr_b16 v[18:19], v77 offset:4608
    v_mfma_f32_16x16x32_bf16 v[124:127], v[24:27], a[192:195], v[124:127]
    ds_read_b64_tr_b16 v[20:21], v77 offset:9216
    v_mfma_f32_16x16x32_bf16 v[124:127], v[28:31], a[208:211], v[124:127]
    s_waitcnt lgkmcnt(3)
    ds_read_b64_tr_b16 v[22:23], v77 offset:13824
    v_mfma_f32_16x16x32_bf16 v[128:131], v[32:35], a[224:227], v[128:131]
    ds_read_b64_tr_b16 v[24:25], v77 offset:18432
    v_mfma_f32_16x16x32_bf16 v[128:131], v[36:39], a[240:243], v[128:131]
    ds_read_b64_tr_b16 v[26:27], v77 offset:23040
    v_mfma_f32_16x16x32_bf16 v[128:131], v[40:43], a[148:151], v[128:131]
    ds_read_b64_tr_b16 v[28:29], v77 offset:27648
    v_mfma_f32_16x16x32_bf16 v[128:131], v[44:47], a[164:167], v[128:131]
    ds_read_b64_tr_b16 v[30:31], v77 offset:32256
    v_mfma_f32_16x16x32_bf16 v[132:135], v[32:35], a[228:231], v[132:135]
    buffer_load_dwordx2 v[194:195], v74, s[20:23], s12 offen offset:32
    v_mfma_f32_16x16x32_bf16 v[132:135], v[36:39], a[244:247], v[132:135]
    v_mfma_f32_16x16x32_bf16 v[132:135], v[40:43], a[152:155], v[132:135]
    v_mfma_f32_16x16x32_bf16 v[132:135], v[44:47], a[168:171], v[132:135]
    buffer_load_dwordx2 v[196:197], v74, s[20:23], s13 offen offset:0
    v_mfma_f32_16x16x32_bf16 v[136:139], v[32:35], a[232:235], v[136:139]
    v_cvt_pk_bf16_f32 v112, v112, v113
    v_cvt_pk_bf16_f32 v113, v114, v115
    v_mfma_f32_16x16x32_bf16 v[136:139], v[36:39], a[248:251], v[136:139]
    buffer_store_dwordx2 v[112:113], v75, s[8:11], s32 offen sc1
    v_mfma_f32_16x16x32_bf16 v[136:139], v[40:43], a[156:159], v[136:139]
    buffer_load_dwordx2 v[198:199], v74, s[20:23], s13 offen offset:32
    v_mfma_f32_16x16x32_bf16 v[136:139], v[44:47], a[172:175], v[136:139]
    v_mfma_f32_16x16x32_bf16 v[140:143], v[32:35], a[236:239], v[140:143]
    ds_read_b64_tr_b16 v[32:33], v76 offset:96
    v_cvt_pk_bf16_f32 v116, v116, v117
    v_mfma_f32_16x16x32_bf16 v[140:143], v[36:39], a[252:255], v[140:143]
    ds_read_b64_tr_b16 v[34:35], v76 offset:4704
    v_cvt_pk_bf16_f32 v117, v118, v119
    v_mfma_f32_16x16x32_bf16 v[140:143], v[40:43], a[160:163], v[140:143]
    ds_read_b64_tr_b16 v[36:37], v76 offset:9312
    v_mfma_f32_16x16x32_bf16 v[140:143], v[44:47], a[176:179], v[140:143]
    s_waitcnt lgkmcnt(3)
    ds_read_b64_tr_b16 v[38:39], v76 offset:13920
    v_mfma_f32_16x16x32_bf16 v[224:227], v[16:19], a[212:215], v[224:227]
    ds_read_b64_tr_b16 v[40:41], v76 offset:18528
    v_mfma_f32_16x16x32_bf16 v[224:227], v[20:23], a[132:135], v[224:227]
    ds_read_b64_tr_b16 v[42:43], v76 offset:23136
    v_mfma_f32_16x16x32_bf16 v[224:227], v[24:27], a[180:183], v[224:227]
    ds_read_b64_tr_b16 v[44:45], v76 offset:27744
    v_mfma_f32_16x16x32_bf16 v[224:227], v[28:31], a[196:199], v[224:227]
    ds_read_b64_tr_b16 v[46:47], v76 offset:32352
    v_mfma_f32_16x16x32_bf16 v[228:231], v[16:19], a[216:219], v[228:231]
    buffer_store_dwordx2 v[116:117], v75, s[8:11], s33 offen sc1
    v_mfma_f32_16x16x32_bf16 v[228:231], v[20:23], a[136:139], v[228:231]
    buffer_load_dwordx2 v[200:201], v74, s[20:23], s14 offen offset:0
    v_mfma_f32_16x16x32_bf16 v[228:231], v[24:27], a[184:187], v[228:231]
    v_mfma_f32_16x16x32_bf16 v[228:231], v[28:31], a[200:203], v[228:231]
    v_cvt_pk_bf16_f32 v120, v120, v121
    v_cvt_pk_bf16_f32 v121, v122, v123
    v_mfma_f32_16x16x32_bf16 v[232:235], v[16:19], a[220:223], v[232:235]
    buffer_store_dwordx2 v[120:121], v75, s[8:11], s34 offen sc1
    v_mfma_f32_16x16x32_bf16 v[232:235], v[20:23], a[140:143], v[232:235]
    v_mfma_f32_16x16x32_bf16 v[232:235], v[24:27], a[188:191], v[232:235]
    v_mfma_f32_16x16x32_bf16 v[232:235], v[28:31], a[204:207], v[232:235]
    v_cvt_pk_bf16_f32 v124, v124, v125
    v_cvt_pk_bf16_f32 v125, v126, v127
    v_mfma_f32_16x16x32_bf16 v[236:239], v[16:19], a[128:131], v[236:239]
    ds_read_b64_tr_b16 v[16:17], v77 offset:32
    v_mfma_f32_16x16x32_bf16 v[236:239], v[20:23], a[144:147], v[236:239]
    ds_read_b64_tr_b16 v[18:19], v77 offset:4640
    v_mfma_f32_16x16x32_bf16 v[236:239], v[24:27], a[192:195], v[236:239]
    ds_read_b64_tr_b16 v[20:21], v77 offset:9248
    v_mfma_f32_16x16x32_bf16 v[236:239], v[28:31], a[208:211], v[236:239]
    s_waitcnt lgkmcnt(3)
    ds_read_b64_tr_b16 v[22:23], v77 offset:13856
    v_mfma_f32_16x16x32_bf16 v[144:147], v[32:35], a[224:227], v[144:147]
    ds_read_b64_tr_b16 v[24:25], v77 offset:18464
    v_mfma_f32_16x16x32_bf16 v[144:147], v[36:39], a[240:243], v[144:147]
    ds_read_b64_tr_b16 v[26:27], v77 offset:23072
    v_mfma_f32_16x16x32_bf16 v[144:147], v[40:43], a[148:151], v[144:147]
    ds_read_b64_tr_b16 v[28:29], v77 offset:27680
    v_mfma_f32_16x16x32_bf16 v[144:147], v[44:47], a[164:167], v[144:147]
    ds_read_b64_tr_b16 v[30:31], v77 offset:32288
    v_mfma_f32_16x16x32_bf16 v[148:151], v[32:35], a[228:231], v[148:151]
    buffer_store_dwordx2 v[124:125], v75, s[8:11], s35 offen sc1
    v_mfma_f32_16x16x32_bf16 v[148:151], v[36:39], a[244:247], v[148:151]
    v_mfma_f32_16x16x32_bf16 v[148:151], v[40:43], a[152:155], v[148:151]
    v_mfma_f32_16x16x32_bf16 v[148:151], v[44:47], a[168:171], v[148:151]
    v_mfma_f32_16x16x32_bf16 v[152:155], v[32:35], a[232:235], v[152:155]
    v_mfma_f32_16x16x32_bf16 v[152:155], v[36:39], a[248:251], v[152:155]
    v_mfma_f32_16x16x32_bf16 v[152:155], v[40:43], a[156:159], v[152:155]
    v_mfma_f32_16x16x32_bf16 v[152:155], v[44:47], a[172:175], v[152:155]
    v_mfma_f32_16x16x32_bf16 v[156:159], v[32:35], a[236:239], v[156:159]
    ds_read_b64_tr_b16 v[32:33], v76 offset:128
    v_mfma_f32_16x16x32_bf16 v[156:159], v[36:39], a[252:255], v[156:159]
    ds_read_b64_tr_b16 v[34:35], v76 offset:4736
    v_mfma_f32_16x16x32_bf16 v[156:159], v[40:43], a[160:163], v[156:159]
    ds_read_b64_tr_b16 v[36:37], v76 offset:9344
    v_mfma_f32_16x16x32_bf16 v[156:159], v[44:47], a[176:179], v[156:159]
    s_waitcnt lgkmcnt(3)
    ds_read_b64_tr_b16 v[38:39], v76 offset:13952
    v_mfma_f32_16x16x32_bf16 v[80:83], v[16:19], a[212:215], v[80:83]
    ds_read_b64_tr_b16 v[40:41], v76 offset:18560
    v_mfma_f32_16x16x32_bf16 v[80:83], v[20:23], a[132:135], v[80:83]
    ds_read_b64_tr_b16 v[42:43], v76 offset:23168
    v_mfma_f32_16x16x32_bf16 v[80:83], v[24:27], a[180:183], v[80:83]
    ds_read_b64_tr_b16 v[44:45], v76 offset:27776
    v_mfma_f32_16x16x32_bf16 v[80:83], v[28:31], a[196:199], v[80:83]
    ds_read_b64_tr_b16 v[46:47], v76 offset:32384
    v_mfma_f32_16x16x32_bf16 v[84:87], v[16:19], a[216:219], v[84:87]
    v_mfma_f32_16x16x32_bf16 v[84:87], v[20:23], a[136:139], v[84:87]
    v_mfma_f32_16x16x32_bf16 v[84:87], v[24:27], a[184:187], v[84:87]
    v_mfma_f32_16x16x32_bf16 v[84:87], v[28:31], a[200:203], v[84:87]
    v_mfma_f32_16x16x32_bf16 v[88:91], v[16:19], a[220:223], v[88:91]
    v_mfma_f32_16x16x32_bf16 v[88:91], v[20:23], a[140:143], v[88:91]
    v_mfma_f32_16x16x32_bf16 v[88:91], v[24:27], a[188:191], v[88:91]
    v_mfma_f32_16x16x32_bf16 v[88:91], v[28:31], a[204:207], v[88:91]
    v_mfma_f32_16x16x32_bf16 v[92:95], v[16:19], a[128:131], v[92:95]
    ds_read_b64_tr_b16 v[16:17], v77 offset:64
    v_mfma_f32_16x16x32_bf16 v[92:95], v[20:23], a[144:147], v[92:95]
    ds_read_b64_tr_b16 v[18:19], v77 offset:4672
    v_mfma_f32_16x16x32_bf16 v[92:95], v[24:27], a[192:195], v[92:95]
    ds_read_b64_tr_b16 v[20:21], v77 offset:9280
    v_mfma_f32_16x16x32_bf16 v[92:95], v[28:31], a[208:211], v[92:95]
    s_waitcnt lgkmcnt(3)
    ds_read_b64_tr_b16 v[22:23], v77 offset:13888
    v_mfma_f32_16x16x32_bf16 v[160:163], v[32:35], a[224:227], v[160:163]
    ds_read_b64_tr_b16 v[24:25], v77 offset:18496
    v_mfma_f32_16x16x32_bf16 v[160:163], v[36:39], a[240:243], v[160:163]
    ds_read_b64_tr_b16 v[26:27], v77 offset:23104
    v_mfma_f32_16x16x32_bf16 v[160:163], v[40:43], a[148:151], v[160:163]
    ds_read_b64_tr_b16 v[28:29], v77 offset:27712
    v_mfma_f32_16x16x32_bf16 v[160:163], v[44:47], a[164:167], v[160:163]
    ds_read_b64_tr_b16 v[30:31], v77 offset:32320
    v_mfma_f32_16x16x32_bf16 v[164:167], v[32:35], a[228:231], v[164:167]
    v_mfma_f32_16x16x32_bf16 v[164:167], v[36:39], a[244:247], v[164:167]
    v_mfma_f32_16x16x32_bf16 v[164:167], v[40:43], a[152:155], v[164:167]
    v_mfma_f32_16x16x32_bf16 v[164:167], v[44:47], a[168:171], v[164:167]
    v_mfma_f32_16x16x32_bf16 v[168:171], v[32:35], a[232:235], v[168:171]
    v_cvt_pk_bf16_f32 v224, v224, v225
    v_cvt_pk_bf16_f32 v225, v226, v227
    v_mfma_f32_16x16x32_bf16 v[168:171], v[36:39], a[248:251], v[168:171]
    v_cvt_pk_bf16_f32 v226, v80, v81
    v_cvt_pk_bf16_f32 v227, v82, v83
    v_mfma_f32_16x16x32_bf16 v[168:171], v[40:43], a[156:159], v[168:171]
    buffer_store_dwordx4 v[224:227], v1, s[8:11], s32 offen offset:0 sc1
    v_mfma_f32_16x16x32_bf16 v[168:171], v[44:47], a[172:175], v[168:171]
    v_mfma_f32_16x16x32_bf16 v[172:175], v[32:35], a[236:239], v[172:175]
    ds_read_b64_tr_b16 v[32:33], v76 offset:160
    v_mfma_f32_16x16x32_bf16 v[172:175], v[36:39], a[252:255], v[172:175]
    ds_read_b64_tr_b16 v[34:35], v76 offset:4768
    v_mfma_f32_16x16x32_bf16 v[172:175], v[40:43], a[160:163], v[172:175]
    ds_read_b64_tr_b16 v[36:37], v76 offset:9376
    v_mfma_f32_16x16x32_bf16 v[172:175], v[44:47], a[176:179], v[172:175]
    s_waitcnt lgkmcnt(3)
    ds_read_b64_tr_b16 v[38:39], v76 offset:13984
    v_mfma_f32_16x16x32_bf16 v[128:131], v[16:19], a[212:215], v[128:131]
    ds_read_b64_tr_b16 v[40:41], v76 offset:18592
    v_cvt_pk_bf16_f32 v228, v228, v229
    v_mfma_f32_16x16x32_bf16 v[128:131], v[20:23], a[132:135], v[128:131]
    ds_read_b64_tr_b16 v[42:43], v76 offset:23200
    v_cvt_pk_bf16_f32 v229, v230, v231
    v_mfma_f32_16x16x32_bf16 v[128:131], v[24:27], a[180:183], v[128:131]
    ds_read_b64_tr_b16 v[44:45], v76 offset:27808
    v_cvt_pk_bf16_f32 v230, v84, v85
    v_mfma_f32_16x16x32_bf16 v[128:131], v[28:31], a[196:199], v[128:131]
    ds_read_b64_tr_b16 v[46:47], v76 offset:32416
    v_cvt_pk_bf16_f32 v231, v86, v87
    v_mfma_f32_16x16x32_bf16 v[132:135], v[16:19], a[216:219], v[132:135]
    buffer_store_dwordx4 v[228:231], v1, s[8:11], s33 offen offset:0 sc1
    v_mfma_f32_16x16x32_bf16 v[132:135], v[20:23], a[136:139], v[132:135]
    v_mfma_f32_16x16x32_bf16 v[132:135], v[24:27], a[184:187], v[132:135]
    v_mfma_f32_16x16x32_bf16 v[132:135], v[28:31], a[200:203], v[132:135]
    v_mfma_f32_16x16x32_bf16 v[136:139], v[16:19], a[220:223], v[136:139]
    v_mfma_f32_16x16x32_bf16 v[136:139], v[20:23], a[140:143], v[136:139]
    v_cvt_pk_bf16_f32 v232, v232, v233
    v_cvt_pk_bf16_f32 v233, v234, v235
    v_mfma_f32_16x16x32_bf16 v[136:139], v[24:27], a[188:191], v[136:139]
    v_cvt_pk_bf16_f32 v234, v88, v89
    v_cvt_pk_bf16_f32 v235, v90, v91
    v_mfma_f32_16x16x32_bf16 v[136:139], v[28:31], a[204:207], v[136:139]
    buffer_store_dwordx4 v[232:235], v1, s[8:11], s34 offen offset:0 sc1
    v_mfma_f32_16x16x32_bf16 v[140:143], v[16:19], a[128:131], v[140:143]
    ds_read_b64_tr_b16 v[16:17], v77 offset:96
    v_mfma_f32_16x16x32_bf16 v[140:143], v[20:23], a[144:147], v[140:143]
    ds_read_b64_tr_b16 v[18:19], v77 offset:4704
    v_mfma_f32_16x16x32_bf16 v[140:143], v[24:27], a[192:195], v[140:143]
    ds_read_b64_tr_b16 v[20:21], v77 offset:9312
    v_mfma_f32_16x16x32_bf16 v[140:143], v[28:31], a[208:211], v[140:143]
    s_waitcnt lgkmcnt(3)
    ds_read_b64_tr_b16 v[22:23], v77 offset:13920
    v_mfma_f32_16x16x32_bf16 v[176:179], v[32:35], a[224:227], v[176:179]
    ds_read_b64_tr_b16 v[24:25], v77 offset:18528
    v_cvt_pk_bf16_f32 v236, v236, v237
    v_mfma_f32_16x16x32_bf16 v[176:179], v[36:39], a[240:243], v[176:179]
    ds_read_b64_tr_b16 v[26:27], v77 offset:23136
    v_cvt_pk_bf16_f32 v237, v238, v239
    v_mfma_f32_16x16x32_bf16 v[176:179], v[40:43], a[148:151], v[176:179]
    ds_read_b64_tr_b16 v[28:29], v77 offset:27744
    v_cvt_pk_bf16_f32 v238, v92, v93
    v_mfma_f32_16x16x32_bf16 v[176:179], v[44:47], a[164:167], v[176:179]
    ds_read_b64_tr_b16 v[30:31], v77 offset:32352
    v_cvt_pk_bf16_f32 v239, v94, v95
    v_mfma_f32_16x16x32_bf16 v[180:183], v[32:35], a[228:231], v[180:183]
    buffer_store_dwordx4 v[236:239], v1, s[8:11], s35 offen offset:0 sc1
    v_mfma_f32_16x16x32_bf16 v[180:183], v[36:39], a[244:247], v[180:183]
    v_mfma_f32_16x16x32_bf16 v[180:183], v[40:43], a[152:155], v[180:183]
    v_mfma_f32_16x16x32_bf16 v[180:183], v[44:47], a[168:171], v[180:183]
    v_mfma_f32_16x16x32_bf16 v[184:187], v[32:35], a[232:235], v[184:187]
    v_mfma_f32_16x16x32_bf16 v[184:187], v[36:39], a[248:251], v[184:187]
    v_mfma_f32_16x16x32_bf16 v[184:187], v[40:43], a[156:159], v[184:187]
    v_mfma_f32_16x16x32_bf16 v[184:187], v[44:47], a[172:175], v[184:187]
    v_mfma_f32_16x16x32_bf16 v[188:191], v[32:35], a[236:239], v[188:191]
    ds_read_b64_tr_b16 v[32:33], v76 offset:192
    v_mfma_f32_16x16x32_bf16 v[188:191], v[36:39], a[252:255], v[188:191]
    ds_read_b64_tr_b16 v[34:35], v76 offset:4800
    v_mfma_f32_16x16x32_bf16 v[188:191], v[40:43], a[160:163], v[188:191]
    ds_read_b64_tr_b16 v[36:37], v76 offset:9408
    v_mfma_f32_16x16x32_bf16 v[188:191], v[44:47], a[176:179], v[188:191]
    s_waitcnt lgkmcnt(3)
    ds_read_b64_tr_b16 v[38:39], v76 offset:14016
    v_mfma_f32_16x16x32_bf16 v[144:147], v[16:19], a[212:215], v[144:147]
    ds_read_b64_tr_b16 v[40:41], v76 offset:18624
    v_mfma_f32_16x16x32_bf16 v[144:147], v[20:23], a[132:135], v[144:147]
    ds_read_b64_tr_b16 v[42:43], v76 offset:23232
    v_mfma_f32_16x16x32_bf16 v[144:147], v[24:27], a[180:183], v[144:147]
    ds_read_b64_tr_b16 v[44:45], v76 offset:27840
    v_mfma_f32_16x16x32_bf16 v[144:147], v[28:31], a[196:199], v[144:147]
    ds_read_b64_tr_b16 v[46:47], v76 offset:32448
    v_mfma_f32_16x16x32_bf16 v[148:151], v[16:19], a[216:219], v[148:151]
    v_mfma_f32_16x16x32_bf16 v[148:151], v[20:23], a[136:139], v[148:151]
    v_mfma_f32_16x16x32_bf16 v[148:151], v[24:27], a[184:187], v[148:151]
    v_mfma_f32_16x16x32_bf16 v[148:151], v[28:31], a[200:203], v[148:151]
    v_mfma_f32_16x16x32_bf16 v[152:155], v[16:19], a[220:223], v[152:155]
    v_mfma_f32_16x16x32_bf16 v[152:155], v[20:23], a[140:143], v[152:155]
    v_mfma_f32_16x16x32_bf16 v[152:155], v[24:27], a[188:191], v[152:155]
    v_mfma_f32_16x16x32_bf16 v[152:155], v[28:31], a[204:207], v[152:155]
    v_mfma_f32_16x16x32_bf16 v[156:159], v[16:19], a[128:131], v[156:159]
    ds_read_b64_tr_b16 v[16:17], v77 offset:128
    v_mfma_f32_16x16x32_bf16 v[156:159], v[20:23], a[144:147], v[156:159]
    ds_read_b64_tr_b16 v[18:19], v77 offset:4736
    v_mfma_f32_16x16x32_bf16 v[156:159], v[24:27], a[192:195], v[156:159]
    ds_read_b64_tr_b16 v[20:21], v77 offset:9344
    v_mfma_f32_16x16x32_bf16 v[156:159], v[28:31], a[208:211], v[156:159]
    s_waitcnt lgkmcnt(3)
    ds_read_b64_tr_b16 v[22:23], v77 offset:13952
    v_mfma_f32_16x16x32_bf16 v[240:243], v[32:35], a[224:227], v[240:243]
    ds_read_b64_tr_b16 v[24:25], v77 offset:18560
    v_mfma_f32_16x16x32_bf16 v[240:243], v[36:39], a[240:243], v[240:243]
    ds_read_b64_tr_b16 v[26:27], v77 offset:23168
    v_mfma_f32_16x16x32_bf16 v[240:243], v[40:43], a[148:151], v[240:243]
    ds_read_b64_tr_b16 v[28:29], v77 offset:27776
    v_mfma_f32_16x16x32_bf16 v[240:243], v[44:47], a[164:167], v[240:243]
    ds_read_b64_tr_b16 v[30:31], v77 offset:32384
    v_mfma_f32_16x16x32_bf16 v[244:247], v[32:35], a[228:231], v[244:247]
    v_mfma_f32_16x16x32_bf16 v[244:247], v[36:39], a[244:247], v[244:247]
    v_mfma_f32_16x16x32_bf16 v[244:247], v[40:43], a[152:155], v[244:247]
    v_mfma_f32_16x16x32_bf16 v[244:247], v[44:47], a[168:171], v[244:247]
    v_mfma_f32_16x16x32_bf16 v[248:251], v[32:35], a[232:235], v[248:251]
    v_cvt_pk_bf16_f32 v128, v128, v129
    v_cvt_pk_bf16_f32 v129, v130, v131
    v_mfma_f32_16x16x32_bf16 v[248:251], v[36:39], a[248:251], v[248:251]
    v_cvt_pk_bf16_f32 v130, v144, v145
    v_cvt_pk_bf16_f32 v131, v146, v147
    v_mfma_f32_16x16x32_bf16 v[248:251], v[40:43], a[156:159], v[248:251]
    buffer_store_dwordx4 v[128:131], v1, s[8:11], s32 offen offset:1024 sc1
    v_mfma_f32_16x16x32_bf16 v[248:251], v[44:47], a[172:175], v[248:251]
    v_mfma_f32_16x16x32_bf16 v[252:255], v[32:35], a[236:239], v[252:255]
    ds_read_b64_tr_b16 v[32:33], v76 offset:224
    v_mfma_f32_16x16x32_bf16 v[252:255], v[36:39], a[252:255], v[252:255]
    ds_read_b64_tr_b16 v[34:35], v76 offset:4832
    v_mfma_f32_16x16x32_bf16 v[252:255], v[40:43], a[160:163], v[252:255]
    ds_read_b64_tr_b16 v[36:37], v76 offset:9440
    v_mfma_f32_16x16x32_bf16 v[252:255], v[44:47], a[176:179], v[252:255]
    s_waitcnt lgkmcnt(3)
    ds_read_b64_tr_b16 v[38:39], v76 offset:14048
    v_mfma_f32_16x16x32_bf16 v[160:163], v[16:19], a[212:215], v[160:163]
    ds_read_b64_tr_b16 v[40:41], v76 offset:18656
    v_cvt_pk_bf16_f32 v132, v132, v133
    v_mfma_f32_16x16x32_bf16 v[160:163], v[20:23], a[132:135], v[160:163]
    ds_read_b64_tr_b16 v[42:43], v76 offset:23264
    v_cvt_pk_bf16_f32 v133, v134, v135
    v_mfma_f32_16x16x32_bf16 v[160:163], v[24:27], a[180:183], v[160:163]
    ds_read_b64_tr_b16 v[44:45], v76 offset:27872
    v_cvt_pk_bf16_f32 v134, v148, v149
    v_mfma_f32_16x16x32_bf16 v[160:163], v[28:31], a[196:199], v[160:163]
    ds_read_b64_tr_b16 v[46:47], v76 offset:32480
    v_cvt_pk_bf16_f32 v135, v150, v151
    v_mfma_f32_16x16x32_bf16 v[164:167], v[16:19], a[216:219], v[164:167]
    buffer_store_dwordx4 v[132:135], v1, s[8:11], s33 offen offset:1024 sc1
    v_mfma_f32_16x16x32_bf16 v[164:167], v[20:23], a[136:139], v[164:167]
    v_mfma_f32_16x16x32_bf16 v[164:167], v[24:27], a[184:187], v[164:167]
    v_mfma_f32_16x16x32_bf16 v[164:167], v[28:31], a[200:203], v[164:167]
    v_mfma_f32_16x16x32_bf16 v[168:171], v[16:19], a[220:223], v[168:171]
    v_mfma_f32_16x16x32_bf16 v[168:171], v[20:23], a[140:143], v[168:171]
    v_cvt_pk_bf16_f32 v136, v136, v137
    v_cvt_pk_bf16_f32 v137, v138, v139
    v_mfma_f32_16x16x32_bf16 v[168:171], v[24:27], a[188:191], v[168:171]
    v_cvt_pk_bf16_f32 v138, v152, v153
    v_cvt_pk_bf16_f32 v139, v154, v155
    v_mfma_f32_16x16x32_bf16 v[168:171], v[28:31], a[204:207], v[168:171]
    buffer_store_dwordx4 v[136:139], v1, s[8:11], s34 offen offset:1024 sc1
    v_mfma_f32_16x16x32_bf16 v[172:175], v[16:19], a[128:131], v[172:175]
    ds_read_b64_tr_b16 v[16:17], v77 offset:160
    v_mfma_f32_16x16x32_bf16 v[172:175], v[20:23], a[144:147], v[172:175]
    ds_read_b64_tr_b16 v[18:19], v77 offset:4768
    v_mfma_f32_16x16x32_bf16 v[172:175], v[24:27], a[192:195], v[172:175]
    ds_read_b64_tr_b16 v[20:21], v77 offset:9376
    v_mfma_f32_16x16x32_bf16 v[172:175], v[28:31], a[208:211], v[172:175]
    s_waitcnt lgkmcnt(3)
    ds_read_b64_tr_b16 v[22:23], v77 offset:13984
    v_mfma_f32_16x16x32_bf16 v[96:99], v[32:35], a[224:227], v[96:99]
    ds_read_b64_tr_b16 v[24:25], v77 offset:18592
    v_cvt_pk_bf16_f32 v140, v140, v141
    v_mfma_f32_16x16x32_bf16 v[96:99], v[36:39], a[240:243], v[96:99]
    ds_read_b64_tr_b16 v[26:27], v77 offset:23200
    v_cvt_pk_bf16_f32 v141, v142, v143
    v_mfma_f32_16x16x32_bf16 v[96:99], v[40:43], a[148:151], v[96:99]
    ds_read_b64_tr_b16 v[28:29], v77 offset:27808
    v_cvt_pk_bf16_f32 v142, v156, v157
    v_mfma_f32_16x16x32_bf16 v[96:99], v[44:47], a[164:167], v[96:99]
    ds_read_b64_tr_b16 v[30:31], v77 offset:32416
    v_cvt_pk_bf16_f32 v143, v158, v159
    v_mfma_f32_16x16x32_bf16 v[100:103], v[32:35], a[228:231], v[100:103]
    buffer_store_dwordx4 v[140:143], v1, s[8:11], s35 offen offset:1024 sc1
    v_mfma_f32_16x16x32_bf16 v[100:103], v[36:39], a[244:247], v[100:103]
    v_mfma_f32_16x16x32_bf16 v[100:103], v[40:43], a[152:155], v[100:103]
    v_mfma_f32_16x16x32_bf16 v[100:103], v[44:47], a[168:171], v[100:103]
    v_mfma_f32_16x16x32_bf16 v[104:107], v[32:35], a[232:235], v[104:107]
    v_mfma_f32_16x16x32_bf16 v[104:107], v[36:39], a[248:251], v[104:107]
    v_mfma_f32_16x16x32_bf16 v[104:107], v[40:43], a[156:159], v[104:107]
    v_mfma_f32_16x16x32_bf16 v[104:107], v[44:47], a[172:175], v[104:107]
    v_mfma_f32_16x16x32_bf16 v[108:111], v[32:35], a[236:239], v[108:111]
    ds_read_b64_tr_b16 v[32:33], v77 offset:192
    v_mfma_f32_16x16x32_bf16 v[108:111], v[36:39], a[252:255], v[108:111]
    ds_read_b64_tr_b16 v[34:35], v77 offset:4800
    v_mfma_f32_16x16x32_bf16 v[108:111], v[40:43], a[160:163], v[108:111]
    ds_read_b64_tr_b16 v[36:37], v77 offset:9408
    v_mfma_f32_16x16x32_bf16 v[108:111], v[44:47], a[176:179], v[108:111]
    s_waitcnt lgkmcnt(3)
    ds_read_b64_tr_b16 v[38:39], v77 offset:14016
    v_mfma_f32_16x16x32_bf16 v[176:179], v[16:19], a[212:215], v[176:179]
    ds_read_b64_tr_b16 v[40:41], v77 offset:18624
    v_mfma_f32_16x16x32_bf16 v[176:179], v[20:23], a[132:135], v[176:179]
    ds_read_b64_tr_b16 v[42:43], v77 offset:23232
    v_mfma_f32_16x16x32_bf16 v[176:179], v[24:27], a[180:183], v[176:179]
    ds_read_b64_tr_b16 v[44:45], v77 offset:27840
    v_mfma_f32_16x16x32_bf16 v[176:179], v[28:31], a[196:199], v[176:179]
    ds_read_b64_tr_b16 v[46:47], v77 offset:32448
    v_mfma_f32_16x16x32_bf16 v[180:183], v[16:19], a[216:219], v[180:183]
    v_mfma_f32_16x16x32_bf16 v[180:183], v[20:23], a[136:139], v[180:183]
    v_mfma_f32_16x16x32_bf16 v[180:183], v[24:27], a[184:187], v[180:183]
    v_mfma_f32_16x16x32_bf16 v[180:183], v[28:31], a[200:203], v[180:183]
    v_mfma_f32_16x16x32_bf16 v[184:187], v[16:19], a[220:223], v[184:187]
    v_mfma_f32_16x16x32_bf16 v[184:187], v[20:23], a[140:143], v[184:187]
    v_mfma_f32_16x16x32_bf16 v[184:187], v[24:27], a[188:191], v[184:187]
    v_mfma_f32_16x16x32_bf16 v[184:187], v[28:31], a[204:207], v[184:187]
    v_mfma_f32_16x16x32_bf16 v[188:191], v[16:19], a[128:131], v[188:191]
    ds_read_b64_tr_b16 v[16:17], v77 offset:224
    v_mfma_f32_16x16x32_bf16 v[188:191], v[20:23], a[144:147], v[188:191]
    ds_read_b64_tr_b16 v[18:19], v77 offset:4832
    v_mfma_f32_16x16x32_bf16 v[188:191], v[24:27], a[192:195], v[188:191]
    ds_read_b64_tr_b16 v[20:21], v77 offset:9440
    v_mfma_f32_16x16x32_bf16 v[188:191], v[28:31], a[208:211], v[188:191]
    s_waitcnt lgkmcnt(3)
    ds_read_b64_tr_b16 v[22:23], v77 offset:14048
    v_mfma_f32_16x16x32_bf16 v[240:243], v[32:35], a[212:215], v[240:243]
    ds_read_b64_tr_b16 v[24:25], v77 offset:18656
    v_mfma_f32_16x16x32_bf16 v[240:243], v[36:39], a[132:135], v[240:243]
    s_add_u32 s87, s53, s86
    ds_read_b64_tr_b16 v[26:27], v77 offset:23264
    v_mfma_f32_16x16x32_bf16 v[240:243], v[40:43], a[180:183], v[240:243]
    ds_read_b64_tr_b16 v[28:29], v77 offset:27872
    v_mov_b32 v14, 0x1
    v_mfma_f32_16x16x32_bf16 v[240:243], v[44:47], a[196:199], v[240:243]
    ds_read_b64_tr_b16 v[30:31], v77 offset:32480
    v_mfma_f32_16x16x32_bf16 v[244:247], v[32:35], a[216:219], v[244:247]
    v_mfma_f32_16x16x32_bf16 v[244:247], v[36:39], a[136:139], v[244:247]
    v_mfma_f32_16x16x32_bf16 v[244:247], v[40:43], a[184:187], v[244:247]
    v_mfma_f32_16x16x32_bf16 v[244:247], v[44:47], a[200:203], v[244:247]
    v_mfma_f32_16x16x32_bf16 v[248:251], v[32:35], a[220:223], v[248:251]
    v_cvt_pk_bf16_f32 v160, v160, v161
    v_cvt_pk_bf16_f32 v161, v162, v163
    v_mfma_f32_16x16x32_bf16 v[248:251], v[36:39], a[140:143], v[248:251]
    s_waitcnt vmcnt(0)
    s_barrier
    v_cvt_pk_bf16_f32 v162, v176, v177
    v_mfma_f32_16x16x32_bf16 v[248:251], v[40:43], a[188:191], v[248:251]
    buffer_atomic_add v14, v6, s[60:63], s87 offen
    v_mfma_f32_16x16x32_bf16 v[248:251], v[44:47], a[204:207], v[248:251]
    v_cvt_pk_bf16_f32 v163, v178, v179
    v_mfma_f32_16x16x32_bf16 v[252:255], v[32:35], a[128:131], v[252:255]
    buffer_store_dwordx4 v[160:163], v1, s[8:11], s32 offen offset:2048 sc1
    v_mfma_f32_16x16x32_bf16 v[252:255], v[36:39], a[144:147], v[252:255]
    v_mfma_f32_16x16x32_bf16 v[252:255], v[40:43], a[192:195], v[252:255]
    v_mfma_f32_16x16x32_bf16 v[252:255], v[44:47], a[208:211], v[252:255]
    s_waitcnt lgkmcnt(0)
    v_cvt_pk_bf16_f32 v164, v164, v165
    v_cvt_pk_bf16_f32 v165, v166, v167
    v_mfma_f32_16x16x32_bf16 v[96:99], v[16:19], a[212:215], v[96:99]
    v_cvt_pk_bf16_f32 v166, v180, v181
    v_cvt_pk_bf16_f32 v167, v182, v183
    v_mfma_f32_16x16x32_bf16 v[96:99], v[20:23], a[132:135], v[96:99]
    buffer_store_dwordx4 v[164:167], v1, s[8:11], s33 offen offset:2048 sc1
    v_mfma_f32_16x16x32_bf16 v[96:99], v[24:27], a[180:183], v[96:99]
    v_mfma_f32_16x16x32_bf16 v[96:99], v[28:31], a[196:199], v[96:99]
    v_mfma_f32_16x16x32_bf16 v[100:103], v[16:19], a[216:219], v[100:103]
    v_cvt_pk_bf16_f32 v168, v168, v169
    v_cvt_pk_bf16_f32 v169, v170, v171
    v_mfma_f32_16x16x32_bf16 v[100:103], v[20:23], a[136:139], v[100:103]
    v_cvt_pk_bf16_f32 v170, v184, v185
    v_cvt_pk_bf16_f32 v171, v186, v187
    v_mfma_f32_16x16x32_bf16 v[100:103], v[24:27], a[184:187], v[100:103]
    buffer_store_dwordx4 v[168:171], v1, s[8:11], s34 offen offset:2048 sc1
    v_mfma_f32_16x16x32_bf16 v[100:103], v[28:31], a[200:203], v[100:103]
    v_mfma_f32_16x16x32_bf16 v[104:107], v[16:19], a[220:223], v[104:107]
    v_mfma_f32_16x16x32_bf16 v[104:107], v[20:23], a[140:143], v[104:107]
    v_cvt_pk_bf16_f32 v172, v172, v173
    v_cvt_pk_bf16_f32 v173, v174, v175
    v_mfma_f32_16x16x32_bf16 v[104:107], v[24:27], a[188:191], v[104:107]
    v_cvt_pk_bf16_f32 v174, v188, v189
    v_cvt_pk_bf16_f32 v175, v190, v191
    v_mfma_f32_16x16x32_bf16 v[104:107], v[28:31], a[204:207], v[104:107]
    buffer_store_dwordx4 v[172:175], v1, s[8:11], s35 offen offset:2048 sc1
    v_mfma_f32_16x16x32_bf16 v[108:111], v[16:19], a[128:131], v[108:111]
    v_mfma_f32_16x16x32_bf16 v[108:111], v[20:23], a[144:147], v[108:111]
    v_mfma_f32_16x16x32_bf16 v[108:111], v[24:27], a[192:195], v[108:111]
    v_mfma_f32_16x16x32_bf16 v[108:111], v[28:31], a[208:211], v[108:111]
    s_nop 7
    v_cvt_pk_bf16_f32 v240, v240, v241
    v_cvt_pk_bf16_f32 v241, v242, v243
    v_cvt_pk_bf16_f32 v242, v96, v97
    v_cvt_pk_bf16_f32 v243, v98, v99
    buffer_store_dwordx4 v[240:243], v1, s[8:11], s32 offen offset:3072 sc1
    v_cvt_pk_bf16_f32 v244, v244, v245
    v_cvt_pk_bf16_f32 v245, v246, v247
    v_cvt_pk_bf16_f32 v246, v100, v101
    v_cvt_pk_bf16_f32 v247, v102, v103
    buffer_store_dwordx4 v[244:247], v1, s[8:11], s33 offen offset:3072 sc1
    v_cvt_pk_bf16_f32 v248, v248, v249
    v_cvt_pk_bf16_f32 v249, v250, v251
    v_cvt_pk_bf16_f32 v250, v104, v105
    v_cvt_pk_bf16_f32 v251, v106, v107
    buffer_store_dwordx4 v[248:251], v1, s[8:11], s34 offen offset:3072 sc1
    v_cvt_pk_bf16_f32 v252, v252, v253
    v_cvt_pk_bf16_f32 v253, v254, v255
    v_cvt_pk_bf16_f32 v254, v108, v109
    v_cvt_pk_bf16_f32 v255, v110, v111
    buffer_store_dwordx4 v[252:255], v1, s[8:11], s35 offen offset:3072 sc1
L_endgame:
    buffer_load_dword v78, v6, s[60:63], s53 offen sc1
    s_mov_b32 s6, 0xbfb8aa3b
    s_waitcnt vmcnt(1)
    s_barrier
    s_add_u32 s87, s53, s86
    v_mov_b32 v14, 0x100
    buffer_atomic_add v14, v6, s[60:63], s87 offen
    s_waitcnt vmcnt(1)
    v_readfirstlane_b32 s3, v78
    s_and_b32 s3, s3, 0xff
    s_cmp_ge_u32 s3, 8
    s_cbranch_scc1 L_eg_early
    s_mov_b32 s4, 0x40000
L_wp_1:
    buffer_load_dword v78, v6, s[60:63], s53 offen sc1
    s_waitcnt vmcnt(0)
    v_readfirstlane_b32 s3, v78
    s_sub_u32 s4, s4, 1
    s_cbranch_scc1 L_wpd_2
    s_bfe_u32 s3, s3, 0x80000
    s_cmp_ge_u32 s3, 8
    s_cbranch_scc0 L_wp_1
L_wpd_2:
L_eg_early:
    s_add_u32 s49, s55, 0
    buffer_load_dwordx4 v[80:83], v1, s[8:11], s49 offen sc1
    s_add_u32 s49, s55, 20480
    buffer_load_dwordx4 v[84:87], v1, s[8:11], s49 offen sc1
    s_add_u32 s49, s55, 40960
    buffer_load_dwordx4 v[88:91], v1, s[8:11], s49 offen sc1
    s_add_u32 s49, s55, 61440
    buffer_load_dwordx4 v[92:95], v1, s[8:11], s49 offen sc1
    s_add_u32 s49, s55, 81920
    buffer_load_dwordx4 v[144:147], v1, s[8:11], s49 offen sc1
    s_add_u32 s49, s55, 102400
    buffer_load_dwordx4 v[148:151], v1, s[8:11], s49 offen sc1
    s_add_u32 s49, s55, 122880
    buffer_load_dwordx4 v[152:155], v1, s[8:11], s49 offen sc1
    s_add_u32 s49, s55, 143360
    buffer_load_dwordx4 v[156:159], v1, s[8:11], s49 offen sc1
    s_add_u32 s49, s47, 0
    buffer_load_dwordx2 v[16:17], v75, s[8:11], s49 offen sc1
    s_add_u32 s49, s47, 20480
    buffer_load_dwordx2 v[18:19], v75, s[8:11], s49 offen sc1
    s_add_u32 s49, s47, 40960
    buffer_load_dwordx2 v[20:21], v75, s[8:11], s49 offen sc1
    s_add_u32 s49, s47, 61440
    buffer_load_dwordx2 v[22:23], v75, s[8:11], s49 offen sc1
    s_add_u32 s49, s47, 81920
    buffer_load_dwordx2 v[24:25], v75, s[8:11], s49 offen sc1
    s_add_u32 s49, s47, 102400
    buffer_load_dwordx2 v[26:27], v75, s[8:11], s49 offen sc1
    s_add_u32 s49, s47, 122880
    buffer_load_dwordx2 v[28:29], v75, s[8:11], s49 offen sc1
    s_add_u32 s49, s47, 143360
    buffer_load_dwordx2 v[30:31], v75, s[8:11], s49 offen sc1
    buffer_load_dword v78, v6, s[60:63], s53 offen sc1
    s_waitcnt vmcnt(0)
    v_readfirstlane_b32 s3, v78
    s_cmp_ge_u32 s3, 0x800
    s_cselect_b32 s5, 0, 0x40000000
    s_add_u32 s7, s50, s5
    s_add_u32 s49, s7, 0
    buffer_load_dwordx4 v[176:179], v1, s[8:11], s49 offen sc1
    s_add_u32 s49, s7, 20480
    buffer_load_dwordx4 v[180:183], v1, s[8:11], s49 offen sc1
    s_add_u32 s49, s7, 40960
    buffer_load_dwordx4 v[184:187], v1, s[8:11], s49 offen sc1
    s_add_u32 s49, s7, 61440
    buffer_load_dwordx4 v[188:191], v1, s[8:11], s49 offen sc1
    s_add_u32 s49, s7, 81920
    buffer_load_dwordx4 v[96:99], v1, s[8:11], s49 offen sc1
    s_add_u32 s49, s7, 102400
    buffer_load_dwordx4 v[100:103], v1, s[8:11], s49 offen sc1
    s_add_u32 s49, s7, 122880
    buffer_load_dwordx4 v[104:107], v1, s[8:11], s49 offen sc1
    s_add_u32 s49, s7, 143360
    buffer_load_dwordx4 v[108:111], v1, s[8:11], s49 offen sc1
    v_lshlrev_b32 v32, 16, v144
    v_and_b32 v33, 0xffff0000, v144
    v_lshlrev_b32 v12, 16, v148
    v_and_b32 v13, 0xffff0000, v148
    v_pk_add_f32 v[32:33], v[32:33], v[12:13]
    v_lshlrev_b32 v12, 16, v152
    v_and_b32 v13, 0xffff0000, v152
    v_pk_add_f32 v[32:33], v[32:33], v[12:13]
    v_lshlrev_b32 v12, 16, v156
    v_and_b32 v13, 0xffff0000, v156
    v_pk_add_f32 v[32:33], v[32:33], v[12:13]
    v_lshlrev_b32 v34, 16, v145
    v_and_b32 v35, 0xffff0000, v145
    v_lshlrev_b32 v12, 16, v149
    v_and_b32 v13, 0xffff0000, v149
    v_pk_add_f32 v[34:35], v[34:35], v[12:13]
    v_lshlrev_b32 v12, 16, v153
    v_and_b32 v13, 0xffff0000, v153
    v_pk_add_f32 v[34:35], v[34:35], v[12:13]
    v_lshlrev_b32 v12, 16, v157
    v_and_b32 v13, 0xffff0000, v157
    v_pk_add_f32 v[34:35], v[34:35], v[12:13]
    v_lshlrev_b32 v36, 16, v146
    v_and_b32 v37, 0xffff0000, v146
    v_lshlrev_b32 v12, 16, v150
    v_and_b32 v13, 0xffff0000, v150
    v_pk_add_f32 v[36:37], v[36:37], v[12:13]
    v_lshlrev_b32 v12, 16, v154
    v_and_b32 v13, 0xffff0000, v154
    v_pk_add_f32 v[36:37], v[36:37], v[12:13]
    v_lshlrev_b32 v12, 16, v158
    v_and_b32 v13, 0xffff0000, v158
    v_pk_add_f32 v[36:37], v[36:37], v[12:13]
    v_lshlrev_b32 v38, 16, v147
    v_and_b32 v39, 0xffff0000, v147
    v_lshlrev_b32 v12, 16, v151
    v_and_b32 v13, 0xffff0000, v151
    v_pk_add_f32 v[38:39], v[38:39], v[12:13]
    v_lshlrev_b32 v12, 16, v155
    v_and_b32 v13, 0xffff0000, v155
    v_pk_add_f32 v[38:39], v[38:39], v[12:13]
    v_lshlrev_b32 v12, 16, v159
    v_and_b32 v13, 0xffff0000, v159
    v_pk_add_f32 v[38:39], v[38:39], v[12:13]
    v_mul_f32 v48, s6, v32
    v_mul_f32 v49, s6, v33
    v_mul_f32 v50, s6, v34
    v_mul_f32 v51, s6, v35
    v_mul_f32 v52, s6, v36
    v_mul_f32 v53, s6, v37
    v_mul_f32 v54, s6, v38
    v_mul_f32 v55, s6, v39
    v_exp_f32 v48, v48
    v_exp_f32 v49, v49
    v_exp_f32 v50, v50
    v_exp_f32 v51, v51
    v_exp_f32 v52, v52
    v_exp_f32 v53, v53
    v_exp_f32 v54, v54
    v_exp_f32 v55, v55
    v_lshlrev_b32 v40, 16, v80
    v_and_b32 v41, 0xffff0000, v80
    v_lshlrev_b32 v12, 16, v84
    v_and_b32 v13, 0xffff0000, v84
    v_pk_add_f32 v[40:41], v[40:41], v[12:13]
    v_lshlrev_b32 v12, 16, v88
    v_and_b32 v13, 0xffff0000, v88
    v_pk_add_f32 v[40:41], v[40:41], v[12:13]
    v_lshlrev_b32 v12, 16, v92
    v_and_b32 v13, 0xffff0000, v92
    v_pk_add_f32 v[40:41], v[40:41], v[12:13]
    v_lshlrev_b32 v42, 16, v81
    v_and_b32 v43, 0xffff0000, v81
    v_lshlrev_b32 v12, 16, v85
    v_and_b32 v13, 0xffff0000, v85
    v_pk_add_f32 v[42:43], v[42:43], v[12:13]
    v_lshlrev_b32 v12, 16, v89
    v_and_b32 v13, 0xffff0000, v89
    v_pk_add_f32 v[42:43], v[42:43], v[12:13]
    v_lshlrev_b32 v12, 16, v93
    v_and_b32 v13, 0xffff0000, v93
    v_pk_add_f32 v[42:43], v[42:43], v[12:13]
    v_lshlrev_b32 v44, 16, v82
    v_and_b32 v45, 0xffff0000, v82
    v_lshlrev_b32 v12, 16, v86
    v_and_b32 v13, 0xffff0000, v86
    v_pk_add_f32 v[44:45], v[44:45], v[12:13]
    v_lshlrev_b32 v12, 16, v90
    v_and_b32 v13, 0xffff0000, v90
    v_pk_add_f32 v[44:45], v[44:45], v[12:13]
    v_lshlrev_b32 v12, 16, v94
    v_and_b32 v13, 0xffff0000, v94
    v_pk_add_f32 v[44:45], v[44:45], v[12:13]
    v_lshlrev_b32 v46, 16, v83
    v_and_b32 v47, 0xffff0000, v83
    v_lshlrev_b32 v12, 16, v87
    v_and_b32 v13, 0xffff0000, v87
    v_pk_add_f32 v[46:47], v[46:47], v[12:13]
    v_lshlrev_b32 v12, 16, v91
    v_and_b32 v13, 0xffff0000, v91
    v_pk_add_f32 v[46:47], v[46:47], v[12:13]
    v_lshlrev_b32 v12, 16, v95
    v_and_b32 v13, 0xffff0000, v95
    v_pk_add_f32 v[46:47], v[46:47], v[12:13]
    v_add_f32 v48, 1.0, v48
    v_add_f32 v49, 1.0, v49
    v_add_f32 v50, 1.0, v50
    v_add_f32 v51, 1.0, v51
    v_add_f32 v52, 1.0, v52
    v_add_f32 v53, 1.0, v53
    v_add_f32 v54, 1.0, v54
    v_add_f32 v55, 1.0, v55
    v_rcp_f32 v48, v48
    v_rcp_f32 v49, v49
    v_rcp_f32 v50, v50
    v_rcp_f32 v51, v51
    v_rcp_f32 v52, v52
    v_rcp_f32 v53, v53
    v_rcp_f32 v54, v54
    v_rcp_f32 v55, v55
    v_pk_mul_f32 v[32:33], v[32:33], v[40:41]
    v_pk_mul_f32 v[34:35], v[34:35], v[42:43]
    v_pk_mul_f32 v[36:37], v[36:37], v[44:45]
    v_pk_mul_f32 v[38:39], v[38:39], v[46:47]
    v_lshlrev_b32 v12, 16, v192
    v_and_b32 v13, 0xffff0000, v192
    v_pk_fma_f32 v[32:33], v[32:33], v[48:49], v[12:13]
    v_cvt_pk_bf16_f32 v192, v32, v33
    v_lshlrev_b32 v12, 16, v193
    v_and_b32 v13, 0xffff0000, v193
    v_pk_fma_f32 v[34:35], v[34:35], v[50:51], v[12:13]
    v_cvt_pk_bf16_f32 v193, v34, v35
    buffer_store_dwordx2 v[192:193], v74, s[24:27], s12 offen offset:0
    v_lshlrev_b32 v12, 16, v194
    v_and_b32 v13, 0xffff0000, v194
    v_pk_fma_f32 v[36:37], v[36:37], v[52:53], v[12:13]
    v_cvt_pk_bf16_f32 v194, v36, v37
    v_lshlrev_b32 v12, 16, v195
    v_and_b32 v13, 0xffff0000, v195
    v_pk_fma_f32 v[38:39], v[38:39], v[54:55], v[12:13]
    v_cvt_pk_bf16_f32 v195, v38, v39
    buffer_store_dwordx2 v[194:195], v74, s[24:27], s12 offen offset:32
    s_bitcmp1_b32 s0, 2
    s_cbranch_scc1 L_eg_no8
    v_lshlrev_b32 v32, 16, v24
    v_and_b32 v33, 0xffff0000, v24
    v_lshlrev_b32 v12, 16, v26
    v_and_b32 v13, 0xffff0000, v26
    v_pk_add_f32 v[32:33], v[32:33], v[12:13]
    v_lshlrev_b32 v12, 16, v28
    v_and_b32 v13, 0xffff0000, v28
    v_pk_add_f32 v[32:33], v[32:33], v[12:13]
    v_lshlrev_b32 v12, 16, v30
    v_and_b32 v13, 0xffff0000, v30
    v_pk_add_f32 v[32:33], v[32:33], v[12:13]
    v_lshlrev_b32 v34, 16, v25
    v_and_b32 v35, 0xffff0000, v25
    v_lshlrev_b32 v12, 16, v27
    v_and_b32 v13, 0xffff0000, v27
    v_pk_add_f32 v[34:35], v[34:35], v[12:13]
    v_lshlrev_b32 v12, 16, v29
    v_and_b32 v13, 0xffff0000, v29
    v_pk_add_f32 v[34:35], v[34:35], v[12:13]
    v_lshlrev_b32 v12, 16, v31
    v_and_b32 v13, 0xffff0000, v31
    v_pk_add_f32 v[34:35], v[34:35], v[12:13]
    v_mul_f32 v48, s6, v32
    v_mul_f32 v49, s6, v33
    v_mul_f32 v50, s6, v34
    v_mul_f32 v51, s6, v35
    v_exp_f32 v48, v48
    v_exp_f32 v49, v49
    v_exp_f32 v50, v50
    v_exp_f32 v51, v51
    v_lshlrev_b32 v40, 16, v16
    v_and_b32 v41, 0xffff0000, v16
    v_lshlrev_b32 v12, 16, v18
    v_and_b32 v13, 0xffff0000, v18
    v_pk_add_f32 v[40:41], v[40:41], v[12:13]
    v_lshlrev_b32 v12, 16, v20
    v_and_b32 v13, 0xffff0000, v20
    v_pk_add_f32 v[40:41], v[40:41], v[12:13]
    v_lshlrev_b32 v12, 16, v22
    v_and_b32 v13, 0xffff0000, v22
    v_pk_add_f32 v[40:41], v[40:41], v[12:13]
    v_lshlrev_b32 v42, 16, v17
    v_and_b32 v43, 0xffff0000, v17
    v_lshlrev_b32 v12, 16, v19
    v_and_b32 v13, 0xffff0000, v19
    v_pk_add_f32 v[42:43], v[42:43], v[12:13]
    v_lshlrev_b32 v12, 16, v21
    v_and_b32 v13, 0xffff0000, v21
    v_pk_add_f32 v[42:43], v[42:43], v[12:13]
    v_lshlrev_b32 v12, 16, v23
    v_and_b32 v13, 0xffff0000, v23
    v_pk_add_f32 v[42:43], v[42:43], v[12:13]
    v_add_f32 v48, 1.0, v48
    v_add_f32 v49, 1.0, v49
    v_add_f32 v50, 1.0, v50
    v_add_f32 v51, 1.0, v51
    v_rcp_f32 v48, v48
    v_rcp_f32 v49, v49
    v_rcp_f32 v50, v50
    v_rcp_f32 v51, v51
    v_pk_mul_f32 v[32:33], v[32:33], v[40:41]
    v_pk_mul_f32 v[34:35], v[34:35], v[42:43]
    v_lshlrev_b32 v12, 16, v200
    v_and_b32 v13, 0xffff0000, v200
    v_pk_fma_f32 v[32:33], v[32:33], v[48:49], v[12:13]
    v_cvt_pk_bf16_f32 v200, v32, v33
    v_lshlrev_b32 v12, 16, v201
    v_and_b32 v13, 0xffff0000, v201
    v_pk_fma_f32 v[34:35], v[34:35], v[50:51], v[12:13]
    v_cvt_pk_bf16_f32 v201, v34, v35
    buffer_store_dwordx2 v[200:201], v74, s[24:27], s14 offen offset:0
L_eg_no8:
    s_waitcnt vmcnt(2)
    s_cmp_eq_u32 s5, 0
    s_cbranch_scc1 L_eg_late
    s_mov_b32 s4, 0x40000
L_wp_3:
    buffer_load_dword v78, v6, s[60:63], s53 offen sc1
    s_waitcnt vmcnt(0)
    v_readfirstlane_b32 s3, v78
    s_sub_u32 s4, s4, 1
    s_cbranch_scc1 L_wpd_4
    s_bfe_u32 s3, s3, 0x80008
    s_cmp_ge_u32 s3, 8
    s_cbranch_scc0 L_wp_3
L_wpd_4:
    s_add_u32 s49, s50, 0
    buffer_load_dwordx4 v[176:179], v1, s[8:11], s49 offen sc1
    s_add_u32 s49, s50, 20480
    buffer_load_dwordx4 v[180:183], v1, s[8:11], s49 offen sc1
    s_add_u32 s49, s50, 40960
    buffer_load_dwordx4 v[184:187], v1, s[8:11], s49 offen sc1
    s_add_u32 s49, s50, 61440
    buffer_load_dwordx4 v[188:191], v1, s[8:11], s49 offen sc1
    s_add_u32 s49, s50, 81920
    buffer_load_dwordx4 v[96:99], v1, s[8:11], s49 offen sc1
    s_add_u32 s49, s50, 102400
    buffer_load_dwordx4 v[100:103], v1, s[8:11], s49 offen sc1
    s_add_u32 s49, s50, 122880
    buffer_load_dwordx4 v[104:107], v1, s[8:11], s49 offen sc1
    s_add_u32 s49, s50, 143360
    buffer_load_dwordx4 v[108:111], v1, s[8:11], s49 offen sc1
    s_waitcnt vmcnt(0)
L_eg_late:
    v_lshlrev_b32 v32, 16, v96
    v_and_b32 v33, 0xffff0000, v96
    v_lshlrev_b32 v12, 16, v100
    v_and_b32 v13, 0xffff0000, v100
    v_pk_add_f32 v[32:33], v[32:33], v[12:13]
    v_lshlrev_b32 v12, 16, v104
    v_and_b32 v13, 0xffff0000, v104
    v_pk_add_f32 v[32:33], v[32:33], v[12:13]
    v_lshlrev_b32 v12, 16, v108
    v_and_b32 v13, 0xffff0000, v108
    v_pk_add_f32 v[32:33], v[32:33], v[12:13]
    v_lshlrev_b32 v34, 16, v97
    v_and_b32 v35, 0xffff0000, v97
    v_lshlrev_b32 v12, 16, v101
    v_and_b32 v13, 0xffff0000, v101
    v_pk_add_f32 v[34:35], v[34:35], v[12:13]
    v_lshlrev_b32 v12, 16, v105
    v_and_b32 v13, 0xffff0000, v105
    v_pk_add_f32 v[34:35], v[34:35], v[12:13]
    v_lshlrev_b32 v12, 16, v109
    v_and_b32 v13, 0xffff0000, v109
    v_pk_add_f32 v[34:35], v[34:35], v[12:13]
    v_lshlrev_b32 v36, 16, v98
    v_and_b32 v37, 0xffff0000, v98
    v_lshlrev_b32 v12, 16, v102
    v_and_b32 v13, 0xffff0000, v102
    v_pk_add_f32 v[36:37], v[36:37], v[12:13]
    v_lshlrev_b32 v12, 16, v106
    v_and_b32 v13, 0xffff0000, v106
    v_pk_add_f32 v[36:37], v[36:37], v[12:13]
    v_lshlrev_b32 v12, 16, v110
    v_and_b32 v13, 0xffff0000, v110
    v_pk_add_f32 v[36:37], v[36:37], v[12:13]
    v_lshlrev_b32 v38, 16, v99
    v_and_b32 v39, 0xffff0000, v99
    v_lshlrev_b32 v12, 16, v103
    v_and_b32 v13, 0xffff0000, v103
    v_pk_add_f32 v[38:39], v[38:39], v[12:13]
    v_lshlrev_b32 v12, 16, v107
    v_and_b32 v13, 0xffff0000, v107
    v_pk_add_f32 v[38:39], v[38:39], v[12:13]
    v_lshlrev_b32 v12, 16, v111
    v_and_b32 v13, 0xffff0000, v111
    v_pk_add_f32 v[38:39], v[38:39], v[12:13]
    v_mul_f32 v48, s6, v32
    v_mul_f32 v49, s6, v33
    v_mul_f32 v50, s6, v34
    v_mul_f32 v51, s6, v35
    v_mul_f32 v52, s6, v36
    v_mul_f32 v53, s6, v37
    v_mul_f32 v54, s6, v38
    v_mul_f32 v55, s6, v39
    v_exp_f32 v48, v48
    v_exp_f32 v49, v49
    v_exp_f32 v50, v50
    v_exp_f32 v51, v51
    v_exp_f32 v52, v52
    v_exp_f32 v53, v53
    v_exp_f32 v54, v54
    v_exp_f32 v55, v55
    v_lshlrev_b32 v40, 16, v176
    v_and_b32 v41, 0xffff0000, v176
    v_lshlrev_b32 v12, 16, v180
    v_and_b32 v13, 0xffff0000, v180
    v_pk_add_f32 v[40:41], v[40:41], v[12:13]
    v_lshlrev_b32 v12, 16, v184
    v_and_b32 v13, 0xffff0000, v184
    v_pk_add_f32 v[40:41], v[40:41], v[12:13]
    v_lshlrev_b32 v12, 16, v188
    v_and_b32 v13, 0xffff0000, v188
    v_pk_add_f32 v[40:41], v[40:41], v[12:13]
    v_lshlrev_b32 v42, 16, v177
    v_and_b32 v43, 0xffff0000, v177
    v_lshlrev_b32 v12, 16, v181
    v_and_b32 v13, 0xffff0000, v181
    v_pk_add_f32 v[42:43], v[42:43], v[12:13]
    v_lshlrev_b32 v12, 16, v185
    v_and_b32 v13, 0xffff0000, v185
    v_pk_add_f32 v[42:43], v[42:43], v[12:13]
    v_lshlrev_b32 v12, 16, v189
    v_and_b32 v13, 0xffff0000, v189
    v_pk_add_f32 v[42:43], v[42:43], v[12:13]
    v_lshlrev_b32 v44, 16, v178
    v_and_b32 v45, 0xffff0000, v178
    v_lshlrev_b32 v12, 16, v182
    v_and_b32 v13, 0xffff0000, v182
    v_pk_add_f32 v[44:45], v[44:45], v[12:13]
    v_lshlrev_b32 v12, 16, v186
    v_and_b32 v13, 0xffff0000, v186
    v_pk_add_f32 v[44:45], v[44:45], v[12:13]
    v_lshlrev_b32 v12, 16, v190
    v_and_b32 v13, 0xffff0000, v190
    v_pk_add_f32 v[44:45], v[44:45], v[12:13]
    v_lshlrev_b32 v46, 16, v179
    v_and_b32 v47, 0xffff0000, v179
    v_lshlrev_b32 v12, 16, v183
    v_and_b32 v13, 0xffff0000, v183
    v_pk_add_f32 v[46:47], v[46:47], v[12:13]
    v_lshlrev_b32 v12, 16, v187
    v_and_b32 v13, 0xffff0000, v187
    v_pk_add_f32 v[46:47], v[46:47], v[12:13]
    v_lshlrev_b32 v12, 16, v191
    v_and_b32 v13, 0xffff0000, v191
    v_pk_add_f32 v[46:47], v[46:47], v[12:13]
    v_add_f32 v48, 1.0, v48
    v_add_f32 v49, 1.0, v49
    v_add_f32 v50, 1.0, v50
    v_add_f32 v51, 1.0, v51
    v_add_f32 v52, 1.0, v52
    v_add_f32 v53, 1.0, v53
    v_add_f32 v54, 1.0, v54
    v_add_f32 v55, 1.0, v55
    v_rcp_f32 v48, v48
    v_rcp_f32 v49, v49
    v_rcp_f32 v50, v50
    v_rcp_f32 v51, v51
    v_rcp_f32 v52, v52
    v_rcp_f32 v53, v53
    v_rcp_f32 v54, v54
    v_rcp_f32 v55, v55
    v_pk_mul_f32 v[32:33], v[32:33], v[40:41]
    v_pk_mul_f32 v[34:35], v[34:35], v[42:43]
    v_pk_mul_f32 v[36:37], v[36:37], v[44:45]
    v_pk_mul_f32 v[38:39], v[38:39], v[46:47]
    v_lshlrev_b32 v12, 16, v196
    v_and_b32 v13, 0xffff0000, v196
    v_pk_fma_f32 v[32:33], v[32:33], v[48:49], v[12:13]
    v_cvt_pk_bf16_f32 v196, v32, v33
    v_lshlrev_b32 v12, 16, v197
    v_and_b32 v13, 0xffff0000, v197
    v_pk_fma_f32 v[34:35], v[34:35], v[50:51], v[12:13]
    v_cvt_pk_bf16_f32 v197, v34, v35
    buffer_store_dwordx2 v[196:197], v74, s[24:27], s13 offen offset:0
    v_lshlrev_b32 v12, 16, v198
    v_and_b32 v13, 0xffff0000, v198
    v_pk_fma_f32 v[36:37], v[36:37], v[52:53], v[12:13]
    v_cvt_pk_bf16_f32 v198, v36, v37
    v_lshlrev_b32 v12, 16, v199
    v_and_b32 v13, 0xffff0000, v199
    v_pk_fma_f32 v[38:39], v[38:39], v[54:55], v[12:13]
    v_cvt_pk_bf16_f32 v199, v38, v39
    buffer_store_dwordx2 v[198:199], v74, s[24:27], s13 offen offset:32
L_fin_done:
L_k2_end:
    s_endpgm
L_role_f:
    v_mfma_f32_16x16x32_bf16 v[224:227], v[32:35], a[224:227], v[224:227]
    s_add_u32 m0, s46, 0
    ds_read_b64_tr_b16 v[24:25], v76 offset:18464
    v_mfma_f32_16x16x32_bf16 v[224:227], v[36:39], a[240:243], v[224:227]
    s_mov_b32 s47, s7
    ds_read_b64_tr_b16 v[26:27], v76 offset:23072
    v_mfma_f32_16x16x32_bf16 v[224:227], v[40:43], a[148:151], v[224:227]
    ds_read_b64_tr_b16 v[28:29], v76 offset:27680
    v_mfma_f32_16x16x32_bf16 v[224:227], v[44:47], a[164:167], v[224:227]
    ds_read_b64_tr_b16 v[30:31], v76 offset:32288
    v_mfma_f32_16x16x32_bf16 v[228:231], v[32:35], a[228:231], v[228:231]
    buffer_load_dwordx4 v64, s[16:19], s47 offen lds
    v_mfma_f32_16x16x32_bf16 v[228:231], v[36:39], a[244:247], v[228:231]
    s_add_u32 m0, s46, 1024
    v_mfma_f32_16x16x32_bf16 v[228:231], v[40:43], a[152:155], v[228:231]
    buffer_load_dwordx4 v65, s[16:19], s47 offen lds
    v_mfma_f32_16x16x32_bf16 v[228:231], v[44:47], a[168:171], v[228:231]
    s_add_u32 m0, s46, 2048
    v_mfma_f32_16x16x32_bf16 v[232:235], v[32:35], a[232:235], v[232:235]
    buffer_load_dword v78, v6, s[60:63], s51 offen sc1
    v_mfma_f32_16x16x32_bf16 v[232:235], v[36:39], a[248:251], v[232:235]
    v_mfma_f32_16x16x32_bf16 v[232:235], v[40:43], a[156:159], v[232:235]
    buffer_load_dwordx4 v66, s[16:19], s47 offen lds
    v_mfma_f32_16x16x32_bf16 v[232:235], v[44:47], a[172:175], v[232:235]
    v_mfma_f32_16x16x32_bf16 v[236:239], v[32:35], a[236:239], v[236:239]
    ds_read_b64_tr_b16 v[32:33], v76 offset:64
    v_mfma_f32_16x16x32_bf16 v[236:239], v[36:39], a[252:255], v[236:239]
    s_add_u32 m0, s46, 3072
    ds_read_b64_tr_b16 v[34:35], v76 offset:4672
    v_mfma_f32_16x16x32_bf16 v[236:239], v[40:43], a[160:163], v[236:239]
    ds_read_b64_tr_b16 v[36:37], v76 offset:9280
    v_mfma_f32_16x16x32_bf16 v[236:239], v[44:47], a[176:179], v[236:239]
    s_waitcnt lgkmcnt(3)
    ds_read_b64_tr_b16 v[38:39], v76 offset:13888
    v_mfma_f32_16x16x32_bf16 v[80:83], v[16:19], a[224:227], v[80:83]
    ds_read_b64_tr_b16 v[40:41], v76 offset:18496
    v_mfma_f32_16x16x32_bf16 v[80:83], v[20:23], a[240:243], v[80:83]
    ds_read_b64_tr_b16 v[42:43], v76 offset:23104
    v_mfma_f32_16x16x32_bf16 v[80:83], v[24:27], a[148:151], v[80:83]
    ds_read_b64_tr_b16 v[44:45], v76 offset:27712
    v_mfma_f32_16x16x32_bf16 v[80:83], v[28:31], a[164:167], v[80:83]
    ds_read_b64_tr_b16 v[46:47], v76 offset:32320
    v_mfma_f32_16x16x32_bf16 v[84:87], v[16:19], a[228:231], v[84:87]
    buffer_load_dwordx4 v67, s[16:19], s47 offen lds
    v_mfma_f32_16x16x32_bf16 v[84:87], v[20:23], a[244:247], v[84:87]
    s_add_u32 m0, s46, 4096
    v_mfma_f32_16x16x32_bf16 v[84:87], v[24:27], a[152:155], v[84:87]
    buffer_load_dwordx4 v68, s[16:19], s47 offen lds
    v_mfma_f32_16x16x32_bf16 v[84:87], v[28:31], a[168:171], v[84:87]
    v_mfma_f32_16x16x32_bf16 v[88:91], v[16:19], a[232:235], v[88:91]
    s_add_u32 m0, s46, 5120
    v_mfma_f32_16x16x32_bf16 v[88:91], v[20:23], a[248:251], v[88:91]
    v_mfma_f32_16x16x32_bf16 v[88:91], v[24:27], a[156:159], v[88:91]
    v_mfma_f32_16x16x32_bf16 v[88:91], v[28:31], a[172:175], v[88:91]
    buffer_load_dwordx4 v69, s[16:19], s47 offen lds
    v_mfma_f32_16x16x32_bf16 v[92:95], v[16:19], a[236:239], v[92:95]
    ds_read_b64_tr_b16 v[16:17], v76 offset:96
    v_mfma_f32_16x16x32_bf16 v[92:95], v[20:23], a[252:255], v[92:95]
    s_add_u32 m0, s46, 6144
    ds_read_b64_tr_b16 v[18:19], v76 offset:4704
    v_mfma_f32_16x16x32_bf16 v[92:95], v[24:27], a[160:163], v[92:95]
    ds_read_b64_tr_b16 v[20:21], v76 offset:9312
    v_mfma_f32_16x16x32_bf16 v[92:95], v[28:31], a[176:179], v[92:95]
    s_waitcnt lgkmcnt(3)
    ds_read_b64_tr_b16 v[22:23], v76 offset:13920
    v_mfma_f32_16x16x32_bf16 v[128:131], v[32:35], a[224:227], v[128:131]
    ds_read_b64_tr_b16 v[24:25], v76 offset:18528
    v_mfma_f32_16x16x32_bf16 v[128:131], v[36:39], a[240:243], v[128:131]
    ds_read_b64_tr_b16 v[26:27], v76 offset:23136
    v_mfma_f32_16x16x32_bf16 v[128:131], v[40:43], a[148:151], v[128:131]
    ds_read_b64_tr_b16 v[28:29], v76 offset:27744
    v_mfma_f32_16x16x32_bf16 v[128:131], v[44:47], a[164:167], v[128:131]
    ds_read_b64_tr_b16 v[30:31], v76 offset:32352
    v_mfma_f32_16x16x32_bf16 v[132:135], v[32:35], a[228:231], v[132:135]
    buffer_load_dwordx4 v70, s[16:19], s47 offen lds
    v_mfma_f32_16x16x32_bf16 v[132:135], v[36:39], a[244:247], v[132:135]
    s_add_u32 m0, s46, 7168
    v_mfma_f32_16x16x32_bf16 v[132:135], v[40:43], a[152:155], v[132:135]
    buffer_load_dwordx4 v71, s[16:19], s47 offen lds
    v_mfma_f32_16x16x32_bf16 v[132:135], v[44:47], a[168:171], v[132:135]
    v_mfma_f32_16x16x32_bf16 v[136:139], v[32:35], a[232:235], v[136:139]
    s_add_u32 m0, s46, 8192
    v_mfma_f32_16x16x32_bf16 v[136:139], v[36:39], a[248:251], v[136:139]
    v_mfma_f32_16x16x32_bf16 v[136:139], v[40:43], a[156:159], v[136:139]
    v_mfma_f32_16x16x32_bf16 v[136:139], v[44:47], a[172:175], v[136:139]
    buffer_load_dwordx4 v72, s[16:19], s47 offen lds
    v_mfma_f32_16x16x32_bf16 v[140:143], v[32:35], a[236:239], v[140:143]
    ds_read_b64_tr_b16 v[32:33], v76 offset:128
    v_mfma_f32_16x16x32_bf16 v[140:143], v[36:39], a[252:255], v[140:143]
    ds_read_b64_tr_b16 v[34:35], v76 offset:4736
    v_mfma_f32_16x16x32_bf16 v[140:143], v[40:43], a[160:163], v[140:143]
    ds_read_b64_tr_b16 v[36:37], v76 offset:9344
    v_mfma_f32_16x16x32_bf16 v[140:143], v[44:47], a[176:179], v[140:143]
    s_waitcnt lgkmcnt(3)
    ds_read_b64_tr_b16 v[38:39], v76 offset:13952
    v_mfma_f32_16x16x32_bf16 v[144:147], v[16:19], a[224:227], v[144:147]
    ds_read_b64_tr_b16 v[40:41], v76 offset:18560
    v_mfma_f32_16x16x32_bf16 v[144:147], v[20:23], a[240:243], v[144:147]
    ds_read_b64_tr_b16 v[42:43], v76 offset:23168
    v_mfma_f32_16x16x32_bf16 v[144:147], v[24:27], a[148:151], v[144:147]
    ds_read_b64_tr_b16 v[44:45], v76 offset:27776
    v_mfma_f32_16x16x32_bf16 v[144:147], v[28:31], a[164:167], v[144:147]
    ds_read_b64_tr_b16 v[46:47], v76 offset:32384
    v_mfma_f32_16x16x32_bf16 v[148:151], v[16:19], a[228:231], v[148:151]
    v_mfma_f32_16x16x32_bf16 v[148:151], v[20:23], a[244:247], v[148:151]
    v_mfma_f32_16x16x32_bf16 v[148:151], v[24:27], a[152:155], v[148:151]
    v_mfma_f32_16x16x32_bf16 v[148:151], v[28:31], a[168:171], v[148:151]
    v_mfma_f32_16x16x32_bf16 v[152:155], v[16:19], a[232:235], v[152:155]
    s_waitcnt vmcnt(7)
    s_add_u32 s49, s12, 61440
    s_or_b32 s49, s49, s58
    v_mfma_f32_16x16x32_bf16 v[152:155], v[20:23], a[248:251], v[152:155]
    v_readfirstlane_b32 s3, v78
    v_mfma_f32_16x16x32_bf16 v[152:155], v[24:27], a[156:159], v[152:155]
    s_bfe_u32 s3, s3, 0x80009
    s_cmp_lt_u32 s3, s48
    s_cbranch_scc1 L_dep8
L_dep8_ret:
    v_mfma_f32_16x16x32_bf16 v[152:155], v[28:31], a[172:175], v[152:155]
    buffer_load_dwordx2 a[0:1], v75, s[36:39], s49 offen offset:0 sc1
    v_mfma_f32_16x16x32_bf16 v[156:159], v[16:19], a[236:239], v[156:159]
    ds_read_b64_tr_b16 v[16:17], v76 offset:160
    v_mfma_f32_16x16x32_bf16 v[156:159], v[20:23], a[252:255], v[156:159]
    ds_read_b64_tr_b16 v[18:19], v76 offset:4768
    v_mfma_f32_16x16x32_bf16 v[156:159], v[24:27], a[160:163], v[156:159]
    ds_read_b64_tr_b16 v[20:21], v76 offset:9376
    v_mfma_f32_16x16x32_bf16 v[156:159], v[28:31], a[176:179], v[156:159]
    s_waitcnt lgkmcnt(3)
    ds_read_b64_tr_b16 v[22:23], v76 offset:13984
    v_mfma_f32_16x16x32_bf16 v[160:163], v[32:35], a[224:227], v[160:163]
    ds_read_b64_tr_b16 v[24:25], v76 offset:18592
    v_mfma_f32_16x16x32_bf16 v[160:163], v[36:39], a[240:243], v[160:163]
    ds_read_b64_tr_b16 v[26:27], v76 offset:23200
    v_mfma_f32_16x16x32_bf16 v[160:163], v[40:43], a[148:151], v[160:163]
    ds_read_b64_tr_b16 v[28:29], v76 offset:27808
    v_mfma_f32_16x16x32_bf16 v[160:163], v[44:47], a[164:167], v[160:163]
    ds_read_b64_tr_b16 v[30:31], v76 offset:32416
    v_mfma_f32_16x16x32_bf16 v[164:167], v[32:35], a[228:231], v[164:167]
    buffer_load_dwordx2 a[2:3], v75, s[36:39], s49 offen offset:512 sc1
    v_mfma_f32_16x16x32_bf16 v[164:167], v[36:39], a[244:247], v[164:167]
    buffer_load_dwordx2 a[4:5], v75, s[36:39], s49 offen offset:1024 sc1
    v_mfma_f32_16x16x32_bf16 v[164:167], v[40:43], a[152:155], v[164:167]
    buffer_load_dwordx2 a[6:7], v75, s[36:39], s49 offen offset:1536 sc1
    v_mfma_f32_16x16x32_bf16 v[164:167], v[44:47], a[168:171], v[164:167]
    buffer_load_dwordx2 a[8:9], v75, s[36:39], s49 offen offset:2048 sc1
    v_mfma_f32_16x16x32_bf16 v[168:171], v[32:35], a[232:235], v[168:171]
    buffer_load_dwordx2 a[10:11], v75, s[36:39], s49 offen offset:2560 sc1
    v_mfma_f32_16x16x32_bf16 v[168:171], v[36:39], a[248:251], v[168:171]
    v_mfma_f32_16x16x32_bf16 v[168:171], v[40:43], a[156:159], v[168:171]
    buffer_load_dwordx2 a[12:13], v75, s[36:39], s49 offen offset:3072 sc1
    v_mfma_f32_16x16x32_bf16 v[168:171], v[44:47], a[172:175], v[168:171]
    v_mfma_f32_16x16x32_bf16 v[172:175], v[32:35], a[236:239], v[172:175]
    ds_read_b64_tr_b16 v[32:33], v76 offset:192
    v_mfma_f32_16x16x32_bf16 v[172:175], v[36:39], a[252:255], v[172:175]
    ds_read_b64_tr_b16 v[34:35], v76 offset:4800
    v_mfma_f32_16x16x32_bf16 v[172:175], v[40:43], a[160:163], v[172:175]
    ds_read_b64_tr_b16 v[36:37], v76 offset:9408
    v_mfma_f32_16x16x32_bf16 v[172:175], v[44:47], a[176:179], v[172:175]
    s_waitcnt lgkmcnt(3)
    ds_read_b64_tr_b16 v[38:39], v76 offset:14016
    v_mfma_f32_16x16x32_bf16 v[176:179], v[16:19], a[224:227], v[176:179]
    ds_read_b64_tr_b16 v[40:41], v76 offset:18624
    v_mfma_f32_16x16x32_bf16 v[176:179], v[20:23], a[240:243], v[176:179]
    ds_read_b64_tr_b16 v[42:43], v76 offset:23232
    v_mfma_f32_16x16x32_bf16 v[176:179], v[24:27], a[148:151], v[176:179]
    ds_read_b64_tr_b16 v[44:45], v76 offset:27840
    v_mfma_f32_16x16x32_bf16 v[176:179], v[28:31], a[164:167], v[176:179]
    ds_read_b64_tr_b16 v[46:47], v76 offset:32448
    v_mfma_f32_16x16x32_bf16 v[180:183], v[16:19], a[228:231], v[180:183]
    buffer_load_dwordx2 a[14:15], v75, s[36:39], s49 offen offset:3584 sc1
    v_mfma_f32_16x16x32_bf16 v[180:183], v[20:23], a[244:247], v[180:183]
    s_add_u32 s49, s12, 65536
    s_or_b32 s49, s49, s58
    v_mfma_f32_16x16x32_bf16 v[180:183], v[24:27], a[152:155], v[180:183]
    buffer_load_dwordx2 a[16:17], v75, s[36:39], s49 offen offset:0 sc1
    v_mfma_f32_16x16x32_bf16 v[180:183], v[28:31], a[168:171], v[180:183]
    buffer_load_dwordx2 a[18:19], v75, s[36:39], s49 offen offset:512 sc1
    v_mfma_f32_16x16x32_bf16 v[184:187], v[16:19], a[232:235], v[184:187]
    buffer_load_dwordx2 a[20:21], v75, s[36:39], s49 offen offset:1024 sc1
    v_mfma_f32_16x16x32_bf16 v[184:187], v[20:23], a[248:251], v[184:187]
    buffer_load_dwordx2 a[22:23], v75, s[36:39], s49 offen offset:1536 sc1
    v_mfma_f32_16x16x32_bf16 v[184:187], v[24:27], a[156:159], v[184:187]
    buffer_load_dwordx2 a[24:25], v75, s[36:39], s49 offen offset:2048 sc1
    v_mfma_f32_16x16x32_bf16 v[184:187], v[28:31], a[172:175], v[184:187]
    buffer_load_dwordx2 a[26:27], v75, s[36:39], s49 offen offset:2560 sc1
    v_mfma_f32_16x16x32_bf16 v[188:191], v[16:19], a[236:239], v[188:191]
    ds_read_b64_tr_b16 v[16:17], v76 offset:224
    v_mfma_f32_16x16x32_bf16 v[188:191], v[20:23], a[252:255], v[188:191]
    ds_read_b64_tr_b16 v[18:19], v76 offset:4832
    v_mfma_f32_16x16x32_bf16 v[188:191], v[24:27], a[160:163], v[188:191]
    ds_read_b64_tr_b16 v[20:21], v76 offset:9440
    v_mfma_f32_16x16x32_bf16 v[188:191], v[28:31], a[176:179], v[188:191]
    s_waitcnt lgkmcnt(3)
    ds_read_b64_tr_b16 v[22:23], v76 offset:14048
    v_mfma_f32_16x16x32_bf16 v[240:243], v[32:35], a[224:227], v[240:243]
    ds_read_b64_tr_b16 v[24:25], v76 offset:18656
    v_mfma_f32_16x16x32_bf16 v[240:243], v[36:39], a[240:243], v[240:243]
    ds_read_b64_tr_b16 v[26:27], v76 offset:23264
    v_mfma_f32_16x16x32_bf16 v[240:243], v[40:43], a[148:151], v[240:243]
    ds_read_b64_tr_b16 v[28:29], v76 offset:27872
    v_mfma_f32_16x16x32_bf16 v[240:243], v[44:47], a[164:167], v[240:243]
    ds_read_b64_tr_b16 v[30:31], v76 offset:32480
    v_mfma_f32_16x16x32_bf16 v[244:247], v[32:35], a[228:231], v[244:247]
    buffer_load_dwordx2 a[28:29], v75, s[36:39], s49 offen offset:3072 sc1
    v_mfma_f32_16x16x32_bf16 v[244:247], v[36:39], a[244:247], v[244:247]
    buffer_load_dwordx2 a[30:31], v75, s[36:39], s49 offen offset:3584 sc1
    v_mfma_f32_16x16x32_bf16 v[244:247], v[40:43], a[152:155], v[244:247]
    s_add_u32 s49, s13, 61440
    s_or_b32 s49, s49, s58
    v_mfma_f32_16x16x32_bf16 v[244:247], v[44:47], a[168:171], v[244:247]
    buffer_load_dwordx2 a[32:33], v75, s[36:39], s49 offen offset:0 sc1
    v_mfma_f32_16x16x32_bf16 v[248:251], v[32:35], a[232:235], v[248:251]
    buffer_load_dwordx2 a[34:35], v75, s[36:39], s49 offen offset:512 sc1
    v_mfma_f32_16x16x32_bf16 v[248:251], v[36:39], a[248:251], v[248:251]
    buffer_load_dwordx2 a[36:37], v75, s[36:39], s49 offen offset:1024 sc1
    v_mfma_f32_16x16x32_bf16 v[248:251], v[40:43], a[156:159], v[248:251]
    buffer_load_dwordx2 a[38:39], v75, s[36:39], s49 offen offset:1536 sc1
    v_mfma_f32_16x16x32_bf16 v[248:251], v[44:47], a[172:175], v[248:251]
    v_mfma_f32_16x16x32_bf16 v[252:255], v[32:35], a[236:239], v[252:255]
    ds_read_b64_tr_b16 v[32:33], v76 offset:256
    v_mfma_f32_16x16x32_bf16 v[252:255], v[36:39], a[252:255], v[252:255]
    ds_read_b64_tr_b16 v[34:35], v76 offset:4864
    v_mfma_f32_16x16x32_bf16 v[252:255], v[40:43], a[160:163], v[252:255]
    ds_read_b64_tr_b16 v[36:37], v76 offset:9472
    v_mfma_f32_16x16x32_bf16 v[252:255], v[44:47], a[176:179], v[252:255]
    s_waitcnt lgkmcnt(3)
    ds_read_b64_tr_b16 v[38:39], v76 offset:14080
    v_mfma_f32_16x16x32_bf16 v[96:99], v[16:19], a[224:227], v[96:99]
    ds_read_b64_tr_b16 v[40:41], v76 offset:18688
    v_mfma_f32_16x16x32_bf16 v[96:99], v[20:23], a[240:243], v[96:99]
    ds_read_b64_tr_b16 v[42:43], v76 offset:23296
    v_mfma_f32_16x16x32_bf16 v[96:99], v[24:27], a[148:151], v[96:99]
    ds_read_b64_tr_b16 v[44:45], v76 offset:27904
    v_mfma_f32_16x16x32_bf16 v[96:99], v[28:31], a[164:167], v[96:99]
    ds_read_b64_tr_b16 v[46:47], v76 offset:32512
    v_mfma_f32_16x16x32_bf16 v[100:103], v[16:19], a[228:231], v[100:103]
    buffer_load_dwordx2 a[40:41], v75, s[36:39], s49 offen offset:2048 sc1
    v_mfma_f32_16x16x32_bf16 v[100:103], v[20:23], a[244:247], v[100:103]
    buffer_load_dwordx2 a[42:43], v75, s[36:39], s49 offen offset:2560 sc1
    v_mfma_f32_16x16x32_bf16 v[100:103], v[24:27], a[152:155], v[100:103]
    buffer_load_dwordx2 a[44:45], v75, s[36:39], s49 offen offset:3072 sc1
    v_mfma_f32_16x16x32_bf16 v[100:103], v[28:31], a[168:171], v[100:103]
    buffer_load_dwordx2 a[46:47], v75, s[36:39], s49 offen offset:3584 sc1
    v_mfma_f32_16x16x32_bf16 v[104:107], v[16:19], a[232:235], v[104:107]
    s_add_u32 s49, s13, 65536
    s_or_b32 s49, s49, s58
    v_mfma_f32_16x16x32_bf16 v[104:107], v[20:23], a[248:251], v[104:107]
    buffer_load_dwordx2 a[48:49], v75, s[36:39], s49 offen offset:0 sc1
    v_mfma_f32_16x16x32_bf16 v[104:107], v[24:27], a[156:159], v[104:107]
    buffer_load_dwordx2 a[50:51], v75, s[36:39], s49 offen offset:512 sc1
    v_mfma_f32_16x16x32_bf16 v[104:107], v[28:31], a[172:175], v[104:107]
    v_mfma_f32_16x16x32_bf16 v[108:111], v[16:19], a[236:239], v[108:111]
    buffer_load_dwordx2 a[52:53], v75, s[36:39], s49 offen offset:1024 sc1
    v_mfma_f32_16x16x32_bf16 v[108:111], v[20:23], a[252:255], v[108:111]
    v_mfma_f32_16x16x32_bf16 v[108:111], v[24:27], a[160:163], v[108:111]
    buffer_load_dwordx2 a[54:55], v75, s[36:39], s49 offen offset:1536 sc1
    v_mfma_f32_16x16x32_bf16 v[108:111], v[28:31], a[176:179], v[108:111]
    s_waitcnt lgkmcnt(0)
    v_mfma_f32_16x16x32_bf16 v[112:115], v[32:35], a[224:227], v[112:115]
    s_waitcnt vmcnt(46)
    s_barrier
    v_mfma_f32_16x16x32_bf16 v[112:115], v[36:39], a[240:243], v[112:115]
    ds_read_b64_tr_b16 v[16:17], v77 offset:0
    v_mfma_f32_16x16x32_bf16 v[112:115], v[40:43], a[148:151], v[112:115]
    ds_read_b64_tr_b16 v[18:19], v77 offset:4608
    v_mfma_f32_16x16x32_bf16 v[112:115], v[44:47], a[164:167], v[112:115]
    ds_read_b64_tr_b16 v[20:21], v77 offset:9216
    v_mfma_f32_16x16x32_bf16 v[116:119], v[32:35], a[228:231], v[116:119]
    ds_read_b64_tr_b16 v[22:23], v77 offset:13824
    v_mfma_f32_16x16x32_bf16 v[116:119], v[36:39], a[244:247], v[116:119]
    ds_read_b64_tr_b16 v[24:25], v77 offset:18432
    v_mfma_f32_16x16x32_bf16 v[116:119], v[40:43], a[152:155], v[116:119]
    ds_read_b64_tr_b16 v[26:27], v77 offset:23040
    v_mfma_f32_16x16x32_bf16 v[116:119], v[44:47], a[168:171], v[116:119]
    ds_read_b64_tr_b16 v[28:29], v77 offset:27648
    v_mfma_f32_16x16x32_bf16 v[120:123], v[32:35], a[232:235], v[120:123]
    ds_read_b64_tr_b16 v[30:31], v77 offset:32256
    v_mfma_f32_16x16x32_bf16 v[120:123], v[36:39], a[248:251], v[120:123]
    buffer_load_dwordx2 a[56:57], v75, s[36:39], s49 offen offset:2048 sc1
    v_mfma_f32_16x16x32_bf16 v[120:123], v[40:43], a[156:159], v[120:123]
    buffer_load_dwordx2 a[58:59], v75, s[36:39], s49 offen offset:2560 sc1
    v_mfma_f32_16x16x32_bf16 v[120:123], v[44:47], a[172:175], v[120:123]
    buffer_load_dwordx2 a[60:61], v75, s[36:39], s49 offen offset:3072 sc1
    v_mfma_f32_16x16x32_bf16 v[124:127], v[32:35], a[236:239], v[124:127]
    ds_read_b64_tr_b16 v[32:33], v77 offset:32
    v_mfma_f32_16x16x32_bf16 v[124:127], v[36:39], a[252:255], v[124:127]
    ds_read_b64_tr_b16 v[34:35], v77 offset:4640
    v_mfma_f32_16x16x32_bf16 v[124:127], v[40:43], a[160:163], v[124:127]
    ds_read_b64_tr_b16 v[36:37], v77 offset:9248
    v_mfma_f32_16x16x32_bf16 v[124:127], v[44:47], a[176:179], v[124:127]
    s_waitcnt vmcnt(41) lgkmcnt(3)
    ds_read_b64_tr_b16 v[38:39], v77 offset:13856
    v_mfma_f32_16x16x32_bf16 v[224:227], v[16:19], a[212:215], v[224:227]
    ds_read_b64_tr_b16 v[40:41], v77 offset:18464
    v_mfma_f32_16x16x32_bf16 v[224:227], v[20:23], a[132:135], v[224:227]
    ds_read_b64_tr_b16 v[42:43], v77 offset:23072
    v_mfma_f32_16x16x32_bf16 v[224:227], v[24:27], a[180:183], v[224:227]
    ds_read_b64_tr_b16 v[44:45], v77 offset:27680
    v_mfma_f32_16x16x32_bf16 v[224:227], v[28:31], a[196:199], v[224:227]
    ds_read_b64_tr_b16 v[46:47], v77 offset:32288
    v_mfma_f32_16x16x32_bf16 v[228:231], v[16:19], a[216:219], v[228:231]
    buffer_load_dwordx2 a[62:63], v75, s[36:39], s49 offen offset:3584 sc1
    v_mfma_f32_16x16x32_bf16 v[228:231], v[20:23], a[136:139], v[228:231]
    v_mfma_f32_16x16x32_bf16 v[228:231], v[24:27], a[184:187], v[228:231]
    v_mfma_f32_16x16x32_bf16 v[228:231], v[28:31], a[200:203], v[228:231]
    v_mfma_f32_16x16x32_bf16 v[232:235], v[16:19], a[220:223], v[232:235]
    v_mfma_f32_16x16x32_bf16 v[232:235], v[20:23], a[140:143], v[232:235]
    v_mfma_f32_16x16x32_bf16 v[232:235], v[24:27], a[188:191], v[232:235]
    v_mfma_f32_16x16x32_bf16 v[232:235], v[28:31], a[204:207], v[232:235]
    v_mfma_f32_16x16x32_bf16 v[236:239], v[16:19], a[128:131], v[236:239]
    ds_read_b64_tr_b16 v[16:17], v77 offset:256
    v_mfma_f32_16x16x32_bf16 v[236:239], v[20:23], a[144:147], v[236:239]
    ds_read_b64_tr_b16 v[18:19], v77 offset:4864
    v_mfma_f32_16x16x32_bf16 v[236:239], v[24:27], a[192:195], v[236:239]
    ds_read_b64_tr_b16 v[20:21], v77 offset:9472
    v_mfma_f32_16x16x32_bf16 v[236:239], v[28:31], a[208:211], v[236:239]
    s_waitcnt lgkmcnt(3)
    ds_read_b64_tr_b16 v[22:23], v77 offset:14080
    v_mfma_f32_16x16x32_bf16 v[80:83], v[32:35], a[212:215], v[80:83]
    ds_read_b64_tr_b16 v[24:25], v77 offset:18688
    v_mfma_f32_16x16x32_bf16 v[80:83], v[36:39], a[132:135], v[80:83]
    ds_read_b64_tr_b16 v[26:27], v77 offset:23296
    v_mfma_f32_16x16x32_bf16 v[80:83], v[40:43], a[180:183], v[80:83]
    ds_read_b64_tr_b16 v[28:29], v77 offset:27904
    v_mfma_f32_16x16x32_bf16 v[80:83], v[44:47], a[196:199], v[80:83]
    ds_read_b64_tr_b16 v[30:31], v77 offset:32512
    v_mfma_f32_16x16x32_bf16 v[84:87], v[32:35], a[216:219], v[84:87]
    v_mfma_f32_16x16x32_bf16 v[84:87], v[36:39], a[136:139], v[84:87]
    v_mfma_f32_16x16x32_bf16 v[84:87], v[40:43], a[184:187], v[84:87]
    v_mfma_f32_16x16x32_bf16 v[84:87], v[44:47], a[200:203], v[84:87]
    v_mfma_f32_16x16x32_bf16 v[88:91], v[32:35], a[220:223], v[88:91]
    v_mfma_f32_16x16x32_bf16 v[88:91], v[36:39], a[140:143], v[88:91]
    v_mfma_f32_16x16x32_bf16 v[88:91], v[40:43], a[188:191], v[88:91]
    v_mfma_f32_16x16x32_bf16 v[88:91], v[44:47], a[204:207], v[88:91]
    v_mfma_f32_16x16x32_bf16 v[92:95], v[32:35], a[128:131], v[92:95]
    v_mfma_f32_16x16x32_bf16 v[92:95], v[36:39], a[144:147], v[92:95]
    v_mfma_f32_16x16x32_bf16 v[92:95], v[40:43], a[192:195], v[92:95]
    s_mov_b64 s[20:21], s[92:93]
    s_mov_b64 s[24:25], s[94:95]
    v_mfma_f32_16x16x32_bf16 v[92:95], v[44:47], a[208:211], v[92:95]
    s_waitcnt lgkmcnt(0)
    v_mfma_f32_16x16x32_bf16 v[112:115], v[16:19], a[212:215], v[112:115]
    s_waitcnt vmcnt(32)
    s_barrier
    v_mfma_f32_16x16x32_bf16 v[112:115], v[20:23], a[132:135], v[112:115]
    ds_read_b64_tr_b16 v[32:33], v73 offset:256
    v_mfma_f32_16x16x32_bf16 v[112:115], v[24:27], a[180:183], v[112:115]
    ds_read_b64_tr_b16 v[34:35], v73 offset:4864
    v_mfma_f32_16x16x32_bf16 v[112:115], v[28:31], a[196:199], v[112:115]
    ds_read_b64_tr_b16 v[36:37], v73 offset:9472
    v_mfma_f32_16x16x32_bf16 v[116:119], v[16:19], a[216:219], v[116:119]
    ds_read_b64_tr_b16 v[38:39], v73 offset:14080
    v_mfma_f32_16x16x32_bf16 v[116:119], v[20:23], a[136:139], v[116:119]
    ds_read_b64_tr_b16 v[40:41], v73 offset:18688
    v_mfma_f32_16x16x32_bf16 v[116:119], v[24:27], a[184:187], v[116:119]
    ds_read_b64_tr_b16 v[42:43], v73 offset:23296
    v_mfma_f32_16x16x32_bf16 v[116:119], v[28:31], a[200:203], v[116:119]
    ds_read_b64_tr_b16 v[44:45], v73 offset:27904
    v_mfma_f32_16x16x32_bf16 v[120:123], v[16:19], a[220:223], v[120:123]
    ds_read_b64_tr_b16 v[46:47], v73 offset:32512
    v_mfma_f32_16x16x32_bf16 v[120:123], v[20:23], a[140:143], v[120:123]
    s_lshl_b32 s5, s42, 2
    s_add_u32 s5, s5, s40
    s_lshl_b32 s5, s5, 2
    v_mfma_f32_16x16x32_bf16 v[120:123], v[24:27], a[188:191], v[120:123]
    s_and_b32 s6, s0, 3
    s_add_u32 s5, s5, s6
    s_mul_i32 s5, s5, 18432
    v_mfma_f32_16x16x32_bf16 v[120:123], v[28:31], a[204:207], v[120:123]
    s_mul_i32 s47, s6, 163840
    s_mul_i32 s6, s43, 288
    s_add_u32 s5, s5, s6
    v_mfma_f32_16x16x32_bf16 v[124:127], v[16:19], a[128:131], v[124:127]
    ds_read_b64_tr_b16 v[16:17], v77 offset:64
    v_mfma_f32_16x16x32_bf16 v[124:127], v[20:23], a[144:147], v[124:127]
    ds_read_b64_tr_b16 v[18:19], v77 offset:4672
    v_mfma_f32_16x16x32_bf16 v[124:127], v[24:27], a[192:195], v[124:127]
    ds_read_b64_tr_b16 v[20:21], v77 offset:9280
    v_mfma_f32_16x16x32_bf16 v[124:127], v[28:31], a[208:211], v[124:127]
    s_waitcnt vmcnt(0) lgkmcnt(3)
    ds_read_b64_tr_b16 v[22:23], v77 offset:13888
    v_mfma_f32_16x16x32_bf16 v[112:115], v[32:35], a[0:3], v[112:115]
    ds_read_b64_tr_b16 v[24:25], v77 offset:18496
    v_mfma_f32_16x16x32_bf16 v[112:115], v[36:39], a[16:19], v[112:115]
    ds_read_b64_tr_b16 v[26:27], v77 offset:23104
    v_mfma_f32_16x16x32_bf16 v[112:115], v[40:43], a[32:35], v[112:115]
    ds_read_b64_tr_b16 v[28:29], v77 offset:27712
    v_mfma_f32_16x16x32_bf16 v[112:115], v[44:47], a[48:51], v[112:115]
    ds_read_b64_tr_b16 v[30:31], v77 offset:32320
    v_mfma_f32_16x16x32_bf16 v[116:119], v[32:35], a[4:7], v[116:119]
    s_mul_i32 s32, s0, 20480
    s_add_u32 s33, s32, 163840
    v_mfma_f32_16x16x32_bf16 v[116:119], v[36:39], a[20:23], v[116:119]
    s_add_u32 s34, s32, 327680
    s_add_u32 s35, s32, 491520
    s_lshl_b32 s3, s42, 5
    v_mfma_f32_16x16x32_bf16 v[116:119], v[40:43], a[36:39], v[116:119]
    s_add_u32 s3, s3, s43
    s_lshl_b32 s3, s3, 8
    v_mfma_f32_16x16x32_bf16 v[116:119], v[44:47], a[52:55], v[116:119]
    s_add_u32 s52, s3, 4096
    s_add_u32 s53, s3, 5120
    v_mfma_f32_16x16x32_bf16 v[120:123], v[32:35], a[8:11], v[120:123]
    s_add_u32 s12, s5, 0
    s_add_u32 s13, s5, 192
    s_add_u32 s14, s5, 1073741824
    v_mfma_f32_16x16x32_bf16 v[120:123], v[36:39], a[24:27], v[120:123]
    s_add_u32 s55, s47, 0
    s_add_u32 s50, s47, 3072
    s_add_u32 s47, s47, 1073741824
    v_mfma_f32_16x16x32_bf16 v[120:123], v[40:43], a[40:43], v[120:123]
    s_mov_b32 s22, 2359296
    s_mov_b32 s26, 2359296
    v_mfma_f32_16x16x32_bf16 v[120:123], v[44:47], a[56:59], v[120:123]
    buffer_load_dwordx2 v[192:193], v74, s[20:23], s12 offen offset:0
    v_mfma_f32_16x16x32_bf16 v[124:127], v[32:35], a[12:15], v[124:127]
    ds_read_b64_tr_b16 v[32:33], v73 offset:0
    v_mfma_f32_16x16x32_bf16 v[124:127], v[36:39], a[28:31], v[124:127]
    ds_read_b64_tr_b16 v[34:35], v73 offset:4608
    v_mfma_f32_16x16x32_bf16 v[124:127], v[40:43], a[44:47], v[124:127]
    ds_read_b64_tr_b16 v[36:37], v73 offset:9216
    v_mfma_f32_16x16x32_bf16 v[124:127], v[44:47], a[60:63], v[124:127]
    s_waitcnt lgkmcnt(3)
    ds_read_b64_tr_b16 v[38:39], v73 offset:13824
    v_mfma_f32_16x16x32_bf16 v[128:131], v[16:19], a[212:215], v[128:131]
    ds_read_b64_tr_b16 v[40:41], v73 offset:18432
    v_mfma_f32_16x16x32_bf16 v[128:131], v[20:23], a[132:135], v[128:131]
    ds_read_b64_tr_b16 v[42:43], v73 offset:23040
    v_mfma_f32_16x16x32_bf16 v[128:131], v[24:27], a[180:183], v[128:131]
    ds_read_b64_tr_b16 v[44:45], v73 offset:27648
    v_mfma_f32_16x16x32_bf16 v[128:131], v[28:31], a[196:199], v[128:131]
    ds_read_b64_tr_b16 v[46:47], v73 offset:32256
    v_mfma_f32_16x16x32_bf16 v[132:135], v[16:19], a[216:219], v[132:135]
    buffer_load_dwordx2 v[194:195], v74, s[20:23], s12 offen offset:32
    v_mfma_f32_16x16x32_bf16 v[132:135], v[20:23], a[136:139], v[132:135]
    v_mfma_f32_16x16x32_bf16 v[132:135], v[24:27], a[184:187], v[132:135]
    v_mfma_f32_16x16x32_bf16 v[132:135], v[28:31], a[200:203], v[132:135]
    buffer_load_dwordx2 v[196:197], v74, s[20:23], s13 offen offset:0
    v_mfma_f32_16x16x32_bf16 v[136:139], v[16:19], a[220:223], v[136:139]
    v_cvt_pk_bf16_f32 v112, v112, v113
    v_cvt_pk_bf16_f32 v113, v114, v115
    v_mfma_f32_16x16x32_bf16 v[136:139], v[20:23], a[140:143], v[136:139]
    buffer_store_dwordx2 v[112:113], v75, s[8:11], s32 offen sc1
    v_mfma_f32_16x16x32_bf16 v[136:139], v[24:27], a[188:191], v[136:139]
    buffer_load_dwordx2 v[198:199], v74, s[20:23], s13 offen offset:32
    v_mfma_f32_16x16x32_bf16 v[136:139], v[28:31], a[204:207], v[136:139]
    v_mfma_f32_16x16x32_bf16 v[140:143], v[16:19], a[128:131], v[140:143]
    ds_read_b64_tr_b16 v[16:17], v77 offset:96
    v_cvt_pk_bf16_f32 v116, v116, v117
    v_mfma_f32_16x16x32_bf16 v[140:143], v[20:23], a[144:147], v[140:143]
    ds_read_b64_tr_b16 v[18:19], v77 offset:4704
    v_cvt_pk_bf16_f32 v117, v118, v119
    v_mfma_f32_16x16x32_bf16 v[140:143], v[24:27], a[192:195], v[140:143]
    ds_read_b64_tr_b16 v[20:21], v77 offset:9312
    v_mfma_f32_16x16x32_bf16 v[140:143], v[28:31], a[208:211], v[140:143]
    s_waitcnt lgkmcnt(3)
    ds_read_b64_tr_b16 v[22:23], v77 offset:13920
    v_mfma_f32_16x16x32_bf16 v[224:227], v[32:35], a[0:3], v[224:227]
    ds_read_b64_tr_b16 v[24:25], v77 offset:18528
    v_mfma_f32_16x16x32_bf16 v[224:227], v[36:39], a[16:19], v[224:227]
    ds_read_b64_tr_b16 v[26:27], v77 offset:23136
    v_mfma_f32_16x16x32_bf16 v[224:227], v[40:43], a[32:35], v[224:227]
    ds_read_b64_tr_b16 v[28:29], v77 offset:27744
    v_mfma_f32_16x16x32_bf16 v[224:227], v[44:47], a[48:51], v[224:227]
    ds_read_b64_tr_b16 v[30:31], v77 offset:32352
    v_mfma_f32_16x16x32_bf16 v[228:231], v[32:35], a[4:7], v[228:231]
    buffer_store_dwordx2 v[116:117], v75, s[8:11], s33 offen sc1
    v_mfma_f32_16x16x32_bf16 v[228:231], v[36:39], a[20:23], v[228:231]
    buffer_load_dwordx2 v[200:201], v74, s[20:23], s14 offen offset:0
    v_mfma_f32_16x16x32_bf16 v[228:231], v[40:43], a[36:39], v[228:231]
    v_mfma_f32_16x16x32_bf16 v[228:231], v[44:47], a[52:55], v[228:231]
    v_cvt_pk_bf16_f32 v120, v120, v121
    v_cvt_pk_bf16_f32 v121, v122, v123
    v_mfma_f32_16x16x32_bf16 v[232:235], v[32:35], a[8:11], v[232:235]
    buffer_store_dwordx2 v[120:121], v75, s[8:11], s34 offen sc1
    v_mfma_f32_16x16x32_bf16 v[232:235], v[36:39], a[24:27], v[232:235]
    v_mfma_f32_16x16x32_bf16 v[232:235], v[40:43], a[40:43], v[232:235]
    v_mfma_f32_16x16x32_bf16 v[232:235], v[44:47], a[56:59], v[232:235]
    v_cvt_pk_bf16_f32 v124, v124, v125
    v_cvt_pk_bf16_f32 v125, v126, v127
    v_mfma_f32_16x16x32_bf16 v[236:239], v[32:35], a[12:15], v[236:239]
    ds_read_b64_tr_b16 v[32:33], v73 offset:32
    v_mfma_f32_16x16x32_bf16 v[236:239], v[36:39], a[28:31], v[236:239]
    ds_read_b64_tr_b16 v[34:35], v73 offset:4640
    v_mfma_f32_16x16x32_bf16 v[236:239], v[40:43], a[44:47], v[236:239]
    ds_read_b64_tr_b16 v[36:37], v73 offset:9248
    v_mfma_f32_16x16x32_bf16 v[236:239], v[44:47], a[60:63], v[236:239]
    s_waitcnt lgkmcnt(3)
    ds_read_b64_tr_b16 v[38:39], v73 offset:13856
    v_mfma_f32_16x16x32_bf16 v[144:147], v[16:19], a[212:215], v[144:147]
    ds_read_b64_tr_b16 v[40:41], v73 offset:18464
    v_mfma_f32_16x16x32_bf16 v[144:147], v[20:23], a[132:135], v[144:147]
    ds_read_b64_tr_b16 v[42:43], v73 offset:23072
    v_mfma_f32_16x16x32_bf16 v[144:147], v[24:27], a[180:183], v[144:147]
    ds_read_b64_tr_b16 v[44:45], v73 offset:27680
    v_mfma_f32_16x16x32_bf16 v[144:147], v[28:31], a[196:199], v[144:147]
    ds_read_b64_tr_b16 v[46:47], v73 offset:32288
    v_mfma_f32_16x16x32_bf16 v[148:151], v[16:19], a[216:219], v[148:151]
    buffer_store_dwordx2 v[124:125], v75, s[8:11], s35 offen sc1
    v_mfma_f32_16x16x32_bf16 v[148:151], v[20:23], a[136:139], v[148:151]
    v_mfma_f32_16x16x32_bf16 v[148:151], v[24:27], a[184:187], v[148:151]
    v_mfma_f32_16x16x32_bf16 v[148:151], v[28:31], a[200:203], v[148:151]
    v_mfma_f32_16x16x32_bf16 v[152:155], v[16:19], a[220:223], v[152:155]
    v_mfma_f32_16x16x32_bf16 v[152:155], v[20:23], a[140:143], v[152:155]
    v_mfma_f32_16x16x32_bf16 v[152:155], v[24:27], a[188:191], v[152:155]
    v_mfma_f32_16x16x32_bf16 v[152:155], v[28:31], a[204:207], v[152:155]
    v_mfma_f32_16x16x32_bf16 v[156:159], v[16:19], a[128:131], v[156:159]
    ds_read_b64_tr_b16 v[16:17], v77 offset:128
    v_mfma_f32_16x16x32_bf16 v[156:159], v[20:23], a[144:147], v[156:159]
    ds_read_b64_tr_b16 v[18:19], v77 offset:4736
    v_mfma_f32_16x16x32_bf16 v[156:159], v[24:27], a[192:195], v[156:159]
    ds_read_b64_tr_b16 v[20:21], v77 offset:9344
    v_mfma_f32_16x16x32_bf16 v[156:159], v[28:31], a[208:211], v[156:159]
    s_waitcnt lgkmcnt(3)
    ds_read_b64_tr_b16 v[22:23], v77 offset:13952
    v_mfma_f32_16x16x32_bf16 v[80:83], v[32:35], a[0:3], v[80:83]
    ds_read_b64_tr_b16 v[24:25], v77 offset:18560
    v_mfma_f32_16x16x32_bf16 v[80:83], v[36:39], a[16:19], v[80:83]
    ds_read_b64_tr_b16 v[26:27], v77 offset:23168
    v_mfma_f32_16x16x32_bf16 v[80:83], v[40:43], a[32:35], v[80:83]
    ds_read_b64_tr_b16 v[28:29], v77 offset:27776
    v_mfma_f32_16x16x32_bf16 v[80:83], v[44:47], a[48:51], v[80:83]
    ds_read_b64_tr_b16 v[30:31], v77 offset:32384
    v_mfma_f32_16x16x32_bf16 v[84:87], v[32:35], a[4:7], v[84:87]
    v_mfma_f32_16x16x32_bf16 v[84:87], v[36:39], a[20:23], v[84:87]
    v_mfma_f32_16x16x32_bf16 v[84:87], v[40:43], a[36:39], v[84:87]
    v_mfma_f32_16x16x32_bf16 v[84:87], v[44:47], a[52:55], v[84:87]
    v_mfma_f32_16x16x32_bf16 v[88:91], v[32:35], a[8:11], v[88:91]
    v_mfma_f32_16x16x32_bf16 v[88:91], v[36:39], a[24:27], v[88:91]
    v_mfma_f32_16x16x32_bf16 v[88:91], v[40:43], a[40:43], v[88:91]
    v_mfma_f32_16x16x32_bf16 v[88:91], v[44:47], a[56:59], v[88:91]
    v_mfma_f32_16x16x32_bf16 v[92:95], v[32:35], a[12:15], v[92:95]
    ds_read_b64_tr_b16 v[32:33], v73 offset:64
    v_mfma_f32_16x16x32_bf16 v[92:95], v[36:39], a[28:31], v[92:95]
    ds_read_b64_tr_b16 v[34:35], v73 offset:4672
    v_mfma_f32_16x16x32_bf16 v[92:95], v[40:43], a[44:47], v[92:95]
    ds_read_b64_tr_b16 v[36:37], v73 offset:9280
    v_mfma_f32_16x16x32_bf16 v[92:95], v[44:47], a[60:63], v[92:95]
    s_waitcnt lgkmcnt(3)
    ds_read_b64_tr_b16 v[38:39], v73 offset:13888
    v_mfma_f32_16x16x32_bf16 v[160:163], v[16:19], a[212:215], v[160:163]
    ds_read_b64_tr_b16 v[40:41], v73 offset:18496
    v_mfma_f32_16x16x32_bf16 v[160:163], v[20:23], a[132:135], v[160:163]
    ds_read_b64_tr_b16 v[42:43], v73 offset:23104
    v_mfma_f32_16x16x32_bf16 v[160:163], v[24:27], a[180:183], v[160:163]
    ds_read_b64_tr_b16 v[44:45], v73 offset:27712
    v_mfma_f32_16x16x32_bf16 v[160:163], v[28:31], a[196:199], v[160:163]
    ds_read_b64_tr_b16 v[46:47], v73 offset:32320
    v_mfma_f32_16x16x32_bf16 v[164:167], v[16:19], a[216:219], v[164:167]
    v_mfma_f32_16x16x32_bf16 v[164:167], v[20:23], a[136:139], v[164:167]
    v_mfma_f32_16x16x32_bf16 v[164:167], v[24:27], a[184:187], v[164:167]
    v_mfma_f32_16x16x32_bf16 v[164:167], v[28:31], a[200:203], v[164:167]
    v_mfma_f32_16x16x32_bf16 v[168:171], v[16:19], a[220:223], v[168:171]
    v_cvt_pk_bf16_f32 v224, v224, v225
    v_cvt_pk_bf16_f32 v225, v226, v227
    v_mfma_f32_16x16x32_bf16 v[168:171], v[20:23], a[140:143], v[168:171]
    v_cvt_pk_bf16_f32 v226, v80, v81
    v_cvt_pk_bf16_f32 v227, v82, v83
    v_mfma_f32_16x16x32_bf16 v[168:171], v[24:27], a[188:191], v[168:171]
    buffer_store_dwordx4 v[224:227], v1, s[8:11], s32 offen offset:0 sc1
    v_mfma_f32_16x16x32_bf16 v[168:171], v[28:31], a[204:207], v[168:171]
    v_mfma_f32_16x16x32_bf16 v[172:175], v[16:19], a[128:131], v[172:175]
    ds_read_b64_tr_b16 v[16:17], v77 offset:160
    v_mfma_f32_16x16x32_bf16 v[172:175], v[20:23], a[144:147], v[172:175]
    ds_read_b64_tr_b16 v[18:19], v77 offset:4768
    v_mfma_f32_16x16x32_bf16 v[172:175], v[24:27], a[192:195], v[172:175]
    ds_read_b64_tr_b16 v[20:21], v77 offset:9376
    v_mfma_f32_16x16x32_bf16 v[172:175], v[28:31], a[208:211], v[172:175]
    s_waitcnt lgkmcnt(3)
    ds_read_b64_tr_b16 v[22:23], v77 offset:13984
    v_mfma_f32_16x16x32_bf16 v[128:131], v[32:35], a[0:3], v[128:131]
    ds_read_b64_tr_b16 v[24:25], v77 offset:18592
    v_cvt_pk_bf16_f32 v228, v228, v229
    v_mfma_f32_16x16x32_bf16 v[128:131], v[36:39], a[16:19], v[128:131]
    ds_read_b64_tr_b16 v[26:27], v77 offset:23200
    v_cvt_pk_bf16_f32 v229, v230, v231
    v_mfma_f32_16x16x32_bf16 v[128:131], v[40:43], a[32:35], v[128:131]
    ds_read_b64_tr_b16 v[28:29], v77 offset:27808
    v_cvt_pk_bf16_f32 v230, v84, v85
    v_mfma_f32_16x16x32_bf16 v[128:131], v[44:47], a[48:51], v[128:131]
    ds_read_b64_tr_b16 v[30:31], v77 offset:32416
    v_cvt_pk_bf16_f32 v231, v86, v87
    v_mfma_f32_16x16x32_bf16 v[132:135], v[32:35], a[4:7], v[132:135]
    buffer_store_dwordx4 v[228:231], v1, s[8:11], s33 offen offset:0 sc1
    v_mfma_f32_16x16x32_bf16 v[132:135], v[36:39], a[20:23], v[132:135]
    v_mfma_f32_16x16x32_bf16 v[132:135], v[40:43], a[36:39], v[132:135]
    v_mfma_f32_16x16x32_bf16 v[132:135], v[44:47], a[52:55], v[132:135]
    v_mfma_f32_16x16x32_bf16 v[136:139], v[32:35], a[8:11], v[136:139]
    v_mfma_f32_16x16x32_bf16 v[136:139], v[36:39], a[24:27], v[136:139]
    v_cvt_pk_bf16_f32 v232, v232, v233
    v_cvt_pk_bf16_f32 v233, v234, v235
    v_mfma_f32_16x16x32_bf16 v[136:139], v[40:43], a[40:43], v[136:139]
    v_cvt_pk_bf16_f32 v234, v88, v89
    v_cvt_pk_bf16_f32 v235, v90, v91
    v_mfma_f32_16x16x32_bf16 v[136:139], v[44:47], a[56:59], v[136:139]
    buffer_store_dwordx4 v[232:235], v1, s[8:11], s34 offen offset:0 sc1
    v_mfma_f32_16x16x32_bf16 v[140:143], v[32:35], a[12:15], v[140:143]
    ds_read_b64_tr_b16 v[32:33], v73 offset:96
    v_mfma_f32_16x16x32_bf16 v[140:143], v[36:39], a[28:31], v[140:143]
    ds_read_b64_tr_b16 v[34:35], v73 offset:4704
    v_mfma_f32_16x16x32_bf16 v[140:143], v[40:43], a[44:47], v[140:143]
    ds_read_b64_tr_b16 v[36:37], v73 offset:9312
    v_mfma_f32_16x16x32_bf16 v[140:143], v[44:47], a[60:63], v[140:143]
    s_waitcnt lgkmcnt(3)
    ds_read_b64_tr_b16 v[38:39], v73 offset:13920
    v_mfma_f32_16x16x32_bf16 v[176:179], v[16:19], a[212:215], v[176:179]
    ds_read_b64_tr_b16 v[40:41], v73 offset:18528
    v_cvt_pk_bf16_f32 v236, v236, v237
    v_mfma_f32_16x16x32_bf16 v[176:179], v[20:23], a[132:135], v[176:179]
    ds_read_b64_tr_b16 v[42:43], v73 offset:23136
    v_cvt_pk_bf16_f32 v237, v238, v239
    v_mfma_f32_16x16x32_bf16 v[176:179], v[24:27], a[180:183], v[176:179]
    ds_read_b64_tr_b16 v[44:45], v73 offset:27744
    v_cvt_pk_bf16_f32 v238, v92, v93
    v_mfma_f32_16x16x32_bf16 v[176:179], v[28:31], a[196:199], v[176:179]
    ds_read_b64_tr_b16 v[46:47], v73 offset:32352
    v_cvt_pk_bf16_f32 v239, v94, v95
    v_mfma_f32_16x16x32_bf16 v[180:183], v[16:19], a[216:219], v[180:183]
    buffer_store_dwordx4 v[236:239], v1, s[8:11], s35 offen offset:0 sc1
    v_mfma_f32_16x16x32_bf16 v[180:183], v[20:23], a[136:139], v[180:183]
    v_mfma_f32_16x16x32_bf16 v[180:183], v[24:27], a[184:187], v[180:183]
    v_mfma_f32_16x16x32_bf16 v[180:183], v[28:31], a[200:203], v[180:183]
    v_mfma_f32_16x16x32_bf16 v[184:187], v[16:19], a[220:223], v[184:187]
    v_mfma_f32_16x16x32_bf16 v[184:187], v[20:23], a[140:143], v[184:187]
    v_mfma_f32_16x16x32_bf16 v[184:187], v[24:27], a[188:191], v[184:187]
    v_mfma_f32_16x16x32_bf16 v[184:187], v[28:31], a[204:207], v[184:187]
    v_mfma_f32_16x16x32_bf16 v[188:191], v[16:19], a[128:131], v[188:191]
    ds_read_b64_tr_b16 v[16:17], v77 offset:192
    v_mfma_f32_16x16x32_bf16 v[188:191], v[20:23], a[144:147], v[188:191]
    ds_read_b64_tr_b16 v[18:19], v77 offset:4800
    v_mfma_f32_16x16x32_bf16 v[188:191], v[24:27], a[192:195], v[188:191]
    ds_read_b64_tr_b16 v[20:21], v77 offset:9408
    v_mfma_f32_16x16x32_bf16 v[188:191], v[28:31], a[208:211], v[188:191]
    s_waitcnt lgkmcnt(3)
    ds_read_b64_tr_b16 v[22:23], v77 offset:14016
    v_mfma_f32_16x16x32_bf16 v[144:147], v[32:35], a[0:3], v[144:147]
    ds_read_b64_tr_b16 v[24:25], v77 offset:18624
    v_mfma_f32_16x16x32_bf16 v[144:147], v[36:39], a[16:19], v[144:147]
    ds_read_b64_tr_b16 v[26:27], v77 offset:23232
    v_mfma_f32_16x16x32_bf16 v[144:147], v[40:43], a[32:35], v[144:147]
    ds_read_b64_tr_b16 v[28:29], v77 offset:27840
    v_mfma_f32_16x16x32_bf16 v[144:147], v[44:47], a[48:51], v[144:147]
    ds_read_b64_tr_b16 v[30:31], v77 offset:32448
    v_mfma_f32_16x16x32_bf16 v[148:151], v[32:35], a[4:7], v[148:151]
    v_mfma_f32_16x16x32_bf16 v[148:151], v[36:39], a[20:23], v[148:151]
    v_mfma_f32_16x16x32_bf16 v[148:151], v[40:43], a[36:39], v[148:151]
    v_mfma_f32_16x16x32_bf16 v[148:151], v[44:47], a[52:55], v[148:151]
    v_mfma_f32_16x16x32_bf16 v[152:155], v[32:35], a[8:11], v[152:155]
    v_mfma_f32_16x16x32_bf16 v[152:155], v[36:39], a[24:27], v[152:155]
    v_mfma_f32_16x16x32_bf16 v[152:155], v[40:43], a[40:43], v[152:155]
    v_mfma_f32_16x16x32_bf16 v[152:155], v[44:47], a[56:59], v[152:155]
    v_mfma_f32_16x16x32_bf16 v[156:159], v[32:35], a[12:15], v[156:159]
    ds_read_b64_tr_b16 v[32:33], v73 offset:128
    v_mfma_f32_16x16x32_bf16 v[156:159], v[36:39], a[28:31], v[156:159]
    ds_read_b64_tr_b16 v[34:35], v73 offset:4736
    v_mfma_f32_16x16x32_bf16 v[156:159], v[40:43], a[44:47], v[156:159]
    ds_read_b64_tr_b16 v[36:37], v73 offset:9344
    v_mfma_f32_16x16x32_bf16 v[156:159], v[44:47], a[60:63], v[156:159]
    s_waitcnt lgkmcnt(3)
    ds_read_b64_tr_b16 v[38:39], v73 offset:13952
    v_mfma_f32_16x16x32_bf16 v[240:243], v[16:19], a[212:215], v[240:243]
    ds_read_b64_tr_b16 v[40:41], v73 offset:18560
    v_mfma_f32_16x16x32_bf16 v[240:243], v[20:23], a[132:135], v[240:243]
    ds_read_b64_tr_b16 v[42:43], v73 offset:23168
    v_mfma_f32_16x16x32_bf16 v[240:243], v[24:27], a[180:183], v[240:243]
    ds_read_b64_tr_b16 v[44:45], v73 offset:27776
    v_mfma_f32_16x16x32_bf16 v[240:243], v[28:31], a[196:199], v[240:243]
    ds_read_b64_tr_b16 v[46:47], v73 offset:32384
    v_mfma_f32_16x16x32_bf16 v[244:247], v[16:19], a[216:219], v[244:247]
    v_mfma_f32_16x16x32_bf16 v[244:247], v[20:23], a[136:139], v[244:247]
    v_mfma_f32_16x16x32_bf16 v[244:247], v[24:27], a[184:187], v[244:247]
    v_mfma_f32_16x16x32_bf16 v[244:247], v[28:31], a[200:203], v[244:247]
    v_mfma_f32_16x16x32_bf16 v[248:251], v[16:19], a[220:223], v[248:251]
    v_cvt_pk_bf16_f32 v128, v128, v129
    v_cvt_pk_bf16_f32 v129, v130, v131
    v_mfma_f32_16x16x32_bf16 v[248:251], v[20:23], a[140:143], v[248:251]
    v_cvt_pk_bf16_f32 v130, v144, v145
    v_cvt_pk_bf16_f32 v131, v146, v147
    v_mfma_f32_16x16x32_bf16 v[248:251], v[24:27], a[188:191], v[248:251]
    buffer_store_dwordx4 v[128:131], v1, s[8:11], s32 offen offset:1024 sc1
    v_mfma_f32_16x16x32_bf16 v[248:251], v[28:31], a[204:207], v[248:251]
    v_mfma_f32_16x16x32_bf16 v[252:255], v[16:19], a[128:131], v[252:255]
    ds_read_b64_tr_b16 v[16:17], v77 offset:224
    v_mfma_f32_16x16x32_bf16 v[252:255], v[20:23], a[144:147], v[252:255]
    ds_read_b64_tr_b16 v[18:19], v77 offset:4832
    v_mfma_f32_16x16x32_bf16 v[252:255], v[24:27], a[192:195], v[252:255]
    ds_read_b64_tr_b16 v[20:21], v77 offset:9440
    v_mfma_f32_16x16x32_bf16 v[252:255], v[28:31], a[208:211], v[252:255]
    s_waitcnt lgkmcnt(3)
    ds_read_b64_tr_b16 v[22:23], v77 offset:14048
    v_mfma_f32_16x16x32_bf16 v[160:163], v[32:35], a[0:3], v[160:163]
    ds_read_b64_tr_b16 v[24:25], v77 offset:18656
    v_cvt_pk_bf16_f32 v132, v132, v133
    v_mfma_f32_16x16x32_bf16 v[160:163], v[36:39], a[16:19], v[160:163]
    ds_read_b64_tr_b16 v[26:27], v77 offset:23264
    v_cvt_pk_bf16_f32 v133, v134, v135
    v_mfma_f32_16x16x32_bf16 v[160:163], v[40:43], a[32:35], v[160:163]
    ds_read_b64_tr_b16 v[28:29], v77 offset:27872
    v_cvt_pk_bf16_f32 v134, v148, v149
    v_mfma_f32_16x16x32_bf16 v[160:163], v[44:47], a[48:51], v[160:163]
    ds_read_b64_tr_b16 v[30:31], v77 offset:32480
    v_cvt_pk_bf16_f32 v135, v150, v151
    v_mfma_f32_16x16x32_bf16 v[164:167], v[32:35], a[4:7], v[164:167]
    buffer_store_dwordx4 v[132:135], v1, s[8:11], s33 offen offset:1024 sc1
    v_mfma_f32_16x16x32_bf16 v[164:167], v[36:39], a[20:23], v[164:167]
    v_mfma_f32_16x16x32_bf16 v[164:167], v[40:43], a[36:39], v[164:167]
    v_mfma_f32_16x16x32_bf16 v[164:167], v[44:47], a[52:55], v[164:167]
    v_mfma_f32_16x16x32_bf16 v[168:171], v[32:35], a[8:11], v[168:171]
    v_mfma_f32_16x16x32_bf16 v[168:171], v[36:39], a[24:27], v[168:171]
    v_cvt_pk_bf16_f32 v136, v136, v137
    v_cvt_pk_bf16_f32 v137, v138, v139
    v_mfma_f32_16x16x32_bf16 v[168:171], v[40:43], a[40:43], v[168:171]
    v_cvt_pk_bf16_f32 v138, v152, v153
    v_cvt_pk_bf16_f32 v139, v154, v155
    v_mfma_f32_16x16x32_bf16 v[168:171], v[44:47], a[56:59], v[168:171]
    buffer_store_dwordx4 v[136:139], v1, s[8:11], s34 offen offset:1024 sc1
    v_mfma_f32_16x16x32_bf16 v[172:175], v[32:35], a[12:15], v[172:175]
    ds_read_b64_tr_b16 v[32:33], v73 offset:160
    v_mfma_f32_16x16x32_bf16 v[172:175], v[36:39], a[28:31], v[172:175]
    ds_read_b64_tr_b16 v[34:35], v73 offset:4768
    v_mfma_f32_16x16x32_bf16 v[172:175], v[40:43], a[44:47], v[172:175]
    ds_read_b64_tr_b16 v[36:37], v73 offset:9376
    v_mfma_f32_16x16x32_bf16 v[172:175], v[44:47], a[60:63], v[172:175]
    s_waitcnt lgkmcnt(3)
    ds_read_b64_tr_b16 v[38:39], v73 offset:13984
    v_mfma_f32_16x16x32_bf16 v[96:99], v[16:19], a[212:215], v[96:99]
    ds_read_b64_tr_b16 v[40:41], v73 offset:18592
    v_cvt_pk_bf16_f32 v140, v140, v141
    v_mfma_f32_16x16x32_bf16 v[96:99], v[20:23], a[132:135], v[96:99]
    ds_read_b64_tr_b16 v[42:43], v73 offset:23200
    v_cvt_pk_bf16_f32 v141, v142, v143
    v_mfma_f32_16x16x32_bf16 v[96:99], v[24:27], a[180:183], v[96:99]
    ds_read_b64_tr_b16 v[44:45], v73 offset:27808
    v_cvt_pk_bf16_f32 v142, v156, v157
    v_mfma_f32_16x16x32_bf16 v[96:99], v[28:31], a[196:199], v[96:99]
    ds_read_b64_tr_b16 v[46:47], v73 offset:32416
    v_cvt_pk_bf16_f32 v143, v158, v159
    v_mfma_f32_16x16x32_bf16 v[100:103], v[16:19], a[216:219], v[100:103]
    buffer_store_dwordx4 v[140:143], v1, s[8:11], s35 offen offset:1024 sc1
    v_mfma_f32_16x16x32_bf16 v[100:103], v[20:23], a[136:139], v[100:103]
    v_mfma_f32_16x16x32_bf16 v[100:103], v[24:27], a[184:187], v[100:103]
    v_mfma_f32_16x16x32_bf16 v[100:103], v[28:31], a[200:203], v[100:103]
    v_mfma_f32_16x16x32_bf16 v[104:107], v[16:19], a[220:223], v[104:107]
    v_mfma_f32_16x16x32_bf16 v[104:107], v[20:23], a[140:143], v[104:107]
    v_mfma_f32_16x16x32_bf16 v[104:107], v[24:27], a[188:191], v[104:107]
    v_mfma_f32_16x16x32_bf16 v[104:107], v[28:31], a[204:207], v[104:107]
    v_mfma_f32_16x16x32_bf16 v[108:111], v[16:19], a[128:131], v[108:111]
    ds_read_b64_tr_b16 v[16:17], v73 offset:192
    v_mfma_f32_16x16x32_bf16 v[108:111], v[20:23], a[144:147], v[108:111]
    ds_read_b64_tr_b16 v[18:19], v73 offset:4800
    v_mfma_f32_16x16x32_bf16 v[108:111], v[24:27], a[192:195], v[108:111]
    ds_read_b64_tr_b16 v[20:21], v73 offset:9408
    v_mfma_f32_16x16x32_bf16 v[108:111], v[28:31], a[208:211], v[108:111]
    s_waitcnt lgkmcnt(3)
    ds_read_b64_tr_b16 v[22:23], v73 offset:14016
    v_mfma_f32_16x16x32_bf16 v[176:179], v[32:35], a[0:3], v[176:179]
    ds_read_b64_tr_b16 v[24:25], v73 offset:18624
    v_mfma_f32_16x16x32_bf16 v[176:179], v[36:39], a[16:19], v[176:179]
    ds_read_b64_tr_b16 v[26:27], v73 offset:23232
    v_mfma_f32_16x16x32_bf16 v[176:179], v[40:43], a[32:35], v[176:179]
    ds_read_b64_tr_b16 v[28:29], v73 offset:27840
    v_mfma_f32_16x16x32_bf16 v[176:179], v[44:47], a[48:51], v[176:179]
    ds_read_b64_tr_b16 v[30:31], v73 offset:32448
    v_mfma_f32_16x16x32_bf16 v[180:183], v[32:35], a[4:7], v[180:183]
    v_mfma_f32_16x16x32_bf16 v[180:183], v[36:39], a[20:23], v[180:183]
    v_mfma_f32_16x16x32_bf16 v[180:183], v[40:43], a[36:39], v[180:183]
    v_mfma_f32_16x16x32_bf16 v[180:183], v[44:47], a[52:55], v[180:183]
    v_mfma_f32_16x16x32_bf16 v[184:187], v[32:35], a[8:11], v[184:187]
    v_mfma_f32_16x16x32_bf16 v[184:187], v[36:39], a[24:27], v[184:187]
    v_mfma_f32_16x16x32_bf16 v[184:187], v[40:43], a[40:43], v[184:187]
    v_mfma_f32_16x16x32_bf16 v[184:187], v[44:47], a[56:59], v[184:187]
    v_mfma_f32_16x16x32_bf16 v[188:191], v[32:35], a[12:15], v[188:191]
    ds_read_b64_tr_b16 v[32:33], v73 offset:224
    v_mfma_f32_16x16x32_bf16 v[188:191], v[36:39], a[28:31], v[188:191]
    ds_read_b64_tr_b16 v[34:35], v73 offset:4832
    v_mfma_f32_16x16x32_bf16 v[188:191], v[40:43], a[44:47], v[188:191]
    ds_read_b64_tr_b16 v[36:37], v73 offset:9440
    v_mfma_f32_16x16x32_bf16 v[188:191], v[44:47], a[60:63], v[188:191]
    s_waitcnt lgkmcnt(3)
    ds_read_b64_tr_b16 v[38:39], v73 offset:14048
    v_mfma_f32_16x16x32_bf16 v[240:243], v[16:19], a[0:3], v[240:243]
    ds_read_b64_tr_b16 v[40:41], v73 offset:18656
    v_mfma_f32_16x16x32_bf16 v[240:243], v[20:23], a[16:19], v[240:243]
    s_add_u32 s87, s53, s86
    ds_read_b64_tr_b16 v[42:43], v73 offset:23264
    v_mfma_f32_16x16x32_bf16 v[240:243], v[24:27], a[32:35], v[240:243]
    ds_read_b64_tr_b16 v[44:45], v73 offset:27872
    v_mov_b32 v14, 0x1
    v_mfma_f32_16x16x32_bf16 v[240:243], v[28:31], a[48:51], v[240:243]
    ds_read_b64_tr_b16 v[46:47], v73 offset:32480
    v_mfma_f32_16x16x32_bf16 v[244:247], v[16:19], a[4:7], v[244:247]
    v_mfma_f32_16x16x32_bf16 v[244:247], v[20:23], a[20:23], v[244:247]
    v_mfma_f32_16x16x32_bf16 v[244:247], v[24:27], a[36:39], v[244:247]
    v_mfma_f32_16x16x32_bf16 v[244:247], v[28:31], a[52:55], v[244:247]
    v_mfma_f32_16x16x32_bf16 v[248:251], v[16:19], a[8:11], v[248:251]
    v_cvt_pk_bf16_f32 v160, v160, v161
    v_cvt_pk_bf16_f32 v161, v162, v163
    v_mfma_f32_16x16x32_bf16 v[248:251], v[20:23], a[24:27], v[248:251]
    s_waitcnt vmcnt(0)
    s_barrier
    v_cvt_pk_bf16_f32 v162, v176, v177
    v_mfma_f32_16x16x32_bf16 v[248:251], v[24:27], a[40:43], v[248:251]
    buffer_atomic_add v14, v6, s[60:63], s87 offen
    v_mfma_f32_16x16x32_bf16 v[248:251], v[28:31], a[56:59], v[248:251]
    v_cvt_pk_bf16_f32 v163, v178, v179
    v_mfma_f32_16x16x32_bf16 v[252:255], v[16:19], a[12:15], v[252:255]
    buffer_store_dwordx4 v[160:163], v1, s[8:11], s32 offen offset:2048 sc1
    v_mfma_f32_16x16x32_bf16 v[252:255], v[20:23], a[28:31], v[252:255]
    v_mfma_f32_16x16x32_bf16 v[252:255], v[24:27], a[44:47], v[252:255]
    v_mfma_f32_16x16x32_bf16 v[252:255], v[28:31], a[60:63], v[252:255]
    s_waitcnt lgkmcnt(0)
    v_cvt_pk_bf16_f32 v164, v164, v165
    v_cvt_pk_bf16_f32 v165, v166, v167
    v_mfma_f32_16x16x32_bf16 v[96:99], v[32:35], a[0:3], v[96:99]
    v_cvt_pk_bf16_f32 v166, v180, v181
    v_cvt_pk_bf16_f32 v167, v182, v183
    v_mfma_f32_16x16x32_bf16 v[96:99], v[36:39], a[16:19], v[96:99]
    buffer_store_dwordx4 v[164:167], v1, s[8:11], s33 offen offset:2048 sc1
    v_mfma_f32_16x16x32_bf16 v[96:99], v[40:43], a[32:35], v[96:99]
    v_mfma_f32_16x16x32_bf16 v[96:99], v[44:47], a[48:51], v[96:99]
    v_mfma_f32_16x16x32_bf16 v[100:103], v[32:35], a[4:7], v[100:103]
    v_cvt_pk_bf16_f32 v168, v168, v169
    v_cvt_pk_bf16_f32 v169, v170, v171
    v_mfma_f32_16x16x32_bf16 v[100:103], v[36:39], a[20:23], v[100:103]
    v_cvt_pk_bf16_f32 v170, v184, v185
    v_cvt_pk_bf16_f32 v171, v186, v187
    v_mfma_f32_16x16x32_bf16 v[100:103], v[40:43], a[36:39], v[100:103]
    buffer_store_dwordx4 v[168:171], v1, s[8:11], s34 offen offset:2048 sc1
    v_mfma_f32_16x16x32_bf16 v[100:103], v[44:47], a[52:55], v[100:103]
    v_mfma_f32_16x16x32_bf16 v[104:107], v[32:35], a[8:11], v[104:107]
    v_mfma_f32_16x16x32_bf16 v[104:107], v[36:39], a[24:27], v[104:107]
    v_cvt_pk_bf16_f32 v172, v172, v173
    v_cvt_pk_bf16_f32 v173, v174, v175
    v_mfma_f32_16x16x32_bf16 v[104:107], v[40:43], a[40:43], v[104:107]
    v_cvt_pk_bf16_f32 v174, v188, v189
    v_cvt_pk_bf16_f32 v175, v190, v191
    v_mfma_f32_16x16x32_bf16 v[104:107], v[44:47], a[56:59], v[104:107]
    buffer_store_dwordx4 v[172:175], v1, s[8:11], s35 offen offset:2048 sc1
    v_mfma_f32_16x16x32_bf16 v[108:111], v[32:35], a[12:15], v[108:111]
    v_mfma_f32_16x16x32_bf16 v[108:111], v[36:39], a[28:31], v[108:111]
    v_mfma_f32_16x16x32_bf16 v[108:111], v[40:43], a[44:47], v[108:111]
    v_mfma_f32_16x16x32_bf16 v[108:111], v[44:47], a[60:63], v[108:111]
    s_nop 7
    v_cvt_pk_bf16_f32 v240, v240, v241
    v_cvt_pk_bf16_f32 v241, v242, v243
    v_cvt_pk_bf16_f32 v242, v96, v97
    v_cvt_pk_bf16_f32 v243, v98, v99
    buffer_store_dwordx4 v[240:243], v1, s[8:11], s32 offen offset:3072 sc1
    v_cvt_pk_bf16_f32 v244, v244, v245
    v_cvt_pk_bf16_f32 v245, v246, v247
    v_cvt_pk_bf16_f32 v246, v100, v101
    v_cvt_pk_bf16_f32 v247, v102, v103
    buffer_store_dwordx4 v[244:247], v1, s[8:11], s33 offen offset:3072 sc1
    v_cvt_pk_bf16_f32 v248, v248, v249
    v_cvt_pk_bf16_f32 v249, v250, v251
    v_cvt_pk_bf16_f32 v250, v104, v105
    v_cvt_pk_bf16_f32 v251, v106, v107
    buffer_store_dwordx4 v[248:251], v1, s[8:11], s34 offen offset:3072 sc1
    v_cvt_pk_bf16_f32 v252, v252, v253
    v_cvt_pk_bf16_f32 v253, v254, v255
    v_cvt_pk_bf16_f32 v254, v108, v109
    v_cvt_pk_bf16_f32 v255, v110, v111
    buffer_store_dwordx4 v[252:255], v1, s[8:11], s35 offen offset:3072 sc1
    s_branch L_endgame
L_dep0:
    s_mov_b32 s4, 0x40000
L_wp_5:
    buffer_load_dword v78, v6, s[60:63], s44 offen sc1
    s_waitcnt vmcnt(0)
    v_readfirstlane_b32 s3, v78
    s_sub_u32 s4, s4, 1
    s_cbranch_scc1 L_wpd_6
    s_bfe_u32 s3, s3, 0x80000
    s_cmp_ge_u32 s3, s41
    s_cbranch_scc0 L_wp_5
L_wpd_6:
    s_branch L_dep0_ret
L_dep2:
    s_mov_b32 s4, 0x40000
L_wp_7:
    buffer_load_dword v78, v6, s[60:63], s97 offen sc1
    s_waitcnt vmcnt(0)
    v_readfirstlane_b32 s3, v78
    s_sub_u32 s4, s4, 1
    s_cbranch_scc1 L_wpd_8
    s_bfe_u32 s3, s3, 0x80000
    s_cmp_ge_u32 s3, s48
    s_cbranch_scc0 L_wp_7
L_wpd_8:
    s_branch L_dep2_ret
L_dep4:
    s_mov_b32 s4, 0x40000
L_wp_9:
    buffer_load_dword v78, v6, s[60:63], s96 offen sc1
    s_waitcnt vmcnt(0)
    v_readfirstlane_b32 s3, v78
    s_sub_u32 s4, s4, 1
    s_cbranch_scc1 L_wpd_10
    s_bfe_u32 s3, s3, 0x80008
    s_cmp_ge_u32 s3, s48
    s_cbranch_scc0 L_wp_9
L_wpd_10:
    s_branch L_dep4_ret
L_dep5:
    s_mov_b32 s4, 0x40000
L_wp_11:
    buffer_load_dword v78, v6, s[60:63], s97 offen sc1
    s_waitcnt vmcnt(0)
    v_readfirstlane_b32 s3, v78
    s_sub_u32 s4, s4, 1
    s_cbranch_scc1 L_wpd_12
    s_bfe_u32 s3, s3, 0x80008
    s_cmp_ge_u32 s3, s48
    s_cbranch_scc0 L_wp_11
L_wpd_12:
    s_branch L_dep5_ret
L_dep6:
    s_mov_b32 s4, 0x40000
L_wp_13:
    buffer_load_dword v78, v6, s[60:63], s96 offen sc1
    s_waitcnt vmcnt(0)
    v_readfirstlane_b32 s3, v78
    s_sub_u32 s4, s4, 1
    s_cbranch_scc1 L_wpd_14
    s_bfe_u32 s3, s3, 0x80010
    s_cmp_ge_u32 s3, s48
    s_cbranch_scc0 L_wp_13
L_wpd_14:
    s_branch L_dep6_ret
L_dep7:
    s_mov_b32 s4, 0x40000
L_wp_15:
    buffer_load_dword v78, v6, s[60:63], s97 offen sc1
    s_waitcnt vmcnt(0)
    v_readfirstlane_b32 s3, v78
    s_sub_u32 s4, s4, 1
    s_cbranch_scc1 L_wpd_16
    s_bfe_u32 s3, s3, 0x80010
    s_cmp_ge_u32 s3, s48
    s_cbranch_scc0 L_wp_15
L_wpd_16:
    s_branch L_dep7_ret
L_dep8:
    s_mov_b32 s4, 0x40000
L_wp_17:
    buffer_load_dword v78, v6, s[60:63], s51 offen sc1
    s_waitcnt vmcnt(0)
    v_readfirstlane_b32 s3, v78
    s_sub_u32 s4, s4, 1
    s_cbranch_scc1 L_wpd_18
    s_bfe_u32 s3, s3, 0x80009
    s_cmp_ge_u32 s3, s48
    s_cbranch_scc0 L_wp_17
L_wpd_18:
    s_branch L_dep8_ret
L_slow_entry:
    v_accvgpr_write_b32 a0, 0
    v_accvgpr_write_b32 a1, 0
    v_accvgpr_write_b32 a2, 0
    v_accvgpr_write_b32 a3, 0
    v_accvgpr_write_b32 a4, 0
    v_accvgpr_write_b32 a5, 0
    v_accvgpr_write_b32 a6, 0
    v_accvgpr_write_b32 a7, 0
    v_accvgpr_write_b32 a8, 0
    v_accvgpr_write_b32 a9, 0
    v_accvgpr_write_b32 a10, 0
    v_accvgpr_write_b32 a11, 0
    v_accvgpr_write_b32 a12, 0
    v_accvgpr_write_b32 a13, 0
    v_accvgpr_write_b32 a14, 0
    v_accvgpr_write_b32 a15, 0
    v_accvgpr_write_b32 a16, 0
    v_accvgpr_write_b32 a17, 0
    v_accvgpr_write_b32 a18, 0
    v_accvgpr_write_b32 a19, 0
    v_accvgpr_write_b32 a20, 0
    v_accvgpr_write_b32 a21, 0
    v_accvgpr_write_b32 a22, 0
    v_accvgpr_write_b32 a23, 0
    v_accvgpr_write_b32 a24, 0
    v_accvgpr_write_b32 a25, 0
    v_accvgpr_write_b32 a26, 0
    v_accvgpr_write_b32 a27, 0
    v_accvgpr_write_b32 a28, 0
    v_accvgpr_write_b32 a29, 0
    v_accvgpr_write_b32 a30, 0
    v_accvgpr_write_b32 a31, 0
    v_accvgpr_write_b32 a32, 0
    v_accvgpr_write_b32 a33, 0
    v_accvgpr_write_b32 a34, 0
    v_accvgpr_write_b32 a35, 0
    v_accvgpr_write_b32 a36, 0
    v_accvgpr_write_b32 a37, 0
    v_accvgpr_write_b32 a38, 0
    v_accvgpr_write_b32 a39, 0
    v_accvgpr_write_b32 a40, 0
    v_accvgpr_write_b32 a41, 0
    v_accvgpr_write_b32 a42, 0
    v_accvgpr_write_b32 a43, 0
    v_accvgpr_write_b32 a44, 0
    v_accvgpr_write_b32 a45, 0
    v_accvgpr_write_b32 a46, 0
    v_accvgpr_write_b32 a47, 0
    v_accvgpr_write_b32 a48, 0
    v_accvgpr_write_b32 a49, 0
    v_accvgpr_write_b32 a50, 0
    v_accvgpr_write_b32 a51, 0
    v_accvgpr_write_b32 a52, 0
    v_accvgpr_write_b32 a53, 0
    v_accvgpr_write_b32 a54, 0
    v_accvgpr_write_b32 a55, 0
    v_accvgpr_write_b32 a56, 0
    v_accvgpr_write_b32 a57, 0
    v_accvgpr_write_b32 a58, 0
    v_accvgpr_write_b32 a59, 0
    v_accvgpr_write_b32 a60, 0
    v_accvgpr_write_b32 a61, 0
    v_accvgpr_write_b32 a62, 0
    v_accvgpr_write_b32 a63, 0
    v_accvgpr_write_b32 a64, 0
    v_accvgpr_write_b32 a65, 0
    v_accvgpr_write_b32 a66, 0
    v_accvgpr_write_b32 a67, 0
    v_accvgpr_write_b32 a68, 0
    v_accvgpr_write_b32 a69, 0
    v_accvgpr_write_b32 a70, 0
    v_accvgpr_write_b32 a71, 0
    v_accvgpr_write_b32 a72, 0
    v_accvgpr_write_b32 a73, 0
    v_accvgpr_write_b32 a74, 0
    v_accvgpr_write_b32 a75, 0
    v_accvgpr_write_b32 a76, 0
    v_accvgpr_write_b32 a77, 0
    v_accvgpr_write_b32 a78, 0
    v_accvgpr_write_b32 a79, 0
    v_accvgpr_write_b32 a80, 0
    v_accvgpr_write_b32 a81, 0
    v_accvgpr_write_b32 a82, 0
    v_accvgpr_write_b32 a83, 0
    v_accvgpr_write_b32 a84, 0
    v_accvgpr_write_b32 a85, 0
    v_accvgpr_write_b32 a86, 0
    v_accvgpr_write_b32 a87, 0
    v_accvgpr_write_b32 a88, 0
    v_accvgpr_write_b32 a89, 0
    v_accvgpr_write_b32 a90, 0
    v_accvgpr_write_b32 a91, 0
    v_accvgpr_write_b32 a92, 0
    v_accvgpr_write_b32 a93, 0
    v_accvgpr_write_b32 a94, 0
    v_accvgpr_write_b32 a95, 0
    v_accvgpr_write_b32 a96, 0
    v_accvgpr_write_b32 a97, 0
    v_accvgpr_write_b32 a98, 0
    v_accvgpr_write_b32 a99, 0
    v_accvgpr_write_b32 a100, 0
    v_accvgpr_write_b32 a101, 0
    v_accvgpr_write_b32 a102, 0
    v_accvgpr_write_b32 a103, 0
    v_accvgpr_write_b32 a104, 0
    v_accvgpr_write_b32 a105, 0
    v_accvgpr_write_b32 a106, 0
    v_accvgpr_write_b32 a107, 0
    v_accvgpr_write_b32 a108, 0
    v_accvgpr_write_b32 a109, 0
    v_accvgpr_write_b32 a110, 0
    v_accvgpr_write_b32 a111, 0
    v_accvgpr_write_b32 a112, 0
    v_accvgpr_write_b32 a113, 0
    v_accvgpr_write_b32 a114, 0
    v_accvgpr_write_b32 a115, 0
    v_accvgpr_write_b32 a116, 0
    v_accvgpr_write_b32 a117, 0
    v_accvgpr_write_b32 a118, 0
    v_accvgpr_write_b32 a119, 0
    v_accvgpr_write_b32 a120, 0
    v_accvgpr_write_b32 a121, 0
    v_accvgpr_write_b32 a122, 0
    v_accvgpr_write_b32 a123, 0
    v_accvgpr_write_b32 a124, 0
    v_accvgpr_write_b32 a125, 0
    v_accvgpr_write_b32 a126, 0
    v_accvgpr_write_b32 a127, 0
    v_accvgpr_write_b32 a128, 0
    v_accvgpr_write_b32 a129, 0
    v_accvgpr_write_b32 a130, 0
    v_accvgpr_write_b32 a131, 0
    v_accvgpr_write_b32 a132, 0
    v_accvgpr_write_b32 a133, 0
    v_accvgpr_write_b32 a134, 0
    v_accvgpr_write_b32 a135, 0
    v_accvgpr_write_b32 a136, 0
    v_accvgpr_write_b32 a137, 0
    v_accvgpr_write_b32 a138, 0
    v_accvgpr_write_b32 a139, 0
    v_accvgpr_write_b32 a140, 0
    v_accvgpr_write_b32 a141, 0
    v_accvgpr_write_b32 a142, 0
    v_accvgpr_write_b32 a143, 0
    v_mov_b32 v24, 0xff61b1e6
    v_mov_b32 v25, 0xff61b1e6
    v_mov_b32 v26, 0xff61b1e6
    v_mov_b32 v27, 0xff61b1e6
    v_subrev_u32 v5, 16384, v5
    s_mov_b32 s47, 0
    s_waitcnt vmcnt(0)
L_slow:
    s_barrier
    s_add_u32 m0, s44, 0
    s_nop 0
    buffer_load_dwordx4 v5, s[8:11], s47 offen offset:0 lds
    buffer_load_dwordx4 v5, s[8:11], s47 offen offset:1024 lds
    buffer_load_dwordx4 v5, s[8:11], s47 offen offset:2048 lds
    buffer_load_dwordx4 v5, s[8:11], s47 offen offset:3072 lds
    s_add_u32 m0, s44, 147456
    s_nop 0
    buffer_load_dwordx4 v6, s[12:15], s47 offen offset:0 lds
    buffer_load_dwordx4 v6, s[12:15], s47 offen offset:1024 lds
    buffer_load_dwordx4 v6, s[12:15], s47 offen offset:2048 lds
    buffer_load_dwordx4 v6, s[12:15], s47 offen offset:3072 lds
    s_waitcnt vmcnt(0)
    s_barrier
    ds_read_b128 a[148:151], v48 offset:0
    ds_read_b128 a[152:155], v49 offset:0
    ds_read_b128 a[156:159], v50 offset:0
    ds_read_b128 a[160:163], v51 offset:0
    ds_read_b128 a[164:167], v48 offset:1024
    ds_read_b128 a[168:171], v49 offset:1024
    ds_read_b128 a[172:175], v50 offset:1024
    ds_read_b128 a[176:179], v51 offset:1024
    ds_read_b64_tr_b16 a[180:181], v52 offset:49152
    ds_read_b64_tr_b16 a[182:183], v52 offset:50176
    ds_read_b64_tr_b16 a[184:185], v53 offset:49152
    ds_read_b64_tr_b16 a[186:187], v53 offset:50176
    ds_read_b64_tr_b16 a[188:189], v54 offset:49152
    ds_read_b64_tr_b16 a[190:191], v54 offset:50176
    s_waitcnt lgkmcnt(4)
    ds_read_b64_tr_b16 a[192:193], v55 offset:49152
    ds_read_b64_tr_b16 a[194:195], v55 offset:50176
    ds_read_b64_tr_b16 a[196:197], v56 offset:49152
    ds_read_b64_tr_b16 a[198:199], v56 offset:50176
    ds_read_b64_tr_b16 a[200:201], v57 offset:49152
    ds_read_b64_tr_b16 a[202:203], v57 offset:50176
    ds_read_b64_tr_b16 a[204:205], v58 offset:49152
    ds_read_b64_tr_b16 a[206:207], v58 offset:50176
    ds_read_b64_tr_b16 a[208:209], v59 offset:49152
    ds_read_b64_tr_b16 a[210:211], v59 offset:50176
    s_waitcnt lgkmcnt(0)
    v_mfma_f32_16x16x32_bf16 v[192:195], a[148:151], v[224:227], 0
    v_mfma_f32_16x16x32_bf16 v[192:195], a[152:155], v[96:99], v[192:195]
    v_mfma_f32_16x16x32_bf16 v[192:195], a[156:159], v[128:131], v[192:195]
    v_mfma_f32_16x16x32_bf16 v[192:195], a[160:163], v[160:163], v[192:195]
    v_mfma_f32_16x16x32_bf16 v[200:203], a[148:151], v[228:231], 0
    v_mfma_f32_16x16x32_bf16 v[200:203], a[152:155], v[100:103], v[200:203]
    v_mfma_f32_16x16x32_bf16 v[200:203], a[156:159], v[132:135], v[200:203]
    v_mfma_f32_16x16x32_bf16 v[200:203], a[160:163], v[164:167], v[200:203]
    v_mfma_f32_16x16x32_bf16 v[208:211], a[148:151], v[232:235], 0
    v_mfma_f32_16x16x32_bf16 v[208:211], a[152:155], v[104:107], v[208:211]
    v_mfma_f32_16x16x32_bf16 v[208:211], a[156:159], v[136:139], v[208:211]
    v_mfma_f32_16x16x32_bf16 v[208:211], a[160:163], v[168:171], v[208:211]
    v_mfma_f32_16x16x32_bf16 v[216:219], a[148:151], v[236:239], 0
    v_mfma_f32_16x16x32_bf16 v[216:219], a[152:155], v[108:111], v[216:219]
    v_mfma_f32_16x16x32_bf16 v[216:219], a[156:159], v[140:143], v[216:219]
    v_mfma_f32_16x16x32_bf16 v[216:219], a[160:163], v[172:175], v[216:219]
    v_mfma_f32_16x16x32_bf16 v[196:199], a[164:167], v[224:227], 0
    v_mfma_f32_16x16x32_bf16 v[196:199], a[168:171], v[96:99], v[196:199]
    v_mfma_f32_16x16x32_bf16 v[196:199], a[172:175], v[128:131], v[196:199]
    v_mfma_f32_16x16x32_bf16 v[196:199], a[176:179], v[160:163], v[196:199]
    v_mfma_f32_16x16x32_bf16 v[204:207], a[164:167], v[228:231], 0
    v_mfma_f32_16x16x32_bf16 v[204:207], a[168:171], v[100:103], v[204:207]
    v_mfma_f32_16x16x32_bf16 v[204:207], a[172:175], v[132:135], v[204:207]
    v_mfma_f32_16x16x32_bf16 v[204:207], a[176:179], v[164:167], v[204:207]
    v_mfma_f32_16x16x32_bf16 v[212:215], a[164:167], v[232:235], 0
    v_mfma_f32_16x16x32_bf16 v[212:215], a[168:171], v[104:107], v[212:215]
    v_mfma_f32_16x16x32_bf16 v[212:215], a[172:175], v[136:139], v[212:215]
    v_mfma_f32_16x16x32_bf16 v[212:215], a[176:179], v[168:171], v[212:215]
    v_mfma_f32_16x16x32_bf16 v[220:223], a[164:167], v[236:239], 0
    v_mfma_f32_16x16x32_bf16 v[220:223], a[168:171], v[108:111], v[220:223]
    v_mfma_f32_16x16x32_bf16 v[220:223], a[172:175], v[140:143], v[220:223]
    v_mfma_f32_16x16x32_bf16 v[220:223], a[176:179], v[172:175], v[220:223]
    s_nop 7
    v_max3_f32 v16, v192, v193, v194
    v_max3_f32 v16, v16, v195, v196
    v_max3_f32 v16, v16, v197, v198
    v_max_f32 v16, v16, v199
    v_max3_f32 v17, v200, v201, v202
    v_max3_f32 v17, v17, v203, v204
    v_max3_f32 v17, v17, v205, v206
    v_max_f32 v17, v17, v207
    v_max3_f32 v18, v208, v209, v210
    v_max3_f32 v18, v18, v211, v212
    v_max3_f32 v18, v18, v213, v214
    v_max_f32 v18, v18, v215
    v_max3_f32 v19, v216, v217, v218
    v_max3_f32 v19, v19, v219, v220
    v_max3_f32 v19, v19, v221, v222
    v_max_f32 v19, v19, v223
    v_mov_b32 v20, v16
    v_mov_b32 v21, v17
    v_mov_b32 v22, v18
    v_mov_b32 v23, v19
    s_nop 0
    v_permlane32_swap_b32 v16, v20
    v_permlane32_swap_b32 v17, v21
    v_permlane32_swap_b32 v18, v22
    v_permlane32_swap_b32 v19, v23
    v_max_f32 v16, v16, v20
    v_max_f32 v17, v17, v21
    v_max_f32 v18, v18, v22
    v_max_f32 v19, v19, v23
    v_mov_b32 v20, v16
    v_mov_b32 v21, v17
    v_mov_b32 v22, v18
    v_mov_b32 v23, v19
    s_nop 0
    v_permlane16_swap_b32 v16, v20
    v_permlane16_swap_b32 v17, v21
    v_permlane16_swap_b32 v18, v22
    v_permlane16_swap_b32 v19, v23
    v_max_f32 v16, v16, v20
    v_max_f32 v17, v17, v21
    v_max_f32 v18, v18, v22
    v_max_f32 v19, v19, v23
    v_max_f32 v16, v16, v24
    v_sub_f32 v28, v24, v16
    v_exp_f32 v28, v28
    v_mov_b32 v24, v16
    v_max_f32 v17, v17, v25
    v_sub_f32 v29, v25, v17
    v_exp_f32 v29, v29
    v_mov_b32 v25, v17
    v_max_f32 v18, v18, v26
    v_sub_f32 v30, v26, v18
    v_exp_f32 v30, v30
    v_mov_b32 v26, v18
    v_max_f32 v19, v19, v27
    v_sub_f32 v31, v27, v19
    v_exp_f32 v31, v31
    v_mov_b32 v27, v19
    v_accvgpr_read_b32 v32, a0
    v_accvgpr_read_b32 v33, a1
    v_accvgpr_read_b32 v34, a2
    v_accvgpr_read_b32 v35, a3
    v_mul_f32 v32, v32, v28
    v_mul_f32 v33, v33, v28
    v_mul_f32 v34, v34, v28
    v_mul_f32 v35, v35, v28
    v_accvgpr_write_b32 a0, v32
    v_accvgpr_write_b32 a1, v33
    v_accvgpr_write_b32 a2, v34
    v_accvgpr_write_b32 a3, v35
    v_accvgpr_read_b32 v32, a4
    v_accvgpr_read_b32 v33, a5
    v_accvgpr_read_b32 v34, a6
    v_accvgpr_read_b32 v35, a7
    v_mul_f32 v32, v32, v29
    v_mul_f32 v33, v33, v29
    v_mul_f32 v34, v34, v29
    v_mul_f32 v35, v35, v29
    v_accvgpr_write_b32 a4, v32
    v_accvgpr_write_b32 a5, v33
    v_accvgpr_write_b32 a6, v34
    v_accvgpr_write_b32 a7, v35
    v_accvgpr_read_b32 v32, a8
    v_accvgpr_read_b32 v33, a9
    v_accvgpr_read_b32 v34, a10
    v_accvgpr_read_b32 v35, a11
    v_mul_f32 v32, v32, v30
    v_mul_f32 v33, v33, v30
    v_mul_f32 v34, v34, v30
    v_mul_f32 v35, v35, v30
    v_accvgpr_write_b32 a8, v32
    v_accvgpr_write_b32 a9, v33
    v_accvgpr_write_b32 a10, v34
    v_accvgpr_write_b32 a11, v35
    v_accvgpr_read_b32 v32, a12
    v_accvgpr_read_b32 v33, a13
    v_accvgpr_read_b32 v34, a14
    v_accvgpr_read_b32 v35, a15
    v_mul_f32 v32, v32, v31
    v_mul_f32 v33, v33, v31
    v_mul_f32 v34, v34, v31
    v_mul_f32 v35, v35, v31
    v_accvgpr_write_b32 a12, v32
    v_accvgpr_write_b32 a13, v33
    v_accvgpr_write_b32 a14, v34
    v_accvgpr_write_b32 a15, v35
    v_accvgpr_read_b32 v32, a16
    v_accvgpr_read_b32 v33, a17
    v_accvgpr_read_b32 v34, a18
    v_accvgpr_read_b32 v35, a19
    v_mul_f32 v32, v32, v28
    v_mul_f32 v33, v33, v28
    v_mul_f32 v34, v34, v28
    v_mul_f32 v35, v35, v28
    v_accvgpr_write_b32 a16, v32
    v_accvgpr_write_b32 a17, v33
    v_accvgpr_write_b32 a18, v34
    v_accvgpr_write_b32 a19, v35
    v_accvgpr_read_b32 v32, a20
    v_accvgpr_read_b32 v33, a21
    v_accvgpr_read_b32 v34, a22
    v_accvgpr_read_b32 v35, a23
    v_mul_f32 v32, v32, v29
    v_mul_f32 v33, v33, v29
    v_mul_f32 v34, v34, v29
    v_mul_f32 v35, v35, v29
    v_accvgpr_write_b32 a20, v32
    v_accvgpr_write_b32 a21, v33
    v_accvgpr_write_b32 a22, v34
    v_accvgpr_write_b32 a23, v35
    v_accvgpr_read_b32 v32, a24
    v_accvgpr_read_b32 v33, a25
    v_accvgpr_read_b32 v34, a26
    v_accvgpr_read_b32 v35, a27
    v_mul_f32 v32, v32, v30
    v_mul_f32 v33, v33, v30
    v_mul_f32 v34, v34, v30
    v_mul_f32 v35, v35, v30
    v_accvgpr_write_b32 a24, v32
    v_accvgpr_write_b32 a25, v33
    v_accvgpr_write_b32 a26, v34
    v_accvgpr_write_b32 a27, v35
    v_accvgpr_read_b32 v32, a28
    v_accvgpr_read_b32 v33, a29
    v_accvgpr_read_b32 v34, a30
    v_accvgpr_read_b32 v35, a31
    v_mul_f32 v32, v32, v31
    v_mul_f32 v33, v33, v31
    v_mul_f32 v34, v34, v31
    v_mul_f32 v35, v35, v31
    v_accvgpr_write_b32 a28, v32
    v_accvgpr_write_b32 a29, v33
    v_accvgpr_write_b32 a30, v34
    v_accvgpr_write_b32 a31, v35
    v_accvgpr_read_b32 v32, a32
    v_accvgpr_read_b32 v33, a33
    v_accvgpr_read_b32 v34, a34
    v_accvgpr_read_b32 v35, a35
    v_mul_f32 v32, v32, v28
    v_mul_f32 v33, v33, v28
    v_mul_f32 v34, v34, v28
    v_mul_f32 v35, v35, v28
    v_accvgpr_write_b32 a32, v32
    v_accvgpr_write_b32 a33, v33
    v_accvgpr_write_b32 a34, v34
    v_accvgpr_write_b32 a35, v35
    v_accvgpr_read_b32 v32, a36
    v_accvgpr_read_b32 v33, a37
    v_accvgpr_read_b32 v34, a38
    v_accvgpr_read_b32 v35, a39
    v_mul_f32 v32, v32, v29
    v_mul_f32 v33, v33, v29
    v_mul_f32 v34, v34, v29
    v_mul_f32 v35, v35, v29
    v_accvgpr_write_b32 a36, v32
    v_accvgpr_write_b32 a37, v33
    v_accvgpr_write_b32 a38, v34
    v_accvgpr_write_b32 a39, v35
    v_accvgpr_read_b32 v32, a40
    v_accvgpr_read_b32 v33, a41
    v_accvgpr_read_b32 v34, a42
    v_accvgpr_read_b32 v35, a43
    v_mul_f32 v32, v32, v30
    v_mul_f32 v33, v33, v30
    v_mul_f32 v34, v34, v30
    v_mul_f32 v35, v35, v30
    v_accvgpr_write_b32 a40, v32
    v_accvgpr_write_b32 a41, v33
    v_accvgpr_write_b32 a42, v34
    v_accvgpr_write_b32 a43, v35
    v_accvgpr_read_b32 v32, a44
    v_accvgpr_read_b32 v33, a45
    v_accvgpr_read_b32 v34, a46
    v_accvgpr_read_b32 v35, a47
    v_mul_f32 v32, v32, v31
    v_mul_f32 v33, v33, v31
    v_mul_f32 v34, v34, v31
    v_mul_f32 v35, v35, v31
    v_accvgpr_write_b32 a44, v32
    v_accvgpr_write_b32 a45, v33
    v_accvgpr_write_b32 a46, v34
    v_accvgpr_write_b32 a47, v35
    v_accvgpr_read_b32 v32, a48
    v_accvgpr_read_b32 v33, a49
    v_accvgpr_read_b32 v34, a50
    v_accvgpr_read_b32 v35, a51
    v_mul_f32 v32, v32, v28
    v_mul_f32 v33, v33, v28
    v_mul_f32 v34, v34, v28
    v_mul_f32 v35, v35, v28
    v_accvgpr_write_b32 a48, v32
    v_accvgpr_write_b32 a49, v33
    v_accvgpr_write_b32 a50, v34
    v_accvgpr_write_b32 a51, v35
    v_accvgpr_read_b32 v32, a52
    v_accvgpr_read_b32 v33, a53
    v_accvgpr_read_b32 v34, a54
    v_accvgpr_read_b32 v35, a55
    v_mul_f32 v32, v32, v29
    v_mul_f32 v33, v33, v29
    v_mul_f32 v34, v34, v29
    v_mul_f32 v35, v35, v29
    v_accvgpr_write_b32 a52, v32
    v_accvgpr_write_b32 a53, v33
    v_accvgpr_write_b32 a54, v34
    v_accvgpr_write_b32 a55, v35
    v_accvgpr_read_b32 v32, a56
    v_accvgpr_read_b32 v33, a57
    v_accvgpr_read_b32 v34, a58
    v_accvgpr_read_b32 v35, a59
    v_mul_f32 v32, v32, v30
    v_mul_f32 v33, v33, v30
    v_mul_f32 v34, v34, v30
    v_mul_f32 v35, v35, v30
    v_accvgpr_write_b32 a56, v32
    v_accvgpr_write_b32 a57, v33
    v_accvgpr_write_b32 a58, v34
    v_accvgpr_write_b32 a59, v35
    v_accvgpr_read_b32 v32, a60
    v_accvgpr_read_b32 v33, a61
    v_accvgpr_read_b32 v34, a62
    v_accvgpr_read_b32 v35, a63
    v_mul_f32 v32, v32, v31
    v_mul_f32 v33, v33, v31
    v_mul_f32 v34, v34, v31
    v_mul_f32 v35, v35, v31
    v_accvgpr_write_b32 a60, v32
    v_accvgpr_write_b32 a61, v33
    v_accvgpr_write_b32 a62, v34
    v_accvgpr_write_b32 a63, v35
    v_accvgpr_read_b32 v32, a64
    v_accvgpr_read_b32 v33, a65
    v_accvgpr_read_b32 v34, a66
    v_accvgpr_read_b32 v35, a67
    v_mul_f32 v32, v32, v28
    v_mul_f32 v33, v33, v28
    v_mul_f32 v34, v34, v28
    v_mul_f32 v35, v35, v28
    v_accvgpr_write_b32 a64, v32
    v_accvgpr_write_b32 a65, v33
    v_accvgpr_write_b32 a66, v34
    v_accvgpr_write_b32 a67, v35
    v_accvgpr_read_b32 v32, a68
    v_accvgpr_read_b32 v33, a69
    v_accvgpr_read_b32 v34, a70
    v_accvgpr_read_b32 v35, a71
    v_mul_f32 v32, v32, v29
    v_mul_f32 v33, v33, v29
    v_mul_f32 v34, v34, v29
    v_mul_f32 v35, v35, v29
    v_accvgpr_write_b32 a68, v32
    v_accvgpr_write_b32 a69, v33
    v_accvgpr_write_b32 a70, v34
    v_accvgpr_write_b32 a71, v35
    v_accvgpr_read_b32 v32, a72
    v_accvgpr_read_b32 v33, a73
    v_accvgpr_read_b32 v34, a74
    v_accvgpr_read_b32 v35, a75
    v_mul_f32 v32, v32, v30
    v_mul_f32 v33, v33, v30
    v_mul_f32 v34, v34, v30
    v_mul_f32 v35, v35, v30
    v_accvgpr_write_b32 a72, v32
    v_accvgpr_write_b32 a73, v33
    v_accvgpr_write_b32 a74, v34
    v_accvgpr_write_b32 a75, v35
    v_accvgpr_read_b32 v32, a76
    v_accvgpr_read_b32 v33, a77
    v_accvgpr_read_b32 v34, a78
    v_accvgpr_read_b32 v35, a79
    v_mul_f32 v32, v32, v31
    v_mul_f32 v33, v33, v31
    v_mul_f32 v34, v34, v31
    v_mul_f32 v35, v35, v31
    v_accvgpr_write_b32 a76, v32
    v_accvgpr_write_b32 a77, v33
    v_accvgpr_write_b32 a78, v34
    v_accvgpr_write_b32 a79, v35
    v_accvgpr_read_b32 v32, a80
    v_accvgpr_read_b32 v33, a81
    v_accvgpr_read_b32 v34, a82
    v_accvgpr_read_b32 v35, a83
    v_mul_f32 v32, v32, v28
    v_mul_f32 v33, v33, v28
    v_mul_f32 v34, v34, v28
    v_mul_f32 v35, v35, v28
    v_accvgpr_write_b32 a80, v32
    v_accvgpr_write_b32 a81, v33
    v_accvgpr_write_b32 a82, v34
    v_accvgpr_write_b32 a83, v35
    v_accvgpr_read_b32 v32, a84
    v_accvgpr_read_b32 v33, a85
    v_accvgpr_read_b32 v34, a86
    v_accvgpr_read_b32 v35, a87
    v_mul_f32 v32, v32, v29
    v_mul_f32 v33, v33, v29
    v_mul_f32 v34, v34, v29
    v_mul_f32 v35, v35, v29
    v_accvgpr_write_b32 a84, v32
    v_accvgpr_write_b32 a85, v33
    v_accvgpr_write_b32 a86, v34
    v_accvgpr_write_b32 a87, v35
    v_accvgpr_read_b32 v32, a88
    v_accvgpr_read_b32 v33, a89
    v_accvgpr_read_b32 v34, a90
    v_accvgpr_read_b32 v35, a91
    v_mul_f32 v32, v32, v30
    v_mul_f32 v33, v33, v30
    v_mul_f32 v34, v34, v30
    v_mul_f32 v35, v35, v30
    v_accvgpr_write_b32 a88, v32
    v_accvgpr_write_b32 a89, v33
    v_accvgpr_write_b32 a90, v34
    v_accvgpr_write_b32 a91, v35
    v_accvgpr_read_b32 v32, a92
    v_accvgpr_read_b32 v33, a93
    v_accvgpr_read_b32 v34, a94
    v_accvgpr_read_b32 v35, a95
    v_mul_f32 v32, v32, v31
    v_mul_f32 v33, v33, v31
    v_mul_f32 v34, v34, v31
    v_mul_f32 v35, v35, v31
    v_accvgpr_write_b32 a92, v32
    v_accvgpr_write_b32 a93, v33
    v_accvgpr_write_b32 a94, v34
    v_accvgpr_write_b32 a95, v35
    v_accvgpr_read_b32 v32, a96
    v_accvgpr_read_b32 v33, a97
    v_accvgpr_read_b32 v34, a98
    v_accvgpr_read_b32 v35, a99
    v_mul_f32 v32, v32, v28
    v_mul_f32 v33, v33, v28
    v_mul_f32 v34, v34, v28
    v_mul_f32 v35, v35, v28
    v_accvgpr_write_b32 a96, v32
    v_accvgpr_write_b32 a97, v33
    v_accvgpr_write_b32 a98, v34
    v_accvgpr_write_b32 a99, v35
    v_accvgpr_read_b32 v32, a100
    v_accvgpr_read_b32 v33, a101
    v_accvgpr_read_b32 v34, a102
    v_accvgpr_read_b32 v35, a103
    v_mul_f32 v32, v32, v29
    v_mul_f32 v33, v33, v29
    v_mul_f32 v34, v34, v29
    v_mul_f32 v35, v35, v29
    v_accvgpr_write_b32 a100, v32
    v_accvgpr_write_b32 a101, v33
    v_accvgpr_write_b32 a102, v34
    v_accvgpr_write_b32 a103, v35
    v_accvgpr_read_b32 v32, a104
    v_accvgpr_read_b32 v33, a105
    v_accvgpr_read_b32 v34, a106
    v_accvgpr_read_b32 v35, a107
    v_mul_f32 v32, v32, v30
    v_mul_f32 v33, v33, v30
    v_mul_f32 v34, v34, v30
    v_mul_f32 v35, v35, v30
    v_accvgpr_write_b32 a104, v32
    v_accvgpr_write_b32 a105, v33
    v_accvgpr_write_b32 a106, v34
    v_accvgpr_write_b32 a107, v35
    v_accvgpr_read_b32 v32, a108
    v_accvgpr_read_b32 v33, a109
    v_accvgpr_read_b32 v34, a110
    v_accvgpr_read_b32 v35, a111
    v_mul_f32 v32, v32, v31
    v_mul_f32 v33, v33, v31
    v_mul_f32 v34, v34, v31
    v_mul_f32 v35, v35, v31
    v_accvgpr_write_b32 a108, v32
    v_accvgpr_write_b32 a109, v33
    v_accvgpr_write_b32 a110, v34
    v_accvgpr_write_b32 a111, v35
    v_accvgpr_read_b32 v32, a112
    v_accvgpr_read_b32 v33, a113
    v_accvgpr_read_b32 v34, a114
    v_accvgpr_read_b32 v35, a115
    v_mul_f32 v32, v32, v28
    v_mul_f32 v33, v33, v28
    v_mul_f32 v34, v34, v28
    v_mul_f32 v35, v35, v28
    v_accvgpr_write_b32 a112, v32
    v_accvgpr_write_b32 a113, v33
    v_accvgpr_write_b32 a114, v34
    v_accvgpr_write_b32 a115, v35
    v_accvgpr_read_b32 v32, a116
    v_accvgpr_read_b32 v33, a117
    v_accvgpr_read_b32 v34, a118
    v_accvgpr_read_b32 v35, a119
    v_mul_f32 v32, v32, v29
    v_mul_f32 v33, v33, v29
    v_mul_f32 v34, v34, v29
    v_mul_f32 v35, v35, v29
    v_accvgpr_write_b32 a116, v32
    v_accvgpr_write_b32 a117, v33
    v_accvgpr_write_b32 a118, v34
    v_accvgpr_write_b32 a119, v35
    v_accvgpr_read_b32 v32, a120
    v_accvgpr_read_b32 v33, a121
    v_accvgpr_read_b32 v34, a122
    v_accvgpr_read_b32 v35, a123
    v_mul_f32 v32, v32, v30
    v_mul_f32 v33, v33, v30
    v_mul_f32 v34, v34, v30
    v_mul_f32 v35, v35, v30
    v_accvgpr_write_b32 a120, v32
    v_accvgpr_write_b32 a121, v33
    v_accvgpr_write_b32 a122, v34
    v_accvgpr_write_b32 a123, v35
    v_accvgpr_read_b32 v32, a124
    v_accvgpr_read_b32 v33, a125
    v_accvgpr_read_b32 v34, a126
    v_accvgpr_read_b32 v35, a127
    v_mul_f32 v32, v32, v31
    v_mul_f32 v33, v33, v31
    v_mul_f32 v34, v34, v31
    v_mul_f32 v35, v35, v31
    v_accvgpr_write_b32 a124, v32
    v_accvgpr_write_b32 a125, v33
    v_accvgpr_write_b32 a126, v34
    v_accvgpr_write_b32 a127, v35
    v_accvgpr_read_b32 v32, a128
    v_accvgpr_read_b32 v33, a129
    v_accvgpr_read_b32 v34, a130
    v_accvgpr_read_b32 v35, a131
    v_mul_f32 v32, v32, v28
    v_mul_f32 v33, v33, v28
    v_mul_f32 v34, v34, v28
    v_mul_f32 v35, v35, v28
    v_accvgpr_write_b32 a128, v32
    v_accvgpr_write_b32 a129, v33
    v_accvgpr_write_b32 a130, v34
    v_accvgpr_write_b32 a131, v35
    v_accvgpr_read_b32 v32, a132
    v_accvgpr_read_b32 v33, a133
    v_accvgpr_read_b32 v34, a134
    v_accvgpr_read_b32 v35, a135
    v_mul_f32 v32, v32, v29
    v_mul_f32 v33, v33, v29
    v_mul_f32 v34, v34, v29
    v_mul_f32 v35, v35, v29
    v_accvgpr_write_b32 a132, v32
    v_accvgpr_write_b32 a133, v33
    v_accvgpr_write_b32 a134, v34
    v_accvgpr_write_b32 a135, v35
    v_accvgpr_read_b32 v32, a136
    v_accvgpr_read_b32 v33, a137
    v_accvgpr_read_b32 v34, a138
    v_accvgpr_read_b32 v35, a139
    v_mul_f32 v32, v32, v30
    v_mul_f32 v33, v33, v30
    v_mul_f32 v34, v34, v30
    v_mul_f32 v35, v35, v30
    v_accvgpr_write_b32 a136, v32
    v_accvgpr_write_b32 a137, v33
    v_accvgpr_write_b32 a138, v34
    v_accvgpr_write_b32 a139, v35
    v_accvgpr_read_b32 v32, a140
    v_accvgpr_read_b32 v33, a141
    v_accvgpr_read_b32 v34, a142
    v_accvgpr_read_b32 v35, a143
    v_mul_f32 v32, v32, v31
    v_mul_f32 v33, v33, v31
    v_mul_f32 v34, v34, v31
    v_mul_f32 v35, v35, v31
    v_accvgpr_write_b32 a140, v32
    v_accvgpr_write_b32 a141, v33
    v_accvgpr_write_b32 a142, v34
    v_accvgpr_write_b32 a143, v35
    v_sub_f32 v192, v192, v24
    v_exp_f32 v192, v192
    v_sub_f32 v193, v193, v24
    v_exp_f32 v193, v193
    v_sub_f32 v194, v194, v24
    v_exp_f32 v194, v194
    v_sub_f32 v195, v195, v24
    v_exp_f32 v195, v195
    v_sub_f32 v196, v196, v24
    v_exp_f32 v196, v196
    v_sub_f32 v197, v197, v24
    v_exp_f32 v197, v197
    v_sub_f32 v198, v198, v24
    v_exp_f32 v198, v198
    v_sub_f32 v199, v199, v24
    v_exp_f32 v199, v199
    v_sub_f32 v200, v200, v25
    v_exp_f32 v200, v200
    v_sub_f32 v201, v201, v25
    v_exp_f32 v201, v201
    v_sub_f32 v202, v202, v25
    v_exp_f32 v202, v202
    v_sub_f32 v203, v203, v25
    v_exp_f32 v203, v203
    v_sub_f32 v204, v204, v25
    v_exp_f32 v204, v204
    v_sub_f32 v205, v205, v25
    v_exp_f32 v205, v205
    v_sub_f32 v206, v206, v25
    v_exp_f32 v206, v206
    v_sub_f32 v207, v207, v25
    v_exp_f32 v207, v207
    v_sub_f32 v208, v208, v26
    v_exp_f32 v208, v208
    v_sub_f32 v209, v209, v26
    v_exp_f32 v209, v209
    v_sub_f32 v210, v210, v26
    v_exp_f32 v210, v210
    v_sub_f32 v211, v211, v26
    v_exp_f32 v211, v211
    v_sub_f32 v212, v212, v26
    v_exp_f32 v212, v212
    v_sub_f32 v213, v213, v26
    v_exp_f32 v213, v213
    v_sub_f32 v214, v214, v26
    v_exp_f32 v214, v214
    v_sub_f32 v215, v215, v26
    v_exp_f32 v215, v215
    v_sub_f32 v216, v216, v27
    v_exp_f32 v216, v216
    v_sub_f32 v217, v217, v27
    v_exp_f32 v217, v217
    v_sub_f32 v218, v218, v27
    v_exp_f32 v218, v218
    v_sub_f32 v219, v219, v27
    v_exp_f32 v219, v219
    v_sub_f32 v220, v220, v27
    v_exp_f32 v220, v220
    v_sub_f32 v221, v221, v27
    v_exp_f32 v221, v221
    v_sub_f32 v222, v222, v27
    v_exp_f32 v222, v222
    v_sub_f32 v223, v223, v27
    v_exp_f32 v223, v223
    s_nop 0
    v_cvt_pk_bf16_f32 v144, v192, v193
    v_cvt_pk_bf16_f32 v145, v194, v195
    v_cvt_pk_bf16_f32 v146, v196, v197
    v_cvt_pk_bf16_f32 v147, v198, v199
    v_cvt_pk_bf16_f32 v152, v200, v201
    v_cvt_pk_bf16_f32 v153, v202, v203
    v_cvt_pk_bf16_f32 v154, v204, v205
    v_cvt_pk_bf16_f32 v155, v206, v207
    v_cvt_pk_bf16_f32 v176, v208, v209
    v_cvt_pk_bf16_f32 v177, v210, v211
    v_cvt_pk_bf16_f32 v178, v212, v213
    v_cvt_pk_bf16_f32 v179, v214, v215
    v_cvt_pk_bf16_f32 v184, v216, v217
    v_cvt_pk_bf16_f32 v185, v218, v219
    v_cvt_pk_bf16_f32 v186, v220, v221
    v_cvt_pk_bf16_f32 v187, v222, v223
    s_nop 1
    v_mfma_f32_16x16x32_bf16 a[0:3], a[180:183], v[144:147], a[0:3]
    v_mfma_f32_16x16x32_bf16 a[4:7], a[180:183], v[152:155], a[4:7]
    v_mfma_f32_16x16x32_bf16 a[8:11], a[180:183], v[176:179], a[8:11]
    v_mfma_f32_16x16x32_bf16 a[12:15], a[180:183], v[184:187], a[12:15]
    v_mfma_f32_16x16x32_bf16 a[16:19], a[184:187], v[144:147], a[16:19]
    v_mfma_f32_16x16x32_bf16 a[20:23], a[184:187], v[152:155], a[20:23]
    v_mfma_f32_16x16x32_bf16 a[24:27], a[184:187], v[176:179], a[24:27]
    v_mfma_f32_16x16x32_bf16 a[28:31], a[184:187], v[184:187], a[28:31]
    v_mfma_f32_16x16x32_bf16 a[32:35], a[188:191], v[144:147], a[32:35]
    v_mfma_f32_16x16x32_bf16 a[36:39], a[188:191], v[152:155], a[36:39]
    v_mfma_f32_16x16x32_bf16 a[40:43], a[188:191], v[176:179], a[40:43]
    v_mfma_f32_16x16x32_bf16 a[44:47], a[188:191], v[184:187], a[44:47]
    v_mfma_f32_16x16x32_bf16 a[48:51], a[192:195], v[144:147], a[48:51]
    v_mfma_f32_16x16x32_bf16 a[52:55], a[192:195], v[152:155], a[52:55]
    v_mfma_f32_16x16x32_bf16 a[56:59], a[192:195], v[176:179], a[56:59]
    v_mfma_f32_16x16x32_bf16 a[60:63], a[192:195], v[184:187], a[60:63]
    v_mfma_f32_16x16x32_bf16 a[64:67], a[196:199], v[144:147], a[64:67]
    v_mfma_f32_16x16x32_bf16 a[68:71], a[196:199], v[152:155], a[68:71]
    v_mfma_f32_16x16x32_bf16 a[72:75], a[196:199], v[176:179], a[72:75]
    v_mfma_f32_16x16x32_bf16 a[76:79], a[196:199], v[184:187], a[76:79]
    v_mfma_f32_16x16x32_bf16 a[80:83], a[200:203], v[144:147], a[80:83]
    v_mfma_f32_16x16x32_bf16 a[84:87], a[200:203], v[152:155], a[84:87]
    v_mfma_f32_16x16x32_bf16 a[88:91], a[200:203], v[176:179], a[88:91]
    v_mfma_f32_16x16x32_bf16 a[92:95], a[200:203], v[184:187], a[92:95]
    v_mfma_f32_16x16x32_bf16 a[96:99], a[204:207], v[144:147], a[96:99]
    v_mfma_f32_16x16x32_bf16 a[100:103], a[204:207], v[152:155], a[100:103]
    v_mfma_f32_16x16x32_bf16 a[104:107], a[204:207], v[176:179], a[104:107]
    v_mfma_f32_16x16x32_bf16 a[108:111], a[204:207], v[184:187], a[108:111]
    v_mfma_f32_16x16x32_bf16 a[112:115], a[208:211], v[144:147], a[112:115]
    v_mfma_f32_16x16x32_bf16 a[116:119], a[208:211], v[152:155], a[116:119]
    v_mfma_f32_16x16x32_bf16 a[120:123], a[208:211], v[176:179], a[120:123]
    v_mfma_f32_16x16x32_bf16 a[124:127], a[208:211], v[184:187], a[124:127]
    v_mfma_f32_16x16x32_bf16 a[128:131], a[144:147], v[144:147], a[128:131]
    v_mfma_f32_16x16x32_bf16 a[132:135], a[144:147], v[152:155], a[132:135]
    v_mfma_f32_16x16x32_bf16 a[136:139], a[144:147], v[176:179], a[136:139]
    v_mfma_f32_16x16x32_bf16 a[140:143], a[144:147], v[184:187], a[140:143]
    s_nop 7
    ds_read_b128 a[148:151], v48 offset:2048
    ds_read_b128 a[152:155], v49 offset:2048
    ds_read_b128 a[156:159], v50 offset:2048
    ds_read_b128 a[160:163], v51 offset:2048
    ds_read_b128 a[164:167], v48 offset:3072
    ds_read_b128 a[168:171], v49 offset:3072
    ds_read_b128 a[172:175], v50 offset:3072
    ds_read_b128 a[176:179], v51 offset:3072
    ds_read_b64_tr_b16 a[180:181], v52 offset:51200
    ds_read_b64_tr_b16 a[182:183], v52 offset:52224
    ds_read_b64_tr_b16 a[184:185], v53 offset:51200
    ds_read_b64_tr_b16 a[186:187], v53 offset:52224
    ds_read_b64_tr_b16 a[188:189], v54 offset:51200
    ds_read_b64_tr_b16 a[190:191], v54 offset:52224
    s_waitcnt lgkmcnt(4)
    ds_read_b64_tr_b16 a[192:193], v55 offset:51200
    ds_read_b64_tr_b16 a[194:195], v55 offset:52224
    ds_read_b64_tr_b16 a[196:197], v56 offset:51200
    ds_read_b64_tr_b16 a[198:199], v56 offset:52224
    ds_read_b64_tr_b16 a[200:201], v57 offset:51200
    ds_read_b64_tr_b16 a[202:203], v57 offset:52224
    ds_read_b64_tr_b16 a[204:205], v58 offset:51200
    ds_read_b64_tr_b16 a[206:207], v58 offset:52224
    ds_read_b64_tr_b16 a[208:209], v59 offset:51200
    ds_read_b64_tr_b16 a[210:211], v59 offset:52224
    s_waitcnt lgkmcnt(0)
    v_mfma_f32_16x16x32_bf16 v[192:195], a[148:151], v[224:227], 0
    v_mfma_f32_16x16x32_bf16 v[192:195], a[152:155], v[96:99], v[192:195]
    v_mfma_f32_16x16x32_bf16 v[192:195], a[156:159], v[128:131], v[192:195]
    v_mfma_f32_16x16x32_bf16 v[192:195], a[160:163], v[160:163], v[192:195]
    v_mfma_f32_16x16x32_bf16 v[200:203], a[148:151], v[228:231], 0
    v_mfma_f32_16x16x32_bf16 v[200:203], a[152:155], v[100:103], v[200:203]
    v_mfma_f32_16x16x32_bf16 v[200:203], a[156:159], v[132:135], v[200:203]
    v_mfma_f32_16x16x32_bf16 v[200:203], a[160:163], v[164:167], v[200:203]
    v_mfma_f32_16x16x32_bf16 v[208:211], a[148:151], v[232:235], 0
    v_mfma_f32_16x16x32_bf16 v[208:211], a[152:155], v[104:107], v[208:211]
    v_mfma_f32_16x16x32_bf16 v[208:211], a[156:159], v[136:139], v[208:211]
    v_mfma_f32_16x16x32_bf16 v[208:211], a[160:163], v[168:171], v[208:211]
    v_mfma_f32_16x16x32_bf16 v[216:219], a[148:151], v[236:239], 0
    v_mfma_f32_16x16x32_bf16 v[216:219], a[152:155], v[108:111], v[216:219]
    v_mfma_f32_16x16x32_bf16 v[216:219], a[156:159], v[140:143], v[216:219]
    v_mfma_f32_16x16x32_bf16 v[216:219], a[160:163], v[172:175], v[216:219]
    v_mfma_f32_16x16x32_bf16 v[196:199], a[164:167], v[224:227], 0
    v_mfma_f32_16x16x32_bf16 v[196:199], a[168:171], v[96:99], v[196:199]
    v_mfma_f32_16x16x32_bf16 v[196:199], a[172:175], v[128:131], v[196:199]
    v_mfma_f32_16x16x32_bf16 v[196:199], a[176:179], v[160:163], v[196:199]
    v_mfma_f32_16x16x32_bf16 v[204:207], a[164:167], v[228:231], 0
    v_mfma_f32_16x16x32_bf16 v[204:207], a[168:171], v[100:103], v[204:207]
    v_mfma_f32_16x16x32_bf16 v[204:207], a[172:175], v[132:135], v[204:207]
    v_mfma_f32_16x16x32_bf16 v[204:207], a[176:179], v[164:167], v[204:207]
    v_mfma_f32_16x16x32_bf16 v[212:215], a[164:167], v[232:235], 0
    v_mfma_f32_16x16x32_bf16 v[212:215], a[168:171], v[104:107], v[212:215]
    v_mfma_f32_16x16x32_bf16 v[212:215], a[172:175], v[136:139], v[212:215]
    v_mfma_f32_16x16x32_bf16 v[212:215], a[176:179], v[168:171], v[212:215]
    v_mfma_f32_16x16x32_bf16 v[220:223], a[164:167], v[236:239], 0
    v_mfma_f32_16x16x32_bf16 v[220:223], a[168:171], v[108:111], v[220:223]
    v_mfma_f32_16x16x32_bf16 v[220:223], a[172:175], v[140:143], v[220:223]
    v_mfma_f32_16x16x32_bf16 v[220:223], a[176:179], v[172:175], v[220:223]
    s_nop 7
    v_max3_f32 v16, v192, v193, v194
    v_max3_f32 v16, v16, v195, v196
    v_max3_f32 v16, v16, v197, v198
    v_max_f32 v16, v16, v199
    v_max3_f32 v17, v200, v201, v202
    v_max3_f32 v17, v17, v203, v204
    v_max3_f32 v17, v17, v205, v206
    v_max_f32 v17, v17, v207
    v_max3_f32 v18, v208, v209, v210
    v_max3_f32 v18, v18, v211, v212
    v_max3_f32 v18, v18, v213, v214
    v_max_f32 v18, v18, v215
    v_max3_f32 v19, v216, v217, v218
    v_max3_f32 v19, v19, v219, v220
    v_max3_f32 v19, v19, v221, v222
    v_max_f32 v19, v19, v223
    v_mov_b32 v20, v16
    v_mov_b32 v21, v17
    v_mov_b32 v22, v18
    v_mov_b32 v23, v19
    s_nop 0
    v_permlane32_swap_b32 v16, v20
    v_permlane32_swap_b32 v17, v21
    v_permlane32_swap_b32 v18, v22
    v_permlane32_swap_b32 v19, v23
    v_max_f32 v16, v16, v20
    v_max_f32 v17, v17, v21
    v_max_f32 v18, v18, v22
    v_max_f32 v19, v19, v23
    v_mov_b32 v20, v16
    v_mov_b32 v21, v17
    v_mov_b32 v22, v18
    v_mov_b32 v23, v19
    s_nop 0
    v_permlane16_swap_b32 v16, v20
    v_permlane16_swap_b32 v17, v21
    v_permlane16_swap_b32 v18, v22
    v_permlane16_swap_b32 v19, v23
    v_max_f32 v16, v16, v20
    v_max_f32 v17, v17, v21
    v_max_f32 v18, v18, v22
    v_max_f32 v19, v19, v23
    v_max_f32 v16, v16, v24
    v_sub_f32 v28, v24, v16
    v_exp_f32 v28, v28
    v_mov_b32 v24, v16
    v_max_f32 v17, v17, v25
    v_sub_f32 v29, v25, v17
    v_exp_f32 v29, v29
    v_mov_b32 v25, v17
    v_max_f32 v18, v18, v26
    v_sub_f32 v30, v26, v18
    v_exp_f32 v30, v30
    v_mov_b32 v26, v18
    v_max_f32 v19, v19, v27
    v_sub_f32 v31, v27, v19
    v_exp_f32 v31, v31
    v_mov_b32 v27, v19
    v_accvgpr_read_b32 v32, a0
    v_accvgpr_read_b32 v33, a1
    v_accvgpr_read_b32 v34, a2
    v_accvgpr_read_b32 v35, a3
    v_mul_f32 v32, v32, v28
    v_mul_f32 v33, v33, v28
    v_mul_f32 v34, v34, v28
    v_mul_f32 v35, v35, v28
    v_accvgpr_write_b32 a0, v32
    v_accvgpr_write_b32 a1, v33
    v_accvgpr_write_b32 a2, v34
    v_accvgpr_write_b32 a3, v35
    v_accvgpr_read_b32 v32, a4
    v_accvgpr_read_b32 v33, a5
    v_accvgpr_read_b32 v34, a6
    v_accvgpr_read_b32 v35, a7
    v_mul_f32 v32, v32, v29
    v_mul_f32 v33, v33, v29
    v_mul_f32 v34, v34, v29
    v_mul_f32 v35, v35, v29
    v_accvgpr_write_b32 a4, v32
    v_accvgpr_write_b32 a5, v33
    v_accvgpr_write_b32 a6, v34
    v_accvgpr_write_b32 a7, v35
    v_accvgpr_read_b32 v32, a8
    v_accvgpr_read_b32 v33, a9
    v_accvgpr_read_b32 v34, a10
    v_accvgpr_read_b32 v35, a11
    v_mul_f32 v32, v32, v30
    v_mul_f32 v33, v33, v30
    v_mul_f32 v34, v34, v30
    v_mul_f32 v35, v35, v30
    v_accvgpr_write_b32 a8, v32
    v_accvgpr_write_b32 a9, v33
    v_accvgpr_write_b32 a10, v34
    v_accvgpr_write_b32 a11, v35
    v_accvgpr_read_b32 v32, a12
    v_accvgpr_read_b32 v33, a13
    v_accvgpr_read_b32 v34, a14
    v_accvgpr_read_b32 v35, a15
    v_mul_f32 v32, v32, v31
    v_mul_f32 v33, v33, v31
    v_mul_f32 v34, v34, v31
    v_mul_f32 v35, v35, v31
    v_accvgpr_write_b32 a12, v32
    v_accvgpr_write_b32 a13, v33
    v_accvgpr_write_b32 a14, v34
    v_accvgpr_write_b32 a15, v35
    v_accvgpr_read_b32 v32, a16
    v_accvgpr_read_b32 v33, a17
    v_accvgpr_read_b32 v34, a18
    v_accvgpr_read_b32 v35, a19
    v_mul_f32 v32, v32, v28
    v_mul_f32 v33, v33, v28
    v_mul_f32 v34, v34, v28
    v_mul_f32 v35, v35, v28
    v_accvgpr_write_b32 a16, v32
    v_accvgpr_write_b32 a17, v33
    v_accvgpr_write_b32 a18, v34
    v_accvgpr_write_b32 a19, v35
    v_accvgpr_read_b32 v32, a20
    v_accvgpr_read_b32 v33, a21
    v_accvgpr_read_b32 v34, a22
    v_accvgpr_read_b32 v35, a23
    v_mul_f32 v32, v32, v29
    v_mul_f32 v33, v33, v29
    v_mul_f32 v34, v34, v29
    v_mul_f32 v35, v35, v29
    v_accvgpr_write_b32 a20, v32
    v_accvgpr_write_b32 a21, v33
    v_accvgpr_write_b32 a22, v34
    v_accvgpr_write_b32 a23, v35
    v_accvgpr_read_b32 v32, a24
    v_accvgpr_read_b32 v33, a25
    v_accvgpr_read_b32 v34, a26
    v_accvgpr_read_b32 v35, a27
    v_mul_f32 v32, v32, v30
    v_mul_f32 v33, v33, v30
    v_mul_f32 v34, v34, v30
    v_mul_f32 v35, v35, v30
    v_accvgpr_write_b32 a24, v32
    v_accvgpr_write_b32 a25, v33
    v_accvgpr_write_b32 a26, v34
    v_accvgpr_write_b32 a27, v35
    v_accvgpr_read_b32 v32, a28
    v_accvgpr_read_b32 v33, a29
    v_accvgpr_read_b32 v34, a30
    v_accvgpr_read_b32 v35, a31
    v_mul_f32 v32, v32, v31
    v_mul_f32 v33, v33, v31
    v_mul_f32 v34, v34, v31
    v_mul_f32 v35, v35, v31
    v_accvgpr_write_b32 a28, v32
    v_accvgpr_write_b32 a29, v33
    v_accvgpr_write_b32 a30, v34
    v_accvgpr_write_b32 a31, v35
    v_accvgpr_read_b32 v32, a32
    v_accvgpr_read_b32 v33, a33
    v_accvgpr_read_b32 v34, a34
    v_accvgpr_read_b32 v35, a35
    v_mul_f32 v32, v32, v28
    v_mul_f32 v33, v33, v28
    v_mul_f32 v34, v34, v28
    v_mul_f32 v35, v35, v28
    v_accvgpr_write_b32 a32, v32
    v_accvgpr_write_b32 a33, v33
    v_accvgpr_write_b32 a34, v34
    v_accvgpr_write_b32 a35, v35
    v_accvgpr_read_b32 v32, a36
    v_accvgpr_read_b32 v33, a37
    v_accvgpr_read_b32 v34, a38
    v_accvgpr_read_b32 v35, a39
    v_mul_f32 v32, v32, v29
    v_mul_f32 v33, v33, v29
    v_mul_f32 v34, v34, v29
    v_mul_f32 v35, v35, v29
    v_accvgpr_write_b32 a36, v32
    v_accvgpr_write_b32 a37, v33
    v_accvgpr_write_b32 a38, v34
    v_accvgpr_write_b32 a39, v35
    v_accvgpr_read_b32 v32, a40
    v_accvgpr_read_b32 v33, a41
    v_accvgpr_read_b32 v34, a42
    v_accvgpr_read_b32 v35, a43
    v_mul_f32 v32, v32, v30
    v_mul_f32 v33, v33, v30
    v_mul_f32 v34, v34, v30
    v_mul_f32 v35, v35, v30
    v_accvgpr_write_b32 a40, v32
    v_accvgpr_write_b32 a41, v33
    v_accvgpr_write_b32 a42, v34
    v_accvgpr_write_b32 a43, v35
    v_accvgpr_read_b32 v32, a44
    v_accvgpr_read_b32 v33, a45
    v_accvgpr_read_b32 v34, a46
    v_accvgpr_read_b32 v35, a47
    v_mul_f32 v32, v32, v31
    v_mul_f32 v33, v33, v31
    v_mul_f32 v34, v34, v31
    v_mul_f32 v35, v35, v31
    v_accvgpr_write_b32 a44, v32
    v_accvgpr_write_b32 a45, v33
    v_accvgpr_write_b32 a46, v34
    v_accvgpr_write_b32 a47, v35
    v_accvgpr_read_b32 v32, a48
    v_accvgpr_read_b32 v33, a49
    v_accvgpr_read_b32 v34, a50
    v_accvgpr_read_b32 v35, a51
    v_mul_f32 v32, v32, v28
    v_mul_f32 v33, v33, v28
    v_mul_f32 v34, v34, v28
    v_mul_f32 v35, v35, v28
    v_accvgpr_write_b32 a48, v32
    v_accvgpr_write_b32 a49, v33
    v_accvgpr_write_b32 a50, v34
    v_accvgpr_write_b32 a51, v35
    v_accvgpr_read_b32 v32, a52
    v_accvgpr_read_b32 v33, a53
    v_accvgpr_read_b32 v34, a54
    v_accvgpr_read_b32 v35, a55
    v_mul_f32 v32, v32, v29
    v_mul_f32 v33, v33, v29
    v_mul_f32 v34, v34, v29
    v_mul_f32 v35, v35, v29
    v_accvgpr_write_b32 a52, v32
    v_accvgpr_write_b32 a53, v33
    v_accvgpr_write_b32 a54, v34
    v_accvgpr_write_b32 a55, v35
    v_accvgpr_read_b32 v32, a56
    v_accvgpr_read_b32 v33, a57
    v_accvgpr_read_b32 v34, a58
    v_accvgpr_read_b32 v35, a59
    v_mul_f32 v32, v32, v30
    v_mul_f32 v33, v33, v30
    v_mul_f32 v34, v34, v30
    v_mul_f32 v35, v35, v30
    v_accvgpr_write_b32 a56, v32
    v_accvgpr_write_b32 a57, v33
    v_accvgpr_write_b32 a58, v34
    v_accvgpr_write_b32 a59, v35
    v_accvgpr_read_b32 v32, a60
    v_accvgpr_read_b32 v33, a61
    v_accvgpr_read_b32 v34, a62
    v_accvgpr_read_b32 v35, a63
    v_mul_f32 v32, v32, v31
    v_mul_f32 v33, v33, v31
    v_mul_f32 v34, v34, v31
    v_mul_f32 v35, v35, v31
    v_accvgpr_write_b32 a60, v32
    v_accvgpr_write_b32 a61, v33
    v_accvgpr_write_b32 a62, v34
    v_accvgpr_write_b32 a63, v35
    v_accvgpr_read_b32 v32, a64
    v_accvgpr_read_b32 v33, a65
    v_accvgpr_read_b32 v34, a66
    v_accvgpr_read_b32 v35, a67
    v_mul_f32 v32, v32, v28
    v_mul_f32 v33, v33, v28
    v_mul_f32 v34, v34, v28
    v_mul_f32 v35, v35, v28
    v_accvgpr_write_b32 a64, v32
    v_accvgpr_write_b32 a65, v33
    v_accvgpr_write_b32 a66, v34
    v_accvgpr_write_b32 a67, v35
    v_accvgpr_read_b32 v32, a68
    v_accvgpr_read_b32 v33, a69
    v_accvgpr_read_b32 v34, a70
    v_accvgpr_read_b32 v35, a71
    v_mul_f32 v32, v32, v29
    v_mul_f32 v33, v33, v29
    v_mul_f32 v34, v34, v29
    v_mul_f32 v35, v35, v29
    v_accvgpr_write_b32 a68, v32
    v_accvgpr_write_b32 a69, v33
    v_accvgpr_write_b32 a70, v34
    v_accvgpr_write_b32 a71, v35
    v_accvgpr_read_b32 v32, a72
    v_accvgpr_read_b32 v33, a73
    v_accvgpr_read_b32 v34, a74
    v_accvgpr_read_b32 v35, a75
    v_mul_f32 v32, v32, v30
    v_mul_f32 v33, v33, v30
    v_mul_f32 v34, v34, v30
    v_mul_f32 v35, v35, v30
    v_accvgpr_write_b32 a72, v32
    v_accvgpr_write_b32 a73, v33
    v_accvgpr_write_b32 a74, v34
    v_accvgpr_write_b32 a75, v35
    v_accvgpr_read_b32 v32, a76
    v_accvgpr_read_b32 v33, a77
    v_accvgpr_read_b32 v34, a78
    v_accvgpr_read_b32 v35, a79
    v_mul_f32 v32, v32, v31
    v_mul_f32 v33, v33, v31
    v_mul_f32 v34, v34, v31
    v_mul_f32 v35, v35, v31
    v_accvgpr_write_b32 a76, v32
    v_accvgpr_write_b32 a77, v33
    v_accvgpr_write_b32 a78, v34
    v_accvgpr_write_b32 a79, v35
    v_accvgpr_read_b32 v32, a80
    v_accvgpr_read_b32 v33, a81
    v_accvgpr_read_b32 v34, a82
    v_accvgpr_read_b32 v35, a83
    v_mul_f32 v32, v32, v28
    v_mul_f32 v33, v33, v28
    v_mul_f32 v34, v34, v28
    v_mul_f32 v35, v35, v28
    v_accvgpr_write_b32 a80, v32
    v_accvgpr_write_b32 a81, v33
    v_accvgpr_write_b32 a82, v34
    v_accvgpr_write_b32 a83, v35
    v_accvgpr_read_b32 v32, a84
    v_accvgpr_read_b32 v33, a85
    v_accvgpr_read_b32 v34, a86
    v_accvgpr_read_b32 v35, a87
    v_mul_f32 v32, v32, v29
    v_mul_f32 v33, v33, v29
    v_mul_f32 v34, v34, v29
    v_mul_f32 v35, v35, v29
    v_accvgpr_write_b32 a84, v32
    v_accvgpr_write_b32 a85, v33
    v_accvgpr_write_b32 a86, v34
    v_accvgpr_write_b32 a87, v35
    v_accvgpr_read_b32 v32, a88
    v_accvgpr_read_b32 v33, a89
    v_accvgpr_read_b32 v34, a90
    v_accvgpr_read_b32 v35, a91
    v_mul_f32 v32, v32, v30
    v_mul_f32 v33, v33, v30
    v_mul_f32 v34, v34, v30
    v_mul_f32 v35, v35, v30
    v_accvgpr_write_b32 a88, v32
    v_accvgpr_write_b32 a89, v33
    v_accvgpr_write_b32 a90, v34
    v_accvgpr_write_b32 a91, v35
    v_accvgpr_read_b32 v32, a92
    v_accvgpr_read_b32 v33, a93
    v_accvgpr_read_b32 v34, a94
    v_accvgpr_read_b32 v35, a95
    v_mul_f32 v32, v32, v31
    v_mul_f32 v33, v33, v31
    v_mul_f32 v34, v34, v31
    v_mul_f32 v35, v35, v31
    v_accvgpr_write_b32 a92, v32
    v_accvgpr_write_b32 a93, v33
    v_accvgpr_write_b32 a94, v34
    v_accvgpr_write_b32 a95, v35
    v_accvgpr_read_b32 v32, a96
    v_accvgpr_read_b32 v33, a97
    v_accvgpr_read_b32 v34, a98
    v_accvgpr_read_b32 v35, a99
    v_mul_f32 v32, v32, v28
    v_mul_f32 v33, v33, v28
    v_mul_f32 v34, v34, v28
    v_mul_f32 v35, v35, v28
    v_accvgpr_write_b32 a96, v32
    v_accvgpr_write_b32 a97, v33
    v_accvgpr_write_b32 a98, v34
    v_accvgpr_write_b32 a99, v35
    v_accvgpr_read_b32 v32, a100
    v_accvgpr_read_b32 v33, a101
    v_accvgpr_read_b32 v34, a102
    v_accvgpr_read_b32 v35, a103
    v_mul_f32 v32, v32, v29
    v_mul_f32 v33, v33, v29
    v_mul_f32 v34, v34, v29
    v_mul_f32 v35, v35, v29
    v_accvgpr_write_b32 a100, v32
    v_accvgpr_write_b32 a101, v33
    v_accvgpr_write_b32 a102, v34
    v_accvgpr_write_b32 a103, v35
    v_accvgpr_read_b32 v32, a104
    v_accvgpr_read_b32 v33, a105
    v_accvgpr_read_b32 v34, a106
    v_accvgpr_read_b32 v35, a107
    v_mul_f32 v32, v32, v30
    v_mul_f32 v33, v33, v30
    v_mul_f32 v34, v34, v30
    v_mul_f32 v35, v35, v30
    v_accvgpr_write_b32 a104, v32
    v_accvgpr_write_b32 a105, v33
    v_accvgpr_write_b32 a106, v34
    v_accvgpr_write_b32 a107, v35
    v_accvgpr_read_b32 v32, a108
    v_accvgpr_read_b32 v33, a109
    v_accvgpr_read_b32 v34, a110
    v_accvgpr_read_b32 v35, a111
    v_mul_f32 v32, v32, v31
    v_mul_f32 v33, v33, v31
    v_mul_f32 v34, v34, v31
    v_mul_f32 v35, v35, v31
    v_accvgpr_write_b32 a108, v32
    v_accvgpr_write_b32 a109, v33
    v_accvgpr_write_b32 a110, v34
    v_accvgpr_write_b32 a111, v35
    v_accvgpr_read_b32 v32, a112
    v_accvgpr_read_b32 v33, a113
    v_accvgpr_read_b32 v34, a114
    v_accvgpr_read_b32 v35, a115
    v_mul_f32 v32, v32, v28
    v_mul_f32 v33, v33, v28
    v_mul_f32 v34, v34, v28
    v_mul_f32 v35, v35, v28
    v_accvgpr_write_b32 a112, v32
    v_accvgpr_write_b32 a113, v33
    v_accvgpr_write_b32 a114, v34
    v_accvgpr_write_b32 a115, v35
    v_accvgpr_read_b32 v32, a116
    v_accvgpr_read_b32 v33, a117
    v_accvgpr_read_b32 v34, a118
    v_accvgpr_read_b32 v35, a119
    v_mul_f32 v32, v32, v29
    v_mul_f32 v33, v33, v29
    v_mul_f32 v34, v34, v29
    v_mul_f32 v35, v35, v29
    v_accvgpr_write_b32 a116, v32
    v_accvgpr_write_b32 a117, v33
    v_accvgpr_write_b32 a118, v34
    v_accvgpr_write_b32 a119, v35
    v_accvgpr_read_b32 v32, a120
    v_accvgpr_read_b32 v33, a121
    v_accvgpr_read_b32 v34, a122
    v_accvgpr_read_b32 v35, a123
    v_mul_f32 v32, v32, v30
    v_mul_f32 v33, v33, v30
    v_mul_f32 v34, v34, v30
    v_mul_f32 v35, v35, v30
    v_accvgpr_write_b32 a120, v32
    v_accvgpr_write_b32 a121, v33
    v_accvgpr_write_b32 a122, v34
    v_accvgpr_write_b32 a123, v35
    v_accvgpr_read_b32 v32, a124
    v_accvgpr_read_b32 v33, a125
    v_accvgpr_read_b32 v34, a126
    v_accvgpr_read_b32 v35, a127
    v_mul_f32 v32, v32, v31
    v_mul_f32 v33, v33, v31
    v_mul_f32 v34, v34, v31
    v_mul_f32 v35, v35, v31
    v_accvgpr_write_b32 a124, v32
    v_accvgpr_write_b32 a125, v33
    v_accvgpr_write_b32 a126, v34
    v_accvgpr_write_b32 a127, v35
    v_accvgpr_read_b32 v32, a128
    v_accvgpr_read_b32 v33, a129
    v_accvgpr_read_b32 v34, a130
    v_accvgpr_read_b32 v35, a131
    v_mul_f32 v32, v32, v28
    v_mul_f32 v33, v33, v28
    v_mul_f32 v34, v34, v28
    v_mul_f32 v35, v35, v28
    v_accvgpr_write_b32 a128, v32
    v_accvgpr_write_b32 a129, v33
    v_accvgpr_write_b32 a130, v34
    v_accvgpr_write_b32 a131, v35
    v_accvgpr_read_b32 v32, a132
    v_accvgpr_read_b32 v33, a133
    v_accvgpr_read_b32 v34, a134
    v_accvgpr_read_b32 v35, a135
    v_mul_f32 v32, v32, v29
    v_mul_f32 v33, v33, v29
    v_mul_f32 v34, v34, v29
    v_mul_f32 v35, v35, v29
    v_accvgpr_write_b32 a132, v32
    v_accvgpr_write_b32 a133, v33
    v_accvgpr_write_b32 a134, v34
    v_accvgpr_write_b32 a135, v35
    v_accvgpr_read_b32 v32, a136
    v_accvgpr_read_b32 v33, a137
    v_accvgpr_read_b32 v34, a138
    v_accvgpr_read_b32 v35, a139
    v_mul_f32 v32, v32, v30
    v_mul_f32 v33, v33, v30
    v_mul_f32 v34, v34, v30
    v_mul_f32 v35, v35, v30
    v_accvgpr_write_b32 a136, v32
    v_accvgpr_write_b32 a137, v33
    v_accvgpr_write_b32 a138, v34
    v_accvgpr_write_b32 a139, v35
    v_accvgpr_read_b32 v32, a140
    v_accvgpr_read_b32 v33, a141
    v_accvgpr_read_b32 v34, a142
    v_accvgpr_read_b32 v35, a143
    v_mul_f32 v32, v32, v31
    v_mul_f32 v33, v33, v31
    v_mul_f32 v34, v34, v31
    v_mul_f32 v35, v35, v31
    v_accvgpr_write_b32 a140, v32
    v_accvgpr_write_b32 a141, v33
    v_accvgpr_write_b32 a142, v34
    v_accvgpr_write_b32 a143, v35
    v_sub_f32 v192, v192, v24
    v_exp_f32 v192, v192
    v_sub_f32 v193, v193, v24
    v_exp_f32 v193, v193
    v_sub_f32 v194, v194, v24
    v_exp_f32 v194, v194
    v_sub_f32 v195, v195, v24
    v_exp_f32 v195, v195
    v_sub_f32 v196, v196, v24
    v_exp_f32 v196, v196
    v_sub_f32 v197, v197, v24
    v_exp_f32 v197, v197
    v_sub_f32 v198, v198, v24
    v_exp_f32 v198, v198
    v_sub_f32 v199, v199, v24
    v_exp_f32 v199, v199
    v_sub_f32 v200, v200, v25
    v_exp_f32 v200, v200
    v_sub_f32 v201, v201, v25
    v_exp_f32 v201, v201
    v_sub_f32 v202, v202, v25
    v_exp_f32 v202, v202
    v_sub_f32 v203, v203, v25
    v_exp_f32 v203, v203
    v_sub_f32 v204, v204, v25
    v_exp_f32 v204, v204
    v_sub_f32 v205, v205, v25
    v_exp_f32 v205, v205
    v_sub_f32 v206, v206, v25
    v_exp_f32 v206, v206
    v_sub_f32 v207, v207, v25
    v_exp_f32 v207, v207
    v_sub_f32 v208, v208, v26
    v_exp_f32 v208, v208
    v_sub_f32 v209, v209, v26
    v_exp_f32 v209, v209
    v_sub_f32 v210, v210, v26
    v_exp_f32 v210, v210
    v_sub_f32 v211, v211, v26
    v_exp_f32 v211, v211
    v_sub_f32 v212, v212, v26
    v_exp_f32 v212, v212
    v_sub_f32 v213, v213, v26
    v_exp_f32 v213, v213
    v_sub_f32 v214, v214, v26
    v_exp_f32 v214, v214
    v_sub_f32 v215, v215, v26
    v_exp_f32 v215, v215
    v_sub_f32 v216, v216, v27
    v_exp_f32 v216, v216
    v_sub_f32 v217, v217, v27
    v_exp_f32 v217, v217
    v_sub_f32 v218, v218, v27
    v_exp_f32 v218, v218
    v_sub_f32 v219, v219, v27
    v_exp_f32 v219, v219
    v_sub_f32 v220, v220, v27
    v_exp_f32 v220, v220
    v_sub_f32 v221, v221, v27
    v_exp_f32 v221, v221
    v_sub_f32 v222, v222, v27
    v_exp_f32 v222, v222
    v_sub_f32 v223, v223, v27
    v_exp_f32 v223, v223
    s_nop 0
    v_cvt_pk_bf16_f32 v144, v192, v193
    v_cvt_pk_bf16_f32 v145, v194, v195
    v_cvt_pk_bf16_f32 v146, v196, v197
    v_cvt_pk_bf16_f32 v147, v198, v199
    v_cvt_pk_bf16_f32 v152, v200, v201
    v_cvt_pk_bf16_f32 v153, v202, v203
    v_cvt_pk_bf16_f32 v154, v204, v205
    v_cvt_pk_bf16_f32 v155, v206, v207
    v_cvt_pk_bf16_f32 v176, v208, v209
    v_cvt_pk_bf16_f32 v177, v210, v211
    v_cvt_pk_bf16_f32 v178, v212, v213
    v_cvt_pk_bf16_f32 v179, v214, v215
    v_cvt_pk_bf16_f32 v184, v216, v217
    v_cvt_pk_bf16_f32 v185, v218, v219
    v_cvt_pk_bf16_f32 v186, v220, v221
    v_cvt_pk_bf16_f32 v187, v222, v223
    s_nop 1
    v_mfma_f32_16x16x32_bf16 a[0:3], a[180:183], v[144:147], a[0:3]
    v_mfma_f32_16x16x32_bf16 a[4:7], a[180:183], v[152:155], a[4:7]
    v_mfma_f32_16x16x32_bf16 a[8:11], a[180:183], v[176:179], a[8:11]
    v_mfma_f32_16x16x32_bf16 a[12:15], a[180:183], v[184:187], a[12:15]
    v_mfma_f32_16x16x32_bf16 a[16:19], a[184:187], v[144:147], a[16:19]
    v_mfma_f32_16x16x32_bf16 a[20:23], a[184:187], v[152:155], a[20:23]
    v_mfma_f32_16x16x32_bf16 a[24:27], a[184:187], v[176:179], a[24:27]
    v_mfma_f32_16x16x32_bf16 a[28:31], a[184:187], v[184:187], a[28:31]
    v_mfma_f32_16x16x32_bf16 a[32:35], a[188:191], v[144:147], a[32:35]
    v_mfma_f32_16x16x32_bf16 a[36:39], a[188:191], v[152:155], a[36:39]
    v_mfma_f32_16x16x32_bf16 a[40:43], a[188:191], v[176:179], a[40:43]
    v_mfma_f32_16x16x32_bf16 a[44:47], a[188:191], v[184:187], a[44:47]
    v_mfma_f32_16x16x32_bf16 a[48:51], a[192:195], v[144:147], a[48:51]
    v_mfma_f32_16x16x32_bf16 a[52:55], a[192:195], v[152:155], a[52:55]
    v_mfma_f32_16x16x32_bf16 a[56:59], a[192:195], v[176:179], a[56:59]
    v_mfma_f32_16x16x32_bf16 a[60:63], a[192:195], v[184:187], a[60:63]
    v_mfma_f32_16x16x32_bf16 a[64:67], a[196:199], v[144:147], a[64:67]
    v_mfma_f32_16x16x32_bf16 a[68:71], a[196:199], v[152:155], a[68:71]
    v_mfma_f32_16x16x32_bf16 a[72:75], a[196:199], v[176:179], a[72:75]
    v_mfma_f32_16x16x32_bf16 a[76:79], a[196:199], v[184:187], a[76:79]
    v_mfma_f32_16x16x32_bf16 a[80:83], a[200:203], v[144:147], a[80:83]
    v_mfma_f32_16x16x32_bf16 a[84:87], a[200:203], v[152:155], a[84:87]
    v_mfma_f32_16x16x32_bf16 a[88:91], a[200:203], v[176:179], a[88:91]
    v_mfma_f32_16x16x32_bf16 a[92:95], a[200:203], v[184:187], a[92:95]
    v_mfma_f32_16x16x32_bf16 a[96:99], a[204:207], v[144:147], a[96:99]
    v_mfma_f32_16x16x32_bf16 a[100:103], a[204:207], v[152:155], a[100:103]
    v_mfma_f32_16x16x32_bf16 a[104:107], a[204:207], v[176:179], a[104:107]
    v_mfma_f32_16x16x32_bf16 a[108:111], a[204:207], v[184:187], a[108:111]
    v_mfma_f32_16x16x32_bf16 a[112:115], a[208:211], v[144:147], a[112:115]
    v_mfma_f32_16x16x32_bf16 a[116:119], a[208:211], v[152:155], a[116:119]
    v_mfma_f32_16x16x32_bf16 a[120:123], a[208:211], v[176:179], a[120:123]
    v_mfma_f32_16x16x32_bf16 a[124:127], a[208:211], v[184:187], a[124:127]
    v_mfma_f32_16x16x32_bf16 a[128:131], a[144:147], v[144:147], a[128:131]
    v_mfma_f32_16x16x32_bf16 a[132:135], a[144:147], v[152:155], a[132:135]
    v_mfma_f32_16x16x32_bf16 a[136:139], a[144:147], v[176:179], a[136:139]
    v_mfma_f32_16x16x32_bf16 a[140:143], a[144:147], v[184:187], a[140:143]
    s_nop 7
    s_add_u32 s47, s47, 16384
    s_cmp_lt_u32 s47, 0x80000
    s_cbranch_scc1 L_slow
    v_accvgpr_read_b32 v16, a128
    v_accvgpr_read_b32 v17, a132
    v_accvgpr_read_b32 v18, a136
    v_accvgpr_read_b32 v19, a140
    s_barrier
    s_mov_b32 s49, 0
    s_add_u32 m0, s45, 98304
    s_nop 0
    buffer_load_dwordx4 v2, s[20:23], s49 offen lds
    s_add_u32 m0, s45, 102400
    s_nop 0
    buffer_load_dwordx4 v2, s[24:27], s49 offen lds
    s_mov_b32 s50, 0
    s_nop 0
    buffer_load_dwordx4 a[148:151], v1, s[32:35], s50 offen offset:0 sc1
    s_nop 0
    buffer_load_dwordx4 a[152:155], v1, s[32:35], s50 offen offset:1024 sc1
    s_nop 0
    buffer_load_dwordx4 a[156:159], v1, s[32:35], s50 offen offset:2048 sc1
    s_nop 0
    buffer_load_dwordx4 a[160:163], v1, s[32:35], s50 offen offset:3072 sc1
    s_mov_b32 s49, 294912
    s_add_u32 m0, s45, 106496
    s_nop 0
    buffer_load_dwordx4 v2, s[20:23], s49 offen lds
    s_add_u32 m0, s45, 110592
    s_nop 0
    buffer_load_dwordx4 v2, s[24:27], s49 offen lds
    s_mov_b32 s50, 4096
    s_nop 0
    buffer_load_dwordx4 a[164:167], v1, s[32:35], s50 offen offset:0 sc1
    s_nop 0
    buffer_load_dwordx4 a[168:171], v1, s[32:35], s50 offen offset:1024 sc1
    s_nop 0
    buffer_load_dwordx4 a[172:175], v1, s[32:35], s50 offen offset:2048 sc1
    s_nop 0
    buffer_load_dwordx4 a[176:179], v1, s[32:35], s50 offen offset:3072 sc1
    s_mov_b32 s49, 589824
    s_add_u32 m0, s45, 114688
    s_nop 0
    buffer_load_dwordx4 v2, s[20:23], s49 offen lds
    s_add_u32 m0, s45, 118784
    s_nop 0
    buffer_load_dwordx4 v2, s[24:27], s49 offen lds
    s_branch L_att_fin
L_text_end:
.section .rodata,"a"
.p2align 6
.amdhsa_kernel recurrent_scan__gqa_block_cached__glu_gated_swiglu__prompt_kernel
  .amdhsa_next_free_vgpr 512
  .amdhsa_next_free_sgpr 102
  .amdhsa_accum_offset 256
  .amdhsa_group_segment_fixed_size 0
  .amdhsa_kernarg_size 96
  .amdhsa_user_sgpr_count 2
  .amdhsa_user_sgpr_kernarg_segment_ptr 1
  .amdhsa_system_sgpr_workgroup_id_x 1
  .amdhsa_float_denorm_mode_32 3
  .amdhsa_float_denorm_mode_16_64 3
.end_amdhsa_kernel
```
